```python
import torch

def _softmax(x, axis=-1):
    return torch.softmax(x, dim=axis)
def _gelu(x):
    return torch.nn.functional.gelu(x, approximate="tanh")
def _silu(x):
    return torch.nn.functional.silu(x)
def _sigmoid(x):
    return torch.sigmoid(x)
def _layernorm(x, axis=-1, eps=1e-5):
    m = x.mean(dim=axis, keepdim=True)
    v = x.var(dim=axis, keepdim=True, unbiased=False)
    return (x - m) / torch.sqrt(v + eps)
def _scatter_add(tgt, idx, src, axis=0):
    return tgt.clone().index_add_(axis, idx, src)
def _segment_sum(src, seg, n):
    out = torch.zeros((n,) + src.shape[1:], dtype=src.dtype)
    return out.index_add_(0, seg, src)
def _pad(x, pw):
    flat = tuple(v for pair in reversed(pw) for v in pair)
    return torch.nn.functional.pad(x, flat)

kernel_name = 'recurrent_scan__linear_attn_block__glu_gated_bilinear__prompt'

def setup_inputs():

    _w = (lambda a: (lambda t: t.to(torch.bfloat16) if t.is_floating_point() else t)(torch.as_tensor(a)))
    def _A_setup():
        B, S, D = 1, 2048, 576
        return {
            "x": _w((lambda *s: torch.randn(*s, dtype=torch.bfloat16) * 0.05)(B, S, D)),
            "wqkv": _w((lambda *s: torch.randn(*s, dtype=torch.bfloat16) * 0.8)(D, 3 * D)),
            "wo": _w((lambda *s: torch.randn(*s, dtype=torch.bfloat16) * 0.8)(D, D)),
        }
    _A_in = _A_setup()

    def _B_setup():
        B, S, D, F = 1, 2048, 576, 4608
        return {
            "x": _w((lambda *s: torch.randn(*s, dtype=torch.bfloat16) * 0.05)(B, S, D)),
            "w_gate": _w((lambda *s: torch.randn(*s, dtype=torch.bfloat16) * 0.2)(D, F) * (D ** -0.5)),
            "w_up": _w((lambda *s: torch.randn(*s, dtype=torch.bfloat16) * 0.2)(D, F) * (D ** -0.5)),
            "w_down": _w((lambda *s: torch.randn(*s, dtype=torch.bfloat16) * 0.2)(F, D) * (F ** -0.5)),
        }
    _B_in = _B_setup()

    return {
        "A_x": _A_in["x"],
        "A_wqkv": _A_in["wqkv"],
        "A_wo": _A_in["wo"],
        "B_x": _B_in["x"],
        "B_w_gate": _B_in["w_gate"],
        "B_w_up": _B_in["w_up"],
        "B_w_down": _B_in["w_down"],
    }

def reference(A_x, A_wqkv, A_wo, B_x, B_w_gate, B_w_up, B_w_down):
    def _A_ref(x, wqkv, wo):
        B, S, D = x.shape
        H = 32; Dh = D // H
        qkv = (lambda x, *d: x.permute(*d))((x @ wqkv).reshape(B, S, 3, H, Dh), 2, 0, 3, 1, 4)
        q, k, v = qkv[0], qkv[1], qkv[2]
        phi = lambda t: torch.where(t > 0, t + 1, torch.exp(t)) + 1e-6
        pq, pk = phi(q), phi(k)
        kv = torch.einsum("bhsd,bhse->bhde", pk, v)
        z = torch.einsum("bhsd->bhd", pk)
        num = torch.einsum("bhqd,bhde->bhqe", pq, kv)
        den = torch.einsum("bhqd,bhd->bhq", pq, z)[..., None] + 1e-6
        o = num / den
        return (lambda x, *d: x.permute(*d))(o, 0, 2, 1, 3).reshape(B, S, D) @ wo

    def _B_ref(x, w_gate, w_up, w_down):
        g = torch.einsum("bsd,df->bsf", x, w_gate)
        u = torch.einsum("bsd,df->bsf", x, w_up)
        h = g * u
        return torch.einsum("bsf,fd->bsd", h, w_down)

    x = A_x
    xn = _layernorm(x, axis=-1)
    s = _A_ref(xn, A_wqkv, A_wo)
    g = _silu(_B_ref(xn, B_w_gate, B_w_up, B_w_down))
    return x + s * g
```

```asm
; @launch grid=(256,1,1) block=(256,1,1) lds=163840
.amdgcn_target "amdgcn-amd-amdhsa--gfx950"
.text
.globl recurrent_scan__linear_attn_block__glu_gated_bilinear__prompt_kernel
.p2align 8
.type recurrent_scan__linear_attn_block__glu_gated_bilinear__prompt_kernel,@function
recurrent_scan__linear_attn_block__glu_gated_bilinear__prompt_kernel:
  s_cmp_ge_u32 s2, 256
  s_cbranch_scc1 recurrent_scan__linear_attn_block__glu_gated_bilinear__prompt_kernel_end
  s_load_dwordx8 s[36:43], s[0:1], 0
  s_load_dwordx8 s[44:51], s[0:1], 32
  s_load_dwordx4 s[52:55], s[0:1], 64
  v_lshrrev_b32 v42, 6, v0
  v_and_b32 v36, 63, v0
  v_readfirstlane_b32 s56, v42
  s_getpc_b64 s[92:93]
recurrent_scan__linear_attn_block__glu_gated_bilinear__prompt_kernel_pc:
  s_lshr_b32 s68, s2, 3
  s_lshl_b32 s68, s68, 2
  v_add_u32 v42, s68, v42
  v_mul_u32_u24 v42, 5, v42
  v_min_u32 v41, 4, v36
  v_add_u32 v42, v42, v41
  v_lshlrev_b32 v42, 7, v42
  v_min_u32 v42, code_end - recurrent_scan__linear_attn_block__glu_gated_bilinear__prompt_kernel_pc - 4, v42
  global_load_dword v109, v42, s[92:93]
  v_lshrrev_b32 v37, 3, v36
  v_lshrrev_b32 v38, 4, v36
  v_and_b32 v39, 7, v36
  v_and_b32 v40, 15, v36
  v_lshlrev_b32 v108, 4, v36
  s_and_b32 s60, s2, 3
  s_bfe_u32 s67, s2, 0x10002
  s_lshr_b32 s68, s2, 5
  s_lshl_b32 s67, s67, 3
  s_add_u32 s59, s67, s68
  s_bfe_u32 s61, s2, 0x20003
  s_lshr_b32 s57, s56, 1
  s_and_b32 s58, s56, 1
  s_lshl_b32 s64, s56, 12
  s_add_u32 s80, s64, 147456
  s_lshl_b32 s67, s56, 5
  v_add_u32 v42, s67, v37
  v_mul_u32_u24 v42, 1152, v42
  v_or_b32 v41, 0, v38
  v_xor_b32 v41, v41, v39
  v_lshl_add_u32 v44, v41, 4, v42
  v_or_b32 v41, 4, v38
  v_xor_b32 v41, v41, v39
  v_lshl_add_u32 v45, v41, 4, v42
  v_add_u32 v45, 8192, v45
  v_or_b32 v41, 0, v38
  v_xor_b32 v41, v41, v39
  v_lshl_add_u32 v46, v41, 4, v42
  v_add_u32 v46, 16384, v46
  v_or_b32 v41, 4, v38
  v_xor_b32 v41, v41, v39
  v_lshl_add_u32 v47, v41, 4, v42
  v_add_u32 v47, 24576, v47
  s_mul_i32 s3, s59, 147456
  s_lshl_b32 s67, s60, 4
  s_lshl_b32 s68, s61, 2
  s_add_u32 s67, s67, s68
  s_add_u32 s67, s67, s56
  s_mul_i32 s67, s67, 18
  v_min_u32 v42, 17, v36
  v_add_u32 v42, s67, v42
  v_lshlrev_b32 v42, 7, v42
  s_waitcnt lgkmcnt(0)
  s_cmp_eq_u32 s2, 0
  s_cbranch_scc1 recurrent_scan__linear_attn_block__glu_gated_bilinear__prompt_kernel_nw
recurrent_scan__linear_attn_block__glu_gated_bilinear__prompt_kernel_nn:
  s_mov_b32 s4, s36
  s_mov_b32 s5, s37
  s_mov_b32 s6, 2359296
  s_mov_b32 s7, 0x20000
  buffer_load_dword v109, v42, s[4:7], s3 offen
  s_add_u32 m0, s64, 0
  s_nop 0
  buffer_load_dwordx4 v44, s[4:7], s3 offen offset:0 lds
  s_sub_u32 s8, s38, 4096
  s_subb_u32 s9, s39, 0
  s_mov_b32 s10, 1994752
  s_mov_b32 s11, 0x20000
  s_mov_b32 s12, s44
  s_mov_b32 s13, s45
  buffer_load_dwordx4 v45, s[4:7], s3 offen offset:1024 lds
  s_mov_b32 s14, 5308416
  s_mov_b32 s15, 0x20000
  s_sub_u32 s16, s46, 2048
  s_subb_u32 s17, s47, 0
  s_mov_b32 s18, 5310464
  s_mov_b32 s19, 0x20000
  buffer_load_dwordx4 v46, s[4:7], s3 offen offset:2048 lds
  s_mov_b32 s100, s36
  s_mov_b32 s101, s37
  s_mov_b32 s20, s54
  s_mov_b32 s21, s55
  s_mov_b32 s22, 41779200
  s_mov_b32 s23, 0x20000
  buffer_load_dwordx4 v47, s[4:7], s3 offen offset:3072 lds
  s_mov_b32 s24, s54
  s_mov_b32 s25, s55
  s_mov_b32 s26, 0
  s_mov_b32 s27, 0x20000
  s_mov_b32 s28, s48
  s_mov_b32 s29, s49
  s_add_u32 m0, s64, 16384
  s_add_u32 s3, s3, 128
  buffer_load_dwordx4 v44, s[4:7], s3 offen offset:0 lds
  s_mov_b32 s30, 0
  s_mov_b32 s31, 0x20000
  s_mov_b32 s32, s54
  s_mov_b32 s33, s55
  s_mov_b32 s34, 31924224
  s_mov_b32 s35, 0x20000
  buffer_load_dwordx4 v45, s[4:7], s3 offen offset:1024 lds
  v_lshrrev_b32 v41, 1, v40
  v_xor_b32 v41, v41, v38
  v_lshlrev_b32 v41, 4, v41
  v_lshl_add_u32 v41, v40, 7, v41
  v_add_u32 v48, s64, v41
  v_xor_b32 v49, 64, v48
  buffer_load_dwordx4 v46, s[4:7], s3 offen offset:2048 lds
  s_mov_b32 s95, 0x3f803f80
  v_mov_b32 v60, s95
  v_mov_b32 v61, s95
  v_mov_b32 v62, s95
  v_mov_b32 v63, s95
  v_xor_b32 v43, 4096, v48
  buffer_load_dwordx4 v47, s[4:7], s3 offen offset:3072 lds
  v_xor_b32 v71, 4096, v49
  v_add_u32 v50, s80, v108
  v_xor_b32 v51, 4096, v50
  s_mul_i32 s67, s61, 5
  s_sub_u32 s67, s67, 2
  s_max_i32 s67, s67, 0
  s_add_u32 m0, s64, 32768
  s_add_u32 s3, s3, 128
  buffer_load_dwordx4 v44, s[4:7], s3 offen offset:0 lds
  s_mul_i32 s68, s60, 18
  s_add_u32 s67, s67, s68
  s_lshl_b32 s62, s67, 7
  s_sub_u32 s67, s61, 4
  s_cmp_eq_u32 s61, 0
  s_cselect_b32 s67, 11, s67
  buffer_load_dwordx4 v45, s[4:7], s3 offen offset:1024 lds
  s_add_u32 s67, s67, s68
  s_lshl_b32 s67, s67, 1
  s_add_u32 s67, s67, s58
  s_lshl_b32 s68, s59, 3
  s_lshl_b32 s69, s57, 2
  s_add_u32 s68, s68, s69
  buffer_load_dwordx4 v46, s[4:7], s3 offen offset:2048 lds
  s_lshl_b32 s69, s58, 1
  s_xor_b32 s96, s69, 0
  s_add_u32 s96, s96, s68
  s_mul_i32 s70, s96, 144
  s_add_u32 s70, s70, s67
  s_lshl_b32 s70, s70, 10
  buffer_load_dwordx4 v47, s[4:7], s3 offen offset:3072 lds
  s_xor_b32 s97, s69, 1
  s_add_u32 s97, s97, s68
  s_mul_i32 s71, s97, 144
  s_add_u32 s71, s71, s67
  s_lshl_b32 s71, s71, 10
  s_xor_b32 s98, s69, 2
  s_add_u32 m0, s64, 49152
  s_add_u32 s3, s3, 128
  buffer_load_dwordx4 v44, s[4:7], s3 offen offset:0 lds
  s_add_u32 s98, s98, s68
  s_mul_i32 s72, s98, 144
  s_add_u32 s72, s72, s67
  s_lshl_b32 s72, s72, 10
  s_xor_b32 s99, s69, 3
  s_add_u32 s99, s99, s68
  buffer_load_dwordx4 v45, s[4:7], s3 offen offset:1024 lds
  s_mul_i32 s73, s99, 144
  s_add_u32 s73, s73, s67
  s_lshl_b32 s73, s73, 10
  s_cmp_eq_u32 s61, 0
  s_cselect_b32 s63, 2, 4
  s_lshr_b32 s67, s2, 5
  buffer_load_dwordx4 v46, s[4:7], s3 offen offset:2048 lds
  s_and_b32 s68, s2, 7
  s_lshl_b32 s67, s67, 3
  s_add_u32 s67, s67, s68
  s_mul_i32 s67, s67, 3
  s_add_u32 s67, s67, s61
  s_sub_u32 s67, s67, 1
  buffer_load_dwordx4 v47, s[4:7], s3 offen offset:3072 lds
  s_lshl_b32 s67, s67, 2
  s_add_u32 s65, s67, s56
  s_mov_b32 s54, s50
  s_mov_b32 s55, s51
  s_mul_i32 s81, s60, 3
  s_add_u32 s81, s81, s61
  s_add_u32 m0, s64, 65536
  s_add_u32 s3, s3, 128
  s_waitcnt vmcnt(12)
  ds_read_b128 v[128:131], v48 offset:0
  ds_read_b128 v[132:135], v48 offset:2048
  ds_read_b128 v[136:139], v49 offset:0
  ds_read_b128 v[140:143], v49 offset:2048
  buffer_load_dwordx4 v44, s[4:7], s3 offen offset:0 lds
  s_sub_u32 s81, s81, 1
  s_lshl_b32 s67, s60, 8
  s_add_u32 s74, s67, 6400
  s_add_u32 s75, s67, 4480
  s_add_u32 s76, s67, 6656
  s_mul_i32 s82, s56, 6144
  buffer_load_dwordx4 v45, s[4:7], s3 offen offset:1024 lds
  s_lshl_b32 s67, s81, 7
  s_add_u32 s67, s67, 4096
  s_lshr_b32 s68, s64, 1
  s_cmp_eq_u32 s61, 0
  s_cselect_b32 s74, s74, s67
  s_cselect_b32 s82, s82, s68
  buffer_load_dwordx4 v46, s[4:7], s3 offen offset:2048 lds
  s_mul_i32 s67, s56, 16
  s_add_u32 s67, s67, 0
  v_add_u32 v42, s67, v37
  v_mul_u32_u24 v42, 9216, v42
  v_and_b32 v41, 1, v38
  v_lshlrev_b32 v41, 1, v41
  buffer_load_dwordx4 v47, s[4:7], s3 offen offset:3072 lds
  v_xor_b32 v41, v41, v39
  v_lshl_add_u32 v106, v41, 4, v42
  s_mul_i32 s67, s56, 16
  s_add_u32 s67, s67, 8
  v_add_u32 v42, s67, v37
  v_mul_u32_u24 v42, 9216, v42
  s_add_u32 m0, s64, 81920
  s_add_u32 s3, s3, 128
  s_waitcnt vmcnt(12)
  ds_read_b128 v[144:147], v48 offset:16384
  ds_read_b128 v[148:151], v48 offset:18432
  ds_read_b128 v[152:155], v49 offset:16384
  ds_read_b128 v[156:159], v49 offset:18432
  buffer_load_dwordx4 v44, s[4:7], s3 offen offset:0 lds
  s_waitcnt lgkmcnt(7)
  v_mfma_f32_16x16x32_bf16 v[4:7], v[60:63], v[128:131], 0
  v_mfma_f32_16x16x32_bf16 v[20:23], v[128:131], v[128:131], 0
  v_and_b32 v41, 1, v38
  v_lshlrev_b32 v41, 1, v41
  v_or_b32 v41, 4, v41
  v_xor_b32 v41, v41, v39
  v_lshl_add_u32 v107, v41, 4, v42
  v_subrev_u32 v107, 1024, v107
  buffer_load_dwordx4 v45, s[4:7], s3 offen offset:1024 lds
  s_waitcnt lgkmcnt(6)
  v_mfma_f32_16x16x32_bf16 v[8:11], v[60:63], v[132:135], 0
  v_mfma_f32_16x16x32_bf16 v[24:27], v[132:135], v[132:135], 0
  s_mul_i32 s67, s56, 16
  s_add_u32 s67, s67, 0
  v_add_u32 v42, s67, v37
  v_mul_u32_u24 v42, 3456, v42
  v_and_b32 v41, 1, v38
  v_lshlrev_b32 v41, 1, v41
  buffer_load_dwordx4 v46, s[4:7], s3 offen offset:2048 lds
  s_waitcnt lgkmcnt(5)
  v_mfma_f32_16x16x32_bf16 v[4:7], v[60:63], v[136:139], v[4:7]
  v_mfma_f32_16x16x32_bf16 v[20:23], v[136:139], v[136:139], v[20:23]
  v_xor_b32 v41, v41, v39
  v_lshl_add_u32 v52, v41, 4, v42
  s_mul_i32 s67, s56, 16
  s_add_u32 s67, s67, 8
  v_add_u32 v42, s67, v37
  v_mul_u32_u24 v42, 3456, v42
  buffer_load_dwordx4 v47, s[4:7], s3 offen offset:3072 lds
  s_waitcnt lgkmcnt(4)
  v_mfma_f32_16x16x32_bf16 v[8:11], v[60:63], v[140:143], v[8:11]
  v_mfma_f32_16x16x32_bf16 v[24:27], v[140:143], v[140:143], v[24:27]
  v_and_b32 v41, 1, v38
  v_lshlrev_b32 v41, 1, v41
  v_or_b32 v41, 4, v41
  v_xor_b32 v41, v41, v39
  v_lshl_add_u32 v53, v41, 4, v42
  v_subrev_u32 v53, 1024, v53
  s_add_u32 m0, s64, 98304
  s_add_u32 s3, s3, 128
  s_waitcnt vmcnt(12)
  ds_read_b128 v[160:163], v48 offset:32768
  ds_read_b128 v[164:167], v48 offset:34816
  ds_read_b128 v[168:171], v49 offset:32768
  ds_read_b128 v[172:175], v49 offset:34816
  s_barrier
  buffer_load_dwordx4 v44, s[4:7], s3 offen offset:0 lds
  s_waitcnt lgkmcnt(7)
  v_mfma_f32_16x16x32_bf16 v[4:7], v[60:63], v[144:147], v[4:7]
  v_mfma_f32_16x16x32_bf16 v[20:23], v[144:147], v[144:147], v[20:23]
  ds_read_b128 a[40:43], v43 offset:0
  v_lshrrev_b32 v41, 3, v40
  v_and_b32 v56, 1, v38
  v_lshl_or_b32 v41, v56, 1, v41
  v_lshlrev_b32 v41, 5, v41
  v_and_b32 v56, 3, v40
  v_lshl_or_b32 v41, v56, 3, v41
  buffer_load_dwordx4 v45, s[4:7], s3 offen offset:1024 lds
  s_waitcnt lgkmcnt(7)
  v_mfma_f32_16x16x32_bf16 v[8:11], v[60:63], v[148:151], v[8:11]
  v_mfma_f32_16x16x32_bf16 v[24:27], v[148:151], v[148:151], v[24:27]
  ds_read_b128 a[44:47], v43 offset:2048
  v_lshrrev_b32 v56, 2, v40
  v_lshl_or_b32 v55, v56, 7, v41
  v_lshrrev_b32 v56, 1, v38
  v_lshlrev_b32 v56, 12, v56
  v_and_b32 v41, 1, v38
  v_lshl_or_b32 v56, v41, 10, v56
  buffer_load_dwordx4 v46, s[4:7], s3 offen offset:2048 lds
  s_waitcnt lgkmcnt(7)
  v_mfma_f32_16x16x32_bf16 v[4:7], v[60:63], v[152:155], v[4:7]
  v_mfma_f32_16x16x32_bf16 v[20:23], v[152:155], v[152:155], v[20:23]
  ds_read_b128 a[48:51], v71 offset:0
  v_or_b32 v56, v56, v55
  s_lshl_b32 s67, s58, 6
  v_xor_b32 v100, s67, v56
  v_xor_b32 v101, 32, v100
  v_add_u32 v102, 65536, v100
  v_add_u32 v103, 65536, v101
  buffer_load_dwordx4 v47, s[4:7], s3 offen offset:3072 lds
  s_waitcnt lgkmcnt(7)
  v_mfma_f32_16x16x32_bf16 v[8:11], v[60:63], v[156:159], v[8:11]
  v_mfma_f32_16x16x32_bf16 v[24:27], v[156:159], v[156:159], v[24:27]
  ds_read_b128 a[52:55], v71 offset:2048
  v_add_u32 v104, 131072, v100
  v_add_u32 v105, 131072, v101
  v_lshlrev_b32 v41, 1, v38
  v_xor_b32 v41, v41, v39
  v_lshlrev_b32 v41, 4, v41
  v_mul_u32_u24 v56, 1152, v37
  s_add_u32 m0, s64, 114688
  s_add_u32 s3, s3, 128
  s_waitcnt vmcnt(12)
  ds_read_b128 v[176:179], v48 offset:49152
  ds_read_b128 v[180:183], v48 offset:51200
  ds_read_b128 v[184:187], v49 offset:49152
  ds_read_b128 v[188:191], v49 offset:51200
  buffer_load_dwordx4 v44, s[4:7], s3 offen offset:0 lds
  s_waitcnt lgkmcnt(11)
  v_mfma_f32_16x16x32_bf16 v[4:7], v[60:63], v[160:163], v[4:7]
  v_mfma_f32_16x16x32_bf16 v[20:23], v[160:163], v[160:163], v[20:23]
  ds_read_b128 a[56:59], v43 offset:16384
  v_add_u32 v1, v56, v41
  v_lshlrev_b32 v56, 9, v38
  v_add_u32 v56, s80, v56
  v_add_u32 v2, v56, v55
  s_cmp_lt_u32 s56, 2
  s_cselect_b32 s24, s12, s16
  s_cselect_b32 s25, s13, s17
  s_cselect_b32 s67, 0, 2048
  buffer_load_dwordx4 v45, s[4:7], s3 offen offset:1024 lds
  s_waitcnt lgkmcnt(11)
  v_mfma_f32_16x16x32_bf16 v[8:11], v[60:63], v[164:167], v[8:11]
  v_mfma_f32_16x16x32_bf16 v[24:27], v[164:167], v[164:167], v[24:27]
  ds_read_b128 a[60:63], v43 offset:18432
  s_add_u32 s26, s67, 5308416
  s_add_u32 s83, s62, s67
  s_mul_i32 s67, s59, 36
  s_mul_i32 s68, s58, 18
  s_add_u32 s68, s68, s67
  v_add_u32 v56, s68, v36
  buffer_load_dwordx4 v46, s[4:7], s3 offen offset:2048 lds
  s_waitcnt lgkmcnt(11)
  v_mfma_f32_16x16x32_bf16 v[4:7], v[60:63], v[168:171], v[4:7]
  v_mfma_f32_16x16x32_bf16 v[20:23], v[168:171], v[168:171], v[20:23]
  ds_read_b128 a[64:67], v71 offset:16384
  v_mul_u32_u24 v56, 9216, v56
  v_mov_b32 v41, 0x40000000
  v_cmp_gt_u32 vcc, 18, v36
  s_nop 1
  v_cndmask_b32 v3, v41, v56, vcc
  s_lshl_b32 s68, s2, 2
  s_add_u32 s68, s68, s56
  buffer_load_dwordx4 v47, s[4:7], s3 offen offset:3072 lds
  s_waitcnt lgkmcnt(11)
  v_mfma_f32_16x16x32_bf16 v[8:11], v[60:63], v[172:175], v[8:11]
  v_mfma_f32_16x16x32_bf16 v[24:27], v[172:175], v[172:175], v[24:27]
  ds_read_b128 a[68:71], v71 offset:18432
  s_lshl_b32 s68, s68, 11
  s_add_u32 s68, s68, 4096
  v_min_u32 v57, 15, v36
  v_lshlrev_b32 v57, 7, v57
  v_add_u32 v57, s68, v57
  v_mul_u32_u24 v56, 1152, v36
  s_add_u32 m0, s64, 131072
  s_add_u32 s3, s3, 128
  s_waitcnt vmcnt(12)
  v_add_u32 v48, 65536, v48
  v_add_u32 v49, 65536, v49
  ds_read_b128 v[192:195], v48 offset:0
  ds_read_b128 v[196:199], v48 offset:2048
  ds_read_b128 v[200:203], v49 offset:0
  ds_read_b128 v[204:207], v49 offset:2048
  buffer_load_dwordx4 v44, s[4:7], s3 offen offset:0 lds
  s_waitcnt lgkmcnt(11)
  v_mfma_f32_16x16x32_bf16 v[4:7], v[60:63], v[176:179], v[4:7]
  v_mfma_f32_16x16x32_bf16 v[20:23], v[176:179], v[176:179], v[20:23]
  ds_read_b128 a[72:75], v43 offset:32768
  v_cmp_gt_u32 vcc, 32, v36
  s_nop 1
  v_cndmask_b32 v118, v41, v56, vcc
  v_mov_b32 v70, 1.0
  v_lshrrev_b32 v56, 2, v40
  v_cmp_eq_u32 s[84:85], v56, v38
  v_and_b32 v56, 3, v40
  buffer_load_dwordx4 v45, s[4:7], s3 offen offset:1024 lds
  s_waitcnt lgkmcnt(11)
  v_mfma_f32_16x16x32_bf16 v[8:11], v[60:63], v[180:183], v[8:11]
  v_mfma_f32_16x16x32_bf16 v[24:27], v[180:183], v[180:183], v[24:27]
  ds_read_b128 a[76:79], v43 offset:34816
  v_cmp_eq_u32 s[86:87], 1, v56
  v_cmp_eq_u32 s[88:89], 2, v56
  v_cmp_eq_u32 s[90:91], 3, v56
  v_and_b32 v41, 1, v40
  v_lshlrev_b32 v41, 4, v41
  v_mov_b32 v42, 0x3f80
  buffer_load_dwordx4 v46, s[4:7], s3 offen offset:2048 lds
  s_waitcnt lgkmcnt(11)
  v_mfma_f32_16x16x32_bf16 v[4:7], v[60:63], v[184:187], v[4:7]
  v_mfma_f32_16x16x32_bf16 v[20:23], v[184:187], v[184:187], v[20:23]
  ds_read_b128 a[80:83], v71 offset:32768
  v_lshlrev_b32 v42, v41, v42
  v_cndmask_b32 v42, 0, v42, s[84:85]
  v_cmp_gt_u32 vcc, 2, v56
  v_mov_b32 v64, 0
  v_mov_b32 v65, 0
  v_mov_b32 v68, 0
  buffer_load_dwordx4 v47, s[4:7], s3 offen offset:3072 lds
  s_waitcnt lgkmcnt(11)
  v_mfma_f32_16x16x32_bf16 v[8:11], v[60:63], v[188:191], v[8:11]
  v_mfma_f32_16x16x32_bf16 v[24:27], v[188:191], v[188:191], v[24:27]
  ds_read_b128 a[84:87], v71 offset:34816
  v_mov_b32 v69, 0
  v_cndmask_b32 v66, 0, v42, vcc
  v_cndmask_b32 v67, v42, 0, vcc
  buffer_load_dword v109, v57, s[8:11], 0 offen
  buffer_load_dword v109, v3, s[24:27], s83 offen
  s_add_u32 s83, s83, 128
  s_mov_b32 s4, s24
  s_mov_b32 s5, s25
  s_mov_b32 s6, s26
  s_mov_b32 s24, s20
  s_mov_b32 s25, s21
  s_mov_b32 s26, 0
  s_waitcnt vmcnt(14)
  ds_read_b128 v[208:211], v48 offset:16384
  ds_read_b128 v[212:215], v48 offset:18432
  ds_read_b128 v[216:219], v49 offset:16384
  ds_read_b128 v[220:223], v49 offset:18432
  s_barrier
  s_waitcnt lgkmcnt(11)
  v_mfma_f32_16x16x32_bf16 v[4:7], v[60:63], v[192:195], v[4:7]
  v_mfma_f32_16x16x32_bf16 v[20:23], v[192:195], v[192:195], v[20:23]
  ds_read_b128 a[88:91], v43 offset:49152
  ds_read_b128 a[92:95], v43 offset:51200
  s_waitcnt lgkmcnt(12)
  v_mfma_f32_16x16x32_bf16 v[8:11], v[60:63], v[196:199], v[8:11]
  v_mfma_f32_16x16x32_bf16 v[24:27], v[196:199], v[196:199], v[24:27]
  ds_read_b128 a[96:99], v71 offset:49152
  ds_read_b128 a[100:103], v71 offset:51200
  s_waitcnt lgkmcnt(13)
  v_mfma_f32_16x16x32_bf16 v[4:7], v[60:63], v[200:203], v[4:7]
  v_mfma_f32_16x16x32_bf16 v[20:23], v[200:203], v[200:203], v[20:23]
  v_add_u32 v43, 65536, v43
  v_add_u32 v71, 65536, v71
  s_waitcnt lgkmcnt(12)
  v_mfma_f32_16x16x32_bf16 v[8:11], v[60:63], v[204:207], v[8:11]
  v_mfma_f32_16x16x32_bf16 v[24:27], v[204:207], v[204:207], v[24:27]
  ds_read_b128 a[104:107], v43 offset:0
  ds_read_b128 a[108:111], v43 offset:2048
  s_waitcnt vmcnt(10)
  ds_read_b128 v[224:227], v48 offset:32768
  ds_read_b128 v[228:231], v48 offset:34816
  ds_read_b128 v[232:235], v49 offset:32768
  ds_read_b128 v[236:239], v49 offset:34816
  s_waitcnt lgkmcnt(13)
  v_mfma_f32_16x16x32_bf16 v[4:7], v[60:63], v[208:211], v[4:7]
  v_mfma_f32_16x16x32_bf16 v[20:23], v[208:211], v[208:211], v[20:23]
  ds_read_b128 a[112:115], v71 offset:0
  ds_read_b128 a[116:119], v71 offset:2048
  s_waitcnt lgkmcnt(14)
  v_mfma_f32_16x16x32_bf16 v[8:11], v[60:63], v[212:215], v[8:11]
  v_mfma_f32_16x16x32_bf16 v[24:27], v[212:215], v[212:215], v[24:27]
  ds_read_b128 a[120:123], v43 offset:16384
  ds_read_b128 a[124:127], v43 offset:18432
  s_waitcnt lgkmcnt(15)
  v_mfma_f32_16x16x32_bf16 v[4:7], v[60:63], v[216:219], v[4:7]
  v_mfma_f32_16x16x32_bf16 v[20:23], v[216:219], v[216:219], v[20:23]
  ds_read_b128 a[128:131], v71 offset:16384
  ds_read_b128 a[132:135], v71 offset:18432
  s_waitcnt lgkmcnt(15)
  v_mfma_f32_16x16x32_bf16 v[8:11], v[60:63], v[220:223], v[8:11]
  v_mfma_f32_16x16x32_bf16 v[24:27], v[220:223], v[220:223], v[24:27]
  s_waitcnt vmcnt(6)
  ds_read_b128 v[240:243], v48 offset:49152
  ds_read_b128 v[244:247], v48 offset:51200
  ds_read_b128 v[248:251], v49 offset:49152
  ds_read_b128 v[252:255], v49 offset:51200
  s_waitcnt lgkmcnt(13)
  v_mfma_f32_16x16x32_bf16 v[4:7], v[60:63], v[224:227], v[4:7]
  v_mfma_f32_16x16x32_bf16 v[20:23], v[224:227], v[224:227], v[20:23]
  s_waitcnt lgkmcnt(12)
  v_mfma_f32_16x16x32_bf16 v[8:11], v[60:63], v[228:231], v[8:11]
  v_mfma_f32_16x16x32_bf16 v[24:27], v[228:231], v[228:231], v[24:27]
  s_waitcnt lgkmcnt(11)
  v_mfma_f32_16x16x32_bf16 v[4:7], v[60:63], v[232:235], v[4:7]
  v_mfma_f32_16x16x32_bf16 v[20:23], v[232:235], v[232:235], v[20:23]
  s_waitcnt lgkmcnt(10)
  v_mfma_f32_16x16x32_bf16 v[8:11], v[60:63], v[236:239], v[8:11]
  v_mfma_f32_16x16x32_bf16 v[24:27], v[236:239], v[236:239], v[24:27]
  s_waitcnt vmcnt(2)
  v_add_u32 v48, 65536, v48
  v_add_u32 v49, 65536, v49
  ds_read_b128 a[24:27], v48 offset:0
  ds_read_b128 a[28:31], v48 offset:2048
  ds_read_b128 a[32:35], v49 offset:0
  ds_read_b128 a[36:39], v49 offset:2048
  s_barrier
  s_waitcnt lgkmcnt(7)
  v_mfma_f32_16x16x32_bf16 v[4:7], v[60:63], v[240:243], v[4:7]
  v_mfma_f32_16x16x32_bf16 v[20:23], v[240:243], v[240:243], v[20:23]
  ds_read_b128 a[136:139], v43 offset:32768
  ds_read_b128 a[140:143], v43 offset:34816
  s_waitcnt lgkmcnt(8)
  v_mfma_f32_16x16x32_bf16 v[8:11], v[60:63], v[244:247], v[8:11]
  v_mfma_f32_16x16x32_bf16 v[24:27], v[244:247], v[244:247], v[24:27]
  ds_read_b128 a[144:147], v71 offset:32768
  ds_read_b128 a[148:151], v71 offset:34816
  s_waitcnt lgkmcnt(9)
  v_mfma_f32_16x16x32_bf16 v[4:7], v[60:63], v[248:251], v[4:7]
  v_mfma_f32_16x16x32_bf16 v[20:23], v[248:251], v[248:251], v[20:23]
  ds_read_b128 a[152:155], v43 offset:49152
  ds_read_b128 a[156:159], v43 offset:51200
  s_waitcnt lgkmcnt(10)
  v_mfma_f32_16x16x32_bf16 v[8:11], v[60:63], v[252:255], v[8:11]
  v_mfma_f32_16x16x32_bf16 v[24:27], v[252:255], v[252:255], v[24:27]
  ds_read_b128 a[160:163], v71 offset:49152
  ds_read_b128 a[164:167], v71 offset:51200
  s_waitcnt lgkmcnt(11)
  v_mfma_f32_16x16x32_bf16 v[4:7], v[60:63], a[24:27], v[4:7]
  v_mfma_f32_16x16x32_bf16 v[20:23], a[24:27], a[24:27], v[20:23]
  v_add_u32 v43, 65536, v43
  v_add_u32 v71, 65536, v71
  ds_read_b128 a[168:171], v43 offset:0
  s_waitcnt lgkmcnt(11)
  v_mfma_f32_16x16x32_bf16 v[8:11], v[60:63], a[28:31], v[8:11]
  v_mfma_f32_16x16x32_bf16 v[24:27], a[28:31], a[28:31], v[24:27]
  ds_read_b128 a[172:175], v43 offset:2048
  ds_read_b128 a[176:179], v71 offset:0
  ds_read_b128 a[180:183], v71 offset:2048
  s_waitcnt lgkmcnt(13)
  v_mfma_f32_16x16x32_bf16 v[4:7], v[60:63], a[32:35], v[4:7]
  v_mfma_f32_16x16x32_bf16 v[20:23], a[32:35], a[32:35], v[20:23]
  s_waitcnt lgkmcnt(12)
  v_mfma_f32_16x16x32_bf16 v[8:11], v[60:63], a[36:39], v[8:11]
  v_mfma_f32_16x16x32_bf16 v[24:27], a[36:39], a[36:39], v[24:27]
  s_nop 3
  v_mul_f32 v4, 0xbae38e39, v4
  v_mul_f32 v5, 0xbae38e39, v5
  v_mul_f32 v6, 0xbae38e39, v6
  v_mul_f32 v7, 0xbae38e39, v7
  ds_write_b128 v50, v[4:7] offset:0
  v_mul_f32 v8, 0xbae38e39, v8
  v_mul_f32 v9, 0xbae38e39, v9
  v_mul_f32 v10, 0xbae38e39, v10
  v_mul_f32 v11, 0xbae38e39, v11
  ds_write_b128 v50, v[8:11] offset:1024
  s_waitcnt lgkmcnt(0)
  s_barrier
  ds_read_b128 v[12:15], v51 offset:0
  ds_read_b128 v[16:19], v51 offset:1024
  s_cmp_eq_u32 s61, 0
  s_cbranch_scc1 recurrent_scan__linear_attn_block__glu_gated_bilinear__prompt_kernel_kv
  s_cmp_lt_u32 s81, 9
  s_cbranch_scc1 recurrent_scan__linear_attn_block__glu_gated_bilinear__prompt_kernel_q
  v_mov_b32 v74, 0
  global_load_dwordx2 v[58:59], v74, s[52:53] sc1
  v_mfma_f32_16x16x32_bf16 v[76:79], v[66:69], v[128:131], v[4:7]
  v_mfma_f32_16x16x32_bf16 v[80:83], v[64:67], v[128:131], v[4:7]
  v_cndmask_b32 v72, v20, v21, s[86:87]
  s_add_u32 m0, s64, 0
  s_nop 0
  buffer_load_dwordx4 v106, s[12:15], s62 offen lds
  v_mfma_f32_16x16x32_bf16 v[84:87], v[66:69], v[132:135], v[8:11]
  v_mfma_f32_16x16x32_bf16 v[88:91], v[64:67], v[132:135], v[8:11]
  v_cndmask_b32 v72, v72, v22, s[88:89]
  v_mfma_f32_16x16x32_bf16 v[92:95], v[66:69], v[136:139], v[4:7]
  v_cvt_pk_bf16_f32 v128, v76, v77
  v_cvt_pk_bf16_f32 v129, v78, v79
  v_mfma_f32_16x16x32_bf16 v[96:99], v[64:67], v[136:139], v[4:7]
  v_cvt_pk_bf16_f32 v130, v80, v81
  v_cvt_pk_bf16_f32 v131, v82, v83
  v_cndmask_b32 v72, v72, v23, s[90:91]
  buffer_load_dwordx4 v107, s[12:15], s62 offen offset:1024 lds
  v_mfma_f32_16x16x32_bf16 v[76:79], v[66:69], v[140:143], v[8:11]
  v_cvt_pk_bf16_f32 v132, v84, v85
  v_cvt_pk_bf16_f32 v133, v86, v87
  v_mfma_f32_16x16x32_bf16 v[80:83], v[64:67], v[140:143], v[8:11]
  v_cvt_pk_bf16_f32 v134, v88, v89
  v_cvt_pk_bf16_f32 v135, v90, v91
  v_cndmask_b32 v72, 0, v72, s[84:85]
  v_mfma_f32_16x16x32_bf16 v[84:87], v[66:69], v[144:147], v[4:7]
  v_cvt_pk_bf16_f32 v136, v92, v93
  v_cvt_pk_bf16_f32 v137, v94, v95
  v_mfma_f32_16x16x32_bf16 v[88:91], v[64:67], v[144:147], v[4:7]
  v_cvt_pk_bf16_f32 v138, v96, v97
  v_cvt_pk_bf16_f32 v139, v98, v99
  v_cndmask_b32 v73, v24, v25, s[86:87]
  buffer_load_dwordx4 v106, s[16:19], s62 offen offset:2048 lds
  v_mfma_f32_16x16x32_bf16 v[92:95], v[66:69], v[148:151], v[8:11]
  v_cvt_pk_bf16_f32 v140, v76, v77
  v_cvt_pk_bf16_f32 v141, v78, v79
  v_mfma_f32_16x16x32_bf16 v[96:99], v[64:67], v[148:151], v[8:11]
  v_cvt_pk_bf16_f32 v142, v80, v81
  v_cvt_pk_bf16_f32 v143, v82, v83
  v_cndmask_b32 v73, v73, v26, s[88:89]
  v_mfma_f32_16x16x32_bf16 v[76:79], v[66:69], v[152:155], v[4:7]
  v_cvt_pk_bf16_f32 v144, v84, v85
  v_cvt_pk_bf16_f32 v145, v86, v87
  v_mfma_f32_16x16x32_bf16 v[80:83], v[64:67], v[152:155], v[4:7]
  v_cvt_pk_bf16_f32 v146, v88, v89
  v_cvt_pk_bf16_f32 v147, v90, v91
  v_cndmask_b32 v73, v73, v27, s[90:91]
  buffer_load_dwordx4 v107, s[16:19], s62 offen offset:3072 lds
  v_mfma_f32_16x16x32_bf16 v[84:87], v[66:69], v[156:159], v[8:11]
  v_cvt_pk_bf16_f32 v148, v92, v93
  v_cvt_pk_bf16_f32 v149, v94, v95
  v_mfma_f32_16x16x32_bf16 v[88:91], v[64:67], v[156:159], v[8:11]
  v_cvt_pk_bf16_f32 v150, v96, v97
  v_cvt_pk_bf16_f32 v151, v98, v99
  v_cndmask_b32 v73, 0, v73, s[84:85]
  v_mfma_f32_16x16x32_bf16 v[92:95], v[66:69], v[160:163], v[4:7]
  v_cvt_pk_bf16_f32 v152, v76, v77
  v_cvt_pk_bf16_f32 v153, v78, v79
  v_mfma_f32_16x16x32_bf16 v[96:99], v[64:67], v[160:163], v[4:7]
  v_cvt_pk_bf16_f32 v154, v80, v81
  v_cvt_pk_bf16_f32 v155, v82, v83
  s_add_u32 s62, s62, 589824
  s_add_u32 m0, s64, 16384
  s_nop 0
  buffer_load_dwordx4 v106, s[12:15], s62 offen lds
  v_mfma_f32_16x16x32_bf16 v[76:79], v[66:69], v[164:167], v[8:11]
  v_cvt_pk_bf16_f32 v156, v84, v85
  v_cvt_pk_bf16_f32 v157, v86, v87
  v_mfma_f32_16x16x32_bf16 v[80:83], v[64:67], v[164:167], v[8:11]
  v_cvt_pk_bf16_f32 v158, v88, v89
  v_cvt_pk_bf16_f32 v159, v90, v91
  v_mfma_f32_16x16x4_f32 v[20:23], v70, v72, 0
  v_mfma_f32_16x16x32_bf16 v[84:87], v[66:69], v[168:171], v[4:7]
  v_cvt_pk_bf16_f32 v160, v92, v93
  v_cvt_pk_bf16_f32 v161, v94, v95
  v_mfma_f32_16x16x32_bf16 v[88:91], v[64:67], v[168:171], v[4:7]
  v_cvt_pk_bf16_f32 v162, v96, v97
  v_cvt_pk_bf16_f32 v163, v98, v99
  v_mfma_f32_16x16x4_f32 v[24:27], v70, v73, 0
  v_mfma_f32_16x16x32_bf16 v[92:95], v[66:69], v[172:175], v[8:11]
  v_cvt_pk_bf16_f32 v164, v76, v77
  v_cvt_pk_bf16_f32 v165, v78, v79
  v_mfma_f32_16x16x32_bf16 v[96:99], v[64:67], v[172:175], v[8:11]
  v_cvt_pk_bf16_f32 v166, v80, v81
  v_cvt_pk_bf16_f32 v167, v82, v83
  v_mul_f32 v72, v4, v4
  buffer_load_dwordx4 v107, s[12:15], s62 offen offset:1024 lds
  v_mfma_f32_16x16x32_bf16 v[76:79], v[66:69], v[176:179], v[4:7]
  v_cvt_pk_bf16_f32 v168, v84, v85
  v_cvt_pk_bf16_f32 v169, v86, v87
  v_mfma_f32_16x16x32_bf16 v[80:83], v[64:67], v[176:179], v[4:7]
  v_cvt_pk_bf16_f32 v170, v88, v89
  v_cvt_pk_bf16_f32 v171, v90, v91
  v_mul_f32 v73, v8, v8
  v_mfma_f32_16x16x32_bf16 v[84:87], v[66:69], v[180:183], v[8:11]
  v_cvt_pk_bf16_f32 v172, v92, v93
  v_cvt_pk_bf16_f32 v173, v94, v95
  v_mfma_f32_16x16x32_bf16 v[88:91], v[64:67], v[180:183], v[8:11]
  v_cvt_pk_bf16_f32 v174, v96, v97
  v_cvt_pk_bf16_f32 v175, v98, v99
  s_mov_b32 s67, 0x3ae38e39
  buffer_load_dwordx4 v106, s[16:19], s62 offen offset:2048 lds
  v_mfma_f32_16x16x32_bf16 v[92:95], v[66:69], v[184:187], v[4:7]
  v_cvt_pk_bf16_f32 v176, v76, v77
  v_cvt_pk_bf16_f32 v177, v78, v79
  v_mfma_f32_16x16x32_bf16 v[96:99], v[64:67], v[184:187], v[4:7]
  v_cvt_pk_bf16_f32 v178, v80, v81
  v_cvt_pk_bf16_f32 v179, v82, v83
  v_mfma_f32_16x16x32_bf16 v[76:79], v[66:69], v[188:191], v[8:11]
  v_cvt_pk_bf16_f32 v180, v84, v85
  v_cvt_pk_bf16_f32 v181, v86, v87
  v_mfma_f32_16x16x32_bf16 v[80:83], v[64:67], v[188:191], v[8:11]
  v_cvt_pk_bf16_f32 v182, v88, v89
  v_cvt_pk_bf16_f32 v183, v90, v91
  v_fma_f32 v72, v20, s67, -v72
  buffer_load_dwordx4 v107, s[16:19], s62 offen offset:3072 lds
  v_mfma_f32_16x16x32_bf16 v[84:87], v[66:69], v[192:195], v[4:7]
  v_cvt_pk_bf16_f32 v184, v92, v93
  v_cvt_pk_bf16_f32 v185, v94, v95
  v_mfma_f32_16x16x32_bf16 v[88:91], v[64:67], v[192:195], v[4:7]
  v_cvt_pk_bf16_f32 v186, v96, v97
  v_cvt_pk_bf16_f32 v187, v98, v99
  v_max_f32 v72, 0, v72
  v_mfma_f32_16x16x32_bf16 v[92:95], v[66:69], v[196:199], v[8:11]
  v_cvt_pk_bf16_f32 v188, v76, v77
  v_cvt_pk_bf16_f32 v189, v78, v79
  v_mfma_f32_16x16x32_bf16 v[96:99], v[64:67], v[196:199], v[8:11]
  v_cvt_pk_bf16_f32 v190, v80, v81
  v_cvt_pk_bf16_f32 v191, v82, v83
  v_add_f32 v72, 0x3727c5ac, v72
  s_add_u32 s62, s62, 589824
  s_add_u32 m0, s64, 32768
  s_nop 0
  buffer_load_dwordx4 v106, s[12:15], s62 offen lds
  v_mfma_f32_16x16x32_bf16 v[76:79], v[66:69], v[200:203], v[4:7]
  v_cvt_pk_bf16_f32 v192, v84, v85
  v_cvt_pk_bf16_f32 v193, v86, v87
  v_mfma_f32_16x16x32_bf16 v[80:83], v[64:67], v[200:203], v[4:7]
  v_cvt_pk_bf16_f32 v194, v88, v89
  v_cvt_pk_bf16_f32 v195, v90, v91
  v_rsq_f32 v110, v72
  v_mfma_f32_16x16x32_bf16 v[84:87], v[66:69], v[204:207], v[8:11]
  v_cvt_pk_bf16_f32 v196, v92, v93
  v_cvt_pk_bf16_f32 v197, v94, v95
  v_mfma_f32_16x16x32_bf16 v[88:91], v[64:67], v[204:207], v[8:11]
  v_cvt_pk_bf16_f32 v198, v96, v97
  v_cvt_pk_bf16_f32 v199, v98, v99
  v_rcp_f32 v114, v72
  buffer_load_dwordx4 v107, s[12:15], s62 offen offset:1024 lds
  v_mfma_f32_16x16x32_bf16 v[92:95], v[66:69], v[208:211], v[4:7]
  v_cvt_pk_bf16_f32 v200, v76, v77
  v_cvt_pk_bf16_f32 v201, v78, v79
  v_mfma_f32_16x16x32_bf16 v[96:99], v[64:67], v[208:211], v[4:7]
  v_cvt_pk_bf16_f32 v202, v80, v81
  v_cvt_pk_bf16_f32 v203, v82, v83
  v_fma_f32 v73, v24, s67, -v73
  v_mfma_f32_16x16x32_bf16 v[76:79], v[66:69], v[212:215], v[8:11]
  v_cvt_pk_bf16_f32 v204, v84, v85
  v_cvt_pk_bf16_f32 v205, v86, v87
  v_mfma_f32_16x16x32_bf16 v[80:83], v[64:67], v[212:215], v[8:11]
  v_cvt_pk_bf16_f32 v206, v88, v89
  v_cvt_pk_bf16_f32 v207, v90, v91
  v_max_f32 v73, 0, v73
  v_mfma_f32_16x16x32_bf16 v[84:87], v[66:69], v[216:219], v[4:7]
  v_cvt_pk_bf16_f32 v208, v92, v93
  v_cvt_pk_bf16_f32 v209, v94, v95
  v_mfma_f32_16x16x32_bf16 v[88:91], v[64:67], v[216:219], v[4:7]
  v_cvt_pk_bf16_f32 v210, v96, v97
  v_cvt_pk_bf16_f32 v211, v98, v99
  v_add_f32 v73, 0x3727c5ac, v73
  buffer_load_dwordx4 v106, s[16:19], s62 offen offset:2048 lds
  v_mfma_f32_16x16x32_bf16 v[92:95], v[66:69], v[220:223], v[8:11]
  v_cvt_pk_bf16_f32 v212, v76, v77
  v_cvt_pk_bf16_f32 v213, v78, v79
  v_mfma_f32_16x16x32_bf16 v[96:99], v[64:67], v[220:223], v[8:11]
  v_cvt_pk_bf16_f32 v214, v80, v81
  v_cvt_pk_bf16_f32 v215, v82, v83
  v_rsq_f32 v111, v73
  v_mfma_f32_16x16x32_bf16 v[76:79], v[66:69], v[224:227], v[4:7]
  v_cvt_pk_bf16_f32 v216, v84, v85
  v_cvt_pk_bf16_f32 v217, v86, v87
  v_mfma_f32_16x16x32_bf16 v[80:83], v[64:67], v[224:227], v[4:7]
  v_cvt_pk_bf16_f32 v218, v88, v89
  v_cvt_pk_bf16_f32 v219, v90, v91
  v_rcp_f32 v115, v73
  buffer_load_dwordx4 v107, s[16:19], s62 offen offset:3072 lds
  v_mfma_f32_16x16x32_bf16 v[84:87], v[66:69], v[228:231], v[8:11]
  v_cvt_pk_bf16_f32 v220, v92, v93
  v_cvt_pk_bf16_f32 v221, v94, v95
  v_mfma_f32_16x16x32_bf16 v[88:91], v[64:67], v[228:231], v[8:11]
  v_cvt_pk_bf16_f32 v222, v96, v97
  v_cvt_pk_bf16_f32 v223, v98, v99
  ds_write_b64 v50, v[110:111] offset:2048
  v_mfma_f32_16x16x32_bf16 v[92:95], v[66:69], v[232:235], v[4:7]
  v_cvt_pk_bf16_f32 v224, v76, v77
  v_cvt_pk_bf16_f32 v225, v78, v79
  v_mfma_f32_16x16x32_bf16 v[96:99], v[64:67], v[232:235], v[4:7]
  v_cvt_pk_bf16_f32 v226, v80, v81
  v_cvt_pk_bf16_f32 v227, v82, v83
  ds_write_b64 v50, v[114:115] offset:2056
  s_add_u32 s62, s62, 589824
  s_add_u32 m0, s64, 49152
  s_nop 0
  buffer_load_dwordx4 v106, s[12:15], s62 offen lds
  v_mfma_f32_16x16x32_bf16 v[76:79], v[66:69], v[236:239], v[8:11]
  v_cvt_pk_bf16_f32 v228, v84, v85
  v_cvt_pk_bf16_f32 v229, v86, v87
  v_mfma_f32_16x16x32_bf16 v[80:83], v[64:67], v[236:239], v[8:11]
  v_cvt_pk_bf16_f32 v230, v88, v89
  v_cvt_pk_bf16_f32 v231, v90, v91
  v_mfma_f32_16x16x32_bf16 v[84:87], v[66:69], v[240:243], v[4:7]
  v_cvt_pk_bf16_f32 v232, v92, v93
  v_cvt_pk_bf16_f32 v233, v94, v95
  v_mfma_f32_16x16x32_bf16 v[88:91], v[64:67], v[240:243], v[4:7]
  v_cvt_pk_bf16_f32 v234, v96, v97
  v_cvt_pk_bf16_f32 v235, v98, v99
  buffer_load_dwordx4 v107, s[12:15], s62 offen offset:1024 lds
  v_mfma_f32_16x16x32_bf16 v[92:95], v[66:69], v[244:247], v[8:11]
  v_cvt_pk_bf16_f32 v236, v76, v77
  v_cvt_pk_bf16_f32 v237, v78, v79
  v_mfma_f32_16x16x32_bf16 v[96:99], v[64:67], v[244:247], v[8:11]
  v_cvt_pk_bf16_f32 v238, v80, v81
  v_cvt_pk_bf16_f32 v239, v82, v83
  v_mfma_f32_16x16x32_bf16 v[76:79], v[66:69], v[248:251], v[4:7]
  v_cvt_pk_bf16_f32 v240, v84, v85
  v_cvt_pk_bf16_f32 v241, v86, v87
  v_mfma_f32_16x16x32_bf16 v[80:83], v[64:67], v[248:251], v[4:7]
  v_cvt_pk_bf16_f32 v242, v88, v89
  v_cvt_pk_bf16_f32 v243, v90, v91
  s_waitcnt lgkmcnt(0)
  s_barrier
  buffer_load_dwordx4 v106, s[16:19], s62 offen offset:2048 lds
  v_mfma_f32_16x16x32_bf16 v[84:87], v[66:69], v[252:255], v[8:11]
  v_cvt_pk_bf16_f32 v244, v92, v93
  v_cvt_pk_bf16_f32 v245, v94, v95
  v_mfma_f32_16x16x32_bf16 v[88:91], v[64:67], v[252:255], v[8:11]
  v_cvt_pk_bf16_f32 v246, v96, v97
  v_cvt_pk_bf16_f32 v247, v98, v99
  ds_read_b64 v[112:113], v51 offset:2048
  v_mfma_f32_16x16x32_bf16 v[92:95], v[66:69], a[24:27], v[4:7]
  v_cvt_pk_bf16_f32 v248, v76, v77
  v_cvt_pk_bf16_f32 v249, v78, v79
  v_mfma_f32_16x16x32_bf16 v[96:99], v[64:67], a[24:27], v[4:7]
  v_cvt_pk_bf16_f32 v250, v80, v81
  v_cvt_pk_bf16_f32 v251, v82, v83
  ds_read_b64 v[116:117], v51 offset:2056
  v_mfma_f32_16x16x32_bf16 v[76:79], v[66:69], a[28:31], v[8:11]
  v_cvt_pk_bf16_f32 v252, v84, v85
  v_cvt_pk_bf16_f32 v253, v86, v87
  v_mfma_f32_16x16x32_bf16 v[80:83], v[64:67], a[28:31], v[8:11]
  v_cvt_pk_bf16_f32 v254, v88, v89
  v_cvt_pk_bf16_f32 v255, v90, v91
  buffer_load_dwordx4 v107, s[16:19], s62 offen offset:3072 lds
  v_mfma_f32_16x16x32_bf16 v[84:87], v[66:69], a[32:35], v[4:7]
  v_cvt_pk_bf16_f32 v92, v92, v93
  v_accvgpr_write_b32 a24, v92
  v_cvt_pk_bf16_f32 v94, v94, v95
  v_accvgpr_write_b32 a25, v94
  v_mfma_f32_16x16x32_bf16 v[88:91], v[64:67], a[32:35], v[4:7]
  v_cvt_pk_bf16_f32 v96, v96, v97
  v_accvgpr_write_b32 a26, v96
  v_cvt_pk_bf16_f32 v98, v98, v99
  v_accvgpr_write_b32 a27, v98
  v_mfma_f32_16x16x32_bf16 v[92:95], v[66:69], a[36:39], v[8:11]
  v_cvt_pk_bf16_f32 v76, v76, v77
  v_accvgpr_write_b32 a28, v76
  v_cvt_pk_bf16_f32 v78, v78, v79
  v_accvgpr_write_b32 a29, v78
  v_mfma_f32_16x16x32_bf16 v[96:99], v[64:67], a[36:39], v[8:11]
  v_cvt_pk_bf16_f32 v80, v80, v81
  v_accvgpr_write_b32 a30, v80
  v_cvt_pk_bf16_f32 v82, v82, v83
  v_accvgpr_write_b32 a31, v82
  s_add_u32 s62, s62, 589824
  s_add_u32 m0, s64, 65536
  s_nop 0
  buffer_load_dwordx4 v106, s[12:15], s62 offen lds
  v_mfma_f32_16x16x32_bf16 v[76:79], v[66:69], a[40:43], v[12:15]
  v_cvt_pk_bf16_f32 v84, v84, v85
  v_accvgpr_write_b32 a32, v84
  v_cvt_pk_bf16_f32 v86, v86, v87
  v_accvgpr_write_b32 a33, v86
  v_mfma_f32_16x16x32_bf16 v[80:83], v[64:67], a[40:43], v[12:15]
  v_cvt_pk_bf16_f32 v88, v88, v89
  v_accvgpr_write_b32 a34, v88
  v_cvt_pk_bf16_f32 v90, v90, v91
  v_accvgpr_write_b32 a35, v90
  v_mfma_f32_16x16x32_bf16 v[84:87], v[66:69], a[44:47], v[16:19]
  v_cvt_pk_bf16_f32 v92, v92, v93
  v_accvgpr_write_b32 a36, v92
  v_cvt_pk_bf16_f32 v94, v94, v95
  v_accvgpr_write_b32 a37, v94
  v_mfma_f32_16x16x32_bf16 v[88:91], v[64:67], a[44:47], v[16:19]
  v_cvt_pk_bf16_f32 v96, v96, v97
  v_accvgpr_write_b32 a38, v96
  v_cvt_pk_bf16_f32 v98, v98, v99
  v_accvgpr_write_b32 a39, v98
  buffer_load_dwordx4 v107, s[12:15], s62 offen offset:1024 lds
  v_mfma_f32_16x16x32_bf16 v[92:95], v[66:69], a[48:51], v[12:15]
  v_cvt_pk_bf16_f32 v76, v76, v77
  v_accvgpr_write_b32 a40, v76
  v_cvt_pk_bf16_f32 v78, v78, v79
  v_accvgpr_write_b32 a41, v78
  v_mfma_f32_16x16x32_bf16 v[96:99], v[64:67], a[48:51], v[12:15]
  v_cvt_pk_bf16_f32 v80, v80, v81
  v_accvgpr_write_b32 a42, v80
  v_cvt_pk_bf16_f32 v82, v82, v83
  v_accvgpr_write_b32 a43, v82
  v_mfma_f32_16x16x32_bf16 v[76:79], v[66:69], a[52:55], v[16:19]
  v_cvt_pk_bf16_f32 v84, v84, v85
  v_accvgpr_write_b32 a44, v84
  v_cvt_pk_bf16_f32 v86, v86, v87
  v_accvgpr_write_b32 a45, v86
  v_mfma_f32_16x16x32_bf16 v[80:83], v[64:67], a[52:55], v[16:19]
  v_cvt_pk_bf16_f32 v88, v88, v89
  v_accvgpr_write_b32 a46, v88
  v_cvt_pk_bf16_f32 v90, v90, v91
  v_accvgpr_write_b32 a47, v90
  buffer_load_dwordx4 v106, s[16:19], s62 offen offset:2048 lds
  v_mfma_f32_16x16x32_bf16 v[84:87], v[66:69], a[56:59], v[12:15]
  v_cvt_pk_bf16_f32 v92, v92, v93
  v_accvgpr_write_b32 a48, v92
  v_cvt_pk_bf16_f32 v94, v94, v95
  v_accvgpr_write_b32 a49, v94
  v_mfma_f32_16x16x32_bf16 v[88:91], v[64:67], a[56:59], v[12:15]
  v_cvt_pk_bf16_f32 v96, v96, v97
  v_accvgpr_write_b32 a50, v96
  v_cvt_pk_bf16_f32 v98, v98, v99
  v_accvgpr_write_b32 a51, v98
  v_mfma_f32_16x16x32_bf16 v[92:95], v[66:69], a[60:63], v[16:19]
  v_cvt_pk_bf16_f32 v76, v76, v77
  v_accvgpr_write_b32 a52, v76
  v_cvt_pk_bf16_f32 v78, v78, v79
  v_accvgpr_write_b32 a53, v78
  v_mfma_f32_16x16x32_bf16 v[96:99], v[64:67], a[60:63], v[16:19]
  v_cvt_pk_bf16_f32 v80, v80, v81
  v_accvgpr_write_b32 a54, v80
  v_cvt_pk_bf16_f32 v82, v82, v83
  v_accvgpr_write_b32 a55, v82
  buffer_load_dwordx4 v107, s[16:19], s62 offen offset:3072 lds
  v_mfma_f32_16x16x32_bf16 v[76:79], v[66:69], a[64:67], v[12:15]
  v_cvt_pk_bf16_f32 v84, v84, v85
  v_accvgpr_write_b32 a56, v84
  v_cvt_pk_bf16_f32 v86, v86, v87
  v_accvgpr_write_b32 a57, v86
  v_mfma_f32_16x16x32_bf16 v[80:83], v[64:67], a[64:67], v[12:15]
  v_cvt_pk_bf16_f32 v88, v88, v89
  v_accvgpr_write_b32 a58, v88
  v_cvt_pk_bf16_f32 v90, v90, v91
  v_accvgpr_write_b32 a59, v90
  v_mfma_f32_16x16x32_bf16 v[84:87], v[66:69], a[68:71], v[16:19]
  v_cvt_pk_bf16_f32 v92, v92, v93
  v_accvgpr_write_b32 a60, v92
  v_cvt_pk_bf16_f32 v94, v94, v95
  v_accvgpr_write_b32 a61, v94
  v_mfma_f32_16x16x32_bf16 v[88:91], v[64:67], a[68:71], v[16:19]
  v_cvt_pk_bf16_f32 v96, v96, v97
  v_accvgpr_write_b32 a62, v96
  v_cvt_pk_bf16_f32 v98, v98, v99
  v_accvgpr_write_b32 a63, v98
  v_mfma_f32_16x16x32_bf16 v[92:95], v[66:69], a[72:75], v[12:15]
  v_cvt_pk_bf16_f32 v76, v76, v77
  v_accvgpr_write_b32 a64, v76
  v_cvt_pk_bf16_f32 v78, v78, v79
  v_accvgpr_write_b32 a65, v78
  v_mfma_f32_16x16x32_bf16 v[96:99], v[64:67], a[72:75], v[12:15]
  v_cvt_pk_bf16_f32 v80, v80, v81
  v_accvgpr_write_b32 a66, v80
  v_cvt_pk_bf16_f32 v82, v82, v83
  v_accvgpr_write_b32 a67, v82
  s_add_u32 s62, s62, 589824
  s_add_u32 m0, s64, 81920
  s_nop 0
  buffer_load_dwordx4 v106, s[12:15], s62 offen lds
  v_mfma_f32_16x16x32_bf16 v[76:79], v[66:69], a[76:79], v[16:19]
  v_cvt_pk_bf16_f32 v84, v84, v85
  v_accvgpr_write_b32 a68, v84
  v_cvt_pk_bf16_f32 v86, v86, v87
  v_accvgpr_write_b32 a69, v86
  v_mfma_f32_16x16x32_bf16 v[80:83], v[64:67], a[76:79], v[16:19]
  v_cvt_pk_bf16_f32 v88, v88, v89
  v_accvgpr_write_b32 a70, v88
  v_cvt_pk_bf16_f32 v90, v90, v91
  v_accvgpr_write_b32 a71, v90
  v_mfma_f32_16x16x32_bf16 v[84:87], v[66:69], a[80:83], v[12:15]
  v_cvt_pk_bf16_f32 v92, v92, v93
  v_accvgpr_write_b32 a72, v92
  v_cvt_pk_bf16_f32 v94, v94, v95
  v_accvgpr_write_b32 a73, v94
  v_mfma_f32_16x16x32_bf16 v[88:91], v[64:67], a[80:83], v[12:15]
  v_cvt_pk_bf16_f32 v96, v96, v97
  v_accvgpr_write_b32 a74, v96
  v_cvt_pk_bf16_f32 v98, v98, v99
  v_accvgpr_write_b32 a75, v98
  buffer_load_dwordx4 v107, s[12:15], s62 offen offset:1024 lds
  v_mfma_f32_16x16x32_bf16 v[92:95], v[66:69], a[84:87], v[16:19]
  v_cvt_pk_bf16_f32 v76, v76, v77
  v_accvgpr_write_b32 a76, v76
  v_cvt_pk_bf16_f32 v78, v78, v79
  v_accvgpr_write_b32 a77, v78
  v_mfma_f32_16x16x32_bf16 v[96:99], v[64:67], a[84:87], v[16:19]
  v_cvt_pk_bf16_f32 v80, v80, v81
  v_accvgpr_write_b32 a78, v80
  v_cvt_pk_bf16_f32 v82, v82, v83
  v_accvgpr_write_b32 a79, v82
  v_mfma_f32_16x16x32_bf16 v[76:79], v[66:69], a[88:91], v[12:15]
  v_cvt_pk_bf16_f32 v84, v84, v85
  v_accvgpr_write_b32 a80, v84
  v_cvt_pk_bf16_f32 v86, v86, v87
  v_accvgpr_write_b32 a81, v86
  v_mfma_f32_16x16x32_bf16 v[80:83], v[64:67], a[88:91], v[12:15]
  v_cvt_pk_bf16_f32 v88, v88, v89
  v_accvgpr_write_b32 a82, v88
  v_cvt_pk_bf16_f32 v90, v90, v91
  v_accvgpr_write_b32 a83, v90
  buffer_load_dwordx4 v106, s[16:19], s62 offen offset:2048 lds
  v_mfma_f32_16x16x32_bf16 v[84:87], v[66:69], a[92:95], v[16:19]
  v_cvt_pk_bf16_f32 v92, v92, v93
  v_accvgpr_write_b32 a84, v92
  v_cvt_pk_bf16_f32 v94, v94, v95
  v_accvgpr_write_b32 a85, v94
  v_mfma_f32_16x16x32_bf16 v[88:91], v[64:67], a[92:95], v[16:19]
  v_cvt_pk_bf16_f32 v96, v96, v97
  v_accvgpr_write_b32 a86, v96
  v_cvt_pk_bf16_f32 v98, v98, v99
  v_accvgpr_write_b32 a87, v98
  v_mfma_f32_16x16x32_bf16 v[92:95], v[66:69], a[96:99], v[12:15]
  v_cvt_pk_bf16_f32 v76, v76, v77
  v_accvgpr_write_b32 a88, v76
  v_cvt_pk_bf16_f32 v78, v78, v79
  v_accvgpr_write_b32 a89, v78
  v_mfma_f32_16x16x32_bf16 v[96:99], v[64:67], a[96:99], v[12:15]
  v_cvt_pk_bf16_f32 v80, v80, v81
  v_accvgpr_write_b32 a90, v80
  v_cvt_pk_bf16_f32 v82, v82, v83
  v_accvgpr_write_b32 a91, v82
  buffer_load_dwordx4 v107, s[16:19], s62 offen offset:3072 lds
  v_mfma_f32_16x16x32_bf16 v[76:79], v[66:69], a[100:103], v[16:19]
  v_cvt_pk_bf16_f32 v84, v84, v85
  v_accvgpr_write_b32 a92, v84
  v_cvt_pk_bf16_f32 v86, v86, v87
  v_accvgpr_write_b32 a93, v86
  v_mfma_f32_16x16x32_bf16 v[80:83], v[64:67], a[100:103], v[16:19]
  v_cvt_pk_bf16_f32 v88, v88, v89
  v_accvgpr_write_b32 a94, v88
  v_cvt_pk_bf16_f32 v90, v90, v91
  v_accvgpr_write_b32 a95, v90
  v_mfma_f32_16x16x32_bf16 v[84:87], v[66:69], a[104:107], v[12:15]
  v_cvt_pk_bf16_f32 v92, v92, v93
  v_accvgpr_write_b32 a96, v92
  v_cvt_pk_bf16_f32 v94, v94, v95
  v_accvgpr_write_b32 a97, v94
  v_mfma_f32_16x16x32_bf16 v[88:91], v[64:67], a[104:107], v[12:15]
  v_cvt_pk_bf16_f32 v96, v96, v97
  v_accvgpr_write_b32 a98, v96
  v_cvt_pk_bf16_f32 v98, v98, v99
  v_accvgpr_write_b32 a99, v98
  s_add_u32 s62, s62, 589824
  s_add_u32 m0, s64, 98304
  s_nop 0
  buffer_load_dwordx4 v106, s[12:15], s62 offen lds
  v_mfma_f32_16x16x32_bf16 v[92:95], v[66:69], a[108:111], v[16:19]
  v_cvt_pk_bf16_f32 v76, v76, v77
  v_accvgpr_write_b32 a100, v76
  v_cvt_pk_bf16_f32 v78, v78, v79
  v_accvgpr_write_b32 a101, v78
  v_mfma_f32_16x16x32_bf16 v[96:99], v[64:67], a[108:111], v[16:19]
  v_cvt_pk_bf16_f32 v80, v80, v81
  v_accvgpr_write_b32 a102, v80
  v_cvt_pk_bf16_f32 v82, v82, v83
  v_accvgpr_write_b32 a103, v82
  v_mfma_f32_16x16x32_bf16 v[76:79], v[66:69], a[112:115], v[12:15]
  v_cvt_pk_bf16_f32 v84, v84, v85
  v_accvgpr_write_b32 a104, v84
  v_cvt_pk_bf16_f32 v86, v86, v87
  v_accvgpr_write_b32 a105, v86
  v_mfma_f32_16x16x32_bf16 v[80:83], v[64:67], a[112:115], v[12:15]
  v_cvt_pk_bf16_f32 v88, v88, v89
  v_accvgpr_write_b32 a106, v88
  v_cvt_pk_bf16_f32 v90, v90, v91
  v_accvgpr_write_b32 a107, v90
  v_mfma_f32_16x16x32_bf16 v[84:87], v[66:69], a[116:119], v[16:19]
  v_cvt_pk_bf16_f32 v92, v92, v93
  v_accvgpr_write_b32 a108, v92
  v_cvt_pk_bf16_f32 v94, v94, v95
  v_accvgpr_write_b32 a109, v94
  v_mfma_f32_16x16x32_bf16 v[88:91], v[64:67], a[116:119], v[16:19]
  v_cvt_pk_bf16_f32 v96, v96, v97
  v_accvgpr_write_b32 a110, v96
  v_cvt_pk_bf16_f32 v98, v98, v99
  v_accvgpr_write_b32 a111, v98
  buffer_load_dwordx4 v107, s[12:15], s62 offen offset:1024 lds
  v_mfma_f32_16x16x32_bf16 v[92:95], v[66:69], a[120:123], v[12:15]
  v_cvt_pk_bf16_f32 v76, v76, v77
  v_accvgpr_write_b32 a112, v76
  v_cvt_pk_bf16_f32 v78, v78, v79
  v_accvgpr_write_b32 a113, v78
  v_mfma_f32_16x16x32_bf16 v[96:99], v[64:67], a[120:123], v[12:15]
  v_cvt_pk_bf16_f32 v80, v80, v81
  v_accvgpr_write_b32 a114, v80
  v_cvt_pk_bf16_f32 v82, v82, v83
  v_accvgpr_write_b32 a115, v82
  v_mfma_f32_16x16x32_bf16 v[76:79], v[66:69], a[124:127], v[16:19]
  v_cvt_pk_bf16_f32 v84, v84, v85
  v_accvgpr_write_b32 a116, v84
  v_cvt_pk_bf16_f32 v86, v86, v87
  v_accvgpr_write_b32 a117, v86
  v_mfma_f32_16x16x32_bf16 v[80:83], v[64:67], a[124:127], v[16:19]
  v_cvt_pk_bf16_f32 v88, v88, v89
  v_accvgpr_write_b32 a118, v88
  v_cvt_pk_bf16_f32 v90, v90, v91
  v_accvgpr_write_b32 a119, v90
  buffer_load_dwordx4 v106, s[16:19], s62 offen offset:2048 lds
  v_mfma_f32_16x16x32_bf16 v[84:87], v[66:69], a[128:131], v[12:15]
  v_cvt_pk_bf16_f32 v92, v92, v93
  v_accvgpr_write_b32 a120, v92
  v_cvt_pk_bf16_f32 v94, v94, v95
  v_accvgpr_write_b32 a121, v94
  v_mfma_f32_16x16x32_bf16 v[88:91], v[64:67], a[128:131], v[12:15]
  v_cvt_pk_bf16_f32 v96, v96, v97
  v_accvgpr_write_b32 a122, v96
  v_cvt_pk_bf16_f32 v98, v98, v99
  v_accvgpr_write_b32 a123, v98
  v_mfma_f32_16x16x32_bf16 v[92:95], v[66:69], a[132:135], v[16:19]
  v_cvt_pk_bf16_f32 v76, v76, v77
  v_accvgpr_write_b32 a124, v76
  v_cvt_pk_bf16_f32 v78, v78, v79
  v_accvgpr_write_b32 a125, v78
  v_mfma_f32_16x16x32_bf16 v[96:99], v[64:67], a[132:135], v[16:19]
  v_cvt_pk_bf16_f32 v80, v80, v81
  v_accvgpr_write_b32 a126, v80
  v_cvt_pk_bf16_f32 v82, v82, v83
  v_accvgpr_write_b32 a127, v82
  buffer_load_dwordx4 v107, s[16:19], s62 offen offset:3072 lds
  v_mfma_f32_16x16x32_bf16 v[76:79], v[66:69], a[136:139], v[12:15]
  v_cvt_pk_bf16_f32 v84, v84, v85
  v_accvgpr_write_b32 a128, v84
  v_cvt_pk_bf16_f32 v86, v86, v87
  v_accvgpr_write_b32 a129, v86
  v_mfma_f32_16x16x32_bf16 v[80:83], v[64:67], a[136:139], v[12:15]
  v_cvt_pk_bf16_f32 v88, v88, v89
  v_accvgpr_write_b32 a130, v88
  v_cvt_pk_bf16_f32 v90, v90, v91
  v_accvgpr_write_b32 a131, v90
  v_mfma_f32_16x16x32_bf16 v[84:87], v[66:69], a[140:143], v[16:19]
  v_cvt_pk_bf16_f32 v92, v92, v93
  v_accvgpr_write_b32 a132, v92
  v_cvt_pk_bf16_f32 v94, v94, v95
  v_accvgpr_write_b32 a133, v94
  v_mfma_f32_16x16x32_bf16 v[88:91], v[64:67], a[140:143], v[16:19]
  v_cvt_pk_bf16_f32 v96, v96, v97
  v_accvgpr_write_b32 a134, v96
  v_cvt_pk_bf16_f32 v98, v98, v99
  v_accvgpr_write_b32 a135, v98
  s_add_u32 s62, s62, 589824
  buffer_load_dword v109, v3, s[4:7], s83 offen
  v_mfma_f32_16x16x32_bf16 v[92:95], v[66:69], a[144:147], v[12:15]
  v_cvt_pk_bf16_f32 v76, v76, v77
  v_accvgpr_write_b32 a136, v76
  v_cvt_pk_bf16_f32 v78, v78, v79
  v_accvgpr_write_b32 a137, v78
  v_mfma_f32_16x16x32_bf16 v[96:99], v[64:67], a[144:147], v[12:15]
  v_cvt_pk_bf16_f32 v80, v80, v81
  v_accvgpr_write_b32 a138, v80
  v_cvt_pk_bf16_f32 v82, v82, v83
  v_accvgpr_write_b32 a139, v82
  v_mfma_f32_16x16x32_bf16 v[76:79], v[66:69], a[148:151], v[16:19]
  v_cvt_pk_bf16_f32 v84, v84, v85
  v_accvgpr_write_b32 a140, v84
  v_cvt_pk_bf16_f32 v86, v86, v87
  v_accvgpr_write_b32 a141, v86
  v_mfma_f32_16x16x32_bf16 v[80:83], v[64:67], a[148:151], v[16:19]
  v_cvt_pk_bf16_f32 v88, v88, v89
  v_accvgpr_write_b32 a142, v88
  v_cvt_pk_bf16_f32 v90, v90, v91
  v_accvgpr_write_b32 a143, v90
  s_add_u32 s83, s83, 128
  buffer_load_dword v109, v3, s[4:7], s83 offen
  v_mfma_f32_16x16x32_bf16 v[84:87], v[66:69], a[152:155], v[12:15]
  v_cvt_pk_bf16_f32 v92, v92, v93
  v_accvgpr_write_b32 a144, v92
  v_cvt_pk_bf16_f32 v94, v94, v95
  v_accvgpr_write_b32 a145, v94
  v_mfma_f32_16x16x32_bf16 v[88:91], v[64:67], a[152:155], v[12:15]
  v_cvt_pk_bf16_f32 v96, v96, v97
  v_accvgpr_write_b32 a146, v96
  v_cvt_pk_bf16_f32 v98, v98, v99
  v_accvgpr_write_b32 a147, v98
  v_mfma_f32_16x16x32_bf16 v[92:95], v[66:69], a[156:159], v[16:19]
  v_cvt_pk_bf16_f32 v76, v76, v77
  v_accvgpr_write_b32 a148, v76
  v_cvt_pk_bf16_f32 v78, v78, v79
  v_accvgpr_write_b32 a149, v78
  v_mfma_f32_16x16x32_bf16 v[96:99], v[64:67], a[156:159], v[16:19]
  v_cvt_pk_bf16_f32 v80, v80, v81
  v_accvgpr_write_b32 a150, v80
  v_cvt_pk_bf16_f32 v82, v82, v83
  v_accvgpr_write_b32 a151, v82
  v_mfma_f32_16x16x32_bf16 v[76:79], v[66:69], a[160:163], v[12:15]
  v_cvt_pk_bf16_f32 v84, v84, v85
  v_accvgpr_write_b32 a152, v84
  v_cvt_pk_bf16_f32 v86, v86, v87
  v_accvgpr_write_b32 a153, v86
  v_mfma_f32_16x16x32_bf16 v[80:83], v[64:67], a[160:163], v[12:15]
  v_cvt_pk_bf16_f32 v88, v88, v89
  v_accvgpr_write_b32 a154, v88
  v_cvt_pk_bf16_f32 v90, v90, v91
  v_accvgpr_write_b32 a155, v90
  s_add_u32 s83, s83, 128
  v_mfma_f32_16x16x32_bf16 v[84:87], v[66:69], a[164:167], v[16:19]
  v_cvt_pk_bf16_f32 v92, v92, v93
  v_accvgpr_write_b32 a156, v92
  v_cvt_pk_bf16_f32 v94, v94, v95
  v_accvgpr_write_b32 a157, v94
  v_mfma_f32_16x16x32_bf16 v[88:91], v[64:67], a[164:167], v[16:19]
  v_cvt_pk_bf16_f32 v96, v96, v97
  v_accvgpr_write_b32 a158, v96
  v_cvt_pk_bf16_f32 v98, v98, v99
  v_accvgpr_write_b32 a159, v98
  v_mfma_f32_16x16x32_bf16 v[92:95], v[66:69], a[168:171], v[12:15]
  v_cvt_pk_bf16_f32 v76, v76, v77
  v_accvgpr_write_b32 a160, v76
  v_cvt_pk_bf16_f32 v78, v78, v79
  v_accvgpr_write_b32 a161, v78
  v_mfma_f32_16x16x32_bf16 v[96:99], v[64:67], a[168:171], v[12:15]
  v_cvt_pk_bf16_f32 v80, v80, v81
  v_accvgpr_write_b32 a162, v80
  v_cvt_pk_bf16_f32 v82, v82, v83
  v_accvgpr_write_b32 a163, v82
  v_mfma_f32_16x16x32_bf16 v[76:79], v[66:69], a[172:175], v[16:19]
  v_cvt_pk_bf16_f32 v84, v84, v85
  v_accvgpr_write_b32 a164, v84
  v_cvt_pk_bf16_f32 v86, v86, v87
  v_accvgpr_write_b32 a165, v86
  v_mfma_f32_16x16x32_bf16 v[80:83], v[64:67], a[172:175], v[16:19]
  v_cvt_pk_bf16_f32 v88, v88, v89
  v_accvgpr_write_b32 a166, v88
  v_cvt_pk_bf16_f32 v90, v90, v91
  v_accvgpr_write_b32 a167, v90
  v_mfma_f32_16x16x32_bf16 v[84:87], v[66:69], a[176:179], v[12:15]
  v_cvt_pk_bf16_f32 v92, v92, v93
  v_accvgpr_write_b32 a168, v92
  v_cvt_pk_bf16_f32 v94, v94, v95
  v_accvgpr_write_b32 a169, v94
  v_mfma_f32_16x16x32_bf16 v[88:91], v[64:67], a[176:179], v[12:15]
  v_cvt_pk_bf16_f32 v96, v96, v97
  v_accvgpr_write_b32 a170, v96
  v_cvt_pk_bf16_f32 v98, v98, v99
  v_accvgpr_write_b32 a171, v98
  v_mfma_f32_16x16x32_bf16 v[92:95], v[66:69], a[180:183], v[16:19]
  v_cvt_pk_bf16_f32 v76, v76, v77
  v_accvgpr_write_b32 a172, v76
  v_cvt_pk_bf16_f32 v78, v78, v79
  v_accvgpr_write_b32 a173, v78
  v_mfma_f32_16x16x32_bf16 v[96:99], v[64:67], a[180:183], v[16:19]
  v_cvt_pk_bf16_f32 v80, v80, v81
  v_accvgpr_write_b32 a174, v80
  v_cvt_pk_bf16_f32 v82, v82, v83
  v_accvgpr_write_b32 a175, v82
  v_cvt_pk_bf16_f32 v84, v84, v85
  v_accvgpr_write_b32 a176, v84
  v_cvt_pk_bf16_f32 v86, v86, v87
  v_accvgpr_write_b32 a177, v86
  v_cvt_pk_bf16_f32 v88, v88, v89
  v_accvgpr_write_b32 a178, v88
  v_cvt_pk_bf16_f32 v90, v90, v91
  v_accvgpr_write_b32 a179, v90
  v_cvt_pk_bf16_f32 v92, v92, v93
  v_accvgpr_write_b32 a180, v92
  v_cvt_pk_bf16_f32 v94, v94, v95
  v_accvgpr_write_b32 a181, v94
  v_cvt_pk_bf16_f32 v96, v96, v97
  v_accvgpr_write_b32 a182, v96
  v_cvt_pk_bf16_f32 v98, v98, v99
  v_accvgpr_write_b32 a183, v98
  s_waitcnt vmcnt(30)
  v_readfirstlane_b32 s48, v58
  v_readfirstlane_b32 s49, v59
  s_cmp_eq_u32 s48, 0
  s_cbranch_scc1 recurrent_scan__linear_attn_block__glu_gated_bilinear__prompt_kernel_f_nw
recurrent_scan__linear_attn_block__glu_gated_bilinear__prompt_kernel_f_nd:
  s_mov_b32 s38, 5308416
  s_cmp_lt_u32 s65, 1296
  s_cselect_b32 s36, s28, s40
  s_cselect_b32 s37, s29, s41
  s_cselect_b32 s38, s38, 663552
  s_cselect_b32 s67, 0, 1296
  s_sub_u32 s67, s65, s67
  s_mul_i32 s68, s67, 7282
  s_lshr_b32 s68, s68, 16
  s_mul_i32 s39, s68, 35712
  s_lshl_b32 s69, s67, 7
  s_add_u32 s39, s39, s69
  s_mul_i32 s69, s68, 9
  s_sub_u32 s67, s67, s69
  s_lshl_b32 s67, s67, 2
  s_mul_i32 s66, s67, 7282
  s_lshr_b32 s66, s66, 16
  s_mul_i32 s69, s66, 9
  s_sub_u32 s67, s67, s69
  s_sub_u32 s43, 9, s67
  s_mul_i32 s66, s66, 1296
  s_add_u32 s66, s66, s67
  s_mul_i32 s67, s68, 1821
  s_lshr_b32 s67, s67, 16
  s_mul_i32 s67, s67, 36
  s_sub_u32 s68, s68, s67
  s_and_b32 s69, s68, 1
  s_add_u32 s67, s67, s69
  s_lshr_b32 s68, s68, 1
  s_mul_i32 s69, s68, 5
  s_mov_b32 s42, 204490156
  s_cmp_ge_u32 s68, 6
  s_cselect_b32 s42, 343016905, s42
  s_cselect_b32 s90, 30, 0
  s_cmp_ge_u32 s68, 12
  s_cselect_b32 s42, 548672591, s42
  s_cselect_b32 s90, 60, s90
  s_sub_u32 s69, s69, s90
  s_lshr_b32 s42, s42, s69
  s_and_b32 s42, s42, 31
  s_lshl_b32 s42, s42, 1
  s_add_u32 s67, s67, s42
  s_mul_i32 s67, s67, 9
  s_add_u32 s67, s67, s66
  s_lshl_b32 s67, s67, 10
  s_lshl_b32 s68, s65, 12
  s_cmp_lt_u32 s65, 1296
  s_cselect_b32 s67, s67, s68
  s_cselect_b32 s43, s43, 9
  s_add_u32 s42, s67, 25952256
  s_add_u32 s43, s43, 31924224
  s_cmp_lt_u32 s65, 1458
  s_cselect_b32 s38, s38, 0
  s_cselect_b32 s43, s43, 0
  s_add_u32 s65, s65, 768
  s_mov_b32 s46, 5308416
  s_cmp_lt_u32 s65, 1296
  s_cselect_b32 s44, s28, s40
  s_cselect_b32 s45, s29, s41
  s_cselect_b32 s46, s46, 663552
  s_cselect_b32 s67, 0, 1296
  s_sub_u32 s67, s65, s67
  s_mul_i32 s68, s67, 7282
  s_lshr_b32 s68, s68, 16
  s_mul_i32 s47, s68, 35712
  s_lshl_b32 s69, s67, 7
  s_add_u32 s47, s47, s69
  s_mul_i32 s69, s68, 9
  s_sub_u32 s67, s67, s69
  s_lshl_b32 s67, s67, 2
  s_mul_i32 s66, s67, 7282
  s_lshr_b32 s66, s66, 16
  s_mul_i32 s69, s66, 9
  s_sub_u32 s67, s67, s69
  s_sub_u32 s51, 9, s67
  s_mul_i32 s66, s66, 1296
  s_add_u32 s66, s66, s67
  s_mul_i32 s67, s68, 1821
  s_lshr_b32 s67, s67, 16
  s_mul_i32 s67, s67, 36
  s_sub_u32 s68, s68, s67
  s_and_b32 s69, s68, 1
  s_add_u32 s67, s67, s69
  s_lshr_b32 s68, s68, 1
  s_mul_i32 s69, s68, 5
  s_mov_b32 s50, 204490156
  s_cmp_ge_u32 s68, 6
  s_cselect_b32 s50, 343016905, s50
  s_cselect_b32 s90, 30, 0
  s_cmp_ge_u32 s68, 12
  s_cselect_b32 s50, 548672591, s50
  s_cselect_b32 s90, 60, s90
  s_sub_u32 s69, s69, s90
  s_lshr_b32 s50, s50, s69
  s_and_b32 s50, s50, 31
  s_lshl_b32 s50, s50, 1
  s_add_u32 s67, s67, s50
  s_mul_i32 s67, s67, 9
  s_add_u32 s67, s67, s66
  s_lshl_b32 s67, s67, 10
  s_lshl_b32 s68, s65, 12
  s_cmp_lt_u32 s65, 1296
  s_cselect_b32 s67, s67, s68
  s_cselect_b32 s51, s51, 9
  s_add_u32 s50, s67, 25952256
  s_add_u32 s51, s51, 31924224
  s_cmp_lt_u32 s65, 1458
  s_cselect_b32 s46, s46, 0
  s_cselect_b32 s51, s51, 0
  s_mov_b32 s28, s36
  s_mov_b32 s29, s37
  s_mov_b32 s30, s38
  buffer_load_dword v109, v118, s[28:31], s39 offen
  s_branch recurrent_scan__linear_attn_block__glu_gated_bilinear__prompt_kernel_hdr
recurrent_scan__linear_attn_block__glu_gated_bilinear__prompt_kernel_q:
  v_mov_b32 v74, 0
  global_load_dwordx2 v[58:59], v74, s[52:53] sc1
  v_mfma_f32_16x16x32_bf16 v[76:79], v[66:69], v[128:131], v[4:7]
  v_mfma_f32_16x16x32_bf16 v[80:83], v[64:67], v[128:131], v[4:7]
  v_cndmask_b32 v72, v20, v21, s[86:87]
  s_add_u32 m0, s82, 73728
  s_nop 0
  buffer_load_dwordx4 v52, s[8:11], s74 offen lds
  v_mfma_f32_16x16x32_bf16 v[84:87], v[66:69], v[132:135], v[8:11]
  v_mfma_f32_16x16x32_bf16 v[88:91], v[64:67], v[132:135], v[8:11]
  v_cndmask_b32 v72, v72, v22, s[88:89]
  buffer_load_dwordx4 v53, s[8:11], s74 offen offset:1024 lds
  v_mfma_f32_16x16x32_bf16 v[92:95], v[66:69], v[136:139], v[4:7]
  v_cvt_pk_bf16_f32 v128, v76, v77
  v_cvt_pk_bf16_f32 v129, v78, v79
  v_mfma_f32_16x16x32_bf16 v[96:99], v[64:67], v[136:139], v[4:7]
  v_cvt_pk_bf16_f32 v130, v80, v81
  v_cvt_pk_bf16_f32 v131, v82, v83
  v_cndmask_b32 v72, v72, v23, s[90:91]
  v_mfma_f32_16x16x32_bf16 v[76:79], v[66:69], v[140:143], v[8:11]
  v_cvt_pk_bf16_f32 v132, v84, v85
  v_cvt_pk_bf16_f32 v133, v86, v87
  v_mfma_f32_16x16x32_bf16 v[80:83], v[64:67], v[140:143], v[8:11]
  v_cvt_pk_bf16_f32 v134, v88, v89
  v_cvt_pk_bf16_f32 v135, v90, v91
  v_cndmask_b32 v72, 0, v72, s[84:85]
  s_add_u32 s74, s74, 221184
  s_add_u32 m0, s82, 81920
  s_nop 0
  buffer_load_dwordx4 v52, s[8:11], s74 offen lds
  v_mfma_f32_16x16x32_bf16 v[84:87], v[66:69], v[144:147], v[4:7]
  v_cvt_pk_bf16_f32 v136, v92, v93
  v_cvt_pk_bf16_f32 v137, v94, v95
  v_mfma_f32_16x16x32_bf16 v[88:91], v[64:67], v[144:147], v[4:7]
  v_cvt_pk_bf16_f32 v138, v96, v97
  v_cvt_pk_bf16_f32 v139, v98, v99
  v_cndmask_b32 v73, v24, v25, s[86:87]
  v_mfma_f32_16x16x32_bf16 v[92:95], v[66:69], v[148:151], v[8:11]
  v_cvt_pk_bf16_f32 v140, v76, v77
  v_cvt_pk_bf16_f32 v141, v78, v79
  v_mfma_f32_16x16x32_bf16 v[96:99], v[64:67], v[148:151], v[8:11]
  v_cvt_pk_bf16_f32 v142, v80, v81
  v_cvt_pk_bf16_f32 v143, v82, v83
  v_cndmask_b32 v73, v73, v26, s[88:89]
  buffer_load_dwordx4 v53, s[8:11], s74 offen offset:1024 lds
  v_mfma_f32_16x16x32_bf16 v[76:79], v[66:69], v[152:155], v[4:7]
  v_cvt_pk_bf16_f32 v144, v84, v85
  v_cvt_pk_bf16_f32 v145, v86, v87
  v_mfma_f32_16x16x32_bf16 v[80:83], v[64:67], v[152:155], v[4:7]
  v_cvt_pk_bf16_f32 v146, v88, v89
  v_cvt_pk_bf16_f32 v147, v90, v91
  v_cndmask_b32 v73, v73, v27, s[90:91]
  v_mfma_f32_16x16x32_bf16 v[84:87], v[66:69], v[156:159], v[8:11]
  v_cvt_pk_bf16_f32 v148, v92, v93
  v_cvt_pk_bf16_f32 v149, v94, v95
  v_mfma_f32_16x16x32_bf16 v[88:91], v[64:67], v[156:159], v[8:11]
  v_cvt_pk_bf16_f32 v150, v96, v97
  v_cvt_pk_bf16_f32 v151, v98, v99
  v_cndmask_b32 v73, 0, v73, s[84:85]
  s_add_u32 s74, s74, 221184
  s_add_u32 m0, s82, 90112
  s_nop 0
  buffer_load_dwordx4 v52, s[8:11], s74 offen lds
  v_mfma_f32_16x16x32_bf16 v[92:95], v[66:69], v[160:163], v[4:7]
  v_cvt_pk_bf16_f32 v152, v76, v77
  v_cvt_pk_bf16_f32 v153, v78, v79
  v_mfma_f32_16x16x32_bf16 v[96:99], v[64:67], v[160:163], v[4:7]
  v_cvt_pk_bf16_f32 v154, v80, v81
  v_cvt_pk_bf16_f32 v155, v82, v83
  v_mfma_f32_16x16x32_bf16 v[76:79], v[66:69], v[164:167], v[8:11]
  v_cvt_pk_bf16_f32 v156, v84, v85
  v_cvt_pk_bf16_f32 v157, v86, v87
  v_mfma_f32_16x16x32_bf16 v[80:83], v[64:67], v[164:167], v[8:11]
  v_cvt_pk_bf16_f32 v158, v88, v89
  v_cvt_pk_bf16_f32 v159, v90, v91
  v_mfma_f32_16x16x4_f32 v[20:23], v70, v72, 0
  buffer_load_dwordx4 v53, s[8:11], s74 offen offset:1024 lds
  v_mfma_f32_16x16x32_bf16 v[84:87], v[66:69], v[168:171], v[4:7]
  v_cvt_pk_bf16_f32 v160, v92, v93
  v_cvt_pk_bf16_f32 v161, v94, v95
  v_mfma_f32_16x16x32_bf16 v[88:91], v[64:67], v[168:171], v[4:7]
  v_cvt_pk_bf16_f32 v162, v96, v97
  v_cvt_pk_bf16_f32 v163, v98, v99
  v_mfma_f32_16x16x4_f32 v[24:27], v70, v73, 0
  v_mfma_f32_16x16x32_bf16 v[92:95], v[66:69], v[172:175], v[8:11]
  v_cvt_pk_bf16_f32 v164, v76, v77
  v_cvt_pk_bf16_f32 v165, v78, v79
  v_mfma_f32_16x16x32_bf16 v[96:99], v[64:67], v[172:175], v[8:11]
  v_cvt_pk_bf16_f32 v166, v80, v81
  v_cvt_pk_bf16_f32 v167, v82, v83
  v_mul_f32 v72, v4, v4
  s_add_u32 s74, s74, 221184
  s_add_u32 m0, s82, 98304
  s_nop 0
  buffer_load_dwordx4 v52, s[8:11], s74 offen lds
  v_mfma_f32_16x16x32_bf16 v[76:79], v[66:69], v[176:179], v[4:7]
  v_cvt_pk_bf16_f32 v168, v84, v85
  v_cvt_pk_bf16_f32 v169, v86, v87
  v_mfma_f32_16x16x32_bf16 v[80:83], v[64:67], v[176:179], v[4:7]
  v_cvt_pk_bf16_f32 v170, v88, v89
  v_cvt_pk_bf16_f32 v171, v90, v91
  v_mul_f32 v73, v8, v8
  buffer_load_dwordx4 v53, s[8:11], s74 offen offset:1024 lds
  v_mfma_f32_16x16x32_bf16 v[84:87], v[66:69], v[180:183], v[8:11]
  v_cvt_pk_bf16_f32 v172, v92, v93
  v_cvt_pk_bf16_f32 v173, v94, v95
  v_mfma_f32_16x16x32_bf16 v[88:91], v[64:67], v[180:183], v[8:11]
  v_cvt_pk_bf16_f32 v174, v96, v97
  v_cvt_pk_bf16_f32 v175, v98, v99
  s_mov_b32 s67, 0x3ae38e39
  v_mfma_f32_16x16x32_bf16 v[92:95], v[66:69], v[184:187], v[4:7]
  v_cvt_pk_bf16_f32 v176, v76, v77
  v_cvt_pk_bf16_f32 v177, v78, v79
  v_mfma_f32_16x16x32_bf16 v[96:99], v[64:67], v[184:187], v[4:7]
  v_cvt_pk_bf16_f32 v178, v80, v81
  v_cvt_pk_bf16_f32 v179, v82, v83
  s_add_u32 s74, s74, 221184
  s_add_u32 m0, s82, 106496
  s_nop 0
  buffer_load_dwordx4 v52, s[8:11], s74 offen lds
  v_mfma_f32_16x16x32_bf16 v[76:79], v[66:69], v[188:191], v[8:11]
  v_cvt_pk_bf16_f32 v180, v84, v85
  v_cvt_pk_bf16_f32 v181, v86, v87
  v_mfma_f32_16x16x32_bf16 v[80:83], v[64:67], v[188:191], v[8:11]
  v_cvt_pk_bf16_f32 v182, v88, v89
  v_cvt_pk_bf16_f32 v183, v90, v91
  v_fma_f32 v72, v20, s67, -v72
  v_mfma_f32_16x16x32_bf16 v[84:87], v[66:69], v[192:195], v[4:7]
  v_cvt_pk_bf16_f32 v184, v92, v93
  v_cvt_pk_bf16_f32 v185, v94, v95
  v_mfma_f32_16x16x32_bf16 v[88:91], v[64:67], v[192:195], v[4:7]
  v_cvt_pk_bf16_f32 v186, v96, v97
  v_cvt_pk_bf16_f32 v187, v98, v99
  v_max_f32 v72, 0, v72
  buffer_load_dwordx4 v53, s[8:11], s74 offen offset:1024 lds
  v_mfma_f32_16x16x32_bf16 v[92:95], v[66:69], v[196:199], v[8:11]
  v_cvt_pk_bf16_f32 v188, v76, v77
  v_cvt_pk_bf16_f32 v189, v78, v79
  v_mfma_f32_16x16x32_bf16 v[96:99], v[64:67], v[196:199], v[8:11]
  v_cvt_pk_bf16_f32 v190, v80, v81
  v_cvt_pk_bf16_f32 v191, v82, v83
  v_add_f32 v72, 0x3727c5ac, v72
  v_mfma_f32_16x16x32_bf16 v[76:79], v[66:69], v[200:203], v[4:7]
  v_cvt_pk_bf16_f32 v192, v84, v85
  v_cvt_pk_bf16_f32 v193, v86, v87
  v_mfma_f32_16x16x32_bf16 v[80:83], v[64:67], v[200:203], v[4:7]
  v_cvt_pk_bf16_f32 v194, v88, v89
  v_cvt_pk_bf16_f32 v195, v90, v91
  v_rsq_f32 v110, v72
  s_add_u32 s74, s74, 221184
  s_add_u32 m0, s82, 114688
  s_nop 0
  buffer_load_dwordx4 v52, s[8:11], s74 offen lds
  v_mfma_f32_16x16x32_bf16 v[84:87], v[66:69], v[204:207], v[8:11]
  v_cvt_pk_bf16_f32 v196, v92, v93
  v_cvt_pk_bf16_f32 v197, v94, v95
  v_mfma_f32_16x16x32_bf16 v[88:91], v[64:67], v[204:207], v[8:11]
  v_cvt_pk_bf16_f32 v198, v96, v97
  v_cvt_pk_bf16_f32 v199, v98, v99
  v_rcp_f32 v114, v72
  v_mfma_f32_16x16x32_bf16 v[92:95], v[66:69], v[208:211], v[4:7]
  v_cvt_pk_bf16_f32 v200, v76, v77
  v_cvt_pk_bf16_f32 v201, v78, v79
  v_mfma_f32_16x16x32_bf16 v[96:99], v[64:67], v[208:211], v[4:7]
  v_cvt_pk_bf16_f32 v202, v80, v81
  v_cvt_pk_bf16_f32 v203, v82, v83
  v_fma_f32 v73, v24, s67, -v73
  buffer_load_dwordx4 v53, s[8:11], s74 offen offset:1024 lds
  v_mfma_f32_16x16x32_bf16 v[76:79], v[66:69], v[212:215], v[8:11]
  v_cvt_pk_bf16_f32 v204, v84, v85
  v_cvt_pk_bf16_f32 v205, v86, v87
  v_mfma_f32_16x16x32_bf16 v[80:83], v[64:67], v[212:215], v[8:11]
  v_cvt_pk_bf16_f32 v206, v88, v89
  v_cvt_pk_bf16_f32 v207, v90, v91
  v_max_f32 v73, 0, v73
  v_mfma_f32_16x16x32_bf16 v[84:87], v[66:69], v[216:219], v[4:7]
  v_cvt_pk_bf16_f32 v208, v92, v93
  v_cvt_pk_bf16_f32 v209, v94, v95
  v_mfma_f32_16x16x32_bf16 v[88:91], v[64:67], v[216:219], v[4:7]
  v_cvt_pk_bf16_f32 v210, v96, v97
  v_cvt_pk_bf16_f32 v211, v98, v99
  v_add_f32 v73, 0x3727c5ac, v73
  s_add_u32 s74, s74, 221184
  s_add_u32 m0, s82, 122880
  s_nop 0
  buffer_load_dwordx4 v52, s[8:11], s74 offen lds
  v_mfma_f32_16x16x32_bf16 v[92:95], v[66:69], v[220:223], v[8:11]
  v_cvt_pk_bf16_f32 v212, v76, v77
  v_cvt_pk_bf16_f32 v213, v78, v79
  v_mfma_f32_16x16x32_bf16 v[96:99], v[64:67], v[220:223], v[8:11]
  v_cvt_pk_bf16_f32 v214, v80, v81
  v_cvt_pk_bf16_f32 v215, v82, v83
  v_rsq_f32 v111, v73
  buffer_load_dwordx4 v53, s[8:11], s74 offen offset:1024 lds
  v_mfma_f32_16x16x32_bf16 v[76:79], v[66:69], v[224:227], v[4:7]
  v_cvt_pk_bf16_f32 v216, v84, v85
  v_cvt_pk_bf16_f32 v217, v86, v87
  v_mfma_f32_16x16x32_bf16 v[80:83], v[64:67], v[224:227], v[4:7]
  v_cvt_pk_bf16_f32 v218, v88, v89
  v_cvt_pk_bf16_f32 v219, v90, v91
  v_rcp_f32 v115, v73
  v_mfma_f32_16x16x32_bf16 v[84:87], v[66:69], v[228:231], v[8:11]
  v_cvt_pk_bf16_f32 v220, v92, v93
  v_cvt_pk_bf16_f32 v221, v94, v95
  v_mfma_f32_16x16x32_bf16 v[88:91], v[64:67], v[228:231], v[8:11]
  v_cvt_pk_bf16_f32 v222, v96, v97
  v_cvt_pk_bf16_f32 v223, v98, v99
  ds_write_b64 v50, v[110:111] offset:2048
  s_add_u32 s74, s74, 221184
  s_add_u32 m0, s82, 131072
  s_nop 0
  buffer_load_dwordx4 v52, s[8:11], s74 offen lds
  v_mfma_f32_16x16x32_bf16 v[92:95], v[66:69], v[232:235], v[4:7]
  v_cvt_pk_bf16_f32 v224, v76, v77
  v_cvt_pk_bf16_f32 v225, v78, v79
  v_mfma_f32_16x16x32_bf16 v[96:99], v[64:67], v[232:235], v[4:7]
  v_cvt_pk_bf16_f32 v226, v80, v81
  v_cvt_pk_bf16_f32 v227, v82, v83
  ds_write_b64 v50, v[114:115] offset:2056
  v_mfma_f32_16x16x32_bf16 v[76:79], v[66:69], v[236:239], v[8:11]
  v_cvt_pk_bf16_f32 v228, v84, v85
  v_cvt_pk_bf16_f32 v229, v86, v87
  v_mfma_f32_16x16x32_bf16 v[80:83], v[64:67], v[236:239], v[8:11]
  v_cvt_pk_bf16_f32 v230, v88, v89
  v_cvt_pk_bf16_f32 v231, v90, v91
  buffer_load_dwordx4 v53, s[8:11], s74 offen offset:1024 lds
  v_mfma_f32_16x16x32_bf16 v[84:87], v[66:69], v[240:243], v[4:7]
  v_cvt_pk_bf16_f32 v232, v92, v93
  v_cvt_pk_bf16_f32 v233, v94, v95
  v_mfma_f32_16x16x32_bf16 v[88:91], v[64:67], v[240:243], v[4:7]
  v_cvt_pk_bf16_f32 v234, v96, v97
  v_cvt_pk_bf16_f32 v235, v98, v99
  v_mfma_f32_16x16x32_bf16 v[92:95], v[66:69], v[244:247], v[8:11]
  v_cvt_pk_bf16_f32 v236, v76, v77
  v_cvt_pk_bf16_f32 v237, v78, v79
  v_mfma_f32_16x16x32_bf16 v[96:99], v[64:67], v[244:247], v[8:11]
  v_cvt_pk_bf16_f32 v238, v80, v81
  v_cvt_pk_bf16_f32 v239, v82, v83
  s_add_u32 s74, s74, 221184
  s_add_u32 m0, s82, 139264
  s_nop 0
  buffer_load_dwordx4 v52, s[8:11], s74 offen lds
  v_mfma_f32_16x16x32_bf16 v[76:79], v[66:69], v[248:251], v[4:7]
  v_cvt_pk_bf16_f32 v240, v84, v85
  v_cvt_pk_bf16_f32 v241, v86, v87
  v_mfma_f32_16x16x32_bf16 v[80:83], v[64:67], v[248:251], v[4:7]
  v_cvt_pk_bf16_f32 v242, v88, v89
  v_cvt_pk_bf16_f32 v243, v90, v91
  s_waitcnt lgkmcnt(0)
  s_barrier
  v_mfma_f32_16x16x32_bf16 v[84:87], v[66:69], v[252:255], v[8:11]
  v_cvt_pk_bf16_f32 v244, v92, v93
  v_cvt_pk_bf16_f32 v245, v94, v95
  v_mfma_f32_16x16x32_bf16 v[88:91], v[64:67], v[252:255], v[8:11]
  v_cvt_pk_bf16_f32 v246, v96, v97
  v_cvt_pk_bf16_f32 v247, v98, v99
  ds_read_b64 v[112:113], v51 offset:2048
  buffer_load_dwordx4 v53, s[8:11], s74 offen offset:1024 lds
  v_mfma_f32_16x16x32_bf16 v[92:95], v[66:69], a[24:27], v[4:7]
  v_cvt_pk_bf16_f32 v248, v76, v77
  v_cvt_pk_bf16_f32 v249, v78, v79
  v_mfma_f32_16x16x32_bf16 v[96:99], v[64:67], a[24:27], v[4:7]
  v_cvt_pk_bf16_f32 v250, v80, v81
  v_cvt_pk_bf16_f32 v251, v82, v83
  ds_read_b64 v[116:117], v51 offset:2056
  v_mfma_f32_16x16x32_bf16 v[76:79], v[66:69], a[28:31], v[8:11]
  v_cvt_pk_bf16_f32 v252, v84, v85
  v_cvt_pk_bf16_f32 v253, v86, v87
  v_mfma_f32_16x16x32_bf16 v[80:83], v[64:67], a[28:31], v[8:11]
  v_cvt_pk_bf16_f32 v254, v88, v89
  v_cvt_pk_bf16_f32 v255, v90, v91
  s_add_u32 s74, s74, 221184
  s_add_u32 m0, s64, 0
  s_nop 0
  buffer_load_dwordx4 v106, s[12:15], s62 offen lds
  v_mfma_f32_16x16x32_bf16 v[84:87], v[66:69], a[32:35], v[4:7]
  v_cvt_pk_bf16_f32 v92, v92, v93
  v_accvgpr_write_b32 a24, v92
  v_cvt_pk_bf16_f32 v94, v94, v95
  v_accvgpr_write_b32 a25, v94
  v_mfma_f32_16x16x32_bf16 v[88:91], v[64:67], a[32:35], v[4:7]
  v_cvt_pk_bf16_f32 v96, v96, v97
  v_accvgpr_write_b32 a26, v96
  v_cvt_pk_bf16_f32 v98, v98, v99
  v_accvgpr_write_b32 a27, v98
  buffer_load_dwordx4 v107, s[12:15], s62 offen offset:1024 lds
  v_mfma_f32_16x16x32_bf16 v[92:95], v[66:69], a[36:39], v[8:11]
  v_cvt_pk_bf16_f32 v76, v76, v77
  v_accvgpr_write_b32 a28, v76
  v_cvt_pk_bf16_f32 v78, v78, v79
  v_accvgpr_write_b32 a29, v78
  v_mfma_f32_16x16x32_bf16 v[96:99], v[64:67], a[36:39], v[8:11]
  v_cvt_pk_bf16_f32 v80, v80, v81
  v_accvgpr_write_b32 a30, v80
  v_cvt_pk_bf16_f32 v82, v82, v83
  v_accvgpr_write_b32 a31, v82
  v_mfma_f32_16x16x32_bf16 v[76:79], v[66:69], a[40:43], v[12:15]
  v_cvt_pk_bf16_f32 v84, v84, v85
  v_accvgpr_write_b32 a32, v84
  v_cvt_pk_bf16_f32 v86, v86, v87
  v_accvgpr_write_b32 a33, v86
  v_mfma_f32_16x16x32_bf16 v[80:83], v[64:67], a[40:43], v[12:15]
  v_cvt_pk_bf16_f32 v88, v88, v89
  v_accvgpr_write_b32 a34, v88
  v_cvt_pk_bf16_f32 v90, v90, v91
  v_accvgpr_write_b32 a35, v90
  buffer_load_dwordx4 v106, s[16:19], s62 offen offset:2048 lds
  v_mfma_f32_16x16x32_bf16 v[84:87], v[66:69], a[44:47], v[16:19]
  v_cvt_pk_bf16_f32 v92, v92, v93
  v_accvgpr_write_b32 a36, v92
  v_cvt_pk_bf16_f32 v94, v94, v95
  v_accvgpr_write_b32 a37, v94
  v_mfma_f32_16x16x32_bf16 v[88:91], v[64:67], a[44:47], v[16:19]
  v_cvt_pk_bf16_f32 v96, v96, v97
  v_accvgpr_write_b32 a38, v96
  v_cvt_pk_bf16_f32 v98, v98, v99
  v_accvgpr_write_b32 a39, v98
  v_mfma_f32_16x16x32_bf16 v[92:95], v[66:69], a[48:51], v[12:15]
  v_cvt_pk_bf16_f32 v76, v76, v77
  v_accvgpr_write_b32 a40, v76
  v_cvt_pk_bf16_f32 v78, v78, v79
  v_accvgpr_write_b32 a41, v78
  v_mfma_f32_16x16x32_bf16 v[96:99], v[64:67], a[48:51], v[12:15]
  v_cvt_pk_bf16_f32 v80, v80, v81
  v_accvgpr_write_b32 a42, v80
  v_cvt_pk_bf16_f32 v82, v82, v83
  v_accvgpr_write_b32 a43, v82
  buffer_load_dwordx4 v107, s[16:19], s62 offen offset:3072 lds
  v_mfma_f32_16x16x32_bf16 v[76:79], v[66:69], a[52:55], v[16:19]
  v_cvt_pk_bf16_f32 v84, v84, v85
  v_accvgpr_write_b32 a44, v84
  v_cvt_pk_bf16_f32 v86, v86, v87
  v_accvgpr_write_b32 a45, v86
  v_mfma_f32_16x16x32_bf16 v[80:83], v[64:67], a[52:55], v[16:19]
  v_cvt_pk_bf16_f32 v88, v88, v89
  v_accvgpr_write_b32 a46, v88
  v_cvt_pk_bf16_f32 v90, v90, v91
  v_accvgpr_write_b32 a47, v90
  v_mfma_f32_16x16x32_bf16 v[84:87], v[66:69], a[56:59], v[12:15]
  v_cvt_pk_bf16_f32 v92, v92, v93
  v_accvgpr_write_b32 a48, v92
  v_cvt_pk_bf16_f32 v94, v94, v95
  v_accvgpr_write_b32 a49, v94
  v_mfma_f32_16x16x32_bf16 v[88:91], v[64:67], a[56:59], v[12:15]
  v_cvt_pk_bf16_f32 v96, v96, v97
  v_accvgpr_write_b32 a50, v96
  v_cvt_pk_bf16_f32 v98, v98, v99
  v_accvgpr_write_b32 a51, v98
  s_add_u32 s62, s62, 589824
  s_add_u32 m0, s64, 16384
  s_nop 0
  buffer_load_dwordx4 v106, s[12:15], s62 offen lds
  v_mfma_f32_16x16x32_bf16 v[92:95], v[66:69], a[60:63], v[16:19]
  v_cvt_pk_bf16_f32 v76, v76, v77
  v_accvgpr_write_b32 a52, v76
  v_cvt_pk_bf16_f32 v78, v78, v79
  v_accvgpr_write_b32 a53, v78
  v_mfma_f32_16x16x32_bf16 v[96:99], v[64:67], a[60:63], v[16:19]
  v_cvt_pk_bf16_f32 v80, v80, v81
  v_accvgpr_write_b32 a54, v80
  v_cvt_pk_bf16_f32 v82, v82, v83
  v_accvgpr_write_b32 a55, v82
  v_mfma_f32_16x16x32_bf16 v[76:79], v[66:69], a[64:67], v[12:15]
  v_cvt_pk_bf16_f32 v84, v84, v85
  v_accvgpr_write_b32 a56, v84
  v_cvt_pk_bf16_f32 v86, v86, v87
  v_accvgpr_write_b32 a57, v86
  v_mfma_f32_16x16x32_bf16 v[80:83], v[64:67], a[64:67], v[12:15]
  v_cvt_pk_bf16_f32 v88, v88, v89
  v_accvgpr_write_b32 a58, v88
  v_cvt_pk_bf16_f32 v90, v90, v91
  v_accvgpr_write_b32 a59, v90
  buffer_load_dwordx4 v107, s[12:15], s62 offen offset:1024 lds
  v_mfma_f32_16x16x32_bf16 v[84:87], v[66:69], a[68:71], v[16:19]
  v_cvt_pk_bf16_f32 v92, v92, v93
  v_accvgpr_write_b32 a60, v92
  v_cvt_pk_bf16_f32 v94, v94, v95
  v_accvgpr_write_b32 a61, v94
  v_mfma_f32_16x16x32_bf16 v[88:91], v[64:67], a[68:71], v[16:19]
  v_cvt_pk_bf16_f32 v96, v96, v97
  v_accvgpr_write_b32 a62, v96
  v_cvt_pk_bf16_f32 v98, v98, v99
  v_accvgpr_write_b32 a63, v98
  v_mfma_f32_16x16x32_bf16 v[92:95], v[66:69], a[72:75], v[12:15]
  v_cvt_pk_bf16_f32 v76, v76, v77
  v_accvgpr_write_b32 a64, v76
  v_cvt_pk_bf16_f32 v78, v78, v79
  v_accvgpr_write_b32 a65, v78
  v_mfma_f32_16x16x32_bf16 v[96:99], v[64:67], a[72:75], v[12:15]
  v_cvt_pk_bf16_f32 v80, v80, v81
  v_accvgpr_write_b32 a66, v80
  v_cvt_pk_bf16_f32 v82, v82, v83
  v_accvgpr_write_b32 a67, v82
  buffer_load_dwordx4 v106, s[16:19], s62 offen offset:2048 lds
  v_mfma_f32_16x16x32_bf16 v[76:79], v[66:69], a[76:79], v[16:19]
  v_cvt_pk_bf16_f32 v84, v84, v85
  v_accvgpr_write_b32 a68, v84
  v_cvt_pk_bf16_f32 v86, v86, v87
  v_accvgpr_write_b32 a69, v86
  v_mfma_f32_16x16x32_bf16 v[80:83], v[64:67], a[76:79], v[16:19]
  v_cvt_pk_bf16_f32 v88, v88, v89
  v_accvgpr_write_b32 a70, v88
  v_cvt_pk_bf16_f32 v90, v90, v91
  v_accvgpr_write_b32 a71, v90
  buffer_load_dwordx4 v107, s[16:19], s62 offen offset:3072 lds
  v_mfma_f32_16x16x32_bf16 v[84:87], v[66:69], a[80:83], v[12:15]
  v_cvt_pk_bf16_f32 v92, v92, v93
  v_accvgpr_write_b32 a72, v92
  v_cvt_pk_bf16_f32 v94, v94, v95
  v_accvgpr_write_b32 a73, v94
  v_mfma_f32_16x16x32_bf16 v[88:91], v[64:67], a[80:83], v[12:15]
  v_cvt_pk_bf16_f32 v96, v96, v97
  v_accvgpr_write_b32 a74, v96
  v_cvt_pk_bf16_f32 v98, v98, v99
  v_accvgpr_write_b32 a75, v98
  v_mfma_f32_16x16x32_bf16 v[92:95], v[66:69], a[84:87], v[16:19]
  v_cvt_pk_bf16_f32 v76, v76, v77
  v_accvgpr_write_b32 a76, v76
  v_cvt_pk_bf16_f32 v78, v78, v79
  v_accvgpr_write_b32 a77, v78
  v_mfma_f32_16x16x32_bf16 v[96:99], v[64:67], a[84:87], v[16:19]
  v_cvt_pk_bf16_f32 v80, v80, v81
  v_accvgpr_write_b32 a78, v80
  v_cvt_pk_bf16_f32 v82, v82, v83
  v_accvgpr_write_b32 a79, v82
  s_add_u32 s62, s62, 589824
  s_add_u32 m0, s64, 32768
  s_nop 0
  buffer_load_dwordx4 v106, s[12:15], s62 offen lds
  v_mfma_f32_16x16x32_bf16 v[76:79], v[66:69], a[88:91], v[12:15]
  v_cvt_pk_bf16_f32 v84, v84, v85
  v_accvgpr_write_b32 a80, v84
  v_cvt_pk_bf16_f32 v86, v86, v87
  v_accvgpr_write_b32 a81, v86
  v_mfma_f32_16x16x32_bf16 v[80:83], v[64:67], a[88:91], v[12:15]
  v_cvt_pk_bf16_f32 v88, v88, v89
  v_accvgpr_write_b32 a82, v88
  v_cvt_pk_bf16_f32 v90, v90, v91
  v_accvgpr_write_b32 a83, v90
  v_mfma_f32_16x16x32_bf16 v[84:87], v[66:69], a[92:95], v[16:19]
  v_cvt_pk_bf16_f32 v92, v92, v93
  v_accvgpr_write_b32 a84, v92
  v_cvt_pk_bf16_f32 v94, v94, v95
  v_accvgpr_write_b32 a85, v94
  v_mfma_f32_16x16x32_bf16 v[88:91], v[64:67], a[92:95], v[16:19]
  v_cvt_pk_bf16_f32 v96, v96, v97
  v_accvgpr_write_b32 a86, v96
  v_cvt_pk_bf16_f32 v98, v98, v99
  v_accvgpr_write_b32 a87, v98
  buffer_load_dwordx4 v107, s[12:15], s62 offen offset:1024 lds
  v_mfma_f32_16x16x32_bf16 v[92:95], v[66:69], a[96:99], v[12:15]
  v_cvt_pk_bf16_f32 v76, v76, v77
  v_accvgpr_write_b32 a88, v76
  v_cvt_pk_bf16_f32 v78, v78, v79
  v_accvgpr_write_b32 a89, v78
  v_mfma_f32_16x16x32_bf16 v[96:99], v[64:67], a[96:99], v[12:15]
  v_cvt_pk_bf16_f32 v80, v80, v81
  v_accvgpr_write_b32 a90, v80
  v_cvt_pk_bf16_f32 v82, v82, v83
  v_accvgpr_write_b32 a91, v82
  v_mfma_f32_16x16x32_bf16 v[76:79], v[66:69], a[100:103], v[16:19]
  v_cvt_pk_bf16_f32 v84, v84, v85
  v_accvgpr_write_b32 a92, v84
  v_cvt_pk_bf16_f32 v86, v86, v87
  v_accvgpr_write_b32 a93, v86
  v_mfma_f32_16x16x32_bf16 v[80:83], v[64:67], a[100:103], v[16:19]
  v_cvt_pk_bf16_f32 v88, v88, v89
  v_accvgpr_write_b32 a94, v88
  v_cvt_pk_bf16_f32 v90, v90, v91
  v_accvgpr_write_b32 a95, v90
  buffer_load_dwordx4 v106, s[16:19], s62 offen offset:2048 lds
  v_mfma_f32_16x16x32_bf16 v[84:87], v[66:69], a[104:107], v[12:15]
  v_cvt_pk_bf16_f32 v92, v92, v93
  v_accvgpr_write_b32 a96, v92
  v_cvt_pk_bf16_f32 v94, v94, v95
  v_accvgpr_write_b32 a97, v94
  v_mfma_f32_16x16x32_bf16 v[88:91], v[64:67], a[104:107], v[12:15]
  v_cvt_pk_bf16_f32 v96, v96, v97
  v_accvgpr_write_b32 a98, v96
  v_cvt_pk_bf16_f32 v98, v98, v99
  v_accvgpr_write_b32 a99, v98
  v_mfma_f32_16x16x32_bf16 v[92:95], v[66:69], a[108:111], v[16:19]
  v_cvt_pk_bf16_f32 v76, v76, v77
  v_accvgpr_write_b32 a100, v76
  v_cvt_pk_bf16_f32 v78, v78, v79
  v_accvgpr_write_b32 a101, v78
  v_mfma_f32_16x16x32_bf16 v[96:99], v[64:67], a[108:111], v[16:19]
  v_cvt_pk_bf16_f32 v80, v80, v81
  v_accvgpr_write_b32 a102, v80
  v_cvt_pk_bf16_f32 v82, v82, v83
  v_accvgpr_write_b32 a103, v82
  buffer_load_dwordx4 v107, s[16:19], s62 offen offset:3072 lds
  v_mfma_f32_16x16x32_bf16 v[76:79], v[66:69], a[112:115], v[12:15]
  v_cvt_pk_bf16_f32 v84, v84, v85
  v_accvgpr_write_b32 a104, v84
  v_cvt_pk_bf16_f32 v86, v86, v87
  v_accvgpr_write_b32 a105, v86
  v_mfma_f32_16x16x32_bf16 v[80:83], v[64:67], a[112:115], v[12:15]
  v_cvt_pk_bf16_f32 v88, v88, v89
  v_accvgpr_write_b32 a106, v88
  v_cvt_pk_bf16_f32 v90, v90, v91
  v_accvgpr_write_b32 a107, v90
  v_mfma_f32_16x16x32_bf16 v[84:87], v[66:69], a[116:119], v[16:19]
  v_cvt_pk_bf16_f32 v92, v92, v93
  v_accvgpr_write_b32 a108, v92
  v_cvt_pk_bf16_f32 v94, v94, v95
  v_accvgpr_write_b32 a109, v94
  v_mfma_f32_16x16x32_bf16 v[88:91], v[64:67], a[116:119], v[16:19]
  v_cvt_pk_bf16_f32 v96, v96, v97
  v_accvgpr_write_b32 a110, v96
  v_cvt_pk_bf16_f32 v98, v98, v99
  v_accvgpr_write_b32 a111, v98
  s_add_u32 s62, s62, 589824
  s_add_u32 m0, s64, 49152
  s_nop 0
  buffer_load_dwordx4 v106, s[12:15], s62 offen lds
  v_mfma_f32_16x16x32_bf16 v[92:95], v[66:69], a[120:123], v[12:15]
  v_cvt_pk_bf16_f32 v76, v76, v77
  v_accvgpr_write_b32 a112, v76
  v_cvt_pk_bf16_f32 v78, v78, v79
  v_accvgpr_write_b32 a113, v78
  v_mfma_f32_16x16x32_bf16 v[96:99], v[64:67], a[120:123], v[12:15]
  v_cvt_pk_bf16_f32 v80, v80, v81
  v_accvgpr_write_b32 a114, v80
  v_cvt_pk_bf16_f32 v82, v82, v83
  v_accvgpr_write_b32 a115, v82
  buffer_load_dwordx4 v107, s[12:15], s62 offen offset:1024 lds
  v_mfma_f32_16x16x32_bf16 v[76:79], v[66:69], a[124:127], v[16:19]
  v_cvt_pk_bf16_f32 v84, v84, v85
  v_accvgpr_write_b32 a116, v84
  v_cvt_pk_bf16_f32 v86, v86, v87
  v_accvgpr_write_b32 a117, v86
  v_mfma_f32_16x16x32_bf16 v[80:83], v[64:67], a[124:127], v[16:19]
  v_cvt_pk_bf16_f32 v88, v88, v89
  v_accvgpr_write_b32 a118, v88
  v_cvt_pk_bf16_f32 v90, v90, v91
  v_accvgpr_write_b32 a119, v90
  v_mfma_f32_16x16x32_bf16 v[84:87], v[66:69], a[128:131], v[12:15]
  v_cvt_pk_bf16_f32 v92, v92, v93
  v_accvgpr_write_b32 a120, v92
  v_cvt_pk_bf16_f32 v94, v94, v95
  v_accvgpr_write_b32 a121, v94
  v_mfma_f32_16x16x32_bf16 v[88:91], v[64:67], a[128:131], v[12:15]
  v_cvt_pk_bf16_f32 v96, v96, v97
  v_accvgpr_write_b32 a122, v96
  v_cvt_pk_bf16_f32 v98, v98, v99
  v_accvgpr_write_b32 a123, v98
  buffer_load_dwordx4 v106, s[16:19], s62 offen offset:2048 lds
  v_mfma_f32_16x16x32_bf16 v[92:95], v[66:69], a[132:135], v[16:19]
  v_cvt_pk_bf16_f32 v76, v76, v77
  v_accvgpr_write_b32 a124, v76
  v_cvt_pk_bf16_f32 v78, v78, v79
  v_accvgpr_write_b32 a125, v78
  v_mfma_f32_16x16x32_bf16 v[96:99], v[64:67], a[132:135], v[16:19]
  v_cvt_pk_bf16_f32 v80, v80, v81
  v_accvgpr_write_b32 a126, v80
  v_cvt_pk_bf16_f32 v82, v82, v83
  v_accvgpr_write_b32 a127, v82
  v_mfma_f32_16x16x32_bf16 v[76:79], v[66:69], a[136:139], v[12:15]
  v_cvt_pk_bf16_f32 v84, v84, v85
  v_accvgpr_write_b32 a128, v84
  v_cvt_pk_bf16_f32 v86, v86, v87
  v_accvgpr_write_b32 a129, v86
  v_mfma_f32_16x16x32_bf16 v[80:83], v[64:67], a[136:139], v[12:15]
  v_cvt_pk_bf16_f32 v88, v88, v89
  v_accvgpr_write_b32 a130, v88
  v_cvt_pk_bf16_f32 v90, v90, v91
  v_accvgpr_write_b32 a131, v90
  buffer_load_dwordx4 v107, s[16:19], s62 offen offset:3072 lds
  v_mfma_f32_16x16x32_bf16 v[84:87], v[66:69], a[140:143], v[16:19]
  v_cvt_pk_bf16_f32 v92, v92, v93
  v_accvgpr_write_b32 a132, v92
  v_cvt_pk_bf16_f32 v94, v94, v95
  v_accvgpr_write_b32 a133, v94
  v_mfma_f32_16x16x32_bf16 v[88:91], v[64:67], a[140:143], v[16:19]
  v_cvt_pk_bf16_f32 v96, v96, v97
  v_accvgpr_write_b32 a134, v96
  v_cvt_pk_bf16_f32 v98, v98, v99
  v_accvgpr_write_b32 a135, v98
  v_mfma_f32_16x16x32_bf16 v[92:95], v[66:69], a[144:147], v[12:15]
  v_cvt_pk_bf16_f32 v76, v76, v77
  v_accvgpr_write_b32 a136, v76
  v_cvt_pk_bf16_f32 v78, v78, v79
  v_accvgpr_write_b32 a137, v78
  v_mfma_f32_16x16x32_bf16 v[96:99], v[64:67], a[144:147], v[12:15]
  v_cvt_pk_bf16_f32 v80, v80, v81
  v_accvgpr_write_b32 a138, v80
  v_cvt_pk_bf16_f32 v82, v82, v83
  v_accvgpr_write_b32 a139, v82
  s_add_u32 s62, s62, 589824
  buffer_load_dword v109, v3, s[4:7], s83 offen
  v_mfma_f32_16x16x32_bf16 v[76:79], v[66:69], a[148:151], v[16:19]
  v_cvt_pk_bf16_f32 v84, v84, v85
  v_accvgpr_write_b32 a140, v84
  v_cvt_pk_bf16_f32 v86, v86, v87
  v_accvgpr_write_b32 a141, v86
  v_mfma_f32_16x16x32_bf16 v[80:83], v[64:67], a[148:151], v[16:19]
  v_cvt_pk_bf16_f32 v88, v88, v89
  v_accvgpr_write_b32 a142, v88
  v_cvt_pk_bf16_f32 v90, v90, v91
  v_accvgpr_write_b32 a143, v90
  v_mfma_f32_16x16x32_bf16 v[84:87], v[66:69], a[152:155], v[12:15]
  v_cvt_pk_bf16_f32 v92, v92, v93
  v_accvgpr_write_b32 a144, v92
  v_cvt_pk_bf16_f32 v94, v94, v95
  v_accvgpr_write_b32 a145, v94
  v_mfma_f32_16x16x32_bf16 v[88:91], v[64:67], a[152:155], v[12:15]
  v_cvt_pk_bf16_f32 v96, v96, v97
  v_accvgpr_write_b32 a146, v96
  v_cvt_pk_bf16_f32 v98, v98, v99
  v_accvgpr_write_b32 a147, v98
  s_add_u32 s83, s83, 128
  buffer_load_dword v109, v3, s[4:7], s83 offen
  v_mfma_f32_16x16x32_bf16 v[92:95], v[66:69], a[156:159], v[16:19]
  v_cvt_pk_bf16_f32 v76, v76, v77
  v_accvgpr_write_b32 a148, v76
  v_cvt_pk_bf16_f32 v78, v78, v79
  v_accvgpr_write_b32 a149, v78
  v_mfma_f32_16x16x32_bf16 v[96:99], v[64:67], a[156:159], v[16:19]
  v_cvt_pk_bf16_f32 v80, v80, v81
  v_accvgpr_write_b32 a150, v80
  v_cvt_pk_bf16_f32 v82, v82, v83
  v_accvgpr_write_b32 a151, v82
  v_mfma_f32_16x16x32_bf16 v[76:79], v[66:69], a[160:163], v[12:15]
  v_cvt_pk_bf16_f32 v84, v84, v85
  v_accvgpr_write_b32 a152, v84
  v_cvt_pk_bf16_f32 v86, v86, v87
  v_accvgpr_write_b32 a153, v86
  v_mfma_f32_16x16x32_bf16 v[80:83], v[64:67], a[160:163], v[12:15]
  v_cvt_pk_bf16_f32 v88, v88, v89
  v_accvgpr_write_b32 a154, v88
  v_cvt_pk_bf16_f32 v90, v90, v91
  v_accvgpr_write_b32 a155, v90
  s_add_u32 s83, s83, 128
  v_mfma_f32_16x16x32_bf16 v[84:87], v[66:69], a[164:167], v[16:19]
  v_cvt_pk_bf16_f32 v92, v92, v93
  v_accvgpr_write_b32 a156, v92
  v_cvt_pk_bf16_f32 v94, v94, v95
  v_accvgpr_write_b32 a157, v94
  v_mfma_f32_16x16x32_bf16 v[88:91], v[64:67], a[164:167], v[16:19]
  v_cvt_pk_bf16_f32 v96, v96, v97
  v_accvgpr_write_b32 a158, v96
  v_cvt_pk_bf16_f32 v98, v98, v99
  v_accvgpr_write_b32 a159, v98
  v_mfma_f32_16x16x32_bf16 v[92:95], v[66:69], a[168:171], v[12:15]
  v_cvt_pk_bf16_f32 v76, v76, v77
  v_accvgpr_write_b32 a160, v76
  v_cvt_pk_bf16_f32 v78, v78, v79
  v_accvgpr_write_b32 a161, v78
  v_mfma_f32_16x16x32_bf16 v[96:99], v[64:67], a[168:171], v[12:15]
  v_cvt_pk_bf16_f32 v80, v80, v81
  v_accvgpr_write_b32 a162, v80
  v_cvt_pk_bf16_f32 v82, v82, v83
  v_accvgpr_write_b32 a163, v82
  v_mfma_f32_16x16x32_bf16 v[76:79], v[66:69], a[172:175], v[16:19]
  v_cvt_pk_bf16_f32 v84, v84, v85
  v_accvgpr_write_b32 a164, v84
  v_cvt_pk_bf16_f32 v86, v86, v87
  v_accvgpr_write_b32 a165, v86
  v_mfma_f32_16x16x32_bf16 v[80:83], v[64:67], a[172:175], v[16:19]
  v_cvt_pk_bf16_f32 v88, v88, v89
  v_accvgpr_write_b32 a166, v88
  v_cvt_pk_bf16_f32 v90, v90, v91
  v_accvgpr_write_b32 a167, v90
  v_mfma_f32_16x16x32_bf16 v[84:87], v[66:69], a[176:179], v[12:15]
  v_cvt_pk_bf16_f32 v92, v92, v93
  v_accvgpr_write_b32 a168, v92
  v_cvt_pk_bf16_f32 v94, v94, v95
  v_accvgpr_write_b32 a169, v94
  v_mfma_f32_16x16x32_bf16 v[88:91], v[64:67], a[176:179], v[12:15]
  v_cvt_pk_bf16_f32 v96, v96, v97
  v_accvgpr_write_b32 a170, v96
  v_cvt_pk_bf16_f32 v98, v98, v99
  v_accvgpr_write_b32 a171, v98
  v_mfma_f32_16x16x32_bf16 v[92:95], v[66:69], a[180:183], v[16:19]
  v_cvt_pk_bf16_f32 v76, v76, v77
  v_accvgpr_write_b32 a172, v76
  v_cvt_pk_bf16_f32 v78, v78, v79
  v_accvgpr_write_b32 a173, v78
  v_mfma_f32_16x16x32_bf16 v[96:99], v[64:67], a[180:183], v[16:19]
  v_cvt_pk_bf16_f32 v80, v80, v81
  v_accvgpr_write_b32 a174, v80
  v_cvt_pk_bf16_f32 v82, v82, v83
  v_accvgpr_write_b32 a175, v82
  v_cvt_pk_bf16_f32 v84, v84, v85
  v_accvgpr_write_b32 a176, v84
  v_cvt_pk_bf16_f32 v86, v86, v87
  v_accvgpr_write_b32 a177, v86
  v_cvt_pk_bf16_f32 v88, v88, v89
  v_accvgpr_write_b32 a178, v88
  v_cvt_pk_bf16_f32 v90, v90, v91
  v_accvgpr_write_b32 a179, v90
  v_cvt_pk_bf16_f32 v92, v92, v93
  v_accvgpr_write_b32 a180, v92
  v_cvt_pk_bf16_f32 v94, v94, v95
  v_accvgpr_write_b32 a181, v94
  v_cvt_pk_bf16_f32 v96, v96, v97
  v_accvgpr_write_b32 a182, v96
  v_cvt_pk_bf16_f32 v98, v98, v99
  v_accvgpr_write_b32 a183, v98
  s_waitcnt vmcnt(36)
  v_readfirstlane_b32 s48, v58
  v_readfirstlane_b32 s49, v59
  s_cmp_eq_u32 s48, 0
  s_cbranch_scc1 recurrent_scan__linear_attn_block__glu_gated_bilinear__prompt_kernel_qq_nw
recurrent_scan__linear_attn_block__glu_gated_bilinear__prompt_kernel_qq_nd:
  v_lshrrev_b32 v6, 5, v0
  v_and_b32 v6, 1, v6
  v_lshlrev_b32 v6, 11, v6
  v_subrev_u32 v6, 73728, v6
  v_sub_u32 v4, v100, v6
  v_sub_u32 v5, v101, v6
  s_waitcnt vmcnt(18)
  s_barrier
  ds_read_b64_tr_b16 a[0:1], v4 offset:0
  ds_read_b64_tr_b16 a[2:3], v4 offset:512
  ds_read_b64_tr_b16 a[4:5], v4 offset:4096
  ds_read_b64_tr_b16 a[6:7], v4 offset:4608
  ds_read_b64_tr_b16 a[8:9], v5 offset:0
  ds_read_b64_tr_b16 a[10:11], v5 offset:512
  ds_read_b64_tr_b16 a[12:13], v5 offset:4096
  ds_read_b64_tr_b16 a[14:15], v5 offset:4608
  s_waitcnt lgkmcnt(4)
  v_mfma_f32_16x16x32_bf16 v[68:71], a[0:3], v[128:131], 0
  ds_read_b64_tr_b16 a[16:17], v4 offset:8192
  s_mov_b32 s38, 5308416
  v_mfma_f32_16x16x32_bf16 v[68:71], a[4:7], v[136:139], v[68:71]
  s_cmp_lt_u32 s65, 1296
  s_cselect_b32 s36, s28, s40
  s_cselect_b32 s37, s29, s41
  s_cselect_b32 s38, s38, 663552
  s_cselect_b32 s67, 0, 1296
  s_sub_u32 s67, s65, s67
  v_mfma_f32_16x16x32_bf16 v[72:75], a[0:3], v[132:135], 0
  ds_read_b64_tr_b16 a[18:19], v4 offset:8704
  s_mul_i32 s68, s67, 7282
  v_mfma_f32_16x16x32_bf16 v[72:75], a[4:7], v[140:143], v[72:75]
  s_lshr_b32 s68, s68, 16
  s_mul_i32 s39, s68, 35712
  v_mfma_f32_16x16x32_bf16 v[76:79], a[0:3], a[40:43], 0
  ds_read_b64_tr_b16 a[20:21], v4 offset:12288
  s_lshl_b32 s69, s67, 7
  v_mfma_f32_16x16x32_bf16 v[76:79], a[4:7], a[48:51], v[76:79]
  s_add_u32 s39, s39, s69
  v_mfma_f32_16x16x32_bf16 v[80:83], a[0:3], a[44:47], 0
  ds_read_b64_tr_b16 a[22:23], v4 offset:12800
  v_mfma_f32_16x16x32_bf16 v[80:83], a[4:7], a[52:55], v[80:83]
  s_waitcnt lgkmcnt(4)
  v_mfma_f32_16x16x32_bf16 v[84:87], a[8:11], v[128:131], 0
  ds_read_b64_tr_b16 a[0:1], v5 offset:8192
  s_mul_i32 s69, s68, 9
  v_mfma_f32_16x16x32_bf16 v[84:87], a[12:15], v[136:139], v[84:87]
  s_sub_u32 s67, s67, s69
  s_lshl_b32 s67, s67, 2
  v_mfma_f32_16x16x32_bf16 v[88:91], a[8:11], v[132:135], 0
  ds_read_b64_tr_b16 a[2:3], v5 offset:8704
  s_mul_i32 s66, s67, 7282
  v_mfma_f32_16x16x32_bf16 v[88:91], a[12:15], v[140:143], v[88:91]
  s_lshr_b32 s66, s66, 16
  s_mul_i32 s69, s66, 9
  v_mfma_f32_16x16x32_bf16 v[92:95], a[8:11], a[40:43], 0
  ds_read_b64_tr_b16 a[4:5], v5 offset:12288
  s_sub_u32 s67, s67, s69
  v_mfma_f32_16x16x32_bf16 v[92:95], a[12:15], a[48:51], v[92:95]
  s_sub_u32 s43, 9, s67
  v_mfma_f32_16x16x32_bf16 v[96:99], a[8:11], a[44:47], 0
  ds_read_b64_tr_b16 a[6:7], v5 offset:12800
  v_mfma_f32_16x16x32_bf16 v[96:99], a[12:15], a[52:55], v[96:99]
  s_waitcnt lgkmcnt(4)
  s_barrier
  v_mfma_f32_16x16x32_bf16 v[68:71], a[16:19], v[144:147], v[68:71]
  ds_read_b64_tr_b16 a[8:9], v4 offset:16384
  s_add_u32 m0, s64, 65536
  v_mfma_f32_16x16x32_bf16 v[68:71], a[20:23], v[152:155], v[68:71]
  buffer_load_dwordx4 v106, s[12:15], s62 offen lds
  v_mfma_f32_16x16x32_bf16 v[72:75], a[16:19], v[148:151], v[72:75]
  ds_read_b64_tr_b16 a[10:11], v4 offset:16896
  v_mfma_f32_16x16x32_bf16 v[72:75], a[20:23], v[156:159], v[72:75]
  buffer_load_dwordx4 v107, s[12:15], s62 offen offset:1024 lds
  v_mfma_f32_16x16x32_bf16 v[76:79], a[16:19], a[56:59], v[76:79]
  ds_read_b64_tr_b16 a[12:13], v4 offset:20480
  v_mfma_f32_16x16x32_bf16 v[76:79], a[20:23], a[64:67], v[76:79]
  buffer_load_dwordx4 v106, s[16:19], s62 offen offset:2048 lds
  v_mfma_f32_16x16x32_bf16 v[80:83], a[16:19], a[60:63], v[80:83]
  ds_read_b64_tr_b16 a[14:15], v4 offset:20992
  v_mfma_f32_16x16x32_bf16 v[80:83], a[20:23], a[68:71], v[80:83]
  buffer_load_dwordx4 v107, s[16:19], s62 offen offset:3072 lds
  s_add_u32 s62, s62, 589824
  s_waitcnt lgkmcnt(4)
  v_mfma_f32_16x16x32_bf16 v[84:87], a[0:3], v[144:147], v[84:87]
  ds_read_b64_tr_b16 a[16:17], v5 offset:16384
  s_mul_i32 s66, s66, 1296
  v_mfma_f32_16x16x32_bf16 v[84:87], a[4:7], v[152:155], v[84:87]
  s_add_u32 s66, s66, s67
  s_mul_i32 s67, s68, 1821
  v_mfma_f32_16x16x32_bf16 v[88:91], a[0:3], v[148:151], v[88:91]
  ds_read_b64_tr_b16 a[18:19], v5 offset:16896
  s_lshr_b32 s67, s67, 16
  v_mfma_f32_16x16x32_bf16 v[88:91], a[4:7], v[156:159], v[88:91]
  s_mul_i32 s67, s67, 36
  s_sub_u32 s68, s68, s67
  v_mfma_f32_16x16x32_bf16 v[92:95], a[0:3], a[56:59], v[92:95]
  ds_read_b64_tr_b16 a[20:21], v5 offset:20480
  s_and_b32 s69, s68, 1
  v_mfma_f32_16x16x32_bf16 v[92:95], a[4:7], a[64:67], v[92:95]
  s_add_u32 s67, s67, s69
  v_mfma_f32_16x16x32_bf16 v[96:99], a[0:3], a[60:63], v[96:99]
  ds_read_b64_tr_b16 a[22:23], v5 offset:20992
  v_mfma_f32_16x16x32_bf16 v[96:99], a[4:7], a[68:71], v[96:99]
  s_waitcnt lgkmcnt(4)
  v_mfma_f32_16x16x32_bf16 v[68:71], a[8:11], v[160:163], v[68:71]
  ds_read_b64_tr_b16 a[0:1], v4 offset:24576
  s_lshr_b32 s68, s68, 1
  v_mfma_f32_16x16x32_bf16 v[68:71], a[12:15], v[168:171], v[68:71]
  s_mul_i32 s69, s68, 5
  s_mov_b32 s42, 204490156
  v_mfma_f32_16x16x32_bf16 v[72:75], a[8:11], v[164:167], v[72:75]
  ds_read_b64_tr_b16 a[2:3], v4 offset:25088
  s_cmp_ge_u32 s68, 6
  s_cselect_b32 s42, 343016905, s42
  s_cselect_b32 s90, 30, 0
  v_mfma_f32_16x16x32_bf16 v[72:75], a[12:15], v[172:175], v[72:75]
  s_cmp_ge_u32 s68, 12
  s_cselect_b32 s42, 548672591, s42
  s_cselect_b32 s90, 60, s90
  s_sub_u32 s69, s69, s90
  v_mfma_f32_16x16x32_bf16 v[76:79], a[8:11], a[72:75], v[76:79]
  ds_read_b64_tr_b16 a[4:5], v4 offset:28672
  s_lshr_b32 s42, s42, s69
  v_mfma_f32_16x16x32_bf16 v[76:79], a[12:15], a[80:83], v[76:79]
  s_and_b32 s42, s42, 31
  v_mfma_f32_16x16x32_bf16 v[80:83], a[8:11], a[76:79], v[80:83]
  ds_read_b64_tr_b16 a[6:7], v4 offset:29184
  v_mfma_f32_16x16x32_bf16 v[80:83], a[12:15], a[84:87], v[80:83]
  s_waitcnt lgkmcnt(4)
  v_mfma_f32_16x16x32_bf16 v[84:87], a[16:19], v[160:163], v[84:87]
  ds_read_b64_tr_b16 a[8:9], v5 offset:24576
  s_lshl_b32 s42, s42, 1
  v_mfma_f32_16x16x32_bf16 v[84:87], a[20:23], v[168:171], v[84:87]
  s_add_u32 s67, s67, s42
  s_mul_i32 s67, s67, 9
  v_mfma_f32_16x16x32_bf16 v[88:91], a[16:19], v[164:167], v[88:91]
  ds_read_b64_tr_b16 a[10:11], v5 offset:25088
  s_add_u32 s67, s67, s66
  v_mfma_f32_16x16x32_bf16 v[88:91], a[20:23], v[172:175], v[88:91]
  s_lshl_b32 s67, s67, 10
  s_lshl_b32 s68, s65, 12
  v_mfma_f32_16x16x32_bf16 v[92:95], a[16:19], a[72:75], v[92:95]
  ds_read_b64_tr_b16 a[12:13], v5 offset:28672
  s_cmp_lt_u32 s65, 1296
  s_cselect_b32 s67, s67, s68
  s_cselect_b32 s43, s43, 9
  v_mfma_f32_16x16x32_bf16 v[92:95], a[20:23], a[80:83], v[92:95]
  s_add_u32 s42, s67, 25952256
  v_mfma_f32_16x16x32_bf16 v[96:99], a[16:19], a[76:79], v[96:99]
  ds_read_b64_tr_b16 a[14:15], v5 offset:29184
  v_mfma_f32_16x16x32_bf16 v[96:99], a[20:23], a[84:87], v[96:99]
  s_waitcnt lgkmcnt(4)
  s_barrier
  v_add_u32 v4, 32768, v4
  v_add_u32 v5, 32768, v5
  v_mfma_f32_16x16x32_bf16 v[68:71], a[0:3], v[176:179], v[68:71]
  ds_read_b64_tr_b16 a[16:17], v4 offset:0
  s_add_u32 m0, s64, 81920
  v_mfma_f32_16x16x32_bf16 v[68:71], a[4:7], v[184:187], v[68:71]
  buffer_load_dwordx4 v106, s[12:15], s62 offen lds
  v_mfma_f32_16x16x32_bf16 v[72:75], a[0:3], v[180:183], v[72:75]
  ds_read_b64_tr_b16 a[18:19], v4 offset:512
  v_mfma_f32_16x16x32_bf16 v[72:75], a[4:7], v[188:191], v[72:75]
  buffer_load_dwordx4 v107, s[12:15], s62 offen offset:1024 lds
  v_mfma_f32_16x16x32_bf16 v[76:79], a[0:3], a[88:91], v[76:79]
  ds_read_b64_tr_b16 a[20:21], v4 offset:4096
  v_mfma_f32_16x16x32_bf16 v[76:79], a[4:7], a[96:99], v[76:79]
  buffer_load_dwordx4 v106, s[16:19], s62 offen offset:2048 lds
  v_mfma_f32_16x16x32_bf16 v[80:83], a[0:3], a[92:95], v[80:83]
  ds_read_b64_tr_b16 a[22:23], v4 offset:4608
  v_mfma_f32_16x16x32_bf16 v[80:83], a[4:7], a[100:103], v[80:83]
  buffer_load_dwordx4 v107, s[16:19], s62 offen offset:3072 lds
  s_add_u32 s62, s62, 589824
  s_waitcnt lgkmcnt(4)
  v_mfma_f32_16x16x32_bf16 v[84:87], a[8:11], v[176:179], v[84:87]
  ds_read_b64_tr_b16 a[0:1], v5 offset:0
  s_add_u32 s43, s43, 31924224
  v_mfma_f32_16x16x32_bf16 v[84:87], a[12:15], v[184:187], v[84:87]
  s_cmp_lt_u32 s65, 1458
  s_cselect_b32 s38, s38, 0
  s_cselect_b32 s43, s43, 0
  s_add_u32 s65, s65, 768
  v_mfma_f32_16x16x32_bf16 v[88:91], a[8:11], v[180:183], v[88:91]
  ds_read_b64_tr_b16 a[2:3], v5 offset:512
  s_mov_b32 s46, 5308416
  v_mfma_f32_16x16x32_bf16 v[88:91], a[12:15], v[188:191], v[88:91]
  s_cmp_lt_u32 s65, 1296
  s_cselect_b32 s44, s28, s40
  s_cselect_b32 s45, s29, s41
  s_cselect_b32 s46, s46, 663552
  s_cselect_b32 s67, 0, 1296
  s_sub_u32 s67, s65, s67
  v_mfma_f32_16x16x32_bf16 v[92:95], a[8:11], a[88:91], v[92:95]
  ds_read_b64_tr_b16 a[4:5], v5 offset:4096
  s_mul_i32 s68, s67, 7282
  v_mfma_f32_16x16x32_bf16 v[92:95], a[12:15], a[96:99], v[92:95]
  s_lshr_b32 s68, s68, 16
  v_mfma_f32_16x16x32_bf16 v[96:99], a[8:11], a[92:95], v[96:99]
  ds_read_b64_tr_b16 a[6:7], v5 offset:4608
  v_mfma_f32_16x16x32_bf16 v[96:99], a[12:15], a[100:103], v[96:99]
  s_waitcnt lgkmcnt(4)
  v_mfma_f32_16x16x32_bf16 v[68:71], a[16:19], v[192:195], v[68:71]
  ds_read_b64_tr_b16 a[8:9], v4 offset:8192
  s_mul_i32 s47, s68, 35712
  v_mfma_f32_16x16x32_bf16 v[68:71], a[20:23], v[200:203], v[68:71]
  s_lshl_b32 s69, s67, 7
  s_add_u32 s47, s47, s69
  v_mfma_f32_16x16x32_bf16 v[72:75], a[16:19], v[196:199], v[72:75]
  ds_read_b64_tr_b16 a[10:11], v4 offset:8704
  s_mul_i32 s69, s68, 9
  v_mfma_f32_16x16x32_bf16 v[72:75], a[20:23], v[204:207], v[72:75]
  s_sub_u32 s67, s67, s69
  s_lshl_b32 s67, s67, 2
  v_mfma_f32_16x16x32_bf16 v[76:79], a[16:19], a[104:107], v[76:79]
  ds_read_b64_tr_b16 a[12:13], v4 offset:12288
  s_mul_i32 s66, s67, 7282
  v_mfma_f32_16x16x32_bf16 v[76:79], a[20:23], a[112:115], v[76:79]
  s_lshr_b32 s66, s66, 16
  v_mfma_f32_16x16x32_bf16 v[80:83], a[16:19], a[108:111], v[80:83]
  ds_read_b64_tr_b16 a[14:15], v4 offset:12800
  v_mfma_f32_16x16x32_bf16 v[80:83], a[20:23], a[116:119], v[80:83]
  s_waitcnt lgkmcnt(4)
  v_mfma_f32_16x16x32_bf16 v[84:87], a[0:3], v[192:195], v[84:87]
  ds_read_b64_tr_b16 a[16:17], v5 offset:8192
  s_mul_i32 s69, s66, 9
  v_mfma_f32_16x16x32_bf16 v[84:87], a[4:7], v[200:203], v[84:87]
  s_sub_u32 s67, s67, s69
  s_sub_u32 s51, 9, s67
  v_mfma_f32_16x16x32_bf16 v[88:91], a[0:3], v[196:199], v[88:91]
  ds_read_b64_tr_b16 a[18:19], v5 offset:8704
  s_mul_i32 s66, s66, 1296
  v_mfma_f32_16x16x32_bf16 v[88:91], a[4:7], v[204:207], v[88:91]
  s_add_u32 s66, s66, s67
  s_mul_i32 s67, s68, 1821
  v_mfma_f32_16x16x32_bf16 v[92:95], a[0:3], a[104:107], v[92:95]
  ds_read_b64_tr_b16 a[20:21], v5 offset:12288
  s_lshr_b32 s67, s67, 16
  v_mfma_f32_16x16x32_bf16 v[92:95], a[4:7], a[112:115], v[92:95]
  s_mul_i32 s67, s67, 36
  v_mfma_f32_16x16x32_bf16 v[96:99], a[0:3], a[108:111], v[96:99]
  ds_read_b64_tr_b16 a[22:23], v5 offset:12800
  v_mfma_f32_16x16x32_bf16 v[96:99], a[4:7], a[116:119], v[96:99]
  s_waitcnt lgkmcnt(4)
  s_barrier
  v_mfma_f32_16x16x32_bf16 v[68:71], a[8:11], v[208:211], v[68:71]
  ds_read_b64_tr_b16 a[0:1], v4 offset:16384
  s_add_u32 m0, s64, 98304
  v_mfma_f32_16x16x32_bf16 v[68:71], a[12:15], v[216:219], v[68:71]
  buffer_load_dwordx4 v106, s[12:15], s62 offen lds
  v_mfma_f32_16x16x32_bf16 v[72:75], a[8:11], v[212:215], v[72:75]
  ds_read_b64_tr_b16 a[2:3], v4 offset:16896
  v_mfma_f32_16x16x32_bf16 v[72:75], a[12:15], v[220:223], v[72:75]
  buffer_load_dwordx4 v107, s[12:15], s62 offen offset:1024 lds
  v_mfma_f32_16x16x32_bf16 v[76:79], a[8:11], a[120:123], v[76:79]
  ds_read_b64_tr_b16 a[4:5], v4 offset:20480
  v_mfma_f32_16x16x32_bf16 v[76:79], a[12:15], a[128:131], v[76:79]
  buffer_load_dwordx4 v106, s[16:19], s62 offen offset:2048 lds
  v_mfma_f32_16x16x32_bf16 v[80:83], a[8:11], a[124:127], v[80:83]
  ds_read_b64_tr_b16 a[6:7], v4 offset:20992
  v_mfma_f32_16x16x32_bf16 v[80:83], a[12:15], a[132:135], v[80:83]
  buffer_load_dwordx4 v107, s[16:19], s62 offen offset:3072 lds
  s_add_u32 s62, s62, 589824
  s_waitcnt lgkmcnt(4)
  v_mfma_f32_16x16x32_bf16 v[84:87], a[16:19], v[208:211], v[84:87]
  ds_read_b64_tr_b16 a[8:9], v5 offset:16384
  s_sub_u32 s68, s68, s67
  v_mfma_f32_16x16x32_bf16 v[84:87], a[20:23], v[216:219], v[84:87]
  s_and_b32 s69, s68, 1
  s_add_u32 s67, s67, s69
  v_mfma_f32_16x16x32_bf16 v[88:91], a[16:19], v[212:215], v[88:91]
  ds_read_b64_tr_b16 a[10:11], v5 offset:16896
  s_lshr_b32 s68, s68, 1
  v_mfma_f32_16x16x32_bf16 v[88:91], a[20:23], v[220:223], v[88:91]
  s_mul_i32 s69, s68, 5
  s_mov_b32 s50, 204490156
  v_mfma_f32_16x16x32_bf16 v[92:95], a[16:19], a[120:123], v[92:95]
  ds_read_b64_tr_b16 a[12:13], v5 offset:20480
  s_cmp_ge_u32 s68, 6
  s_cselect_b32 s50, 343016905, s50
  s_cselect_b32 s90, 30, 0
  v_mfma_f32_16x16x32_bf16 v[92:95], a[20:23], a[128:131], v[92:95]
  s_cmp_ge_u32 s68, 12
  s_cselect_b32 s50, 548672591, s50
  s_cselect_b32 s90, 60, s90
  v_mfma_f32_16x16x32_bf16 v[96:99], a[16:19], a[124:127], v[96:99]
  ds_read_b64_tr_b16 a[14:15], v5 offset:20992
  v_mfma_f32_16x16x32_bf16 v[96:99], a[20:23], a[132:135], v[96:99]
  s_waitcnt lgkmcnt(4)
  v_mfma_f32_16x16x32_bf16 v[68:71], a[0:3], v[224:227], v[68:71]
  ds_read_b64_tr_b16 a[16:17], v4 offset:24576
  s_sub_u32 s69, s69, s90
  v_mfma_f32_16x16x32_bf16 v[68:71], a[4:7], v[232:235], v[68:71]
  s_lshr_b32 s50, s50, s69
  s_and_b32 s50, s50, 31
  v_mfma_f32_16x16x32_bf16 v[72:75], a[0:3], v[228:231], v[72:75]
  ds_read_b64_tr_b16 a[18:19], v4 offset:25088
  s_lshl_b32 s50, s50, 1
  v_mfma_f32_16x16x32_bf16 v[72:75], a[4:7], v[236:239], v[72:75]
  s_add_u32 s67, s67, s50
  s_mul_i32 s67, s67, 9
  v_mfma_f32_16x16x32_bf16 v[76:79], a[0:3], a[136:139], v[76:79]
  ds_read_b64_tr_b16 a[20:21], v4 offset:28672
  s_add_u32 s67, s67, s66
  v_mfma_f32_16x16x32_bf16 v[76:79], a[4:7], a[144:147], v[76:79]
  s_lshl_b32 s67, s67, 10
  v_mfma_f32_16x16x32_bf16 v[80:83], a[0:3], a[140:143], v[80:83]
  ds_read_b64_tr_b16 a[22:23], v4 offset:29184
  v_mfma_f32_16x16x32_bf16 v[80:83], a[4:7], a[148:151], v[80:83]
  s_waitcnt lgkmcnt(4)
  v_mfma_f32_16x16x32_bf16 v[84:87], a[8:11], v[224:227], v[84:87]
  ds_read_b64_tr_b16 a[0:1], v5 offset:24576
  s_lshl_b32 s68, s65, 12
  v_mfma_f32_16x16x32_bf16 v[84:87], a[12:15], v[232:235], v[84:87]
  s_cmp_lt_u32 s65, 1296
  s_cselect_b32 s67, s67, s68
  s_cselect_b32 s51, s51, 9
  s_add_u32 s50, s67, 25952256
  v_mfma_f32_16x16x32_bf16 v[88:91], a[8:11], v[228:231], v[88:91]
  ds_read_b64_tr_b16 a[2:3], v5 offset:25088
  s_add_u32 s51, s51, 31924224
  v_mfma_f32_16x16x32_bf16 v[88:91], a[12:15], v[236:239], v[88:91]
  s_cmp_lt_u32 s65, 1458
  s_cselect_b32 s46, s46, 0
  s_cselect_b32 s51, s51, 0
  s_mov_b32 s28, s36
  v_mfma_f32_16x16x32_bf16 v[92:95], a[8:11], a[136:139], v[92:95]
  ds_read_b64_tr_b16 a[4:5], v5 offset:28672
  s_mov_b32 s29, s37
  v_mfma_f32_16x16x32_bf16 v[92:95], a[12:15], a[144:147], v[92:95]
  s_mov_b32 s30, s38
  v_mfma_f32_16x16x32_bf16 v[96:99], a[8:11], a[140:143], v[96:99]
  ds_read_b64_tr_b16 a[6:7], v5 offset:29184
  v_mfma_f32_16x16x32_bf16 v[96:99], a[12:15], a[148:151], v[96:99]
  s_waitcnt lgkmcnt(4)
  v_mfma_f32_16x16x32_bf16 v[68:71], a[16:19], v[240:243], v[68:71]
  ds_read_b64_tr_b16 a[8:9], v4 offset:32768
  v_mfma_f32_16x16x32_bf16 v[68:71], a[20:23], v[248:251], v[68:71]
  v_mfma_f32_16x16x32_bf16 v[72:75], a[16:19], v[244:247], v[72:75]
  ds_read_b64_tr_b16 a[10:11], v4 offset:33280
  v_mfma_f32_16x16x32_bf16 v[72:75], a[20:23], v[252:255], v[72:75]
  v_mfma_f32_16x16x32_bf16 v[76:79], a[16:19], a[152:155], v[76:79]
  ds_read_b64_tr_b16 a[12:13], v4 offset:36864
  v_mfma_f32_16x16x32_bf16 v[76:79], a[20:23], a[160:163], v[76:79]
  v_mfma_f32_16x16x32_bf16 v[80:83], a[16:19], a[156:159], v[80:83]
  ds_read_b64_tr_b16 a[14:15], v4 offset:37376
  v_mfma_f32_16x16x32_bf16 v[80:83], a[20:23], a[164:167], v[80:83]
  s_waitcnt lgkmcnt(4)
  v_mfma_f32_16x16x32_bf16 v[84:87], a[0:3], v[240:243], v[84:87]
  ds_read_b64_tr_b16 a[16:17], v5 offset:32768
  v_mfma_f32_16x16x32_bf16 v[84:87], a[4:7], v[248:251], v[84:87]
  v_mfma_f32_16x16x32_bf16 v[88:91], a[0:3], v[244:247], v[88:91]
  ds_read_b64_tr_b16 a[18:19], v5 offset:33280
  v_mfma_f32_16x16x32_bf16 v[88:91], a[4:7], v[252:255], v[88:91]
  v_mfma_f32_16x16x32_bf16 v[92:95], a[0:3], a[152:155], v[92:95]
  ds_read_b64_tr_b16 a[20:21], v5 offset:36864
  v_mfma_f32_16x16x32_bf16 v[92:95], a[4:7], a[160:163], v[92:95]
  v_mfma_f32_16x16x32_bf16 v[96:99], a[0:3], a[156:159], v[96:99]
  ds_read_b64_tr_b16 a[22:23], v5 offset:37376
  v_mfma_f32_16x16x32_bf16 v[96:99], a[4:7], a[164:167], v[96:99]
  s_waitcnt lgkmcnt(4)
  v_mfma_f32_16x16x32_bf16 v[68:71], a[8:11], a[24:27], v[68:71]
  v_mfma_f32_16x16x32_bf16 v[68:71], a[12:15], a[32:35], v[68:71]
  v_mfma_f32_16x16x32_bf16 v[72:75], a[8:11], a[28:31], v[72:75]
  v_mfma_f32_16x16x32_bf16 v[72:75], a[12:15], a[36:39], v[72:75]
  v_mfma_f32_16x16x32_bf16 v[76:79], a[8:11], a[168:171], v[76:79]
  v_mfma_f32_16x16x32_bf16 v[76:79], a[12:15], a[176:179], v[76:79]
  v_mfma_f32_16x16x32_bf16 v[80:83], a[8:11], a[172:175], v[80:83]
  v_mfma_f32_16x16x32_bf16 v[80:83], a[12:15], a[180:183], v[80:83]
  s_waitcnt lgkmcnt(0)
  v_mfma_f32_16x16x32_bf16 v[84:87], a[16:19], a[24:27], v[84:87]
  v_mfma_f32_16x16x32_bf16 v[84:87], a[20:23], a[32:35], v[84:87]
  v_mfma_f32_16x16x32_bf16 v[88:91], a[16:19], a[28:31], v[88:91]
  v_mfma_f32_16x16x32_bf16 v[88:91], a[20:23], a[36:39], v[88:91]
  v_mfma_f32_16x16x32_bf16 v[92:95], a[16:19], a[168:171], v[92:95]
  v_mfma_f32_16x16x32_bf16 v[92:95], a[20:23], a[176:179], v[92:95]
  v_mfma_f32_16x16x32_bf16 v[96:99], a[16:19], a[172:175], v[96:99]
  v_mfma_f32_16x16x32_bf16 v[96:99], a[20:23], a[180:183], v[96:99]
  buffer_load_dword v109, v118, s[28:31], s39 offen
  s_mov_b32 s90, 0x35c1a2a0
  s_mov_b32 s88, 0x3fb8aa3b
  s_mov_b32 s91, 0x35c1a2a0
  s_mov_b32 s89, 0x3fb8aa3b
  v_mul_f32 v8, 0x3fb8aa3b, v110
  v_mul_f32 v9, 0x3fb8aa3b, v111
  v_mul_f32 v10, 0x3fb8aa3b, v112
  v_mul_f32 v11, 0x3fb8aa3b, v113
  v_pk_fma_f32 v[68:69], v[68:69], v[8:9], s[90:91] op_sel:[0,0,0] op_sel_hi:[1,0,1]
  v_pk_fma_f32 v[70:71], v[70:71], v[8:9], s[90:91] op_sel:[0,0,0] op_sel_hi:[1,0,1]
  v_pk_fma_f32 v[84:85], v[84:85], v[8:9], s[90:91] op_sel:[0,0,0] op_sel_hi:[1,0,1]
  v_pk_fma_f32 v[86:87], v[86:87], v[8:9], s[90:91] op_sel:[0,0,0] op_sel_hi:[1,0,1]
  v_exp_f32_e64 v12, v68 clamp
  v_exp_f32_e64 v14, v70 clamp
  v_exp_f32_e64 v16, v84 clamp
  v_exp_f32_e64 v18, v86 clamp
  v_exp_f32_e64 v13, v69 clamp
  v_exp_f32_e64 v15, v71 clamp
  v_exp_f32_e64 v17, v85 clamp
  v_exp_f32_e64 v19, v87 clamp
  v_max_f32 v68, s90, v68
  v_max_f32 v70, s90, v70
  v_max_f32 v84, s90, v84
  v_max_f32 v86, s90, v86
  v_max_f32 v69, s90, v69
  v_max_f32 v71, s90, v71
  v_max_f32 v85, s90, v85
  v_max_f32 v87, s90, v87
  v_pk_fma_f32 v[68:69], v[12:13], s[88:89], v[68:69]
  v_pk_fma_f32 v[70:71], v[14:15], s[88:89], v[70:71]
  v_pk_fma_f32 v[84:85], v[16:17], s[88:89], v[84:85]
  v_pk_fma_f32 v[86:87], v[18:19], s[88:89], v[86:87]
  v_cvt_pk_bf16_f32 v68, v68, v69
  v_cvt_pk_bf16_f32 v69, v70, v71
  v_cvt_pk_bf16_f32 v70, v84, v85
  v_cvt_pk_bf16_f32 v71, v86, v87
  s_mul_i32 s67, s96, 18
  s_lshl_b32 s69, s81, 1
  s_add_u32 s67, s67, s69
  s_add_u32 s67, s67, s58
  s_lshl_b32 s67, s67, 10
  s_add_u32 s67, s67, 18874368
  buffer_store_dwordx4 v[68:71], v108, s[20:23], s67 offen sc1
  v_pk_fma_f32 v[72:73], v[72:73], v[8:9], s[90:91] op_sel:[0,1,0] op_sel_hi:[1,1,1]
  v_pk_fma_f32 v[74:75], v[74:75], v[8:9], s[90:91] op_sel:[0,1,0] op_sel_hi:[1,1,1]
  v_pk_fma_f32 v[88:89], v[88:89], v[8:9], s[90:91] op_sel:[0,1,0] op_sel_hi:[1,1,1]
  v_pk_fma_f32 v[90:91], v[90:91], v[8:9], s[90:91] op_sel:[0,1,0] op_sel_hi:[1,1,1]
  v_exp_f32_e64 v12, v72 clamp
  v_exp_f32_e64 v14, v74 clamp
  v_exp_f32_e64 v16, v88 clamp
  v_exp_f32_e64 v18, v90 clamp
  v_exp_f32_e64 v13, v73 clamp
  v_exp_f32_e64 v15, v75 clamp
  v_exp_f32_e64 v17, v89 clamp
  v_exp_f32_e64 v19, v91 clamp
  v_max_f32 v72, s90, v72
  v_max_f32 v74, s90, v74
  v_max_f32 v88, s90, v88
  v_max_f32 v90, s90, v90
  v_max_f32 v73, s90, v73
  v_max_f32 v75, s90, v75
  v_max_f32 v89, s90, v89
  v_max_f32 v91, s90, v91
  v_pk_fma_f32 v[72:73], v[12:13], s[88:89], v[72:73]
  v_pk_fma_f32 v[74:75], v[14:15], s[88:89], v[74:75]
  v_pk_fma_f32 v[88:89], v[16:17], s[88:89], v[88:89]
  v_pk_fma_f32 v[90:91], v[18:19], s[88:89], v[90:91]
  v_cvt_pk_bf16_f32 v72, v72, v73
  v_cvt_pk_bf16_f32 v73, v74, v75
  v_cvt_pk_bf16_f32 v74, v88, v89
  v_cvt_pk_bf16_f32 v75, v90, v91
  s_mul_i32 s67, s97, 18
  s_lshl_b32 s69, s81, 1
  s_add_u32 s67, s67, s69
  s_add_u32 s67, s67, s58
  s_lshl_b32 s67, s67, 10
  s_add_u32 s67, s67, 18874368
  buffer_store_dwordx4 v[72:75], v108, s[20:23], s67 offen sc1
  v_pk_fma_f32 v[76:77], v[76:77], v[10:11], s[90:91] op_sel:[0,0,0] op_sel_hi:[1,0,1]
  v_pk_fma_f32 v[78:79], v[78:79], v[10:11], s[90:91] op_sel:[0,0,0] op_sel_hi:[1,0,1]
  v_pk_fma_f32 v[92:93], v[92:93], v[10:11], s[90:91] op_sel:[0,0,0] op_sel_hi:[1,0,1]
  v_pk_fma_f32 v[94:95], v[94:95], v[10:11], s[90:91] op_sel:[0,0,0] op_sel_hi:[1,0,1]
  v_exp_f32_e64 v12, v76 clamp
  v_exp_f32_e64 v14, v78 clamp
  v_exp_f32_e64 v16, v92 clamp
  v_exp_f32_e64 v18, v94 clamp
  v_exp_f32_e64 v13, v77 clamp
  v_exp_f32_e64 v15, v79 clamp
  v_exp_f32_e64 v17, v93 clamp
  v_exp_f32_e64 v19, v95 clamp
  v_max_f32 v76, s90, v76
  v_max_f32 v78, s90, v78
  v_max_f32 v92, s90, v92
  v_max_f32 v94, s90, v94
  v_max_f32 v77, s90, v77
  v_max_f32 v79, s90, v79
  v_max_f32 v93, s90, v93
  v_max_f32 v95, s90, v95
  v_pk_fma_f32 v[76:77], v[12:13], s[88:89], v[76:77]
  v_pk_fma_f32 v[78:79], v[14:15], s[88:89], v[78:79]
  v_pk_fma_f32 v[92:93], v[16:17], s[88:89], v[92:93]
  v_pk_fma_f32 v[94:95], v[18:19], s[88:89], v[94:95]
  v_cvt_pk_bf16_f32 v76, v76, v77
  v_cvt_pk_bf16_f32 v77, v78, v79
  v_cvt_pk_bf16_f32 v78, v92, v93
  v_cvt_pk_bf16_f32 v79, v94, v95
  s_mul_i32 s67, s98, 18
  s_lshl_b32 s69, s81, 1
  s_add_u32 s67, s67, s69
  s_add_u32 s67, s67, s58
  s_lshl_b32 s67, s67, 10
  s_add_u32 s67, s67, 18874368
  buffer_store_dwordx4 v[76:79], v108, s[20:23], s67 offen sc1
  v_pk_fma_f32 v[80:81], v[80:81], v[10:11], s[90:91] op_sel:[0,1,0] op_sel_hi:[1,1,1]
  v_pk_fma_f32 v[82:83], v[82:83], v[10:11], s[90:91] op_sel:[0,1,0] op_sel_hi:[1,1,1]
  v_pk_fma_f32 v[96:97], v[96:97], v[10:11], s[90:91] op_sel:[0,1,0] op_sel_hi:[1,1,1]
  v_pk_fma_f32 v[98:99], v[98:99], v[10:11], s[90:91] op_sel:[0,1,0] op_sel_hi:[1,1,1]
  v_exp_f32_e64 v12, v80 clamp
  v_exp_f32_e64 v14, v82 clamp
  v_exp_f32_e64 v16, v96 clamp
  v_exp_f32_e64 v18, v98 clamp
  v_exp_f32_e64 v13, v81 clamp
  v_exp_f32_e64 v15, v83 clamp
  v_exp_f32_e64 v17, v97 clamp
  v_exp_f32_e64 v19, v99 clamp
  v_max_f32 v80, s90, v80
  v_max_f32 v82, s90, v82
  v_max_f32 v96, s90, v96
  v_max_f32 v98, s90, v98
  v_max_f32 v81, s90, v81
  v_max_f32 v83, s90, v83
  v_max_f32 v97, s90, v97
  v_max_f32 v99, s90, v99
  v_pk_fma_f32 v[80:81], v[12:13], s[88:89], v[80:81]
  v_pk_fma_f32 v[82:83], v[14:15], s[88:89], v[82:83]
  v_pk_fma_f32 v[96:97], v[16:17], s[88:89], v[96:97]
  v_pk_fma_f32 v[98:99], v[18:19], s[88:89], v[98:99]
  v_cvt_pk_bf16_f32 v80, v80, v81
  v_cvt_pk_bf16_f32 v81, v82, v83
  v_cvt_pk_bf16_f32 v82, v96, v97
  v_cvt_pk_bf16_f32 v83, v98, v99
  s_mul_i32 s67, s99, 18
  s_lshl_b32 s69, s81, 1
  s_add_u32 s67, s67, s69
  s_add_u32 s67, s67, s58
  s_lshl_b32 s67, s67, 10
  s_add_u32 s67, s67, 18874368
  buffer_store_dwordx4 v[80:83], v108, s[20:23], s67 offen sc1
  s_branch recurrent_scan__linear_attn_block__glu_gated_bilinear__prompt_kernel_hdr
recurrent_scan__linear_attn_block__glu_gated_bilinear__prompt_kernel_kv:
  v_mov_b32 v74, 0
  global_load_dwordx2 v[58:59], v74, s[52:53] sc1
  v_mfma_f32_16x16x32_bf16 v[76:79], v[66:69], v[128:131], v[4:7]
  v_mfma_f32_16x16x32_bf16 v[80:83], v[64:67], v[128:131], v[4:7]
  v_cndmask_b32 v72, v20, v21, s[86:87]
  s_add_u32 m0, s82, 0
  s_nop 0
  buffer_load_dwordx4 v52, s[8:11], s74 offen offset:0 lds
  v_mfma_f32_16x16x32_bf16 v[84:87], v[66:69], v[132:135], v[8:11]
  v_mfma_f32_16x16x32_bf16 v[88:91], v[64:67], v[132:135], v[8:11]
  v_cndmask_b32 v72, v72, v22, s[88:89]
  buffer_load_dwordx4 v53, s[8:11], s74 offen offset:1024 lds
  v_mfma_f32_16x16x32_bf16 v[92:95], v[66:69], v[136:139], v[4:7]
  v_cvt_pk_bf16_f32 v128, v76, v77
  v_cvt_pk_bf16_f32 v129, v78, v79
  v_mfma_f32_16x16x32_bf16 v[96:99], v[64:67], v[136:139], v[4:7]
  v_cvt_pk_bf16_f32 v130, v80, v81
  v_cvt_pk_bf16_f32 v131, v82, v83
  v_cndmask_b32 v72, v72, v23, s[90:91]
  v_mfma_f32_16x16x32_bf16 v[76:79], v[66:69], v[140:143], v[8:11]
  v_cvt_pk_bf16_f32 v132, v84, v85
  v_cvt_pk_bf16_f32 v133, v86, v87
  v_mfma_f32_16x16x32_bf16 v[80:83], v[64:67], v[140:143], v[8:11]
  v_cvt_pk_bf16_f32 v134, v88, v89
  v_cvt_pk_bf16_f32 v135, v90, v91
  v_cndmask_b32 v72, 0, v72, s[84:85]
  s_add_u32 s74, s74, 0x36000
  buffer_load_dwordx4 v52, s[8:11], s75 offen offset:2048 lds
  v_mfma_f32_16x16x32_bf16 v[84:87], v[66:69], v[144:147], v[4:7]
  v_cvt_pk_bf16_f32 v136, v92, v93
  v_cvt_pk_bf16_f32 v137, v94, v95
  v_mfma_f32_16x16x32_bf16 v[88:91], v[64:67], v[144:147], v[4:7]
  v_cvt_pk_bf16_f32 v138, v96, v97
  v_cvt_pk_bf16_f32 v139, v98, v99
  v_cndmask_b32 v73, v24, v25, s[86:87]
  v_mfma_f32_16x16x32_bf16 v[92:95], v[66:69], v[148:151], v[8:11]
  v_cvt_pk_bf16_f32 v140, v76, v77
  v_cvt_pk_bf16_f32 v141, v78, v79
  v_mfma_f32_16x16x32_bf16 v[96:99], v[64:67], v[148:151], v[8:11]
  v_cvt_pk_bf16_f32 v142, v80, v81
  v_cvt_pk_bf16_f32 v143, v82, v83
  v_cndmask_b32 v73, v73, v26, s[88:89]
  buffer_load_dwordx4 v53, s[8:11], s75 offen offset:3072 lds
  v_mfma_f32_16x16x32_bf16 v[76:79], v[66:69], v[152:155], v[4:7]
  v_cvt_pk_bf16_f32 v144, v84, v85
  v_cvt_pk_bf16_f32 v145, v86, v87
  v_mfma_f32_16x16x32_bf16 v[80:83], v[64:67], v[152:155], v[4:7]
  v_cvt_pk_bf16_f32 v146, v88, v89
  v_cvt_pk_bf16_f32 v147, v90, v91
  v_cndmask_b32 v73, v73, v27, s[90:91]
  s_add_u32 s75, s75, 0x36000
  s_add_u32 m0, s82, 4096
  s_nop 0
  buffer_load_dwordx4 v52, s[8:11], s76 offen offset:0 lds
  v_mfma_f32_16x16x32_bf16 v[84:87], v[66:69], v[156:159], v[8:11]
  v_cvt_pk_bf16_f32 v148, v92, v93
  v_cvt_pk_bf16_f32 v149, v94, v95
  v_mfma_f32_16x16x32_bf16 v[88:91], v[64:67], v[156:159], v[8:11]
  v_cvt_pk_bf16_f32 v150, v96, v97
  v_cvt_pk_bf16_f32 v151, v98, v99
  v_cndmask_b32 v73, 0, v73, s[84:85]
  v_mfma_f32_16x16x32_bf16 v[92:95], v[66:69], v[160:163], v[4:7]
  v_cvt_pk_bf16_f32 v152, v76, v77
  v_cvt_pk_bf16_f32 v153, v78, v79
  v_mfma_f32_16x16x32_bf16 v[96:99], v[64:67], v[160:163], v[4:7]
  v_cvt_pk_bf16_f32 v154, v80, v81
  v_cvt_pk_bf16_f32 v155, v82, v83
  buffer_load_dwordx4 v53, s[8:11], s76 offen offset:1024 lds
  v_mfma_f32_16x16x32_bf16 v[76:79], v[66:69], v[164:167], v[8:11]
  v_cvt_pk_bf16_f32 v156, v84, v85
  v_cvt_pk_bf16_f32 v157, v86, v87
  v_mfma_f32_16x16x32_bf16 v[80:83], v[64:67], v[164:167], v[8:11]
  v_cvt_pk_bf16_f32 v158, v88, v89
  v_cvt_pk_bf16_f32 v159, v90, v91
  v_mfma_f32_16x16x4_f32 v[20:23], v70, v72, 0
  v_mfma_f32_16x16x32_bf16 v[84:87], v[66:69], v[168:171], v[4:7]
  v_cvt_pk_bf16_f32 v160, v92, v93
  v_cvt_pk_bf16_f32 v161, v94, v95
  v_mfma_f32_16x16x32_bf16 v[88:91], v[64:67], v[168:171], v[4:7]
  v_cvt_pk_bf16_f32 v162, v96, v97
  v_cvt_pk_bf16_f32 v163, v98, v99
  v_mfma_f32_16x16x4_f32 v[24:27], v70, v73, 0
  s_add_u32 s76, s76, 0x36000
  s_add_u32 m0, s82, 24576
  s_nop 0
  buffer_load_dwordx4 v52, s[8:11], s74 offen offset:0 lds
  v_mfma_f32_16x16x32_bf16 v[92:95], v[66:69], v[172:175], v[8:11]
  v_cvt_pk_bf16_f32 v164, v76, v77
  v_cvt_pk_bf16_f32 v165, v78, v79
  v_mfma_f32_16x16x32_bf16 v[96:99], v[64:67], v[172:175], v[8:11]
  v_cvt_pk_bf16_f32 v166, v80, v81
  v_cvt_pk_bf16_f32 v167, v82, v83
  v_mul_f32 v72, v4, v4
  v_mfma_f32_16x16x32_bf16 v[76:79], v[66:69], v[176:179], v[4:7]
  v_cvt_pk_bf16_f32 v168, v84, v85
  v_cvt_pk_bf16_f32 v169, v86, v87
  v_mfma_f32_16x16x32_bf16 v[80:83], v[64:67], v[176:179], v[4:7]
  v_cvt_pk_bf16_f32 v170, v88, v89
  v_cvt_pk_bf16_f32 v171, v90, v91
  v_mul_f32 v73, v8, v8
  buffer_load_dwordx4 v53, s[8:11], s74 offen offset:1024 lds
  v_mfma_f32_16x16x32_bf16 v[84:87], v[66:69], v[180:183], v[8:11]
  v_cvt_pk_bf16_f32 v172, v92, v93
  v_cvt_pk_bf16_f32 v173, v94, v95
  v_mfma_f32_16x16x32_bf16 v[88:91], v[64:67], v[180:183], v[8:11]
  v_cvt_pk_bf16_f32 v174, v96, v97
  v_cvt_pk_bf16_f32 v175, v98, v99
  s_mov_b32 s67, 0x3ae38e39
  s_add_u32 s74, s74, 0x36000
  buffer_load_dwordx4 v52, s[8:11], s75 offen offset:2048 lds
  v_mfma_f32_16x16x32_bf16 v[92:95], v[66:69], v[184:187], v[4:7]
  v_cvt_pk_bf16_f32 v176, v76, v77
  v_cvt_pk_bf16_f32 v177, v78, v79
  v_mfma_f32_16x16x32_bf16 v[96:99], v[64:67], v[184:187], v[4:7]
  v_cvt_pk_bf16_f32 v178, v80, v81
  v_cvt_pk_bf16_f32 v179, v82, v83
  v_mfma_f32_16x16x32_bf16 v[76:79], v[66:69], v[188:191], v[8:11]
  v_cvt_pk_bf16_f32 v180, v84, v85
  v_cvt_pk_bf16_f32 v181, v86, v87
  v_mfma_f32_16x16x32_bf16 v[80:83], v[64:67], v[188:191], v[8:11]
  v_cvt_pk_bf16_f32 v182, v88, v89
  v_cvt_pk_bf16_f32 v183, v90, v91
  v_fma_f32 v72, v20, s67, -v72
  buffer_load_dwordx4 v53, s[8:11], s75 offen offset:3072 lds
  v_mfma_f32_16x16x32_bf16 v[84:87], v[66:69], v[192:195], v[4:7]
  v_cvt_pk_bf16_f32 v184, v92, v93
  v_cvt_pk_bf16_f32 v185, v94, v95
  v_mfma_f32_16x16x32_bf16 v[88:91], v[64:67], v[192:195], v[4:7]
  v_cvt_pk_bf16_f32 v186, v96, v97
  v_cvt_pk_bf16_f32 v187, v98, v99
  v_max_f32 v72, 0, v72
  v_mfma_f32_16x16x32_bf16 v[92:95], v[66:69], v[196:199], v[8:11]
  v_cvt_pk_bf16_f32 v188, v76, v77
  v_cvt_pk_bf16_f32 v189, v78, v79
  v_mfma_f32_16x16x32_bf16 v[96:99], v[64:67], v[196:199], v[8:11]
  v_cvt_pk_bf16_f32 v190, v80, v81
  v_cvt_pk_bf16_f32 v191, v82, v83
  v_add_f32 v72, 0x3727c5ac, v72
  s_add_u32 s75, s75, 0x36000
  s_add_u32 m0, s82, 28672
  s_nop 0
  buffer_load_dwordx4 v52, s[8:11], s76 offen offset:0 lds
  v_mfma_f32_16x16x32_bf16 v[76:79], v[66:69], v[200:203], v[4:7]
  v_cvt_pk_bf16_f32 v192, v84, v85
  v_cvt_pk_bf16_f32 v193, v86, v87
  v_mfma_f32_16x16x32_bf16 v[80:83], v[64:67], v[200:203], v[4:7]
  v_cvt_pk_bf16_f32 v194, v88, v89
  v_cvt_pk_bf16_f32 v195, v90, v91
  v_rsq_f32 v110, v72
  v_mfma_f32_16x16x32_bf16 v[84:87], v[66:69], v[204:207], v[8:11]
  v_cvt_pk_bf16_f32 v196, v92, v93
  v_cvt_pk_bf16_f32 v197, v94, v95
  v_mfma_f32_16x16x32_bf16 v[88:91], v[64:67], v[204:207], v[8:11]
  v_cvt_pk_bf16_f32 v198, v96, v97
  v_cvt_pk_bf16_f32 v199, v98, v99
  v_rcp_f32 v114, v72
  buffer_load_dwordx4 v53, s[8:11], s76 offen offset:1024 lds
  v_mfma_f32_16x16x32_bf16 v[92:95], v[66:69], v[208:211], v[4:7]
  v_cvt_pk_bf16_f32 v200, v76, v77
  v_cvt_pk_bf16_f32 v201, v78, v79
  v_mfma_f32_16x16x32_bf16 v[96:99], v[64:67], v[208:211], v[4:7]
  v_cvt_pk_bf16_f32 v202, v80, v81
  v_cvt_pk_bf16_f32 v203, v82, v83
  v_fma_f32 v73, v24, s67, -v73
  s_add_u32 s76, s76, 0x36000
  s_add_u32 m0, s82, 49152
  s_nop 0
  buffer_load_dwordx4 v52, s[8:11], s74 offen offset:0 lds
  v_mfma_f32_16x16x32_bf16 v[76:79], v[66:69], v[212:215], v[8:11]
  v_cvt_pk_bf16_f32 v204, v84, v85
  v_cvt_pk_bf16_f32 v205, v86, v87
  v_mfma_f32_16x16x32_bf16 v[80:83], v[64:67], v[212:215], v[8:11]
  v_cvt_pk_bf16_f32 v206, v88, v89
  v_cvt_pk_bf16_f32 v207, v90, v91
  v_max_f32 v73, 0, v73
  v_mfma_f32_16x16x32_bf16 v[84:87], v[66:69], v[216:219], v[4:7]
  v_cvt_pk_bf16_f32 v208, v92, v93
  v_cvt_pk_bf16_f32 v209, v94, v95
  v_mfma_f32_16x16x32_bf16 v[88:91], v[64:67], v[216:219], v[4:7]
  v_cvt_pk_bf16_f32 v210, v96, v97
  v_cvt_pk_bf16_f32 v211, v98, v99
  v_add_f32 v73, 0x3727c5ac, v73
  buffer_load_dwordx4 v53, s[8:11], s74 offen offset:1024 lds
  v_mfma_f32_16x16x32_bf16 v[92:95], v[66:69], v[220:223], v[8:11]
  v_cvt_pk_bf16_f32 v212, v76, v77
  v_cvt_pk_bf16_f32 v213, v78, v79
  v_mfma_f32_16x16x32_bf16 v[96:99], v[64:67], v[220:223], v[8:11]
  v_cvt_pk_bf16_f32 v214, v80, v81
  v_cvt_pk_bf16_f32 v215, v82, v83
  v_rsq_f32 v111, v73
  v_mfma_f32_16x16x32_bf16 v[76:79], v[66:69], v[224:227], v[4:7]
  v_cvt_pk_bf16_f32 v216, v84, v85
  v_cvt_pk_bf16_f32 v217, v86, v87
  v_mfma_f32_16x16x32_bf16 v[80:83], v[64:67], v[224:227], v[4:7]
  v_cvt_pk_bf16_f32 v218, v88, v89
  v_cvt_pk_bf16_f32 v219, v90, v91
  v_rcp_f32 v115, v73
  s_add_u32 s74, s74, 0x36000
  buffer_load_dwordx4 v52, s[8:11], s75 offen offset:2048 lds
  v_mfma_f32_16x16x32_bf16 v[84:87], v[66:69], v[228:231], v[8:11]
  v_cvt_pk_bf16_f32 v220, v92, v93
  v_cvt_pk_bf16_f32 v221, v94, v95
  v_mfma_f32_16x16x32_bf16 v[88:91], v[64:67], v[228:231], v[8:11]
  v_cvt_pk_bf16_f32 v222, v96, v97
  v_cvt_pk_bf16_f32 v223, v98, v99
  ds_write_b64 v50, v[110:111] offset:2048
  v_mfma_f32_16x16x32_bf16 v[92:95], v[66:69], v[232:235], v[4:7]
  v_cvt_pk_bf16_f32 v224, v76, v77
  v_cvt_pk_bf16_f32 v225, v78, v79
  v_mfma_f32_16x16x32_bf16 v[96:99], v[64:67], v[232:235], v[4:7]
  v_cvt_pk_bf16_f32 v226, v80, v81
  v_cvt_pk_bf16_f32 v227, v82, v83
  ds_write_b64 v50, v[114:115] offset:2056
  buffer_load_dwordx4 v53, s[8:11], s75 offen offset:3072 lds
  v_mfma_f32_16x16x32_bf16 v[76:79], v[66:69], v[236:239], v[8:11]
  v_cvt_pk_bf16_f32 v228, v84, v85
  v_cvt_pk_bf16_f32 v229, v86, v87
  v_mfma_f32_16x16x32_bf16 v[80:83], v[64:67], v[236:239], v[8:11]
  v_cvt_pk_bf16_f32 v230, v88, v89
  v_cvt_pk_bf16_f32 v231, v90, v91
  s_add_u32 s75, s75, 0x36000
  s_add_u32 m0, s82, 53248
  s_nop 0
  buffer_load_dwordx4 v52, s[8:11], s76 offen offset:0 lds
  v_mfma_f32_16x16x32_bf16 v[84:87], v[66:69], v[240:243], v[4:7]
  v_cvt_pk_bf16_f32 v232, v92, v93
  v_cvt_pk_bf16_f32 v233, v94, v95
  v_mfma_f32_16x16x32_bf16 v[88:91], v[64:67], v[240:243], v[4:7]
  v_cvt_pk_bf16_f32 v234, v96, v97
  v_cvt_pk_bf16_f32 v235, v98, v99
  v_mfma_f32_16x16x32_bf16 v[92:95], v[66:69], v[244:247], v[8:11]
  v_cvt_pk_bf16_f32 v236, v76, v77
  v_cvt_pk_bf16_f32 v237, v78, v79
  v_mfma_f32_16x16x32_bf16 v[96:99], v[64:67], v[244:247], v[8:11]
  v_cvt_pk_bf16_f32 v238, v80, v81
  v_cvt_pk_bf16_f32 v239, v82, v83
  buffer_load_dwordx4 v53, s[8:11], s76 offen offset:1024 lds
  v_mfma_f32_16x16x32_bf16 v[76:79], v[66:69], v[248:251], v[4:7]
  v_cvt_pk_bf16_f32 v240, v84, v85
  v_cvt_pk_bf16_f32 v241, v86, v87
  v_mfma_f32_16x16x32_bf16 v[80:83], v[64:67], v[248:251], v[4:7]
  v_cvt_pk_bf16_f32 v242, v88, v89
  v_cvt_pk_bf16_f32 v243, v90, v91
  s_waitcnt lgkmcnt(0)
  s_barrier
  v_mfma_f32_16x16x32_bf16 v[84:87], v[66:69], v[252:255], v[8:11]
  v_cvt_pk_bf16_f32 v244, v92, v93
  v_cvt_pk_bf16_f32 v245, v94, v95
  v_mfma_f32_16x16x32_bf16 v[88:91], v[64:67], v[252:255], v[8:11]
  v_cvt_pk_bf16_f32 v246, v96, v97
  v_cvt_pk_bf16_f32 v247, v98, v99
  ds_read_b64 v[112:113], v51 offset:2048
  s_add_u32 s76, s76, 0x36000
  s_add_u32 m0, s82, 73728
  s_nop 0
  buffer_load_dwordx4 v52, s[8:11], s74 offen offset:0 lds
  v_mfma_f32_16x16x32_bf16 v[92:95], v[66:69], a[24:27], v[4:7]
  v_cvt_pk_bf16_f32 v248, v76, v77
  v_cvt_pk_bf16_f32 v249, v78, v79
  v_mfma_f32_16x16x32_bf16 v[96:99], v[64:67], a[24:27], v[4:7]
  v_cvt_pk_bf16_f32 v250, v80, v81
  v_cvt_pk_bf16_f32 v251, v82, v83
  ds_read_b64 v[116:117], v51 offset:2056
  v_mfma_f32_16x16x32_bf16 v[76:79], v[66:69], a[28:31], v[8:11]
  v_cvt_pk_bf16_f32 v252, v84, v85
  v_cvt_pk_bf16_f32 v253, v86, v87
  v_mfma_f32_16x16x32_bf16 v[80:83], v[64:67], a[28:31], v[8:11]
  v_cvt_pk_bf16_f32 v254, v88, v89
  v_cvt_pk_bf16_f32 v255, v90, v91
  buffer_load_dwordx4 v53, s[8:11], s74 offen offset:1024 lds
  v_mfma_f32_16x16x32_bf16 v[84:87], v[66:69], a[32:35], v[4:7]
  v_cvt_pk_bf16_f32 v92, v92, v93
  v_accvgpr_write_b32 a24, v92
  v_cvt_pk_bf16_f32 v94, v94, v95
  v_accvgpr_write_b32 a25, v94
  v_mfma_f32_16x16x32_bf16 v[88:91], v[64:67], a[32:35], v[4:7]
  v_cvt_pk_bf16_f32 v96, v96, v97
  v_accvgpr_write_b32 a26, v96
  v_cvt_pk_bf16_f32 v98, v98, v99
  v_accvgpr_write_b32 a27, v98
  s_add_u32 s74, s74, 0x36000
  buffer_load_dwordx4 v52, s[8:11], s75 offen offset:2048 lds
  v_mfma_f32_16x16x32_bf16 v[92:95], v[66:69], a[36:39], v[8:11]
  v_cvt_pk_bf16_f32 v76, v76, v77
  v_accvgpr_write_b32 a28, v76
  v_cvt_pk_bf16_f32 v78, v78, v79
  v_accvgpr_write_b32 a29, v78
  v_mfma_f32_16x16x32_bf16 v[96:99], v[64:67], a[36:39], v[8:11]
  v_cvt_pk_bf16_f32 v80, v80, v81
  v_accvgpr_write_b32 a30, v80
  v_cvt_pk_bf16_f32 v82, v82, v83
  v_accvgpr_write_b32 a31, v82
  v_mfma_f32_16x16x32_bf16 v[76:79], v[66:69], a[40:43], v[12:15]
  v_cvt_pk_bf16_f32 v84, v84, v85
  v_accvgpr_write_b32 a32, v84
  v_cvt_pk_bf16_f32 v86, v86, v87
  v_accvgpr_write_b32 a33, v86
  v_mfma_f32_16x16x32_bf16 v[80:83], v[64:67], a[40:43], v[12:15]
  v_cvt_pk_bf16_f32 v88, v88, v89
  v_accvgpr_write_b32 a34, v88
  v_cvt_pk_bf16_f32 v90, v90, v91
  v_accvgpr_write_b32 a35, v90
  buffer_load_dwordx4 v53, s[8:11], s75 offen offset:3072 lds
  v_mfma_f32_16x16x32_bf16 v[84:87], v[66:69], a[44:47], v[16:19]
  v_cvt_pk_bf16_f32 v92, v92, v93
  v_accvgpr_write_b32 a36, v92
  v_cvt_pk_bf16_f32 v94, v94, v95
  v_accvgpr_write_b32 a37, v94
  v_mfma_f32_16x16x32_bf16 v[88:91], v[64:67], a[44:47], v[16:19]
  v_cvt_pk_bf16_f32 v96, v96, v97
  v_accvgpr_write_b32 a38, v96
  v_cvt_pk_bf16_f32 v98, v98, v99
  v_accvgpr_write_b32 a39, v98
  v_mfma_f32_16x16x32_bf16 v[92:95], v[66:69], a[48:51], v[12:15]
  v_cvt_pk_bf16_f32 v76, v76, v77
  v_accvgpr_write_b32 a40, v76
  v_cvt_pk_bf16_f32 v78, v78, v79
  v_accvgpr_write_b32 a41, v78
  v_mfma_f32_16x16x32_bf16 v[96:99], v[64:67], a[48:51], v[12:15]
  v_cvt_pk_bf16_f32 v80, v80, v81
  v_accvgpr_write_b32 a42, v80
  v_cvt_pk_bf16_f32 v82, v82, v83
  v_accvgpr_write_b32 a43, v82
  s_add_u32 s75, s75, 0x36000
  s_add_u32 m0, s82, 77824
  s_nop 0
  buffer_load_dwordx4 v52, s[8:11], s76 offen offset:0 lds
  v_mfma_f32_16x16x32_bf16 v[76:79], v[66:69], a[52:55], v[16:19]
  v_cvt_pk_bf16_f32 v84, v84, v85
  v_accvgpr_write_b32 a44, v84
  v_cvt_pk_bf16_f32 v86, v86, v87
  v_accvgpr_write_b32 a45, v86
  v_mfma_f32_16x16x32_bf16 v[80:83], v[64:67], a[52:55], v[16:19]
  v_cvt_pk_bf16_f32 v88, v88, v89
  v_accvgpr_write_b32 a46, v88
  v_cvt_pk_bf16_f32 v90, v90, v91
  v_accvgpr_write_b32 a47, v90
  buffer_load_dwordx4 v53, s[8:11], s76 offen offset:1024 lds
  v_mfma_f32_16x16x32_bf16 v[84:87], v[66:69], a[56:59], v[12:15]
  v_cvt_pk_bf16_f32 v92, v92, v93
  v_accvgpr_write_b32 a48, v92
  v_cvt_pk_bf16_f32 v94, v94, v95
  v_accvgpr_write_b32 a49, v94
  v_mfma_f32_16x16x32_bf16 v[88:91], v[64:67], a[56:59], v[12:15]
  v_cvt_pk_bf16_f32 v96, v96, v97
  v_accvgpr_write_b32 a50, v96
  v_cvt_pk_bf16_f32 v98, v98, v99
  v_accvgpr_write_b32 a51, v98
  v_mfma_f32_16x16x32_bf16 v[92:95], v[66:69], a[60:63], v[16:19]
  v_cvt_pk_bf16_f32 v76, v76, v77
  v_accvgpr_write_b32 a52, v76
  v_cvt_pk_bf16_f32 v78, v78, v79
  v_accvgpr_write_b32 a53, v78
  v_mfma_f32_16x16x32_bf16 v[96:99], v[64:67], a[60:63], v[16:19]
  v_cvt_pk_bf16_f32 v80, v80, v81
  v_accvgpr_write_b32 a54, v80
  v_cvt_pk_bf16_f32 v82, v82, v83
  v_accvgpr_write_b32 a55, v82
  s_add_u32 s76, s76, 0x36000
  s_add_u32 m0, s82, 98304
  s_nop 0
  buffer_load_dwordx4 v52, s[8:11], s74 offen offset:0 lds
  v_mfma_f32_16x16x32_bf16 v[76:79], v[66:69], a[64:67], v[12:15]
  v_cvt_pk_bf16_f32 v84, v84, v85
  v_accvgpr_write_b32 a56, v84
  v_cvt_pk_bf16_f32 v86, v86, v87
  v_accvgpr_write_b32 a57, v86
  v_mfma_f32_16x16x32_bf16 v[80:83], v[64:67], a[64:67], v[12:15]
  v_cvt_pk_bf16_f32 v88, v88, v89
  v_accvgpr_write_b32 a58, v88
  v_cvt_pk_bf16_f32 v90, v90, v91
  v_accvgpr_write_b32 a59, v90
  v_mfma_f32_16x16x32_bf16 v[84:87], v[66:69], a[68:71], v[16:19]
  v_cvt_pk_bf16_f32 v92, v92, v93
  v_accvgpr_write_b32 a60, v92
  v_cvt_pk_bf16_f32 v94, v94, v95
  v_accvgpr_write_b32 a61, v94
  v_mfma_f32_16x16x32_bf16 v[88:91], v[64:67], a[68:71], v[16:19]
  v_cvt_pk_bf16_f32 v96, v96, v97
  v_accvgpr_write_b32 a62, v96
  v_cvt_pk_bf16_f32 v98, v98, v99
  v_accvgpr_write_b32 a63, v98
  buffer_load_dwordx4 v53, s[8:11], s74 offen offset:1024 lds
  v_mfma_f32_16x16x32_bf16 v[92:95], v[66:69], a[72:75], v[12:15]
  v_cvt_pk_bf16_f32 v76, v76, v77
  v_accvgpr_write_b32 a64, v76
  v_cvt_pk_bf16_f32 v78, v78, v79
  v_accvgpr_write_b32 a65, v78
  v_mfma_f32_16x16x32_bf16 v[96:99], v[64:67], a[72:75], v[12:15]
  v_cvt_pk_bf16_f32 v80, v80, v81
  v_accvgpr_write_b32 a66, v80
  v_cvt_pk_bf16_f32 v82, v82, v83
  v_accvgpr_write_b32 a67, v82
  v_mfma_f32_16x16x32_bf16 v[76:79], v[66:69], a[76:79], v[16:19]
  v_cvt_pk_bf16_f32 v84, v84, v85
  v_accvgpr_write_b32 a68, v84
  v_cvt_pk_bf16_f32 v86, v86, v87
  v_accvgpr_write_b32 a69, v86
  v_mfma_f32_16x16x32_bf16 v[80:83], v[64:67], a[76:79], v[16:19]
  v_cvt_pk_bf16_f32 v88, v88, v89
  v_accvgpr_write_b32 a70, v88
  v_cvt_pk_bf16_f32 v90, v90, v91
  v_accvgpr_write_b32 a71, v90
  s_add_u32 s74, s74, 0x36000
  buffer_load_dwordx4 v52, s[8:11], s75 offen offset:2048 lds
  v_mfma_f32_16x16x32_bf16 v[84:87], v[66:69], a[80:83], v[12:15]
  v_cvt_pk_bf16_f32 v92, v92, v93
  v_accvgpr_write_b32 a72, v92
  v_cvt_pk_bf16_f32 v94, v94, v95
  v_accvgpr_write_b32 a73, v94
  v_mfma_f32_16x16x32_bf16 v[88:91], v[64:67], a[80:83], v[12:15]
  v_cvt_pk_bf16_f32 v96, v96, v97
  v_accvgpr_write_b32 a74, v96
  v_cvt_pk_bf16_f32 v98, v98, v99
  v_accvgpr_write_b32 a75, v98
  buffer_load_dwordx4 v53, s[8:11], s75 offen offset:3072 lds
  v_mfma_f32_16x16x32_bf16 v[92:95], v[66:69], a[84:87], v[16:19]
  v_cvt_pk_bf16_f32 v76, v76, v77
  v_accvgpr_write_b32 a76, v76
  v_cvt_pk_bf16_f32 v78, v78, v79
  v_accvgpr_write_b32 a77, v78
  v_mfma_f32_16x16x32_bf16 v[96:99], v[64:67], a[84:87], v[16:19]
  v_cvt_pk_bf16_f32 v80, v80, v81
  v_accvgpr_write_b32 a78, v80
  v_cvt_pk_bf16_f32 v82, v82, v83
  v_accvgpr_write_b32 a79, v82
  v_mfma_f32_16x16x32_bf16 v[76:79], v[66:69], a[88:91], v[12:15]
  v_cvt_pk_bf16_f32 v84, v84, v85
  v_accvgpr_write_b32 a80, v84
  v_cvt_pk_bf16_f32 v86, v86, v87
  v_accvgpr_write_b32 a81, v86
  v_mfma_f32_16x16x32_bf16 v[80:83], v[64:67], a[88:91], v[12:15]
  v_cvt_pk_bf16_f32 v88, v88, v89
  v_accvgpr_write_b32 a82, v88
  v_cvt_pk_bf16_f32 v90, v90, v91
  v_accvgpr_write_b32 a83, v90
  s_add_u32 s75, s75, 0x36000
  s_add_u32 m0, s82, 102400
  s_nop 0
  buffer_load_dwordx4 v52, s[8:11], s76 offen offset:0 lds
  v_mfma_f32_16x16x32_bf16 v[84:87], v[66:69], a[92:95], v[16:19]
  v_cvt_pk_bf16_f32 v92, v92, v93
  v_accvgpr_write_b32 a84, v92
  v_cvt_pk_bf16_f32 v94, v94, v95
  v_accvgpr_write_b32 a85, v94
  v_mfma_f32_16x16x32_bf16 v[88:91], v[64:67], a[92:95], v[16:19]
  v_cvt_pk_bf16_f32 v96, v96, v97
  v_accvgpr_write_b32 a86, v96
  v_cvt_pk_bf16_f32 v98, v98, v99
  v_accvgpr_write_b32 a87, v98
  v_mfma_f32_16x16x32_bf16 v[92:95], v[66:69], a[96:99], v[12:15]
  v_cvt_pk_bf16_f32 v76, v76, v77
  v_accvgpr_write_b32 a88, v76
  v_cvt_pk_bf16_f32 v78, v78, v79
  v_accvgpr_write_b32 a89, v78
  v_mfma_f32_16x16x32_bf16 v[96:99], v[64:67], a[96:99], v[12:15]
  v_cvt_pk_bf16_f32 v80, v80, v81
  v_accvgpr_write_b32 a90, v80
  v_cvt_pk_bf16_f32 v82, v82, v83
  v_accvgpr_write_b32 a91, v82
  buffer_load_dwordx4 v53, s[8:11], s76 offen offset:1024 lds
  v_mfma_f32_16x16x32_bf16 v[76:79], v[66:69], a[100:103], v[16:19]
  v_cvt_pk_bf16_f32 v84, v84, v85
  v_accvgpr_write_b32 a92, v84
  v_cvt_pk_bf16_f32 v86, v86, v87
  v_accvgpr_write_b32 a93, v86
  v_mfma_f32_16x16x32_bf16 v[80:83], v[64:67], a[100:103], v[16:19]
  v_cvt_pk_bf16_f32 v88, v88, v89
  v_accvgpr_write_b32 a94, v88
  v_cvt_pk_bf16_f32 v90, v90, v91
  v_accvgpr_write_b32 a95, v90
  v_mfma_f32_16x16x32_bf16 v[84:87], v[66:69], a[104:107], v[12:15]
  v_cvt_pk_bf16_f32 v92, v92, v93
  v_accvgpr_write_b32 a96, v92
  v_cvt_pk_bf16_f32 v94, v94, v95
  v_accvgpr_write_b32 a97, v94
  v_mfma_f32_16x16x32_bf16 v[88:91], v[64:67], a[104:107], v[12:15]
  v_cvt_pk_bf16_f32 v96, v96, v97
  v_accvgpr_write_b32 a98, v96
  v_cvt_pk_bf16_f32 v98, v98, v99
  v_accvgpr_write_b32 a99, v98
  s_add_u32 s76, s76, 0x36000
  s_add_u32 m0, s82, 122880
  s_nop 0
  buffer_load_dwordx4 v52, s[8:11], s74 offen offset:0 lds
  v_mfma_f32_16x16x32_bf16 v[92:95], v[66:69], a[108:111], v[16:19]
  v_cvt_pk_bf16_f32 v76, v76, v77
  v_accvgpr_write_b32 a100, v76
  v_cvt_pk_bf16_f32 v78, v78, v79
  v_accvgpr_write_b32 a101, v78
  v_mfma_f32_16x16x32_bf16 v[96:99], v[64:67], a[108:111], v[16:19]
  v_cvt_pk_bf16_f32 v80, v80, v81
  v_accvgpr_write_b32 a102, v80
  v_cvt_pk_bf16_f32 v82, v82, v83
  v_accvgpr_write_b32 a103, v82
  buffer_load_dwordx4 v53, s[8:11], s74 offen offset:1024 lds
  v_mfma_f32_16x16x32_bf16 v[76:79], v[66:69], a[112:115], v[12:15]
  v_cvt_pk_bf16_f32 v84, v84, v85
  v_accvgpr_write_b32 a104, v84
  v_cvt_pk_bf16_f32 v86, v86, v87
  v_accvgpr_write_b32 a105, v86
  v_mfma_f32_16x16x32_bf16 v[80:83], v[64:67], a[112:115], v[12:15]
  v_cvt_pk_bf16_f32 v88, v88, v89
  v_accvgpr_write_b32 a106, v88
  v_cvt_pk_bf16_f32 v90, v90, v91
  v_accvgpr_write_b32 a107, v90
  v_mfma_f32_16x16x32_bf16 v[84:87], v[66:69], a[116:119], v[16:19]
  v_cvt_pk_bf16_f32 v92, v92, v93
  v_accvgpr_write_b32 a108, v92
  v_cvt_pk_bf16_f32 v94, v94, v95
  v_accvgpr_write_b32 a109, v94
  v_mfma_f32_16x16x32_bf16 v[88:91], v[64:67], a[116:119], v[16:19]
  v_cvt_pk_bf16_f32 v96, v96, v97
  v_accvgpr_write_b32 a110, v96
  v_cvt_pk_bf16_f32 v98, v98, v99
  v_accvgpr_write_b32 a111, v98
  s_add_u32 s74, s74, 0x36000
  buffer_load_dwordx4 v52, s[8:11], s75 offen offset:2048 lds
  v_mfma_f32_16x16x32_bf16 v[92:95], v[66:69], a[120:123], v[12:15]
  v_cvt_pk_bf16_f32 v76, v76, v77
  v_accvgpr_write_b32 a112, v76
  v_cvt_pk_bf16_f32 v78, v78, v79
  v_accvgpr_write_b32 a113, v78
  v_mfma_f32_16x16x32_bf16 v[96:99], v[64:67], a[120:123], v[12:15]
  v_cvt_pk_bf16_f32 v80, v80, v81
  v_accvgpr_write_b32 a114, v80
  v_cvt_pk_bf16_f32 v82, v82, v83
  v_accvgpr_write_b32 a115, v82
  v_mfma_f32_16x16x32_bf16 v[76:79], v[66:69], a[124:127], v[16:19]
  v_cvt_pk_bf16_f32 v84, v84, v85
  v_accvgpr_write_b32 a116, v84
  v_cvt_pk_bf16_f32 v86, v86, v87
  v_accvgpr_write_b32 a117, v86
  v_mfma_f32_16x16x32_bf16 v[80:83], v[64:67], a[124:127], v[16:19]
  v_cvt_pk_bf16_f32 v88, v88, v89
  v_accvgpr_write_b32 a118, v88
  v_cvt_pk_bf16_f32 v90, v90, v91
  v_accvgpr_write_b32 a119, v90
  buffer_load_dwordx4 v53, s[8:11], s75 offen offset:3072 lds
  v_mfma_f32_16x16x32_bf16 v[84:87], v[66:69], a[128:131], v[12:15]
  v_cvt_pk_bf16_f32 v92, v92, v93
  v_accvgpr_write_b32 a120, v92
  v_cvt_pk_bf16_f32 v94, v94, v95
  v_accvgpr_write_b32 a121, v94
  v_mfma_f32_16x16x32_bf16 v[88:91], v[64:67], a[128:131], v[12:15]
  v_cvt_pk_bf16_f32 v96, v96, v97
  v_accvgpr_write_b32 a122, v96
  v_cvt_pk_bf16_f32 v98, v98, v99
  v_accvgpr_write_b32 a123, v98
  v_mfma_f32_16x16x32_bf16 v[92:95], v[66:69], a[132:135], v[16:19]
  v_cvt_pk_bf16_f32 v76, v76, v77
  v_accvgpr_write_b32 a124, v76
  v_cvt_pk_bf16_f32 v78, v78, v79
  v_accvgpr_write_b32 a125, v78
  v_mfma_f32_16x16x32_bf16 v[96:99], v[64:67], a[132:135], v[16:19]
  v_cvt_pk_bf16_f32 v80, v80, v81
  v_accvgpr_write_b32 a126, v80
  v_cvt_pk_bf16_f32 v82, v82, v83
  v_accvgpr_write_b32 a127, v82
  s_add_u32 s75, s75, 0x36000
  s_add_u32 m0, s82, 126976
  s_nop 0
  buffer_load_dwordx4 v52, s[8:11], s76 offen offset:0 lds
  v_mfma_f32_16x16x32_bf16 v[76:79], v[66:69], a[136:139], v[12:15]
  v_cvt_pk_bf16_f32 v84, v84, v85
  v_accvgpr_write_b32 a128, v84
  v_cvt_pk_bf16_f32 v86, v86, v87
  v_accvgpr_write_b32 a129, v86
  v_mfma_f32_16x16x32_bf16 v[80:83], v[64:67], a[136:139], v[12:15]
  v_cvt_pk_bf16_f32 v88, v88, v89
  v_accvgpr_write_b32 a130, v88
  v_cvt_pk_bf16_f32 v90, v90, v91
  v_accvgpr_write_b32 a131, v90
  buffer_load_dwordx4 v53, s[8:11], s76 offen offset:1024 lds
  v_mfma_f32_16x16x32_bf16 v[84:87], v[66:69], a[140:143], v[16:19]
  v_cvt_pk_bf16_f32 v92, v92, v93
  v_accvgpr_write_b32 a132, v92
  v_cvt_pk_bf16_f32 v94, v94, v95
  v_accvgpr_write_b32 a133, v94
  v_mfma_f32_16x16x32_bf16 v[88:91], v[64:67], a[140:143], v[16:19]
  v_cvt_pk_bf16_f32 v96, v96, v97
  v_accvgpr_write_b32 a134, v96
  v_cvt_pk_bf16_f32 v98, v98, v99
  v_accvgpr_write_b32 a135, v98
  v_mfma_f32_16x16x32_bf16 v[92:95], v[66:69], a[144:147], v[12:15]
  v_cvt_pk_bf16_f32 v76, v76, v77
  v_accvgpr_write_b32 a136, v76
  v_cvt_pk_bf16_f32 v78, v78, v79
  v_accvgpr_write_b32 a137, v78
  v_mfma_f32_16x16x32_bf16 v[96:99], v[64:67], a[144:147], v[12:15]
  v_cvt_pk_bf16_f32 v80, v80, v81
  v_accvgpr_write_b32 a138, v80
  v_cvt_pk_bf16_f32 v82, v82, v83
  v_accvgpr_write_b32 a139, v82
  s_add_u32 s76, s76, 0x36000
  buffer_load_dword v109, v3, s[4:7], s83 offen
  v_mfma_f32_16x16x32_bf16 v[76:79], v[66:69], a[148:151], v[16:19]
  v_cvt_pk_bf16_f32 v84, v84, v85
  v_accvgpr_write_b32 a140, v84
  v_cvt_pk_bf16_f32 v86, v86, v87
  v_accvgpr_write_b32 a141, v86
  v_mfma_f32_16x16x32_bf16 v[80:83], v[64:67], a[148:151], v[16:19]
  v_cvt_pk_bf16_f32 v88, v88, v89
  v_accvgpr_write_b32 a142, v88
  v_cvt_pk_bf16_f32 v90, v90, v91
  v_accvgpr_write_b32 a143, v90
  v_mfma_f32_16x16x32_bf16 v[84:87], v[66:69], a[152:155], v[12:15]
  v_cvt_pk_bf16_f32 v92, v92, v93
  v_accvgpr_write_b32 a144, v92
  v_cvt_pk_bf16_f32 v94, v94, v95
  v_accvgpr_write_b32 a145, v94
  v_mfma_f32_16x16x32_bf16 v[88:91], v[64:67], a[152:155], v[12:15]
  v_cvt_pk_bf16_f32 v96, v96, v97
  v_accvgpr_write_b32 a146, v96
  v_cvt_pk_bf16_f32 v98, v98, v99
  v_accvgpr_write_b32 a147, v98
  s_add_u32 s83, s83, 128
  buffer_load_dword v109, v3, s[4:7], s83 offen
  v_mfma_f32_16x16x32_bf16 v[92:95], v[66:69], a[156:159], v[16:19]
  v_cvt_pk_bf16_f32 v76, v76, v77
  v_accvgpr_write_b32 a148, v76
  v_cvt_pk_bf16_f32 v78, v78, v79
  v_accvgpr_write_b32 a149, v78
  v_mfma_f32_16x16x32_bf16 v[96:99], v[64:67], a[156:159], v[16:19]
  v_cvt_pk_bf16_f32 v80, v80, v81
  v_accvgpr_write_b32 a150, v80
  v_cvt_pk_bf16_f32 v82, v82, v83
  v_accvgpr_write_b32 a151, v82
  v_mfma_f32_16x16x32_bf16 v[76:79], v[66:69], a[160:163], v[12:15]
  v_cvt_pk_bf16_f32 v84, v84, v85
  v_accvgpr_write_b32 a152, v84
  v_cvt_pk_bf16_f32 v86, v86, v87
  v_accvgpr_write_b32 a153, v86
  v_mfma_f32_16x16x32_bf16 v[80:83], v[64:67], a[160:163], v[12:15]
  v_cvt_pk_bf16_f32 v88, v88, v89
  v_accvgpr_write_b32 a154, v88
  v_cvt_pk_bf16_f32 v90, v90, v91
  v_accvgpr_write_b32 a155, v90
  s_add_u32 s83, s83, 128
  v_mfma_f32_16x16x32_bf16 v[84:87], v[66:69], a[164:167], v[16:19]
  v_cvt_pk_bf16_f32 v92, v92, v93
  v_accvgpr_write_b32 a156, v92
  v_cvt_pk_bf16_f32 v94, v94, v95
  v_accvgpr_write_b32 a157, v94
  v_mfma_f32_16x16x32_bf16 v[88:91], v[64:67], a[164:167], v[16:19]
  v_cvt_pk_bf16_f32 v96, v96, v97
  v_accvgpr_write_b32 a158, v96
  v_cvt_pk_bf16_f32 v98, v98, v99
  v_accvgpr_write_b32 a159, v98
  v_mfma_f32_16x16x32_bf16 v[92:95], v[66:69], a[168:171], v[12:15]
  v_cvt_pk_bf16_f32 v76, v76, v77
  v_accvgpr_write_b32 a160, v76
  v_cvt_pk_bf16_f32 v78, v78, v79
  v_accvgpr_write_b32 a161, v78
  v_mfma_f32_16x16x32_bf16 v[96:99], v[64:67], a[168:171], v[12:15]
  v_cvt_pk_bf16_f32 v80, v80, v81
  v_accvgpr_write_b32 a162, v80
  v_cvt_pk_bf16_f32 v82, v82, v83
  v_accvgpr_write_b32 a163, v82
  v_mfma_f32_16x16x32_bf16 v[76:79], v[66:69], a[172:175], v[16:19]
  v_cvt_pk_bf16_f32 v84, v84, v85
  v_accvgpr_write_b32 a164, v84
  v_cvt_pk_bf16_f32 v86, v86, v87
  v_accvgpr_write_b32 a165, v86
  v_mfma_f32_16x16x32_bf16 v[80:83], v[64:67], a[172:175], v[16:19]
  v_cvt_pk_bf16_f32 v88, v88, v89
  v_accvgpr_write_b32 a166, v88
  v_cvt_pk_bf16_f32 v90, v90, v91
  v_accvgpr_write_b32 a167, v90
  v_mfma_f32_16x16x32_bf16 v[84:87], v[66:69], a[176:179], v[12:15]
  v_cvt_pk_bf16_f32 v92, v92, v93
  v_accvgpr_write_b32 a168, v92
  v_cvt_pk_bf16_f32 v94, v94, v95
  v_accvgpr_write_b32 a169, v94
  v_mfma_f32_16x16x32_bf16 v[88:91], v[64:67], a[176:179], v[12:15]
  v_cvt_pk_bf16_f32 v96, v96, v97
  v_accvgpr_write_b32 a170, v96
  v_cvt_pk_bf16_f32 v98, v98, v99
  v_accvgpr_write_b32 a171, v98
  v_mfma_f32_16x16x32_bf16 v[92:95], v[66:69], a[180:183], v[16:19]
  v_cvt_pk_bf16_f32 v76, v76, v77
  v_accvgpr_write_b32 a172, v76
  v_cvt_pk_bf16_f32 v78, v78, v79
  v_accvgpr_write_b32 a173, v78
  v_mfma_f32_16x16x32_bf16 v[96:99], v[64:67], a[180:183], v[16:19]
  v_cvt_pk_bf16_f32 v80, v80, v81
  v_accvgpr_write_b32 a174, v80
  v_cvt_pk_bf16_f32 v82, v82, v83
  v_accvgpr_write_b32 a175, v82
  v_cvt_pk_bf16_f32 v84, v84, v85
  v_accvgpr_write_b32 a176, v84
  v_cvt_pk_bf16_f32 v86, v86, v87
  v_accvgpr_write_b32 a177, v86
  v_cvt_pk_bf16_f32 v88, v88, v89
  v_accvgpr_write_b32 a178, v88
  v_cvt_pk_bf16_f32 v90, v90, v91
  v_accvgpr_write_b32 a179, v90
  v_cvt_pk_bf16_f32 v92, v92, v93
  v_accvgpr_write_b32 a180, v92
  v_cvt_pk_bf16_f32 v94, v94, v95
  v_accvgpr_write_b32 a181, v94
  v_cvt_pk_bf16_f32 v96, v96, v97
  v_accvgpr_write_b32 a182, v96
  v_cvt_pk_bf16_f32 v98, v98, v99
  v_accvgpr_write_b32 a183, v98
  s_waitcnt vmcnt(38)
  v_readfirstlane_b32 s48, v58
  v_readfirstlane_b32 s49, v59
  s_cmp_eq_u32 s48, 0
  s_cbranch_scc1 recurrent_scan__linear_attn_block__glu_gated_bilinear__prompt_kernel_kk_nw
recurrent_scan__linear_attn_block__glu_gated_bilinear__prompt_kernel_kk_nd:
  v_mov_b32 v124, v52
  v_mov_b32 v125, v53
  v_bfe_u32 v56, v0, 5, 1
  v_mul_u32_u24 v56, 6144, v56
  v_and_b32 v41, 0x5ff, v100
  s_lshl_b32 s67, s58, 6
  v_xor_b32 v41, s67, v41
  s_mul_i32 s67, s58, 8
  s_add_u32 s67, s67, s60
  s_add_u32 s67, s67, 0
  s_and_b32 s68, s67, 3
  s_lshl_b32 s68, s68, 5
  s_lshr_b32 s67, s67, 2
  s_lshl_b32 s67, s67, 11
  v_xor_b32 v120, s68, v41
  v_add3_u32 v120, v120, s67, v56
  s_mul_i32 s67, s58, 6
  s_add_u32 s67, s67, s60
  s_add_u32 s67, s67, 1
  s_and_b32 s68, s67, 3
  s_lshl_b32 s68, s68, 5
  s_lshr_b32 s67, s67, 2
  s_lshl_b32 s67, s67, 11
  v_xor_b32 v121, s68, v41
  v_add3_u32 v121, v121, s67, v56
  s_mul_i32 s67, s58, 4
  s_add_u32 s67, s67, s60
  s_add_u32 s67, s67, 2
  s_and_b32 s68, s67, 3
  s_lshl_b32 s68, s68, 5
  s_lshr_b32 s67, s67, 2
  s_lshl_b32 s67, s67, 11
  v_xor_b32 v122, s68, v41
  v_add3_u32 v122, v122, s67, v56
  s_mul_i32 s67, s58, 2
  s_add_u32 s67, s67, s60
  s_add_u32 s67, s67, 3
  s_and_b32 s68, s67, 3
  s_lshl_b32 s68, s68, 5
  s_lshr_b32 s67, s67, 2
  s_lshl_b32 s67, s67, 11
  v_xor_b32 v123, s68, v41
  v_add3_u32 v123, v123, s67, v56
  s_mul_i32 s67, s58, 0
  s_add_u32 s67, s67, s60
  s_add_u32 s67, s67, 4
  s_and_b32 s68, s67, 3
  s_lshl_b32 s68, s68, 5
  s_lshr_b32 s67, s67, 2
  s_lshl_b32 s67, s67, 11
  v_xor_b32 v118, s68, v41
  v_add3_u32 v118, v118, s67, v56
  s_waitcnt vmcnt(32)
  s_barrier
  ds_read_b64_tr_b16 a[0:1], v118 offset:0
  ds_read_b64_tr_b16 a[2:3], v118 offset:512
  ds_read_b64_tr_b16 a[4:5], v118 offset:12288
  ds_read_b64_tr_b16 a[6:7], v118 offset:12800
  ds_read_b64_tr_b16 a[8:9], v120 offset:0
  ds_read_b64_tr_b16 a[10:11], v120 offset:512
  ds_read_b64_tr_b16 a[12:13], v120 offset:12288
  ds_read_b64_tr_b16 a[14:15], v120 offset:12800
  s_waitcnt lgkmcnt(4)
  v_mfma_f32_16x16x32_bf16 a[232:235], v[128:131], a[0:3], 0
  ds_read_b64_tr_b16 a[16:17], v121 offset:0
  s_lshl_b32 s78, s59, 2
  v_mfma_f32_16x16x32_bf16 a[232:235], v[136:139], a[4:7], a[232:235]
  ds_read_b64_tr_b16 a[18:19], v121 offset:512
  s_add_u32 s78, s78, s60
  v_mfma_f32_16x16x32_bf16 a[236:239], v[132:135], a[0:3], 0
  s_waitcnt lgkmcnt(2)
  ds_read_b64_tr_b16 a[20:21], v121 offset:12288
  v_mfma_f32_16x16x32_bf16 a[236:239], v[140:143], a[4:7], a[236:239]
  ds_read_b64_tr_b16 a[22:23], v121 offset:12800
  s_lshl_b32 s78, s78, 2
  v_mfma_f32_16x16x32_bf16 v[92:95], v[128:131], a[8:11], 0
  ds_read_b64_tr_b16 a[0:1], v122 offset:0
  s_add_u32 s77, s78, s56
  v_mfma_f32_16x16x32_bf16 v[92:95], v[136:139], a[12:15], v[92:95]
  s_mul_i32 s78, s77, 6912
  v_lshrrev_b32 v84, 4, v108
  v_mfma_f32_16x16x32_bf16 v[96:99], v[132:135], a[8:11], 0
  ds_read_b64_tr_b16 a[2:3], v122 offset:512
  v_min_u32 v85, 20, v84
  v_mfma_f32_16x16x32_bf16 v[96:99], v[140:143], a[12:15], v[96:99]
  v_min_u32 v84, 53, v84
  v_lshlrev_b32 v84, 7, v84
  v_mfma_f32_16x16x32_bf16 a[248:251], a[40:43], a[8:11], 0
  ds_read_b64_tr_b16 a[4:5], v122 offset:12288
  v_lshlrev_b32 v85, 7, v85
  v_mfma_f32_16x16x32_bf16 a[248:251], a[48:51], a[12:15], a[248:251]
  s_mov_b32 s24, s28
  s_mov_b32 s25, s29
  v_mfma_f32_16x16x32_bf16 a[252:255], a[44:47], a[8:11], 0
  s_waitcnt lgkmcnt(3)
  ds_read_b64_tr_b16 a[6:7], v122 offset:12800
  v_mfma_f32_16x16x32_bf16 a[252:255], a[52:55], a[12:15], a[252:255]
  s_mov_b32 s26, 5308416
  v_mfma_f32_16x16x32_bf16 a[184:187], v[128:131], a[16:19], 0
  ds_read_b64_tr_b16 a[8:9], v123 offset:0
  v_mfma_f32_16x16x32_bf16 a[184:187], v[136:139], a[20:23], a[184:187]
  buffer_load_dword v109, v84, s[24:27], s78 offen
  v_mfma_f32_16x16x32_bf16 a[188:191], v[132:135], a[16:19], 0
  ds_read_b64_tr_b16 a[10:11], v123 offset:512
  s_add_u32 s78, s78, 1769472
  v_mfma_f32_16x16x32_bf16 a[188:191], v[140:143], a[20:23], a[188:191]
  v_mfma_f32_16x16x32_bf16 a[192:195], a[40:43], a[16:19], 0
  ds_read_b64_tr_b16 a[12:13], v123 offset:12288
  v_mfma_f32_16x16x32_bf16 a[192:195], a[48:51], a[20:23], a[192:195]
  v_mfma_f32_16x16x32_bf16 a[196:199], a[44:47], a[16:19], 0
  s_waitcnt lgkmcnt(3)
  ds_read_b64_tr_b16 a[14:15], v123 offset:12800
  v_mfma_f32_16x16x32_bf16 a[196:199], a[52:55], a[20:23], a[196:199]
  s_waitcnt vmcnt(27)
  v_mfma_f32_16x16x32_bf16 a[200:203], v[128:131], a[0:3], 0
  s_barrier
  v_mfma_f32_16x16x32_bf16 a[200:203], v[136:139], a[4:7], a[200:203]
  ds_read_b64_tr_b16 a[16:17], v118 offset:24576
  v_mfma_f32_16x16x32_bf16 a[204:207], v[132:135], a[0:3], 0
  v_mfma_f32_16x16x32_bf16 a[204:207], v[140:143], a[4:7], a[204:207]
  ds_read_b64_tr_b16 a[18:19], v118 offset:25088
  v_mfma_f32_16x16x32_bf16 a[208:211], a[40:43], a[0:3], 0
  v_mfma_f32_16x16x32_bf16 a[208:211], a[48:51], a[4:7], a[208:211]
  ds_read_b64_tr_b16 a[20:21], v118 offset:36864
  v_mfma_f32_16x16x32_bf16 a[212:215], a[44:47], a[0:3], 0
  v_mfma_f32_16x16x32_bf16 a[212:215], a[52:55], a[4:7], a[212:215]
  ds_read_b64_tr_b16 a[22:23], v118 offset:37376
  s_waitcnt lgkmcnt(4)
  v_mfma_f32_16x16x32_bf16 a[216:219], v[128:131], a[8:11], 0
  ds_read_b64_tr_b16 a[0:1], v120 offset:24576
  v_mfma_f32_16x16x32_bf16 a[216:219], v[136:139], a[12:15], a[216:219]
  ds_read_b64_tr_b16 a[2:3], v120 offset:25088
  v_mfma_f32_16x16x32_bf16 a[220:223], v[132:135], a[8:11], 0
  ds_read_b64_tr_b16 a[4:5], v120 offset:36864
  s_mov_b32 s38, 0
  v_mfma_f32_16x16x32_bf16 a[220:223], v[140:143], a[12:15], a[220:223]
  ds_read_b64_tr_b16 a[6:7], v120 offset:37376
  s_mov_b32 s43, 0
  v_mfma_f32_16x16x32_bf16 a[224:227], a[40:43], a[8:11], 0
  s_mov_b32 s46, 0
  s_mov_b32 s51, 0
  v_mfma_f32_16x16x32_bf16 a[224:227], a[48:51], a[12:15], a[224:227]
  s_mov_b32 s90, 0x35c1a2a0
  s_mov_b32 s91, 0x35c1a2a0
  v_mfma_f32_16x16x32_bf16 a[228:231], a[44:47], a[8:11], 0
  s_waitcnt lgkmcnt(4)
  s_mov_b32 s88, 0x3fb8aa3b
  v_mfma_f32_16x16x32_bf16 a[228:231], a[52:55], a[12:15], a[228:231]
  s_mov_b32 s89, 0x3fb8aa3b
  v_and_b32 v126, 15, v0
  v_mfma_f32_16x16x32_bf16 a[232:235], v[144:147], a[16:19], a[232:235]
  ds_read_b64_tr_b16 a[8:9], v121 offset:24576
  v_lshlrev_b32 v126, 2, v126
  v_mfma_f32_16x16x32_bf16 a[232:235], v[152:155], a[20:23], a[232:235]
  ds_read_b64_tr_b16 a[10:11], v121 offset:25088
  v_add_u32 v126, s80, v126
  v_mfma_f32_16x16x32_bf16 a[236:239], v[148:151], a[16:19], a[236:239]
  s_waitcnt lgkmcnt(2)
  ds_read_b64_tr_b16 a[12:13], v121 offset:36864
  v_mfma_f32_16x16x32_bf16 a[236:239], v[156:159], a[20:23], a[236:239]
  ds_read_b64_tr_b16 a[14:15], v121 offset:37376
  ds_write_b32 v126, v110 offset:0
  v_mfma_f32_16x16x32_bf16 v[92:95], v[144:147], a[0:3], v[92:95]
  ds_read_b64_tr_b16 a[16:17], v122 offset:24576
  ds_write_b32 v126, v111 offset:64
  v_mfma_f32_16x16x32_bf16 v[92:95], v[152:155], a[4:7], v[92:95]
  ds_write_b32 v126, v112 offset:128
  ds_write_b32 v126, v113 offset:192
  v_mfma_f32_16x16x32_bf16 v[96:99], v[148:151], a[0:3], v[96:99]
  ds_read_b64_tr_b16 a[18:19], v122 offset:25088
  v_bfe_u32 v126, v0, 4, 2
  v_mfma_f32_16x16x32_bf16 v[96:99], v[156:159], a[4:7], v[96:99]
  v_lshlrev_b32 v126, 4, v126
  v_add_u32 v126, s80, v126
  v_mfma_f32_16x16x32_bf16 a[248:251], a[56:59], a[0:3], a[248:251]
  ds_read_b64_tr_b16 a[20:21], v122 offset:36864
  ds_read_b64 v[110:111], v126 offset:0
  v_mfma_f32_16x16x32_bf16 a[248:251], a[64:67], a[4:7], a[248:251]
  ds_read_b64 v[112:113], v126 offset:8
  s_lshl_b32 s68, s59, 1
  v_mfma_f32_16x16x32_bf16 a[252:255], a[60:63], a[0:3], a[252:255]
  s_waitcnt lgkmcnt(9)
  ds_read_b64_tr_b16 a[22:23], v122 offset:37376
  v_mfma_f32_16x16x32_bf16 a[252:255], a[68:71], a[4:7], a[252:255]
  s_add_u32 s68, s68, s57
  s_lshl_b32 s68, s68, 3
  v_mfma_f32_16x16x32_bf16 a[184:187], v[144:147], a[8:11], a[184:187]
  ds_read_b64_tr_b16 a[0:1], v123 offset:24576
  s_lshl_b32 s67, s60, 1
  v_mfma_f32_16x16x32_bf16 a[184:187], v[152:155], a[12:15], a[184:187]
  s_add_u32 s67, s67, s58
  s_add_u32 s68, s68, s67
  v_mfma_f32_16x16x32_bf16 a[188:191], v[148:151], a[8:11], a[188:191]
  ds_read_b64_tr_b16 a[2:3], v123 offset:25088
  s_mul_i32 s68, s68, 18432
  v_mfma_f32_16x16x32_bf16 a[188:191], v[156:159], a[12:15], a[188:191]
  s_add_u32 s68, s68, 21233664
  v_mfma_f32_16x16x32_bf16 a[192:195], a[56:59], a[8:11], a[192:195]
  ds_read_b64_tr_b16 a[4:5], v123 offset:36864
  v_mfma_f32_16x16x32_bf16 a[192:195], a[64:67], a[12:15], a[192:195]
  buffer_load_dword v109, v84, s[24:27], s78 offen
  v_mfma_f32_16x16x32_bf16 a[196:199], a[60:63], a[8:11], a[196:199]
  s_waitcnt lgkmcnt(3)
  ds_read_b64_tr_b16 a[6:7], v123 offset:37376
  v_mfma_f32_16x16x32_bf16 a[196:199], a[68:71], a[12:15], a[196:199]
  v_add_u32 v120, 0xc000, v120
  v_add_u32 v121, 0xc000, v121
  v_add_u32 v122, 0xc000, v122
  v_add_u32 v123, 0xc000, v123
  v_add_u32 v118, 0xc000, v118
  s_waitcnt vmcnt(22)
  v_mfma_f32_16x16x32_bf16 a[200:203], v[144:147], a[16:19], a[200:203]
  s_barrier
  s_add_u32 s78, s78, 1769472
  v_mfma_f32_16x16x32_bf16 a[200:203], v[152:155], a[20:23], a[200:203]
  ds_read_b64_tr_b16 a[8:9], v118 offset:0
  s_add_u32 m0, s82, 0
  v_mfma_f32_16x16x32_bf16 a[204:207], v[148:151], a[16:19], a[204:207]
  buffer_load_dwordx4 v124, s[8:11], s74 offen offset:0 lds
  v_mfma_f32_16x16x32_bf16 a[204:207], v[156:159], a[20:23], a[204:207]
  ds_read_b64_tr_b16 a[10:11], v118 offset:512
  v_mfma_f32_16x16x32_bf16 a[208:211], a[56:59], a[16:19], a[208:211]
  v_mfma_f32_16x16x32_bf16 a[208:211], a[64:67], a[20:23], a[208:211]
  ds_read_b64_tr_b16 a[12:13], v118 offset:12288
  v_mfma_f32_16x16x32_bf16 a[212:215], a[60:63], a[16:19], a[212:215]
  buffer_load_dwordx4 v125, s[8:11], s74 offen offset:1024 lds
  v_mfma_f32_16x16x32_bf16 a[212:215], a[68:71], a[20:23], a[212:215]
  ds_read_b64_tr_b16 a[14:15], v118 offset:12800
  s_waitcnt lgkmcnt(4)
  v_mfma_f32_16x16x32_bf16 a[216:219], v[144:147], a[0:3], a[216:219]
  ds_read_b64_tr_b16 a[16:17], v120 offset:0
  v_mfma_f32_16x16x32_bf16 a[216:219], v[152:155], a[4:7], a[216:219]
  ds_read_b64_tr_b16 a[18:19], v120 offset:512
  v_mfma_f32_16x16x32_bf16 a[220:223], v[148:151], a[0:3], a[220:223]
  ds_read_b64_tr_b16 a[20:21], v120 offset:12288
  v_mfma_f32_16x16x32_bf16 a[220:223], v[156:159], a[4:7], a[220:223]
  ds_read_b64_tr_b16 a[22:23], v120 offset:12800
  s_add_u32 s74, s74, 0x36000
  v_mfma_f32_16x16x32_bf16 a[224:227], a[56:59], a[0:3], a[224:227]
  buffer_load_dwordx4 v124, s[8:11], s75 offen offset:2048 lds
  v_mfma_f32_16x16x32_bf16 a[224:227], a[64:67], a[4:7], a[224:227]
  v_mfma_f32_16x16x32_bf16 a[228:231], a[60:63], a[0:3], a[228:231]
  s_waitcnt lgkmcnt(4)
  v_mfma_f32_16x16x32_bf16 a[228:231], a[68:71], a[4:7], a[228:231]
  v_mfma_f32_16x16x32_bf16 a[232:235], v[160:163], a[8:11], a[232:235]
  ds_read_b64_tr_b16 a[0:1], v121 offset:0
  v_mfma_f32_16x16x32_bf16 a[232:235], v[168:171], a[12:15], a[232:235]
  ds_read_b64_tr_b16 a[2:3], v121 offset:512
  v_mfma_f32_16x16x32_bf16 a[236:239], v[164:167], a[8:11], a[236:239]
  s_waitcnt lgkmcnt(2)
  ds_read_b64_tr_b16 a[4:5], v121 offset:12288
  v_mfma_f32_16x16x32_bf16 a[236:239], v[172:175], a[12:15], a[236:239]
  ds_read_b64_tr_b16 a[6:7], v121 offset:12800
  v_mfma_f32_16x16x32_bf16 v[92:95], v[160:163], a[16:19], v[92:95]
  ds_read_b64_tr_b16 a[8:9], v122 offset:0
  v_mfma_f32_16x16x32_bf16 v[92:95], v[168:171], a[20:23], v[92:95]
  buffer_load_dwordx4 v125, s[8:11], s75 offen offset:3072 lds
  v_mfma_f32_16x16x32_bf16 v[96:99], v[164:167], a[16:19], v[96:99]
  ds_read_b64_tr_b16 a[10:11], v122 offset:512
  s_add_u32 s75, s75, 0x36000
  v_mfma_f32_16x16x32_bf16 v[96:99], v[172:175], a[20:23], v[96:99]
  s_add_u32 m0, s82, 4096
  v_mfma_f32_16x16x32_bf16 a[248:251], a[72:75], a[16:19], a[248:251]
  ds_read_b64_tr_b16 a[12:13], v122 offset:12288
  v_mfma_f32_16x16x32_bf16 a[248:251], a[80:83], a[20:23], a[248:251]
  buffer_load_dwordx4 v124, s[8:11], s76 offen offset:0 lds
  v_mfma_f32_16x16x32_bf16 a[252:255], a[76:79], a[16:19], a[252:255]
  s_waitcnt lgkmcnt(3)
  ds_read_b64_tr_b16 a[14:15], v122 offset:12800
  v_mfma_f32_16x16x32_bf16 a[252:255], a[84:87], a[20:23], a[252:255]
  v_mfma_f32_16x16x32_bf16 a[184:187], v[160:163], a[0:3], a[184:187]
  ds_read_b64_tr_b16 a[16:17], v123 offset:0
  v_mfma_f32_16x16x32_bf16 a[184:187], v[168:171], a[4:7], a[184:187]
  buffer_load_dwordx4 v125, s[8:11], s76 offen offset:1024 lds
  v_mfma_f32_16x16x32_bf16 a[188:191], v[164:167], a[0:3], a[188:191]
  ds_read_b64_tr_b16 a[18:19], v123 offset:512
  s_add_u32 s76, s76, 0x36000
  v_mfma_f32_16x16x32_bf16 a[188:191], v[172:175], a[4:7], a[188:191]
  v_mfma_f32_16x16x32_bf16 a[192:195], a[72:75], a[0:3], a[192:195]
  ds_read_b64_tr_b16 a[20:21], v123 offset:12288
  v_mfma_f32_16x16x32_bf16 a[192:195], a[80:83], a[4:7], a[192:195]
  v_mfma_f32_16x16x32_bf16 a[196:199], a[76:79], a[0:3], a[196:199]
  s_waitcnt lgkmcnt(3)
  ds_read_b64_tr_b16 a[22:23], v123 offset:12800
  v_mfma_f32_16x16x32_bf16 a[196:199], a[84:87], a[4:7], a[196:199]
  s_waitcnt vmcnt(22)
  v_mfma_f32_16x16x32_bf16 a[200:203], v[160:163], a[8:11], a[200:203]
  s_barrier
  v_mfma_f32_16x16x32_bf16 a[200:203], v[168:171], a[12:15], a[200:203]
  ds_read_b64_tr_b16 a[0:1], v118 offset:24576
  s_add_u32 m0, s82, 24576
  v_mfma_f32_16x16x32_bf16 a[204:207], v[164:167], a[8:11], a[204:207]
  buffer_load_dwordx4 v124, s[8:11], s74 offen offset:0 lds
  v_mfma_f32_16x16x32_bf16 a[204:207], v[172:175], a[12:15], a[204:207]
  ds_read_b64_tr_b16 a[2:3], v118 offset:25088
  v_mfma_f32_16x16x32_bf16 a[208:211], a[72:75], a[8:11], a[208:211]
  v_mfma_f32_16x16x32_bf16 a[208:211], a[80:83], a[12:15], a[208:211]
  ds_read_b64_tr_b16 a[4:5], v118 offset:36864
  v_mfma_f32_16x16x32_bf16 a[212:215], a[76:79], a[8:11], a[212:215]
  buffer_load_dwordx4 v125, s[8:11], s74 offen offset:1024 lds
  v_mfma_f32_16x16x32_bf16 a[212:215], a[84:87], a[12:15], a[212:215]
  ds_read_b64_tr_b16 a[6:7], v118 offset:37376
  s_waitcnt lgkmcnt(4)
  v_mfma_f32_16x16x32_bf16 a[216:219], v[160:163], a[16:19], a[216:219]
  ds_read_b64_tr_b16 a[8:9], v120 offset:24576
  v_mfma_f32_16x16x32_bf16 a[216:219], v[168:171], a[20:23], a[216:219]
  ds_read_b64_tr_b16 a[10:11], v120 offset:25088
  v_mfma_f32_16x16x32_bf16 a[220:223], v[164:167], a[16:19], a[220:223]
  ds_read_b64_tr_b16 a[12:13], v120 offset:36864
  v_mfma_f32_16x16x32_bf16 a[220:223], v[172:175], a[20:23], a[220:223]
  ds_read_b64_tr_b16 a[14:15], v120 offset:37376
  s_add_u32 s74, s74, 0x36000
  v_mfma_f32_16x16x32_bf16 a[224:227], a[72:75], a[16:19], a[224:227]
  buffer_load_dwordx4 v124, s[8:11], s75 offen offset:2048 lds
  v_mfma_f32_16x16x32_bf16 a[224:227], a[80:83], a[20:23], a[224:227]
  v_mfma_f32_16x16x32_bf16 a[228:231], a[76:79], a[16:19], a[228:231]
  s_waitcnt lgkmcnt(4)
  v_mfma_f32_16x16x32_bf16 a[228:231], a[84:87], a[20:23], a[228:231]
  v_mfma_f32_16x16x32_bf16 a[232:235], v[176:179], a[0:3], a[232:235]
  ds_read_b64_tr_b16 a[16:17], v121 offset:24576
  v_mfma_f32_16x16x32_bf16 a[232:235], v[184:187], a[4:7], a[232:235]
  ds_read_b64_tr_b16 a[18:19], v121 offset:25088
  v_mfma_f32_16x16x32_bf16 a[236:239], v[180:183], a[0:3], a[236:239]
  s_waitcnt lgkmcnt(2)
  ds_read_b64_tr_b16 a[20:21], v121 offset:36864
  v_mfma_f32_16x16x32_bf16 a[236:239], v[188:191], a[4:7], a[236:239]
  ds_read_b64_tr_b16 a[22:23], v121 offset:37376
  v_mfma_f32_16x16x32_bf16 v[92:95], v[176:179], a[8:11], v[92:95]
  ds_read_b64_tr_b16 a[0:1], v122 offset:24576
  v_mfma_f32_16x16x32_bf16 v[92:95], v[184:187], a[12:15], v[92:95]
  buffer_load_dwordx4 v125, s[8:11], s75 offen offset:3072 lds
  v_mfma_f32_16x16x32_bf16 v[96:99], v[180:183], a[8:11], v[96:99]
  ds_read_b64_tr_b16 a[2:3], v122 offset:25088
  s_add_u32 s75, s75, 0x36000
  v_mfma_f32_16x16x32_bf16 v[96:99], v[188:191], a[12:15], v[96:99]
  s_add_u32 m0, s82, 28672
  v_mfma_f32_16x16x32_bf16 a[248:251], a[88:91], a[8:11], a[248:251]
  ds_read_b64_tr_b16 a[4:5], v122 offset:36864
  v_mfma_f32_16x16x32_bf16 a[248:251], a[96:99], a[12:15], a[248:251]
  buffer_load_dwordx4 v124, s[8:11], s76 offen offset:0 lds
  v_mfma_f32_16x16x32_bf16 a[252:255], a[92:95], a[8:11], a[252:255]
  s_waitcnt lgkmcnt(3)
  ds_read_b64_tr_b16 a[6:7], v122 offset:37376
  v_mfma_f32_16x16x32_bf16 a[252:255], a[100:103], a[12:15], a[252:255]
  v_mfma_f32_16x16x32_bf16 a[184:187], v[176:179], a[16:19], a[184:187]
  ds_read_b64_tr_b16 a[8:9], v123 offset:24576
  v_mfma_f32_16x16x32_bf16 a[184:187], v[184:187], a[20:23], a[184:187]
  buffer_load_dwordx4 v125, s[8:11], s76 offen offset:1024 lds
  v_mfma_f32_16x16x32_bf16 a[188:191], v[180:183], a[16:19], a[188:191]
  ds_read_b64_tr_b16 a[10:11], v123 offset:25088
  s_add_u32 s76, s76, 0x36000
  v_mfma_f32_16x16x32_bf16 a[188:191], v[188:191], a[20:23], a[188:191]
  buffer_load_dword v109, v84, s[24:27], s78 offen
  v_mfma_f32_16x16x32_bf16 a[192:195], a[88:91], a[16:19], a[192:195]
  ds_read_b64_tr_b16 a[12:13], v123 offset:36864
  s_add_u32 s78, s78, 1769472
  v_mfma_f32_16x16x32_bf16 a[192:195], a[96:99], a[20:23], a[192:195]
  s_mov_b32 s24, s40
  s_mov_b32 s25, s41
  v_mfma_f32_16x16x32_bf16 a[196:199], a[92:95], a[16:19], a[196:199]
  s_waitcnt lgkmcnt(3)
  ds_read_b64_tr_b16 a[14:15], v123 offset:37376
  v_mfma_f32_16x16x32_bf16 a[196:199], a[100:103], a[20:23], a[196:199]
  v_add_u32 v120, 0xc000, v120
  v_add_u32 v121, 0xc000, v121
  v_add_u32 v122, 0xc000, v122
  v_add_u32 v123, 0xc000, v123
  v_add_u32 v118, 0xc000, v118
  s_waitcnt vmcnt(23)
  v_mfma_f32_16x16x32_bf16 a[200:203], v[176:179], a[0:3], a[200:203]
  s_barrier
  s_mov_b32 s26, 663552
  v_mfma_f32_16x16x32_bf16 a[200:203], v[184:187], a[4:7], a[200:203]
  ds_read_b64_tr_b16 a[16:17], v118 offset:0
  s_add_u32 m0, s82, 49152
  v_mfma_f32_16x16x32_bf16 a[204:207], v[180:183], a[0:3], a[204:207]
  buffer_load_dwordx4 v124, s[8:11], s74 offen offset:0 lds
  v_mfma_f32_16x16x32_bf16 a[204:207], v[188:191], a[4:7], a[204:207]
  ds_read_b64_tr_b16 a[18:19], v118 offset:512
  s_mul_i32 s78, s77, 2688
  v_mfma_f32_16x16x32_bf16 a[208:211], a[88:91], a[0:3], a[208:211]
  v_mfma_f32_16x16x32_bf16 a[208:211], a[96:99], a[4:7], a[208:211]
  ds_read_b64_tr_b16 a[20:21], v118 offset:12288
  v_mfma_f32_16x16x32_bf16 a[212:215], a[92:95], a[0:3], a[212:215]
  buffer_load_dwordx4 v125, s[8:11], s74 offen offset:1024 lds
  v_mfma_f32_16x16x32_bf16 a[212:215], a[100:103], a[4:7], a[212:215]
  ds_read_b64_tr_b16 a[22:23], v118 offset:12800
  s_waitcnt lgkmcnt(4)
  v_mfma_f32_16x16x32_bf16 a[216:219], v[176:179], a[8:11], a[216:219]
  ds_read_b64_tr_b16 a[0:1], v120 offset:0
  v_mfma_f32_16x16x32_bf16 a[216:219], v[184:187], a[12:15], a[216:219]
  ds_read_b64_tr_b16 a[2:3], v120 offset:512
  v_mfma_f32_16x16x32_bf16 a[220:223], v[180:183], a[8:11], a[220:223]
  ds_read_b64_tr_b16 a[4:5], v120 offset:12288
  v_mfma_f32_16x16x32_bf16 a[220:223], v[188:191], a[12:15], a[220:223]
  ds_read_b64_tr_b16 a[6:7], v120 offset:12800
  s_add_u32 s74, s74, 0xffe4fb80
  v_mfma_f32_16x16x32_bf16 a[224:227], a[88:91], a[8:11], a[224:227]
  buffer_load_dwordx4 v124, s[8:11], s75 offen offset:2048 lds
  v_mfma_f32_16x16x32_bf16 a[224:227], a[96:99], a[12:15], a[224:227]
  v_mfma_f32_16x16x32_bf16 a[228:231], a[92:95], a[8:11], a[228:231]
  s_waitcnt lgkmcnt(4)
  v_mfma_f32_16x16x32_bf16 a[228:231], a[100:103], a[12:15], a[228:231]
  v_mfma_f32_16x16x32_bf16 a[232:235], v[192:195], a[16:19], a[232:235]
  ds_read_b64_tr_b16 a[8:9], v121 offset:0
  v_mfma_f32_16x16x32_bf16 a[232:235], v[200:203], a[20:23], a[232:235]
  ds_read_b64_tr_b16 a[10:11], v121 offset:512
  v_mfma_f32_16x16x32_bf16 a[236:239], v[196:199], a[16:19], a[236:239]
  s_waitcnt lgkmcnt(2)
  ds_read_b64_tr_b16 a[12:13], v121 offset:12288
  v_mfma_f32_16x16x32_bf16 a[236:239], v[204:207], a[20:23], a[236:239]
  ds_read_b64_tr_b16 a[14:15], v121 offset:12800
  v_mfma_f32_16x16x32_bf16 v[92:95], v[192:195], a[0:3], v[92:95]
  ds_read_b64_tr_b16 a[16:17], v122 offset:0
  v_mfma_f32_16x16x32_bf16 v[92:95], v[200:203], a[4:7], v[92:95]
  buffer_load_dwordx4 v125, s[8:11], s75 offen offset:3072 lds
  v_mfma_f32_16x16x32_bf16 v[96:99], v[196:199], a[0:3], v[96:99]
  ds_read_b64_tr_b16 a[18:19], v122 offset:512
  s_add_u32 s75, s75, 0xffe4fb80
  v_mfma_f32_16x16x32_bf16 v[96:99], v[204:207], a[4:7], v[96:99]
  s_add_u32 m0, s82, 53248
  v_mfma_f32_16x16x32_bf16 a[248:251], a[104:107], a[0:3], a[248:251]
  ds_read_b64_tr_b16 a[20:21], v122 offset:12288
  v_mfma_f32_16x16x32_bf16 a[248:251], a[112:115], a[4:7], a[248:251]
  buffer_load_dwordx4 v124, s[8:11], s76 offen offset:0 lds
  v_mfma_f32_16x16x32_bf16 a[252:255], a[108:111], a[0:3], a[252:255]
  s_waitcnt lgkmcnt(3)
  ds_read_b64_tr_b16 a[22:23], v122 offset:12800
  v_mfma_f32_16x16x32_bf16 a[252:255], a[116:119], a[4:7], a[252:255]
  v_mfma_f32_16x16x32_bf16 a[184:187], v[192:195], a[8:11], a[184:187]
  ds_read_b64_tr_b16 a[0:1], v123 offset:0
  v_mfma_f32_16x16x32_bf16 a[184:187], v[200:203], a[12:15], a[184:187]
  buffer_load_dwordx4 v125, s[8:11], s76 offen offset:1024 lds
  v_mfma_f32_16x16x32_bf16 a[188:191], v[196:199], a[8:11], a[188:191]
  ds_read_b64_tr_b16 a[2:3], v123 offset:512
  s_add_u32 s76, s76, 0xffe4fb80
  v_mfma_f32_16x16x32_bf16 a[188:191], v[204:207], a[12:15], a[188:191]
  v_mfma_f32_16x16x32_bf16 a[192:195], a[104:107], a[8:11], a[192:195]
  ds_read_b64_tr_b16 a[4:5], v123 offset:12288
  v_mfma_f32_16x16x32_bf16 a[192:195], a[112:115], a[12:15], a[192:195]
  buffer_load_dword v109, v85, s[24:27], s78 offen
  v_mfma_f32_16x16x32_bf16 a[196:199], a[108:111], a[8:11], a[196:199]
  s_waitcnt lgkmcnt(3)
  ds_read_b64_tr_b16 a[6:7], v123 offset:12800
  v_mfma_f32_16x16x32_bf16 a[196:199], a[116:119], a[12:15], a[196:199]
  s_waitcnt vmcnt(24)
  s_mov_b32 s24, s20
  v_mfma_f32_16x16x32_bf16 a[200:203], v[192:195], a[16:19], a[200:203]
  s_barrier
  s_mov_b32 s25, s21
  v_mfma_f32_16x16x32_bf16 a[200:203], v[200:203], a[20:23], a[200:203]
  ds_read_b64_tr_b16 a[8:9], v118 offset:24576
  s_add_u32 m0, s82, 73728
  v_mfma_f32_16x16x32_bf16 a[204:207], v[196:199], a[16:19], a[204:207]
  buffer_load_dwordx4 v124, s[8:11], s74 offen offset:0 lds
  v_mfma_f32_16x16x32_bf16 a[204:207], v[204:207], a[20:23], a[204:207]
  ds_read_b64_tr_b16 a[10:11], v118 offset:25088
  s_mov_b32 s26, 0
  v_mfma_f32_16x16x32_bf16 a[208:211], a[104:107], a[16:19], a[208:211]
  v_mfma_f32_16x16x32_bf16 a[208:211], a[112:115], a[20:23], a[208:211]
  ds_read_b64_tr_b16 a[12:13], v118 offset:36864
  v_mfma_f32_16x16x32_bf16 a[212:215], a[108:111], a[16:19], a[212:215]
  buffer_load_dwordx4 v125, s[8:11], s74 offen offset:1024 lds
  v_mfma_f32_16x16x32_bf16 a[212:215], a[116:119], a[20:23], a[212:215]
  ds_read_b64_tr_b16 a[14:15], v118 offset:37376
  s_waitcnt lgkmcnt(4)
  v_mfma_f32_16x16x32_bf16 a[216:219], v[192:195], a[0:3], a[216:219]
  ds_read_b64_tr_b16 a[16:17], v120 offset:24576
  v_mfma_f32_16x16x32_bf16 a[216:219], v[200:203], a[4:7], a[216:219]
  ds_read_b64_tr_b16 a[18:19], v120 offset:25088
  v_mfma_f32_16x16x32_bf16 a[220:223], v[196:199], a[0:3], a[220:223]
  ds_read_b64_tr_b16 a[20:21], v120 offset:36864
  v_mfma_f32_16x16x32_bf16 a[220:223], v[204:207], a[4:7], a[220:223]
  ds_read_b64_tr_b16 a[22:23], v120 offset:37376
  s_add_u32 s74, s74, 0x36000
  v_mfma_f32_16x16x32_bf16 a[224:227], a[104:107], a[0:3], a[224:227]
  buffer_load_dwordx4 v124, s[8:11], s75 offen offset:2048 lds
  v_mfma_f32_16x16x32_bf16 a[224:227], a[112:115], a[4:7], a[224:227]
  v_mfma_f32_16x16x32_bf16 a[228:231], a[108:111], a[0:3], a[228:231]
  s_waitcnt lgkmcnt(4)
  v_mfma_f32_16x16x32_bf16 a[228:231], a[116:119], a[4:7], a[228:231]
  v_mfma_f32_16x16x32_bf16 a[232:235], v[208:211], a[8:11], a[232:235]
  ds_read_b64_tr_b16 a[0:1], v121 offset:24576
  v_mfma_f32_16x16x32_bf16 a[232:235], v[216:219], a[12:15], a[232:235]
  ds_read_b64_tr_b16 a[2:3], v121 offset:25088
  v_mfma_f32_16x16x32_bf16 a[236:239], v[212:215], a[8:11], a[236:239]
  s_waitcnt lgkmcnt(2)
  ds_read_b64_tr_b16 a[4:5], v121 offset:36864
  v_mfma_f32_16x16x32_bf16 a[236:239], v[220:223], a[12:15], a[236:239]
  ds_read_b64_tr_b16 a[6:7], v121 offset:37376
  v_mfma_f32_16x16x32_bf16 v[92:95], v[208:211], a[16:19], v[92:95]
  ds_read_b64_tr_b16 a[8:9], v122 offset:24576
  v_mfma_f32_16x16x32_bf16 v[92:95], v[216:219], a[20:23], v[92:95]
  buffer_load_dwordx4 v125, s[8:11], s75 offen offset:3072 lds
  v_mfma_f32_16x16x32_bf16 v[96:99], v[212:215], a[16:19], v[96:99]
  ds_read_b64_tr_b16 a[10:11], v122 offset:25088
  s_add_u32 s75, s75, 0x36000
  v_mfma_f32_16x16x32_bf16 v[96:99], v[220:223], a[20:23], v[96:99]
  s_add_u32 m0, s82, 77824
  v_mfma_f32_16x16x32_bf16 a[248:251], a[120:123], a[16:19], a[248:251]
  ds_read_b64_tr_b16 a[12:13], v122 offset:36864
  v_mfma_f32_16x16x32_bf16 a[248:251], a[128:131], a[20:23], a[248:251]
  buffer_load_dwordx4 v124, s[8:11], s76 offen offset:0 lds
  v_mfma_f32_16x16x32_bf16 a[252:255], a[124:127], a[16:19], a[252:255]
  s_waitcnt lgkmcnt(3)
  ds_read_b64_tr_b16 a[14:15], v122 offset:37376
  v_mfma_f32_16x16x32_bf16 a[252:255], a[132:135], a[20:23], a[252:255]
  v_mfma_f32_16x16x32_bf16 a[184:187], v[208:211], a[0:3], a[184:187]
  ds_read_b64_tr_b16 a[16:17], v123 offset:24576
  v_mfma_f32_16x16x32_bf16 a[184:187], v[216:219], a[4:7], a[184:187]
  buffer_load_dwordx4 v125, s[8:11], s76 offen offset:1024 lds
  v_mfma_f32_16x16x32_bf16 a[188:191], v[212:215], a[0:3], a[188:191]
  ds_read_b64_tr_b16 a[18:19], v123 offset:25088
  s_add_u32 s76, s76, 0x36000
  v_mfma_f32_16x16x32_bf16 a[188:191], v[220:223], a[4:7], a[188:191]
  v_mfma_f32_16x16x32_bf16 a[192:195], a[120:123], a[0:3], a[192:195]
  ds_read_b64_tr_b16 a[20:21], v123 offset:36864
  v_mfma_f32_16x16x32_bf16 a[192:195], a[128:131], a[4:7], a[192:195]
  v_mfma_f32_16x16x32_bf16 a[196:199], a[124:127], a[0:3], a[196:199]
  s_waitcnt lgkmcnt(3)
  ds_read_b64_tr_b16 a[22:23], v123 offset:37376
  v_mfma_f32_16x16x32_bf16 a[196:199], a[132:135], a[4:7], a[196:199]
  v_add_u32 v120, 0xfffe8000, v120
  v_add_u32 v121, 0xfffe8000, v121
  v_add_u32 v122, 0xfffe8000, v122
  v_add_u32 v123, 0xfffe8000, v123
  v_add_u32 v118, 0xfffe8000, v118
  s_waitcnt vmcnt(20)
  v_mfma_f32_16x16x32_bf16 a[200:203], v[208:211], a[8:11], a[200:203]
  s_barrier
  v_mfma_f32_16x16x32_bf16 a[200:203], v[216:219], a[12:15], a[200:203]
  ds_read_b64_tr_b16 a[0:1], v118 offset:0
  s_add_u32 m0, s82, 98304
  v_mfma_f32_16x16x32_bf16 a[204:207], v[212:215], a[8:11], a[204:207]
  buffer_load_dwordx4 v124, s[8:11], s74 offen offset:0 lds
  v_mfma_f32_16x16x32_bf16 a[204:207], v[220:223], a[12:15], a[204:207]
  ds_read_b64_tr_b16 a[2:3], v118 offset:512
  v_mfma_f32_16x16x32_bf16 a[208:211], a[120:123], a[8:11], a[208:211]
  v_mfma_f32_16x16x32_bf16 a[208:211], a[128:131], a[12:15], a[208:211]
  ds_read_b64_tr_b16 a[4:5], v118 offset:12288
  v_mfma_f32_16x16x32_bf16 a[212:215], a[124:127], a[8:11], a[212:215]
  buffer_load_dwordx4 v125, s[8:11], s74 offen offset:1024 lds
  v_mfma_f32_16x16x32_bf16 a[212:215], a[132:135], a[12:15], a[212:215]
  ds_read_b64_tr_b16 a[6:7], v118 offset:12800
  s_waitcnt lgkmcnt(4)
  v_mfma_f32_16x16x32_bf16 a[216:219], v[208:211], a[16:19], a[216:219]
  ds_read_b64_tr_b16 a[8:9], v120 offset:0
  v_mfma_f32_16x16x32_bf16 a[216:219], v[216:219], a[20:23], a[216:219]
  ds_read_b64_tr_b16 a[10:11], v120 offset:512
  v_mfma_f32_16x16x32_bf16 a[220:223], v[212:215], a[16:19], a[220:223]
  ds_read_b64_tr_b16 a[12:13], v120 offset:12288
  v_mfma_f32_16x16x32_bf16 a[220:223], v[220:223], a[20:23], a[220:223]
  ds_read_b64_tr_b16 a[14:15], v120 offset:12800
  s_add_u32 s74, s74, 0x36000
  v_mfma_f32_16x16x32_bf16 a[224:227], a[120:123], a[16:19], a[224:227]
  buffer_load_dwordx4 v124, s[8:11], s75 offen offset:2048 lds
  v_mfma_f32_16x16x32_bf16 a[224:227], a[128:131], a[20:23], a[224:227]
  v_mfma_f32_16x16x32_bf16 a[228:231], a[124:127], a[16:19], a[228:231]
  s_waitcnt lgkmcnt(4)
  v_mfma_f32_16x16x32_bf16 a[228:231], a[132:135], a[20:23], a[228:231]
  v_mfma_f32_16x16x32_bf16 a[232:235], v[224:227], a[0:3], a[232:235]
  ds_read_b64_tr_b16 a[16:17], v121 offset:0
  v_mfma_f32_16x16x32_bf16 a[232:235], v[232:235], a[4:7], a[232:235]
  ds_read_b64_tr_b16 a[18:19], v121 offset:512
  v_mfma_f32_16x16x32_bf16 a[236:239], v[228:231], a[0:3], a[236:239]
  s_waitcnt lgkmcnt(2)
  ds_read_b64_tr_b16 a[20:21], v121 offset:12288
  v_mfma_f32_16x16x32_bf16 a[236:239], v[236:239], a[4:7], a[236:239]
  ds_read_b64_tr_b16 a[22:23], v121 offset:12800
  v_mfma_f32_16x16x32_bf16 v[92:95], v[224:227], a[8:11], v[92:95]
  ds_read_b64_tr_b16 a[0:1], v122 offset:0
  v_mfma_f32_16x16x32_bf16 v[92:95], v[232:235], a[12:15], v[92:95]
  buffer_load_dwordx4 v125, s[8:11], s75 offen offset:3072 lds
  v_mfma_f32_16x16x32_bf16 v[96:99], v[228:231], a[8:11], v[96:99]
  ds_read_b64_tr_b16 a[2:3], v122 offset:512
  s_add_u32 s75, s75, 0x36000
  v_mfma_f32_16x16x32_bf16 v[96:99], v[236:239], a[12:15], v[96:99]
  s_add_u32 m0, s82, 102400
  v_mfma_f32_16x16x32_bf16 a[248:251], a[136:139], a[8:11], a[248:251]
  ds_read_b64_tr_b16 a[4:5], v122 offset:12288
  v_mfma_f32_16x16x32_bf16 a[248:251], a[144:147], a[12:15], a[248:251]
  buffer_load_dwordx4 v124, s[8:11], s76 offen offset:0 lds
  v_mfma_f32_16x16x32_bf16 a[252:255], a[140:143], a[8:11], a[252:255]
  s_waitcnt lgkmcnt(3)
  ds_read_b64_tr_b16 a[6:7], v122 offset:12800
  v_mfma_f32_16x16x32_bf16 a[252:255], a[148:151], a[12:15], a[252:255]
  v_mfma_f32_16x16x32_bf16 a[184:187], v[224:227], a[16:19], a[184:187]
  ds_read_b64_tr_b16 a[8:9], v123 offset:0
  v_mfma_f32_16x16x32_bf16 a[184:187], v[232:235], a[20:23], a[184:187]
  buffer_load_dwordx4 v125, s[8:11], s76 offen offset:1024 lds
  v_mfma_f32_16x16x32_bf16 a[188:191], v[228:231], a[16:19], a[188:191]
  ds_read_b64_tr_b16 a[10:11], v123 offset:512
  s_add_u32 s76, s76, 0x36000
  v_mfma_f32_16x16x32_bf16 a[188:191], v[236:239], a[20:23], a[188:191]
  v_mfma_f32_16x16x32_bf16 a[192:195], a[136:139], a[16:19], a[192:195]
  ds_read_b64_tr_b16 a[12:13], v123 offset:12288
  v_mfma_f32_16x16x32_bf16 a[192:195], a[144:147], a[20:23], a[192:195]
  v_mfma_f32_16x16x32_bf16 a[196:199], a[140:143], a[16:19], a[196:199]
  s_waitcnt lgkmcnt(3)
  ds_read_b64_tr_b16 a[14:15], v123 offset:12800
  v_mfma_f32_16x16x32_bf16 a[196:199], a[148:151], a[20:23], a[196:199]
  s_waitcnt vmcnt(20)
  v_mfma_f32_16x16x32_bf16 a[200:203], v[224:227], a[0:3], a[200:203]
  s_barrier
  v_mfma_f32_16x16x32_bf16 a[200:203], v[232:235], a[4:7], a[200:203]
  ds_read_b64_tr_b16 a[16:17], v118 offset:24576
  s_add_u32 m0, s82, 122880
  v_mfma_f32_16x16x32_bf16 a[204:207], v[228:231], a[0:3], a[204:207]
  buffer_load_dwordx4 v124, s[8:11], s74 offen offset:0 lds
  v_mfma_f32_16x16x32_bf16 a[204:207], v[236:239], a[4:7], a[204:207]
  ds_read_b64_tr_b16 a[18:19], v118 offset:25088
  v_mfma_f32_16x16x32_bf16 a[208:211], a[136:139], a[0:3], a[208:211]
  v_mfma_f32_16x16x32_bf16 a[208:211], a[144:147], a[4:7], a[208:211]
  ds_read_b64_tr_b16 a[20:21], v118 offset:36864
  v_mfma_f32_16x16x32_bf16 a[212:215], a[140:143], a[0:3], a[212:215]
  buffer_load_dwordx4 v125, s[8:11], s74 offen offset:1024 lds
  v_mfma_f32_16x16x32_bf16 a[212:215], a[148:151], a[4:7], a[212:215]
  ds_read_b64_tr_b16 a[22:23], v118 offset:37376
  s_waitcnt lgkmcnt(4)
  v_mfma_f32_16x16x32_bf16 a[216:219], v[224:227], a[8:11], a[216:219]
  ds_read_b64_tr_b16 a[0:1], v120 offset:24576
  v_mfma_f32_16x16x32_bf16 a[216:219], v[232:235], a[12:15], a[216:219]
  ds_read_b64_tr_b16 a[2:3], v120 offset:25088
  v_mfma_f32_16x16x32_bf16 a[220:223], v[228:231], a[8:11], a[220:223]
  ds_read_b64_tr_b16 a[4:5], v120 offset:36864
  v_mfma_f32_16x16x32_bf16 a[220:223], v[236:239], a[12:15], a[220:223]
  ds_read_b64_tr_b16 a[6:7], v120 offset:37376
  s_add_u32 s74, s74, 0x36000
  v_mfma_f32_16x16x32_bf16 a[224:227], a[136:139], a[8:11], a[224:227]
  buffer_load_dwordx4 v124, s[8:11], s75 offen offset:2048 lds
  v_mfma_f32_16x16x32_bf16 a[224:227], a[144:147], a[12:15], a[224:227]
  v_mfma_f32_16x16x32_bf16 a[228:231], a[140:143], a[8:11], a[228:231]
  s_waitcnt lgkmcnt(4)
  v_mfma_f32_16x16x32_bf16 a[228:231], a[148:151], a[12:15], a[228:231]
  v_mfma_f32_16x16x32_bf16 a[232:235], v[240:243], a[16:19], a[232:235]
  ds_read_b64_tr_b16 a[8:9], v121 offset:24576
  v_mfma_f32_16x16x32_bf16 a[232:235], v[248:251], a[20:23], a[232:235]
  ds_read_b64_tr_b16 a[10:11], v121 offset:25088
  v_mfma_f32_16x16x32_bf16 a[236:239], v[244:247], a[16:19], a[236:239]
  s_waitcnt lgkmcnt(2)
  ds_read_b64_tr_b16 a[12:13], v121 offset:36864
  v_mfma_f32_16x16x32_bf16 a[236:239], v[252:255], a[20:23], a[236:239]
  ds_read_b64_tr_b16 a[14:15], v121 offset:37376
  v_mfma_f32_16x16x32_bf16 v[92:95], v[240:243], a[0:3], v[92:95]
  ds_read_b64_tr_b16 a[16:17], v122 offset:24576
  v_mfma_f32_16x16x32_bf16 v[92:95], v[248:251], a[4:7], v[92:95]
  buffer_load_dwordx4 v125, s[8:11], s75 offen offset:3072 lds
  v_mfma_f32_16x16x32_bf16 v[96:99], v[244:247], a[0:3], v[96:99]
  ds_read_b64_tr_b16 a[18:19], v122 offset:25088
  s_add_u32 s75, s75, 0x36000
  v_mfma_f32_16x16x32_bf16 v[96:99], v[252:255], a[4:7], v[96:99]
  s_add_u32 m0, s82, 126976
  v_mfma_f32_16x16x32_bf16 a[248:251], a[152:155], a[0:3], a[248:251]
  ds_read_b64_tr_b16 a[20:21], v122 offset:36864
  v_mfma_f32_16x16x32_bf16 a[248:251], a[160:163], a[4:7], a[248:251]
  buffer_load_dwordx4 v124, s[8:11], s76 offen offset:0 lds
  v_mfma_f32_16x16x32_bf16 a[252:255], a[156:159], a[0:3], a[252:255]
  s_waitcnt lgkmcnt(3)
  ds_read_b64_tr_b16 a[22:23], v122 offset:37376
  v_mfma_f32_16x16x32_bf16 a[252:255], a[164:167], a[4:7], a[252:255]
  v_mfma_f32_16x16x32_bf16 a[184:187], v[240:243], a[8:11], a[184:187]
  ds_read_b64_tr_b16 a[0:1], v123 offset:24576
  v_mfma_f32_16x16x32_bf16 a[184:187], v[248:251], a[12:15], a[184:187]
  buffer_load_dwordx4 v125, s[8:11], s76 offen offset:1024 lds
  v_mfma_f32_16x16x32_bf16 a[188:191], v[244:247], a[8:11], a[188:191]
  ds_read_b64_tr_b16 a[2:3], v123 offset:25088
  s_add_u32 s76, s76, 0x36000
  v_mfma_f32_16x16x32_bf16 a[188:191], v[252:255], a[12:15], a[188:191]
  v_mfma_f32_16x16x32_bf16 a[192:195], a[152:155], a[8:11], a[192:195]
  ds_read_b64_tr_b16 a[4:5], v123 offset:36864
  v_mfma_f32_16x16x32_bf16 a[192:195], a[160:163], a[12:15], a[192:195]
  v_mfma_f32_16x16x32_bf16 a[196:199], a[156:159], a[8:11], a[196:199]
  s_waitcnt lgkmcnt(3)
  ds_read_b64_tr_b16 a[6:7], v123 offset:37376
  v_mfma_f32_16x16x32_bf16 a[196:199], a[164:167], a[12:15], a[196:199]
  v_add_u32 v120, 0xc000, v120
  v_add_u32 v121, 0xc000, v121
  v_add_u32 v122, 0xc000, v122
  v_add_u32 v123, 0xc000, v123
  v_add_u32 v118, 0xc000, v118
  s_waitcnt vmcnt(19)
  v_mfma_f32_16x16x32_bf16 a[200:203], v[240:243], a[16:19], a[200:203]
  s_barrier
  v_mfma_f32_16x16x32_bf16 a[200:203], v[248:251], a[20:23], a[200:203]
  ds_read_b64_tr_b16 a[8:9], v118 offset:0
  s_add_u32 m0, s82, 0
  v_mfma_f32_16x16x32_bf16 a[204:207], v[244:247], a[16:19], a[204:207]
  buffer_load_dwordx4 v124, s[8:11], s74 offen offset:0 lds
  v_mfma_f32_16x16x32_bf16 a[204:207], v[252:255], a[20:23], a[204:207]
  ds_read_b64_tr_b16 a[10:11], v118 offset:512
  v_mfma_f32_16x16x32_bf16 a[208:211], a[152:155], a[16:19], a[208:211]
  v_mfma_f32_16x16x32_bf16 a[208:211], a[160:163], a[20:23], a[208:211]
  ds_read_b64_tr_b16 a[12:13], v118 offset:12288
  v_mfma_f32_16x16x32_bf16 a[212:215], a[156:159], a[16:19], a[212:215]
  buffer_load_dwordx4 v125, s[8:11], s74 offen offset:1024 lds
  v_mfma_f32_16x16x32_bf16 a[212:215], a[164:167], a[20:23], a[212:215]
  ds_read_b64_tr_b16 a[14:15], v118 offset:12800
  s_waitcnt lgkmcnt(4)
  v_mfma_f32_16x16x32_bf16 a[216:219], v[240:243], a[0:3], a[216:219]
  ds_read_b64_tr_b16 a[16:17], v120 offset:0
  v_mfma_f32_16x16x32_bf16 a[216:219], v[248:251], a[4:7], a[216:219]
  ds_read_b64_tr_b16 a[18:19], v120 offset:512
  v_mfma_f32_16x16x32_bf16 a[220:223], v[244:247], a[0:3], a[220:223]
  ds_read_b64_tr_b16 a[20:21], v120 offset:12288
  v_mfma_f32_16x16x32_bf16 a[220:223], v[252:255], a[4:7], a[220:223]
  ds_read_b64_tr_b16 a[22:23], v120 offset:12800
  s_add_u32 s74, s74, 0x36000
  v_mfma_f32_16x16x32_bf16 a[224:227], a[152:155], a[0:3], a[224:227]
  buffer_load_dwordx4 v124, s[8:11], s75 offen offset:2048 lds
  v_mfma_f32_16x16x32_bf16 a[224:227], a[160:163], a[4:7], a[224:227]
  v_mfma_f32_16x16x32_bf16 a[228:231], a[156:159], a[0:3], a[228:231]
  s_waitcnt lgkmcnt(4)
  v_mfma_f32_16x16x32_bf16 a[228:231], a[164:167], a[4:7], a[228:231]
  v_mfma_f32_16x16x32_bf16 a[232:235], a[24:27], a[8:11], a[232:235]
  ds_read_b64_tr_b16 a[0:1], v121 offset:0
  v_mfma_f32_16x16x32_bf16 a[232:235], a[32:35], a[12:15], a[232:235]
  ds_read_b64_tr_b16 a[2:3], v121 offset:512
  v_mfma_f32_16x16x32_bf16 a[236:239], a[28:31], a[8:11], a[236:239]
  s_waitcnt lgkmcnt(2)
  ds_read_b64_tr_b16 a[4:5], v121 offset:12288
  v_mfma_f32_16x16x32_bf16 a[236:239], a[36:39], a[12:15], a[236:239]
  ds_read_b64_tr_b16 a[6:7], v121 offset:12800
  v_mfma_f32_16x16x32_bf16 v[92:95], a[24:27], a[16:19], v[92:95]
  ds_read_b64_tr_b16 a[8:9], v122 offset:0
  v_mfma_f32_16x16x32_bf16 v[92:95], a[32:35], a[20:23], v[92:95]
  buffer_load_dwordx4 v125, s[8:11], s75 offen offset:3072 lds
  v_mfma_f32_16x16x32_bf16 v[96:99], a[28:31], a[16:19], v[96:99]
  ds_read_b64_tr_b16 a[10:11], v122 offset:512
  s_add_u32 s75, s75, 0x36000
  v_mfma_f32_16x16x32_bf16 v[96:99], a[36:39], a[20:23], v[96:99]
  s_add_u32 m0, s82, 4096
  v_mfma_f32_16x16x32_bf16 a[248:251], a[168:171], a[16:19], a[248:251]
  ds_read_b64_tr_b16 a[12:13], v122 offset:12288
  v_mfma_f32_16x16x32_bf16 a[248:251], a[176:179], a[20:23], a[248:251]
  buffer_load_dwordx4 v124, s[8:11], s76 offen offset:0 lds
  v_mfma_f32_16x16x32_bf16 a[252:255], a[172:175], a[16:19], a[252:255]
  s_waitcnt lgkmcnt(3)
  ds_read_b64_tr_b16 a[14:15], v122 offset:12800
  v_mfma_f32_16x16x32_bf16 a[252:255], a[180:183], a[20:23], a[252:255]
  v_mfma_f32_16x16x32_bf16 a[184:187], a[24:27], a[0:3], a[184:187]
  ds_read_b64_tr_b16 a[16:17], v123 offset:0
  v_mfma_f32_16x16x32_bf16 a[184:187], a[32:35], a[4:7], a[184:187]
  buffer_load_dwordx4 v125, s[8:11], s76 offen offset:1024 lds
  v_mfma_f32_16x16x32_bf16 a[188:191], a[28:31], a[0:3], a[188:191]
  ds_read_b64_tr_b16 a[18:19], v123 offset:512
  s_add_u32 s76, s76, 0x36000
  v_mfma_f32_16x16x32_bf16 a[188:191], a[36:39], a[4:7], a[188:191]
  v_mfma_f32_16x16x32_bf16 a[192:195], a[168:171], a[0:3], a[192:195]
  ds_read_b64_tr_b16 a[20:21], v123 offset:12288
  v_mfma_f32_16x16x32_bf16 a[192:195], a[176:179], a[4:7], a[192:195]
  v_mfma_f32_16x16x32_bf16 a[196:199], a[172:175], a[0:3], a[196:199]
  s_waitcnt lgkmcnt(3)
  ds_read_b64_tr_b16 a[22:23], v123 offset:12800
  v_mfma_f32_16x16x32_bf16 a[196:199], a[180:183], a[4:7], a[196:199]
  s_waitcnt vmcnt(18)
  v_mfma_f32_16x16x32_bf16 a[200:203], a[24:27], a[8:11], a[200:203]
  s_barrier
  v_mfma_f32_16x16x32_bf16 a[200:203], a[32:35], a[12:15], a[200:203]
  ds_read_b64_tr_b16 a[0:1], v118 offset:24576
  s_add_u32 m0, s82, 24576
  v_mfma_f32_16x16x32_bf16 a[204:207], a[28:31], a[8:11], a[204:207]
  buffer_load_dwordx4 v124, s[8:11], s74 offen offset:0 lds
  v_mfma_f32_16x16x32_bf16 a[204:207], a[36:39], a[12:15], a[204:207]
  ds_read_b64_tr_b16 a[2:3], v118 offset:25088
  v_mfma_f32_16x16x32_bf16 a[208:211], a[168:171], a[8:11], a[208:211]
  v_mfma_f32_16x16x32_bf16 a[208:211], a[176:179], a[12:15], a[208:211]
  ds_read_b64_tr_b16 a[4:5], v118 offset:36864
  v_mfma_f32_16x16x32_bf16 a[212:215], a[172:175], a[8:11], a[212:215]
  buffer_load_dwordx4 v125, s[8:11], s74 offen offset:1024 lds
  v_mfma_f32_16x16x32_bf16 a[212:215], a[180:183], a[12:15], a[212:215]
  ds_read_b64_tr_b16 a[6:7], v118 offset:37376
  s_waitcnt lgkmcnt(4)
  v_mfma_f32_16x16x32_bf16 a[216:219], a[24:27], a[16:19], a[216:219]
  ds_read_b64_tr_b16 a[8:9], v120 offset:24576
  v_mfma_f32_16x16x32_bf16 a[216:219], a[32:35], a[20:23], a[216:219]
  ds_read_b64_tr_b16 a[10:11], v120 offset:25088
  v_mfma_f32_16x16x32_bf16 a[220:223], a[28:31], a[16:19], a[220:223]
  ds_read_b64_tr_b16 a[12:13], v120 offset:36864
  v_mfma_f32_16x16x32_bf16 a[220:223], a[36:39], a[20:23], a[220:223]
  ds_read_b64_tr_b16 a[14:15], v120 offset:37376
  s_add_u32 s74, s74, 0x36000
  v_mfma_f32_16x16x32_bf16 a[224:227], a[168:171], a[16:19], a[224:227]
  buffer_load_dwordx4 v124, s[8:11], s75 offen offset:2048 lds
  v_mfma_f32_16x16x32_bf16 a[224:227], a[176:179], a[20:23], a[224:227]
  v_mfma_f32_16x16x32_bf16 a[228:231], a[172:175], a[16:19], a[228:231]
  s_waitcnt lgkmcnt(4)
  v_mfma_f32_16x16x32_bf16 a[228:231], a[180:183], a[20:23], a[228:231]
  v_mfma_f32_16x16x32_bf16 v[68:71], v[128:131], a[0:3], 0
  ds_read_b64_tr_b16 a[16:17], v121 offset:24576
  v_mfma_f32_16x16x32_bf16 v[68:71], v[136:139], a[4:7], v[68:71]
  ds_read_b64_tr_b16 a[18:19], v121 offset:25088
  v_mfma_f32_16x16x32_bf16 v[72:75], v[132:135], a[0:3], 0
  s_waitcnt lgkmcnt(2)
  ds_read_b64_tr_b16 a[20:21], v121 offset:36864
  v_mfma_f32_16x16x32_bf16 v[72:75], v[140:143], a[4:7], v[72:75]
  ds_read_b64_tr_b16 a[22:23], v121 offset:37376
  v_mfma_f32_16x16x32_bf16 v[4:7], v[128:131], a[8:11], 0
  ds_read_b64_tr_b16 a[0:1], v122 offset:24576
  v_add_u32 v80, s80, v108
  v_mfma_f32_16x16x32_bf16 v[4:7], v[136:139], a[12:15], v[4:7]
  buffer_load_dwordx4 v125, s[8:11], s75 offen offset:3072 lds
  v_mfma_f32_16x16x32_bf16 v[8:11], v[132:135], a[8:11], 0
  ds_read_b64_tr_b16 a[2:3], v122 offset:25088
  s_add_u32 s75, s75, 0x36000
  v_mfma_f32_16x16x32_bf16 v[8:11], v[140:143], a[12:15], v[8:11]
  s_add_u32 m0, s82, 28672
  v_xor_b32 v81, 4096, v80
  v_mfma_f32_16x16x32_bf16 v[12:15], a[40:43], a[8:11], 0
  ds_read_b64_tr_b16 a[4:5], v122 offset:36864
  v_mul_f32 v92, v92, v110
  v_mfma_f32_16x16x32_bf16 v[12:15], a[48:51], a[12:15], v[12:15]
  buffer_load_dwordx4 v124, s[8:11], s76 offen offset:0 lds
  v_mfma_f32_16x16x32_bf16 v[16:19], a[44:47], a[8:11], 0
  s_waitcnt lgkmcnt(3)
  ds_read_b64_tr_b16 a[6:7], v122 offset:37376
  v_mfma_f32_16x16x32_bf16 v[16:19], a[52:55], a[12:15], v[16:19]
  v_mul_f32 v93, v93, v111
  v_mul_f32 v94, v94, v112
  v_mfma_f32_16x16x32_bf16 v[20:23], v[128:131], a[16:19], 0
  ds_read_b64_tr_b16 a[8:9], v123 offset:24576
  v_mul_f32 v95, v95, v113
  v_mfma_f32_16x16x32_bf16 v[20:23], v[136:139], a[20:23], v[20:23]
  buffer_load_dwordx4 v125, s[8:11], s76 offen offset:1024 lds
  v_mfma_f32_16x16x32_bf16 v[24:27], v[132:135], a[16:19], 0
  ds_read_b64_tr_b16 a[10:11], v123 offset:25088
  s_add_u32 s76, s76, 0x36000
  v_mfma_f32_16x16x32_bf16 v[24:27], v[140:143], a[20:23], v[24:27]
  v_cvt_pk_bf16_f32 v92, v92, v93
  v_cvt_pk_bf16_f32 v93, v94, v95
  v_mfma_f32_16x16x32_bf16 v[28:31], a[40:43], a[16:19], 0
  ds_read_b64_tr_b16 a[12:13], v123 offset:36864
  v_accvgpr_read_b32 v84, a184
  v_mfma_f32_16x16x32_bf16 v[28:31], a[48:51], a[20:23], v[28:31]
  v_accvgpr_read_b32 v85, a185
  v_accvgpr_read_b32 v86, a186
  v_mfma_f32_16x16x32_bf16 v[32:35], a[44:47], a[16:19], 0
  s_waitcnt lgkmcnt(3)
  ds_read_b64_tr_b16 a[14:15], v123 offset:37376
  v_mfma_f32_16x16x32_bf16 v[32:35], a[52:55], a[20:23], v[32:35]
  v_add_u32 v120, 0xc000, v120
  v_add_u32 v121, 0xc000, v121
  v_add_u32 v122, 0xc000, v122
  v_add_u32 v123, 0xc000, v123
  v_add_u32 v118, 0xc000, v118
  s_waitcnt vmcnt(18)
  v_mfma_f32_16x16x32_bf16 v[36:39], v[128:131], a[0:3], 0
  s_barrier
  v_accvgpr_read_b32 v87, a187
  v_mfma_f32_16x16x32_bf16 v[36:39], v[136:139], a[4:7], v[36:39]
  ds_read_b64_tr_b16 a[16:17], v118 offset:0
  s_add_u32 m0, s82, 49152
  v_mfma_f32_16x16x32_bf16 v[40:43], v[132:135], a[0:3], 0
  buffer_load_dwordx4 v124, s[8:11], s74 offen offset:0 lds
  v_mfma_f32_16x16x32_bf16 v[40:43], v[140:143], a[4:7], v[40:43]
  ds_read_b64_tr_b16 a[18:19], v118 offset:512
  v_mul_f32 v84, v84, v110
  v_mfma_f32_16x16x32_bf16 v[44:47], a[40:43], a[0:3], 0
  v_mul_f32 v85, v85, v111
  v_mul_f32 v86, v86, v112
  v_mfma_f32_16x16x32_bf16 v[44:47], a[48:51], a[4:7], v[44:47]
  ds_read_b64_tr_b16 a[20:21], v118 offset:12288
  v_mul_f32 v87, v87, v113
  v_mfma_f32_16x16x32_bf16 v[48:51], a[44:47], a[0:3], 0
  buffer_load_dwordx4 v125, s[8:11], s74 offen offset:1024 lds
  v_mfma_f32_16x16x32_bf16 v[48:51], a[52:55], a[4:7], v[48:51]
  ds_read_b64_tr_b16 a[22:23], v118 offset:12800
  s_waitcnt lgkmcnt(4)
  v_mfma_f32_16x16x32_bf16 v[52:55], v[128:131], a[8:11], 0
  ds_read_b64_tr_b16 a[0:1], v120 offset:0
  v_cvt_pk_bf16_f32 v84, v84, v85
  v_mfma_f32_16x16x32_bf16 v[52:55], v[136:139], a[12:15], v[52:55]
  ds_read_b64_tr_b16 a[2:3], v120 offset:512
  v_cvt_pk_bf16_f32 v86, v86, v87
  v_mfma_f32_16x16x32_bf16 v[56:59], v[132:135], a[8:11], 0
  ds_read_b64_tr_b16 a[4:5], v120 offset:12288
  v_accvgpr_write_b32 a184, v84
  v_mfma_f32_16x16x32_bf16 v[56:59], v[140:143], a[12:15], v[56:59]
  ds_read_b64_tr_b16 a[6:7], v120 offset:12800
  s_add_u32 s74, s74, 0x36000
  v_mfma_f32_16x16x32_bf16 v[60:63], a[40:43], a[8:11], 0
  buffer_load_dwordx4 v124, s[8:11], s75 offen offset:2048 lds
  v_mfma_f32_16x16x32_bf16 v[60:63], a[48:51], a[12:15], v[60:63]
  v_accvgpr_write_b32 a185, v86
  v_accvgpr_read_b32 v88, a200
  v_mfma_f32_16x16x32_bf16 v[64:67], a[44:47], a[8:11], 0
  s_waitcnt lgkmcnt(4)
  v_accvgpr_read_b32 v89, a201
  v_mfma_f32_16x16x32_bf16 v[64:67], a[52:55], a[12:15], v[64:67]
  v_accvgpr_read_b32 v90, a202
  v_accvgpr_read_b32 v91, a203
  v_mfma_f32_16x16x32_bf16 v[68:71], v[144:147], a[16:19], v[68:71]
  ds_read_b64_tr_b16 a[8:9], v121 offset:0
  v_mul_f32 v88, v88, v110
  v_mfma_f32_16x16x32_bf16 v[68:71], v[152:155], a[20:23], v[68:71]
  ds_read_b64_tr_b16 a[10:11], v121 offset:512
  v_mul_f32 v89, v89, v111
  v_mfma_f32_16x16x32_bf16 v[72:75], v[148:151], a[16:19], v[72:75]
  s_waitcnt lgkmcnt(2)
  ds_read_b64_tr_b16 a[12:13], v121 offset:12288
  v_mfma_f32_16x16x32_bf16 v[72:75], v[156:159], a[20:23], v[72:75]
  ds_read_b64_tr_b16 a[14:15], v121 offset:12800
  v_mul_f32 v90, v90, v112
  v_mfma_f32_16x16x32_bf16 v[4:7], v[144:147], a[0:3], v[4:7]
  ds_read_b64_tr_b16 a[16:17], v122 offset:0
  v_mul_f32 v91, v91, v113
  v_mfma_f32_16x16x32_bf16 v[4:7], v[152:155], a[4:7], v[4:7]
  buffer_load_dwordx4 v125, s[8:11], s75 offen offset:3072 lds
  v_mfma_f32_16x16x32_bf16 v[8:11], v[148:151], a[0:3], v[8:11]
  ds_read_b64_tr_b16 a[18:19], v122 offset:512
  s_add_u32 s75, s75, 0x36000
  v_mfma_f32_16x16x32_bf16 v[8:11], v[156:159], a[4:7], v[8:11]
  s_add_u32 m0, s82, 53248
  v_cvt_pk_bf16_f32 v88, v88, v89
  v_mfma_f32_16x16x32_bf16 v[12:15], a[56:59], a[0:3], v[12:15]
  ds_read_b64_tr_b16 a[20:21], v122 offset:12288
  v_cvt_pk_bf16_f32 v90, v90, v91
  v_mfma_f32_16x16x32_bf16 v[12:15], a[64:67], a[4:7], v[12:15]
  buffer_load_dwordx4 v124, s[8:11], s76 offen offset:0 lds
  v_mfma_f32_16x16x32_bf16 v[16:19], a[60:63], a[0:3], v[16:19]
  s_waitcnt lgkmcnt(3)
  ds_read_b64_tr_b16 a[22:23], v122 offset:12800
  v_mfma_f32_16x16x32_bf16 v[16:19], a[68:71], a[4:7], v[16:19]
  v_accvgpr_write_b32 a200, v88
  v_accvgpr_write_b32 a201, v90
  v_mfma_f32_16x16x32_bf16 v[20:23], v[144:147], a[8:11], v[20:23]
  ds_read_b64_tr_b16 a[0:1], v123 offset:0
  v_accvgpr_read_b32 v84, a216
  v_mfma_f32_16x16x32_bf16 v[20:23], v[152:155], a[12:15], v[20:23]
  buffer_load_dwordx4 v125, s[8:11], s76 offen offset:1024 lds
  v_mfma_f32_16x16x32_bf16 v[24:27], v[148:151], a[8:11], v[24:27]
  ds_read_b64_tr_b16 a[2:3], v123 offset:512
  s_add_u32 s76, s76, 0x36000
  v_mfma_f32_16x16x32_bf16 v[24:27], v[156:159], a[12:15], v[24:27]
  v_accvgpr_read_b32 v85, a217
  v_accvgpr_read_b32 v86, a218
  v_mfma_f32_16x16x32_bf16 v[28:31], a[56:59], a[8:11], v[28:31]
  ds_read_b64_tr_b16 a[4:5], v123 offset:12288
  v_accvgpr_read_b32 v87, a219
  v_mfma_f32_16x16x32_bf16 v[28:31], a[64:67], a[12:15], v[28:31]
  v_mul_f32 v84, v84, v110
  v_mul_f32 v85, v85, v111
  v_mfma_f32_16x16x32_bf16 v[32:35], a[60:63], a[8:11], v[32:35]
  s_waitcnt lgkmcnt(3)
  ds_read_b64_tr_b16 a[6:7], v123 offset:12800
  v_mfma_f32_16x16x32_bf16 v[32:35], a[68:71], a[12:15], v[32:35]
  s_waitcnt vmcnt(18)
  v_mul_f32 v86, v86, v112
  v_mfma_f32_16x16x32_bf16 v[36:39], v[144:147], a[16:19], v[36:39]
  s_barrier
  v_mul_f32 v87, v87, v113
  v_mfma_f32_16x16x32_bf16 v[36:39], v[152:155], a[20:23], v[36:39]
  ds_read_b64_tr_b16 a[8:9], v118 offset:24576
  s_add_u32 m0, s82, 73728
  v_mfma_f32_16x16x32_bf16 v[40:43], v[148:151], a[16:19], v[40:43]
  buffer_load_dwordx4 v124, s[8:11], s74 offen offset:0 lds
  v_mfma_f32_16x16x32_bf16 v[40:43], v[156:159], a[20:23], v[40:43]
  ds_read_b64_tr_b16 a[10:11], v118 offset:25088
  v_cvt_pk_bf16_f32 v84, v84, v85
  v_mfma_f32_16x16x32_bf16 v[44:47], a[56:59], a[16:19], v[44:47]
  v_cvt_pk_bf16_f32 v86, v86, v87
  v_accvgpr_write_b32 a216, v84
  v_mfma_f32_16x16x32_bf16 v[44:47], a[64:67], a[20:23], v[44:47]
  ds_read_b64_tr_b16 a[12:13], v118 offset:36864
  v_accvgpr_write_b32 a217, v86
  v_mfma_f32_16x16x32_bf16 v[48:51], a[60:63], a[16:19], v[48:51]
  buffer_load_dwordx4 v125, s[8:11], s74 offen offset:1024 lds
  v_mfma_f32_16x16x32_bf16 v[48:51], a[68:71], a[20:23], v[48:51]
  ds_read_b64_tr_b16 a[14:15], v118 offset:37376
  s_waitcnt lgkmcnt(4)
  v_mfma_f32_16x16x32_bf16 v[52:55], v[144:147], a[0:3], v[52:55]
  ds_read_b64_tr_b16 a[16:17], v120 offset:24576
  v_accvgpr_read_b32 v88, a232
  v_mfma_f32_16x16x32_bf16 v[52:55], v[152:155], a[4:7], v[52:55]
  ds_read_b64_tr_b16 a[18:19], v120 offset:25088
  v_accvgpr_read_b32 v89, a233
  v_mfma_f32_16x16x32_bf16 v[56:59], v[148:151], a[0:3], v[56:59]
  ds_read_b64_tr_b16 a[20:21], v120 offset:36864
  v_accvgpr_read_b32 v90, a234
  v_mfma_f32_16x16x32_bf16 v[56:59], v[156:159], a[4:7], v[56:59]
  ds_read_b64_tr_b16 a[22:23], v120 offset:37376
  s_add_u32 s74, s74, 0x36000
  v_mfma_f32_16x16x32_bf16 v[60:63], a[56:59], a[0:3], v[60:63]
  buffer_load_dwordx4 v124, s[8:11], s75 offen offset:2048 lds
  v_mfma_f32_16x16x32_bf16 v[60:63], a[64:67], a[4:7], v[60:63]
  v_accvgpr_read_b32 v91, a235
  v_mul_f32 v88, v88, v110
  v_mfma_f32_16x16x32_bf16 v[64:67], a[60:63], a[0:3], v[64:67]
  s_waitcnt lgkmcnt(4)
  v_mul_f32 v89, v89, v111
  v_mfma_f32_16x16x32_bf16 v[64:67], a[68:71], a[4:7], v[64:67]
  v_mul_f32 v90, v90, v112
  v_mul_f32 v91, v91, v113
  v_mfma_f32_16x16x32_bf16 v[68:71], v[160:163], a[8:11], v[68:71]
  ds_read_b64_tr_b16 a[0:1], v121 offset:24576
  ds_read_b64 v[110:111], v126 offset:64
  v_mfma_f32_16x16x32_bf16 v[68:71], v[168:171], a[12:15], v[68:71]
  ds_read_b64_tr_b16 a[2:3], v121 offset:25088
  ds_read_b64 v[112:113], v126 offset:72
  v_mfma_f32_16x16x32_bf16 v[72:75], v[164:167], a[8:11], v[72:75]
  s_waitcnt lgkmcnt(4)
  ds_read_b64_tr_b16 a[4:5], v121 offset:36864
  v_mfma_f32_16x16x32_bf16 v[72:75], v[172:175], a[12:15], v[72:75]
  ds_read_b64_tr_b16 a[6:7], v121 offset:37376
  v_cvt_pk_bf16_f32 v88, v88, v89
  v_mfma_f32_16x16x32_bf16 v[4:7], v[160:163], a[16:19], v[4:7]
  ds_read_b64_tr_b16 a[8:9], v122 offset:24576
  v_cvt_pk_bf16_f32 v90, v90, v91
  v_mfma_f32_16x16x32_bf16 v[4:7], v[168:171], a[20:23], v[4:7]
  buffer_load_dwordx4 v125, s[8:11], s75 offen offset:3072 lds
  v_mfma_f32_16x16x32_bf16 v[8:11], v[164:167], a[16:19], v[8:11]
  ds_read_b64_tr_b16 a[10:11], v122 offset:25088
  s_add_u32 s75, s75, 0x36000
  v_mfma_f32_16x16x32_bf16 v[8:11], v[172:175], a[20:23], v[8:11]
  s_add_u32 m0, s82, 77824
  v_accvgpr_write_b32 a232, v88
  v_mfma_f32_16x16x32_bf16 v[12:15], a[72:75], a[16:19], v[12:15]
  ds_read_b64_tr_b16 a[12:13], v122 offset:36864
  v_accvgpr_write_b32 a233, v90
  v_mfma_f32_16x16x32_bf16 v[12:15], a[80:83], a[20:23], v[12:15]
  buffer_load_dwordx4 v124, s[8:11], s76 offen offset:0 lds
  v_mfma_f32_16x16x32_bf16 v[16:19], a[76:79], a[16:19], v[16:19]
  s_waitcnt lgkmcnt(3)
  ds_read_b64_tr_b16 a[14:15], v122 offset:37376
  v_mfma_f32_16x16x32_bf16 v[16:19], a[84:87], a[20:23], v[16:19]
  v_mul_f32 v96, v96, v110
  v_mul_f32 v97, v97, v111
  v_mfma_f32_16x16x32_bf16 v[20:23], v[160:163], a[0:3], v[20:23]
  ds_read_b64_tr_b16 a[16:17], v123 offset:24576
  v_mul_f32 v98, v98, v112
  v_mfma_f32_16x16x32_bf16 v[20:23], v[168:171], a[4:7], v[20:23]
  buffer_load_dwordx4 v125, s[8:11], s76 offen offset:1024 lds
  v_mfma_f32_16x16x32_bf16 v[24:27], v[164:167], a[0:3], v[24:27]
  ds_read_b64_tr_b16 a[18:19], v123 offset:25088
  s_add_u32 s76, s76, 0x36000
  v_mfma_f32_16x16x32_bf16 v[24:27], v[172:175], a[4:7], v[24:27]
  v_mul_f32 v99, v99, v113
  v_cvt_pk_bf16_f32 v94, v96, v97
  v_mfma_f32_16x16x32_bf16 v[28:31], a[72:75], a[0:3], v[28:31]
  ds_read_b64_tr_b16 a[20:21], v123 offset:36864
  v_cvt_pk_bf16_f32 v95, v98, v99
  v_mfma_f32_16x16x32_bf16 v[28:31], a[80:83], a[4:7], v[28:31]
  v_accvgpr_read_b32 v84, a188
  v_accvgpr_read_b32 v85, a189
  v_mfma_f32_16x16x32_bf16 v[32:35], a[76:79], a[0:3], v[32:35]
  s_waitcnt lgkmcnt(3)
  ds_read_b64_tr_b16 a[22:23], v123 offset:37376
  v_mfma_f32_16x16x32_bf16 v[32:35], a[84:87], a[4:7], v[32:35]
  v_add_u32 v120, 0xfffe8000, v120
  v_add_u32 v121, 0xfffe8000, v121
  v_add_u32 v122, 0xfffe8000, v122
  v_add_u32 v123, 0xfffe8000, v123
  v_add_u32 v118, 0xfffe8000, v118
  s_waitcnt vmcnt(18)
  v_mfma_f32_16x16x32_bf16 v[36:39], v[160:163], a[8:11], v[36:39]
  s_barrier
  v_accvgpr_read_b32 v86, a190
  v_mfma_f32_16x16x32_bf16 v[36:39], v[168:171], a[12:15], v[36:39]
  ds_read_b64_tr_b16 a[0:1], v118 offset:0
  s_add_u32 m0, s82, 98304
  v_mfma_f32_16x16x32_bf16 v[40:43], v[164:167], a[8:11], v[40:43]
  buffer_load_dwordx4 v124, s[8:11], s74 offen offset:0 lds
  v_mfma_f32_16x16x32_bf16 v[40:43], v[172:175], a[12:15], v[40:43]
  ds_read_b64_tr_b16 a[2:3], v118 offset:512
  v_accvgpr_read_b32 v87, a191
  v_mfma_f32_16x16x32_bf16 v[44:47], a[72:75], a[8:11], v[44:47]
  v_mul_f32 v84, v84, v110
  v_mul_f32 v85, v85, v111
  v_mfma_f32_16x16x32_bf16 v[44:47], a[80:83], a[12:15], v[44:47]
  ds_read_b64_tr_b16 a[4:5], v118 offset:12288
  v_mul_f32 v86, v86, v112
  v_mfma_f32_16x16x32_bf16 v[48:51], a[76:79], a[8:11], v[48:51]
  buffer_load_dwordx4 v125, s[8:11], s74 offen offset:1024 lds
  v_mfma_f32_16x16x32_bf16 v[48:51], a[84:87], a[12:15], v[48:51]
  ds_read_b64_tr_b16 a[6:7], v118 offset:12800
  s_waitcnt lgkmcnt(4)
  v_mfma_f32_16x16x32_bf16 v[52:55], v[160:163], a[16:19], v[52:55]
  ds_read_b64_tr_b16 a[8:9], v120 offset:0
  v_mul_f32 v87, v87, v113
  v_mfma_f32_16x16x32_bf16 v[52:55], v[168:171], a[20:23], v[52:55]
  ds_read_b64_tr_b16 a[10:11], v120 offset:512
  v_cvt_pk_bf16_f32 v84, v84, v85
  v_mfma_f32_16x16x32_bf16 v[56:59], v[164:167], a[16:19], v[56:59]
  ds_read_b64_tr_b16 a[12:13], v120 offset:12288
  v_cvt_pk_bf16_f32 v86, v86, v87
  v_mfma_f32_16x16x32_bf16 v[56:59], v[172:175], a[20:23], v[56:59]
  ds_read_b64_tr_b16 a[14:15], v120 offset:12800
  s_add_u32 s74, s74, 0x36000
  v_mfma_f32_16x16x32_bf16 v[60:63], a[72:75], a[16:19], v[60:63]
  buffer_load_dwordx4 v124, s[8:11], s75 offen offset:2048 lds
  v_mfma_f32_16x16x32_bf16 v[60:63], a[80:83], a[20:23], v[60:63]
  v_accvgpr_write_b32 a186, v84
  v_accvgpr_write_b32 a187, v86
  v_mfma_f32_16x16x32_bf16 v[64:67], a[76:79], a[16:19], v[64:67]
  s_waitcnt lgkmcnt(4)
  v_accvgpr_read_b32 v88, a204
  v_mfma_f32_16x16x32_bf16 v[64:67], a[84:87], a[20:23], v[64:67]
  v_accvgpr_read_b32 v89, a205
  v_accvgpr_read_b32 v90, a206
  v_mfma_f32_16x16x32_bf16 v[68:71], v[176:179], a[0:3], v[68:71]
  ds_read_b64_tr_b16 a[16:17], v121 offset:0
  v_accvgpr_read_b32 v91, a207
  v_mfma_f32_16x16x32_bf16 v[68:71], v[184:187], a[4:7], v[68:71]
  ds_read_b64_tr_b16 a[18:19], v121 offset:512
  v_mul_f32 v88, v88, v110
  v_mfma_f32_16x16x32_bf16 v[72:75], v[180:183], a[0:3], v[72:75]
  s_waitcnt lgkmcnt(2)
  ds_read_b64_tr_b16 a[20:21], v121 offset:12288
  v_mfma_f32_16x16x32_bf16 v[72:75], v[188:191], a[4:7], v[72:75]
  ds_read_b64_tr_b16 a[22:23], v121 offset:12800
  v_mul_f32 v89, v89, v111
  v_mfma_f32_16x16x32_bf16 v[4:7], v[176:179], a[8:11], v[4:7]
  ds_read_b64_tr_b16 a[0:1], v122 offset:0
  v_mul_f32 v90, v90, v112
  v_mfma_f32_16x16x32_bf16 v[4:7], v[184:187], a[12:15], v[4:7]
  buffer_load_dwordx4 v125, s[8:11], s75 offen offset:3072 lds
  v_mfma_f32_16x16x32_bf16 v[8:11], v[180:183], a[8:11], v[8:11]
  ds_read_b64_tr_b16 a[2:3], v122 offset:512
  s_add_u32 s75, s75, 0x36000
  v_mfma_f32_16x16x32_bf16 v[8:11], v[188:191], a[12:15], v[8:11]
  s_add_u32 m0, s82, 102400
  v_mul_f32 v91, v91, v113
  v_mfma_f32_16x16x32_bf16 v[12:15], a[88:91], a[8:11], v[12:15]
  ds_read_b64_tr_b16 a[4:5], v122 offset:12288
  v_cvt_pk_bf16_f32 v88, v88, v89
  v_mfma_f32_16x16x32_bf16 v[12:15], a[96:99], a[12:15], v[12:15]
  buffer_load_dwordx4 v124, s[8:11], s76 offen offset:0 lds
  v_mfma_f32_16x16x32_bf16 v[16:19], a[92:95], a[8:11], v[16:19]
  s_waitcnt lgkmcnt(3)
  ds_read_b64_tr_b16 a[6:7], v122 offset:12800
  v_mfma_f32_16x16x32_bf16 v[16:19], a[100:103], a[12:15], v[16:19]
  v_cvt_pk_bf16_f32 v90, v90, v91
  v_accvgpr_write_b32 a202, v88
  v_mfma_f32_16x16x32_bf16 v[20:23], v[176:179], a[16:19], v[20:23]
  ds_read_b64_tr_b16 a[8:9], v123 offset:0
  v_accvgpr_write_b32 a203, v90
  v_mfma_f32_16x16x32_bf16 v[20:23], v[184:187], a[20:23], v[20:23]
  buffer_load_dwordx4 v125, s[8:11], s76 offen offset:1024 lds
  v_mfma_f32_16x16x32_bf16 v[24:27], v[180:183], a[16:19], v[24:27]
  ds_read_b64_tr_b16 a[10:11], v123 offset:512
  s_add_u32 s76, s76, 0x36000
  v_mfma_f32_16x16x32_bf16 v[24:27], v[188:191], a[20:23], v[24:27]
  v_accvgpr_read_b32 v84, a220
  v_accvgpr_read_b32 v85, a221
  v_mfma_f32_16x16x32_bf16 v[28:31], a[88:91], a[16:19], v[28:31]
  ds_read_b64_tr_b16 a[12:13], v123 offset:12288
  v_accvgpr_read_b32 v86, a222
  v_mfma_f32_16x16x32_bf16 v[28:31], a[96:99], a[20:23], v[28:31]
  v_accvgpr_read_b32 v87, a223
  v_mul_f32 v84, v84, v110
  v_mfma_f32_16x16x32_bf16 v[32:35], a[92:95], a[16:19], v[32:35]
  s_waitcnt lgkmcnt(3)
  ds_read_b64_tr_b16 a[14:15], v123 offset:12800
  v_mfma_f32_16x16x32_bf16 v[32:35], a[100:103], a[20:23], v[32:35]
  s_waitcnt vmcnt(18)
  v_mul_f32 v85, v85, v111
  v_mfma_f32_16x16x32_bf16 v[36:39], v[176:179], a[0:3], v[36:39]
  s_barrier
  v_mul_f32 v86, v86, v112
  v_mfma_f32_16x16x32_bf16 v[36:39], v[184:187], a[4:7], v[36:39]
  ds_read_b64_tr_b16 a[16:17], v118 offset:24576
  s_add_u32 m0, s82, 122880
  v_mfma_f32_16x16x32_bf16 v[40:43], v[180:183], a[0:3], v[40:43]
  buffer_load_dwordx4 v124, s[8:11], s74 offen offset:0 lds
  v_mfma_f32_16x16x32_bf16 v[40:43], v[188:191], a[4:7], v[40:43]
  ds_read_b64_tr_b16 a[18:19], v118 offset:25088
  v_mul_f32 v87, v87, v113
  v_mfma_f32_16x16x32_bf16 v[44:47], a[88:91], a[0:3], v[44:47]
  v_cvt_pk_bf16_f32 v84, v84, v85
  v_cvt_pk_bf16_f32 v86, v86, v87
  v_mfma_f32_16x16x32_bf16 v[44:47], a[96:99], a[4:7], v[44:47]
  ds_read_b64_tr_b16 a[20:21], v118 offset:36864
  v_accvgpr_write_b32 a218, v84
  v_mfma_f32_16x16x32_bf16 v[48:51], a[92:95], a[0:3], v[48:51]
  buffer_load_dwordx4 v125, s[8:11], s74 offen offset:1024 lds
  v_mfma_f32_16x16x32_bf16 v[48:51], a[100:103], a[4:7], v[48:51]
  ds_read_b64_tr_b16 a[22:23], v118 offset:37376
  s_waitcnt lgkmcnt(4)
  v_mfma_f32_16x16x32_bf16 v[52:55], v[176:179], a[8:11], v[52:55]
  ds_read_b64_tr_b16 a[0:1], v120 offset:24576
  v_accvgpr_write_b32 a219, v86
  v_mfma_f32_16x16x32_bf16 v[52:55], v[184:187], a[12:15], v[52:55]
  ds_read_b64_tr_b16 a[2:3], v120 offset:25088
  v_accvgpr_read_b32 v88, a236
  v_mfma_f32_16x16x32_bf16 v[56:59], v[180:183], a[8:11], v[56:59]
  ds_read_b64_tr_b16 a[4:5], v120 offset:36864
  v_accvgpr_read_b32 v89, a237
  v_mfma_f32_16x16x32_bf16 v[56:59], v[188:191], a[12:15], v[56:59]
  ds_read_b64_tr_b16 a[6:7], v120 offset:37376
  s_add_u32 s74, s74, 0x36000
  v_mfma_f32_16x16x32_bf16 v[60:63], a[88:91], a[8:11], v[60:63]
  buffer_load_dwordx4 v124, s[8:11], s75 offen offset:2048 lds
  v_mfma_f32_16x16x32_bf16 v[60:63], a[96:99], a[12:15], v[60:63]
  v_accvgpr_read_b32 v90, a238
  v_accvgpr_read_b32 v91, a239
  v_mfma_f32_16x16x32_bf16 v[64:67], a[92:95], a[8:11], v[64:67]
  s_waitcnt lgkmcnt(4)
  v_mul_f32 v88, v88, v110
  v_mfma_f32_16x16x32_bf16 v[64:67], a[100:103], a[12:15], v[64:67]
  v_mul_f32 v89, v89, v111
  v_mul_f32 v90, v90, v112
  v_mfma_f32_16x16x32_bf16 v[68:71], v[192:195], a[16:19], v[68:71]
  ds_read_b64_tr_b16 a[8:9], v121 offset:24576
  v_mul_f32 v91, v91, v113
  v_mfma_f32_16x16x32_bf16 v[68:71], v[200:203], a[20:23], v[68:71]
  ds_read_b64_tr_b16 a[10:11], v121 offset:25088
  ds_read_b64 v[110:111], v126 offset:128
  v_mfma_f32_16x16x32_bf16 v[72:75], v[196:199], a[16:19], v[72:75]
  s_waitcnt lgkmcnt(3)
  ds_read_b64_tr_b16 a[12:13], v121 offset:36864
  v_mfma_f32_16x16x32_bf16 v[72:75], v[204:207], a[20:23], v[72:75]
  ds_read_b64_tr_b16 a[14:15], v121 offset:37376
  ds_read_b64 v[112:113], v126 offset:136
  v_mfma_f32_16x16x32_bf16 v[4:7], v[192:195], a[0:3], v[4:7]
  ds_read_b64_tr_b16 a[16:17], v122 offset:24576
  v_cvt_pk_bf16_f32 v88, v88, v89
  v_mfma_f32_16x16x32_bf16 v[4:7], v[200:203], a[4:7], v[4:7]
  buffer_load_dwordx4 v125, s[8:11], s75 offen offset:3072 lds
  v_mfma_f32_16x16x32_bf16 v[8:11], v[196:199], a[0:3], v[8:11]
  ds_read_b64_tr_b16 a[18:19], v122 offset:25088
  s_add_u32 s75, s75, 0x36000
  v_mfma_f32_16x16x32_bf16 v[8:11], v[204:207], a[4:7], v[8:11]
  s_add_u32 m0, s82, 126976
  v_cvt_pk_bf16_f32 v90, v90, v91
  v_mfma_f32_16x16x32_bf16 v[12:15], a[104:107], a[0:3], v[12:15]
  ds_read_b64_tr_b16 a[20:21], v122 offset:36864
  v_accvgpr_write_b32 a234, v88
  v_mfma_f32_16x16x32_bf16 v[12:15], a[112:115], a[4:7], v[12:15]
  buffer_load_dwordx4 v124, s[8:11], s76 offen offset:0 lds
  v_mfma_f32_16x16x32_bf16 v[16:19], a[108:111], a[0:3], v[16:19]
  s_waitcnt lgkmcnt(4)
  ds_read_b64_tr_b16 a[22:23], v122 offset:37376
  v_mfma_f32_16x16x32_bf16 v[16:19], a[116:119], a[4:7], v[16:19]
  v_accvgpr_write_b32 a235, v90
  ds_write_b128 v80, a[232:235] offset:1024
  v_mfma_f32_16x16x32_bf16 v[20:23], v[192:195], a[8:11], v[20:23]
  ds_read_b64_tr_b16 a[0:1], v123 offset:24576
  v_accvgpr_read_b32 v84, a248
  v_mfma_f32_16x16x32_bf16 v[20:23], v[200:203], a[12:15], v[20:23]
  buffer_load_dwordx4 v125, s[8:11], s76 offen offset:1024 lds
  v_mfma_f32_16x16x32_bf16 v[24:27], v[196:199], a[8:11], v[24:27]
  ds_read_b64_tr_b16 a[2:3], v123 offset:25088
  s_add_u32 s76, s76, 0x36000
  v_mfma_f32_16x16x32_bf16 v[24:27], v[204:207], a[12:15], v[24:27]
  v_accvgpr_read_b32 v85, a249
  v_accvgpr_read_b32 v86, a250
  v_mfma_f32_16x16x32_bf16 v[28:31], a[104:107], a[8:11], v[28:31]
  ds_read_b64_tr_b16 a[4:5], v123 offset:36864
  v_accvgpr_read_b32 v87, a251
  v_mfma_f32_16x16x32_bf16 v[28:31], a[112:115], a[12:15], v[28:31]
  v_mul_f32 v84, v84, v110
  v_mul_f32 v85, v85, v111
  v_mfma_f32_16x16x32_bf16 v[32:35], a[108:111], a[8:11], v[32:35]
  s_waitcnt lgkmcnt(4)
  ds_read_b64_tr_b16 a[6:7], v123 offset:37376
  v_mfma_f32_16x16x32_bf16 v[32:35], a[116:119], a[12:15], v[32:35]
  v_add_u32 v120, 0xc000, v120
  v_add_u32 v121, 0xc000, v121
  v_add_u32 v122, 0xc000, v122
  v_add_u32 v123, 0xc000, v123
  v_add_u32 v118, 0xc000, v118
  s_waitcnt vmcnt(18)
  s_waitcnt lgkmcnt(4)
  v_mfma_f32_16x16x32_bf16 v[36:39], v[192:195], a[16:19], v[36:39]
  s_barrier
  v_mul_f32 v86, v86, v112
  v_mfma_f32_16x16x32_bf16 v[36:39], v[200:203], a[20:23], v[36:39]
  ds_read_b64_tr_b16 a[8:9], v118 offset:0
  s_add_u32 m0, s64, 0
  v_mfma_f32_16x16x32_bf16 v[40:43], v[196:199], a[16:19], v[40:43]
  buffer_load_dwordx4 v106, s[12:15], s62 offen lds
  v_mfma_f32_16x16x32_bf16 v[40:43], v[204:207], a[20:23], v[40:43]
  ds_read_b64_tr_b16 a[10:11], v118 offset:512
  ds_read_b128 a[240:243], v81 offset:1024
  v_mfma_f32_16x16x32_bf16 v[44:47], a[104:107], a[16:19], v[44:47]
  v_mul_f32 v87, v87, v113
  v_cvt_pk_bf16_f32 v84, v84, v85
  v_mfma_f32_16x16x32_bf16 v[44:47], a[112:115], a[20:23], v[44:47]
  ds_read_b64_tr_b16 a[12:13], v118 offset:12288
  v_cvt_pk_bf16_f32 v86, v86, v87
  v_mfma_f32_16x16x32_bf16 v[48:51], a[108:111], a[16:19], v[48:51]
  v_accvgpr_write_b32 a248, v84
  v_accvgpr_write_b32 a249, v86
  v_mfma_f32_16x16x32_bf16 v[48:51], a[116:119], a[20:23], v[48:51]
  ds_read_b64_tr_b16 a[14:15], v118 offset:12800
  s_waitcnt lgkmcnt(5)
  v_mfma_f32_16x16x32_bf16 v[52:55], v[192:195], a[0:3], v[52:55]
  ds_read_b64_tr_b16 a[16:17], v120 offset:0
  v_accvgpr_read_b32 v88, a192
  v_mfma_f32_16x16x32_bf16 v[52:55], v[200:203], a[4:7], v[52:55]
  ds_read_b64_tr_b16 a[18:19], v120 offset:512
  v_accvgpr_read_b32 v89, a193
  v_mfma_f32_16x16x32_bf16 v[56:59], v[196:199], a[0:3], v[56:59]
  ds_read_b64_tr_b16 a[20:21], v120 offset:12288
  v_accvgpr_read_b32 v90, a194
  v_mfma_f32_16x16x32_bf16 v[56:59], v[204:207], a[4:7], v[56:59]
  ds_read_b64_tr_b16 a[22:23], v120 offset:12800
  v_accvgpr_read_b32 v91, a195
  v_mfma_f32_16x16x32_bf16 v[60:63], a[104:107], a[0:3], v[60:63]
  buffer_load_dwordx4 v107, s[12:15], s62 offen offset:1024 lds
  v_mfma_f32_16x16x32_bf16 v[60:63], a[112:115], a[4:7], v[60:63]
  v_mul_f32 v88, v88, v110
  v_mul_f32 v89, v89, v111
  v_mfma_f32_16x16x32_bf16 v[64:67], a[108:111], a[0:3], v[64:67]
  s_waitcnt lgkmcnt(4)
  v_mul_f32 v90, v90, v112
  v_mfma_f32_16x16x32_bf16 v[64:67], a[116:119], a[4:7], v[64:67]
  v_mul_f32 v91, v91, v113
  v_cvt_pk_bf16_f32 v88, v88, v89
  v_mfma_f32_16x16x32_bf16 v[68:71], v[208:211], a[8:11], v[68:71]
  ds_read_b64_tr_b16 a[0:1], v121 offset:0
  v_cvt_pk_bf16_f32 v90, v90, v91
  v_mfma_f32_16x16x32_bf16 v[68:71], v[216:219], a[12:15], v[68:71]
  ds_read_b64_tr_b16 a[2:3], v121 offset:512
  v_accvgpr_write_b32 a192, v88
  v_mfma_f32_16x16x32_bf16 v[72:75], v[212:215], a[8:11], v[72:75]
  s_waitcnt lgkmcnt(2)
  ds_read_b64_tr_b16 a[4:5], v121 offset:12288
  v_mfma_f32_16x16x32_bf16 v[72:75], v[220:223], a[12:15], v[72:75]
  ds_read_b64_tr_b16 a[6:7], v121 offset:12800
  v_accvgpr_write_b32 a193, v90
  v_mfma_f32_16x16x32_bf16 v[4:7], v[208:211], a[16:19], v[4:7]
  ds_read_b64_tr_b16 a[8:9], v122 offset:0
  v_accvgpr_read_b32 v84, a208
  v_mfma_f32_16x16x32_bf16 v[4:7], v[216:219], a[20:23], v[4:7]
  buffer_load_dwordx4 v106, s[16:19], s62 offen offset:2048 lds
  v_mfma_f32_16x16x32_bf16 v[8:11], v[212:215], a[16:19], v[8:11]
  ds_read_b64_tr_b16 a[10:11], v122 offset:512
  v_accvgpr_read_b32 v85, a209
  v_mfma_f32_16x16x32_bf16 v[8:11], v[220:223], a[20:23], v[8:11]
  v_accvgpr_read_b32 v86, a210
  v_accvgpr_read_b32 v87, a211
  v_mfma_f32_16x16x32_bf16 v[12:15], a[120:123], a[16:19], v[12:15]
  ds_read_b64_tr_b16 a[12:13], v122 offset:12288
  v_mul_f32 v84, v84, v110
  v_mfma_f32_16x16x32_bf16 v[12:15], a[128:131], a[20:23], v[12:15]
  v_mul_f32 v85, v85, v111
  v_mul_f32 v86, v86, v112
  v_mfma_f32_16x16x32_bf16 v[16:19], a[124:127], a[16:19], v[16:19]
  s_waitcnt lgkmcnt(3)
  ds_read_b64_tr_b16 a[14:15], v122 offset:12800
  v_mfma_f32_16x16x32_bf16 v[16:19], a[132:135], a[20:23], v[16:19]
  buffer_load_dwordx4 v107, s[16:19], s62 offen offset:3072 lds
  v_mfma_f32_16x16x32_bf16 v[20:23], v[208:211], a[0:3], v[20:23]
  ds_read_b64_tr_b16 a[16:17], v123 offset:0
  s_add_u32 s62, s62, 589824
  v_mfma_f32_16x16x32_bf16 v[20:23], v[216:219], a[4:7], v[20:23]
  v_mul_f32 v87, v87, v113
  v_cvt_pk_bf16_f32 v84, v84, v85
  v_mfma_f32_16x16x32_bf16 v[24:27], v[212:215], a[0:3], v[24:27]
  ds_read_b64_tr_b16 a[18:19], v123 offset:512
  v_cvt_pk_bf16_f32 v86, v86, v87
  v_mfma_f32_16x16x32_bf16 v[24:27], v[220:223], a[4:7], v[24:27]
  v_accvgpr_write_b32 a208, v84
  v_accvgpr_write_b32 a209, v86
  v_mfma_f32_16x16x32_bf16 v[28:31], a[120:123], a[0:3], v[28:31]
  ds_read_b64_tr_b16 a[20:21], v123 offset:12288
  v_accvgpr_read_b32 v88, a224
  v_mfma_f32_16x16x32_bf16 v[28:31], a[128:131], a[4:7], v[28:31]
  v_accvgpr_read_b32 v89, a225
  v_accvgpr_read_b32 v90, a226
  v_mfma_f32_16x16x32_bf16 v[32:35], a[124:127], a[0:3], v[32:35]
  s_waitcnt lgkmcnt(3)
  ds_read_b64_tr_b16 a[22:23], v123 offset:12800
  v_mfma_f32_16x16x32_bf16 v[32:35], a[132:135], a[4:7], v[32:35]
  s_waitcnt vmcnt(16)
  v_accvgpr_read_b32 v91, a227
  v_mfma_f32_16x16x32_bf16 v[36:39], v[208:211], a[8:11], v[36:39]
  s_barrier
  v_mul_f32 v88, v88, v110
  v_mfma_f32_16x16x32_bf16 v[36:39], v[216:219], a[12:15], v[36:39]
  ds_read_b64_tr_b16 a[0:1], v118 offset:24576
  s_add_u32 m0, s64, 16384
  v_mfma_f32_16x16x32_bf16 v[40:43], v[212:215], a[8:11], v[40:43]
  buffer_load_dwordx4 v106, s[12:15], s62 offen lds
  v_mfma_f32_16x16x32_bf16 v[40:43], v[220:223], a[12:15], v[40:43]
  ds_read_b64_tr_b16 a[2:3], v118 offset:25088
  v_mul_f32 v89, v89, v111
  v_mfma_f32_16x16x32_bf16 v[44:47], a[120:123], a[8:11], v[44:47]
  v_mul_f32 v90, v90, v112
  v_mul_f32 v91, v91, v113
  v_mfma_f32_16x16x32_bf16 v[44:47], a[128:131], a[12:15], v[44:47]
  ds_read_b64_tr_b16 a[4:5], v118 offset:36864
  ds_read_b64 v[110:111], v126 offset:192
  v_mfma_f32_16x16x32_bf16 v[48:51], a[124:127], a[8:11], v[48:51]
  buffer_load_dwordx4 v107, s[12:15], s62 offen offset:1024 lds
  v_mfma_f32_16x16x32_bf16 v[48:51], a[132:135], a[12:15], v[48:51]
  ds_read_b64_tr_b16 a[6:7], v118 offset:37376
  s_waitcnt lgkmcnt(5)
  v_mfma_f32_16x16x32_bf16 v[52:55], v[208:211], a[16:19], v[52:55]
  ds_read_b64_tr_b16 a[8:9], v120 offset:24576
  ds_read_b64 v[112:113], v126 offset:200
  v_mfma_f32_16x16x32_bf16 v[52:55], v[216:219], a[20:23], v[52:55]
  ds_read_b64_tr_b16 a[10:11], v120 offset:25088
  v_cvt_pk_bf16_f32 v88, v88, v89
  v_mfma_f32_16x16x32_bf16 v[56:59], v[212:215], a[16:19], v[56:59]
  ds_read_b64_tr_b16 a[12:13], v120 offset:36864
  v_cvt_pk_bf16_f32 v90, v90, v91
  v_mfma_f32_16x16x32_bf16 v[56:59], v[220:223], a[20:23], v[56:59]
  ds_read_b64_tr_b16 a[14:15], v120 offset:37376
  v_accvgpr_write_b32 a224, v88
  v_mfma_f32_16x16x32_bf16 v[60:63], a[120:123], a[16:19], v[60:63]
  buffer_load_dwordx4 v106, s[16:19], s62 offen offset:2048 lds
  v_mfma_f32_16x16x32_bf16 v[60:63], a[128:131], a[20:23], v[60:63]
  buffer_load_dwordx4 v107, s[16:19], s62 offen offset:3072 lds
  v_mfma_f32_16x16x32_bf16 v[64:67], a[124:127], a[16:19], v[64:67]
  s_waitcnt lgkmcnt(5)
  v_accvgpr_write_b32 a225, v90
  v_mfma_f32_16x16x32_bf16 v[64:67], a[132:135], a[20:23], v[64:67]
  v_accvgpr_read_b32 v84, a252
  v_accvgpr_read_b32 v85, a253
  v_mfma_f32_16x16x32_bf16 v[68:71], v[224:227], a[0:3], v[68:71]
  ds_read_b64_tr_b16 a[16:17], v121 offset:24576
  v_accvgpr_read_b32 v86, a254
  v_mfma_f32_16x16x32_bf16 v[68:71], v[232:235], a[4:7], v[68:71]
  ds_read_b64_tr_b16 a[18:19], v121 offset:25088
  s_add_u32 s62, s62, 589824
  v_mfma_f32_16x16x32_bf16 v[72:75], v[228:231], a[0:3], v[72:75]
  s_waitcnt lgkmcnt(2)
  ds_read_b64_tr_b16 a[20:21], v121 offset:36864
  v_mfma_f32_16x16x32_bf16 v[72:75], v[236:239], a[4:7], v[72:75]
  ds_read_b64_tr_b16 a[22:23], v121 offset:37376
  s_add_u32 m0, s64, 32768
  v_mfma_f32_16x16x32_bf16 v[4:7], v[224:227], a[8:11], v[4:7]
  ds_read_b64_tr_b16 a[0:1], v122 offset:24576
  v_accvgpr_read_b32 v87, a255
  v_mfma_f32_16x16x32_bf16 v[4:7], v[232:235], a[12:15], v[4:7]
  buffer_load_dwordx4 v106, s[12:15], s62 offen lds
  v_mfma_f32_16x16x32_bf16 v[8:11], v[228:231], a[8:11], v[8:11]
  ds_read_b64_tr_b16 a[2:3], v122 offset:25088
  v_mul_f32 v84, v84, v110
  v_mfma_f32_16x16x32_bf16 v[8:11], v[236:239], a[12:15], v[8:11]
  buffer_load_dwordx4 v107, s[12:15], s62 offen offset:1024 lds
  v_mfma_f32_16x16x32_bf16 v[12:15], a[136:139], a[8:11], v[12:15]
  ds_read_b64_tr_b16 a[4:5], v122 offset:36864
  v_mul_f32 v85, v85, v111
  v_mfma_f32_16x16x32_bf16 v[12:15], a[144:147], a[12:15], v[12:15]
  v_mul_f32 v86, v86, v112
  v_mul_f32 v87, v87, v113
  v_mfma_f32_16x16x32_bf16 v[16:19], a[140:143], a[8:11], v[16:19]
  s_waitcnt lgkmcnt(3)
  ds_read_b64_tr_b16 a[6:7], v122 offset:37376
  v_mfma_f32_16x16x32_bf16 v[16:19], a[148:151], a[12:15], v[16:19]
  buffer_load_dwordx4 v106, s[16:19], s62 offen offset:2048 lds
  v_mfma_f32_16x16x32_bf16 v[20:23], v[224:227], a[16:19], v[20:23]
  ds_read_b64_tr_b16 a[8:9], v123 offset:24576
  v_cvt_pk_bf16_f32 v84, v84, v85
  v_mfma_f32_16x16x32_bf16 v[20:23], v[232:235], a[20:23], v[20:23]
  v_cvt_pk_bf16_f32 v86, v86, v87
  v_accvgpr_write_b32 a250, v84
  v_mfma_f32_16x16x32_bf16 v[24:27], v[228:231], a[16:19], v[24:27]
  ds_read_b64_tr_b16 a[10:11], v123 offset:25088
  v_accvgpr_write_b32 a251, v86
  v_mfma_f32_16x16x32_bf16 v[24:27], v[236:239], a[20:23], v[24:27]
  buffer_load_dwordx4 v107, s[16:19], s62 offen offset:3072 lds
  v_mfma_f32_16x16x32_bf16 v[28:31], a[136:139], a[16:19], v[28:31]
  ds_read_b64_tr_b16 a[12:13], v123 offset:36864
  s_add_u32 s62, s62, 589824
  v_mfma_f32_16x16x32_bf16 v[28:31], a[144:147], a[20:23], v[28:31]
  v_accvgpr_read_b32 v88, a196
  v_accvgpr_read_b32 v89, a197
  v_mfma_f32_16x16x32_bf16 v[32:35], a[140:143], a[16:19], v[32:35]
  s_waitcnt lgkmcnt(3)
  ds_read_b64_tr_b16 a[14:15], v123 offset:37376
  v_mfma_f32_16x16x32_bf16 v[32:35], a[148:151], a[20:23], v[32:35]
  v_add_u32 v120, 0xc000, v120
  v_add_u32 v121, 0xc000, v121
  v_add_u32 v122, 0xc000, v122
  v_add_u32 v123, 0xc000, v123
  v_add_u32 v118, 0xc000, v118
  s_waitcnt vmcnt(18)
  v_mfma_f32_16x16x32_bf16 v[36:39], v[224:227], a[0:3], v[36:39]
  s_barrier
  v_accvgpr_read_b32 v90, a198
  v_mfma_f32_16x16x32_bf16 v[36:39], v[232:235], a[4:7], v[36:39]
  ds_read_b64_tr_b16 a[16:17], v118 offset:0
  s_add_u32 m0, s64, 49152
  v_mfma_f32_16x16x32_bf16 v[40:43], v[228:231], a[0:3], v[40:43]
  buffer_load_dwordx4 v106, s[12:15], s62 offen lds
  v_mfma_f32_16x16x32_bf16 v[40:43], v[236:239], a[4:7], v[40:43]
  ds_read_b64_tr_b16 a[18:19], v118 offset:512
  v_accvgpr_read_b32 v91, a199
  v_mfma_f32_16x16x32_bf16 v[44:47], a[136:139], a[0:3], v[44:47]
  v_mul_f32 v88, v88, v110
  v_mul_f32 v89, v89, v111
  v_mfma_f32_16x16x32_bf16 v[44:47], a[144:147], a[4:7], v[44:47]
  ds_read_b64_tr_b16 a[20:21], v118 offset:12288
  v_mul_f32 v90, v90, v112
  v_mfma_f32_16x16x32_bf16 v[48:51], a[140:143], a[0:3], v[48:51]
  v_mul_f32 v91, v91, v113
  v_cvt_pk_bf16_f32 v88, v88, v89
  v_mfma_f32_16x16x32_bf16 v[48:51], a[148:151], a[4:7], v[48:51]
  ds_read_b64_tr_b16 a[22:23], v118 offset:12800
  s_waitcnt lgkmcnt(4)
  v_mfma_f32_16x16x32_bf16 v[52:55], v[224:227], a[8:11], v[52:55]
  ds_read_b64_tr_b16 a[0:1], v120 offset:0
  v_cvt_pk_bf16_f32 v90, v90, v91
  v_mfma_f32_16x16x32_bf16 v[52:55], v[232:235], a[12:15], v[52:55]
  ds_read_b64_tr_b16 a[2:3], v120 offset:512
  v_accvgpr_write_b32 a194, v88
  v_mfma_f32_16x16x32_bf16 v[56:59], v[228:231], a[8:11], v[56:59]
  ds_read_b64_tr_b16 a[4:5], v120 offset:12288
  v_accvgpr_write_b32 a195, v90
  v_mfma_f32_16x16x32_bf16 v[56:59], v[236:239], a[12:15], v[56:59]
  ds_read_b64_tr_b16 a[6:7], v120 offset:12800
  v_accvgpr_read_b32 v84, a212
  v_mfma_f32_16x16x32_bf16 v[60:63], a[136:139], a[8:11], v[60:63]
  buffer_load_dwordx4 v107, s[12:15], s62 offen offset:1024 lds
  v_mfma_f32_16x16x32_bf16 v[60:63], a[144:147], a[12:15], v[60:63]
  v_accvgpr_read_b32 v85, a213
  v_accvgpr_read_b32 v86, a214
  v_mfma_f32_16x16x32_bf16 v[64:67], a[140:143], a[8:11], v[64:67]
  s_waitcnt lgkmcnt(4)
  v_accvgpr_read_b32 v87, a215
  v_mfma_f32_16x16x32_bf16 v[64:67], a[148:151], a[12:15], v[64:67]
  v_mul_f32 v84, v84, v110
  v_mul_f32 v85, v85, v111
  v_mfma_f32_16x16x32_bf16 v[68:71], v[240:243], a[16:19], v[68:71]
  ds_read_b64_tr_b16 a[8:9], v121 offset:0
  v_mul_f32 v86, v86, v112
  v_mfma_f32_16x16x32_bf16 v[68:71], v[248:251], a[20:23], v[68:71]
  ds_read_b64_tr_b16 a[10:11], v121 offset:512
  v_mul_f32 v87, v87, v113
  v_mfma_f32_16x16x32_bf16 v[72:75], v[244:247], a[16:19], v[72:75]
  s_waitcnt lgkmcnt(2)
  ds_read_b64_tr_b16 a[12:13], v121 offset:12288
  v_mfma_f32_16x16x32_bf16 v[72:75], v[252:255], a[20:23], v[72:75]
  ds_read_b64_tr_b16 a[14:15], v121 offset:12800
  v_cvt_pk_bf16_f32 v84, v84, v85
  v_mfma_f32_16x16x32_bf16 v[4:7], v[240:243], a[0:3], v[4:7]
  ds_read_b64_tr_b16 a[16:17], v122 offset:0
  v_cvt_pk_bf16_f32 v86, v86, v87
  v_mfma_f32_16x16x32_bf16 v[4:7], v[248:251], a[4:7], v[4:7]
  buffer_load_dwordx4 v106, s[16:19], s62 offen offset:2048 lds
  v_mfma_f32_16x16x32_bf16 v[8:11], v[244:247], a[0:3], v[8:11]
  ds_read_b64_tr_b16 a[18:19], v122 offset:512
  v_accvgpr_write_b32 a210, v84
  v_mfma_f32_16x16x32_bf16 v[8:11], v[252:255], a[4:7], v[8:11]
  v_accvgpr_write_b32 a211, v86
  v_accvgpr_read_b32 v88, a228
  v_mfma_f32_16x16x32_bf16 v[12:15], a[152:155], a[0:3], v[12:15]
  ds_read_b64_tr_b16 a[20:21], v122 offset:12288
  v_accvgpr_read_b32 v89, a229
  v_mfma_f32_16x16x32_bf16 v[12:15], a[160:163], a[4:7], v[12:15]
  v_accvgpr_read_b32 v90, a230
  v_accvgpr_read_b32 v91, a231
  v_mfma_f32_16x16x32_bf16 v[16:19], a[156:159], a[0:3], v[16:19]
  s_waitcnt lgkmcnt(3)
  ds_read_b64_tr_b16 a[22:23], v122 offset:12800
  v_mfma_f32_16x16x32_bf16 v[16:19], a[164:167], a[4:7], v[16:19]
  buffer_load_dwordx4 v107, s[16:19], s62 offen offset:3072 lds
  v_mfma_f32_16x16x32_bf16 v[20:23], v[240:243], a[8:11], v[20:23]
  ds_read_b64_tr_b16 a[0:1], v123 offset:0
  s_add_u32 s62, s62, 589824
  v_mfma_f32_16x16x32_bf16 v[20:23], v[248:251], a[12:15], v[20:23]
  v_mul_f32 v88, v88, v110
  v_mul_f32 v89, v89, v111
  v_mfma_f32_16x16x32_bf16 v[24:27], v[244:247], a[8:11], v[24:27]
  ds_read_b64_tr_b16 a[2:3], v123 offset:512
  v_mul_f32 v90, v90, v112
  v_mfma_f32_16x16x32_bf16 v[24:27], v[252:255], a[12:15], v[24:27]
  v_mul_f32 v91, v91, v113
  v_cvt_pk_bf16_f32 v88, v88, v89
  v_mfma_f32_16x16x32_bf16 v[28:31], a[152:155], a[8:11], v[28:31]
  ds_read_b64_tr_b16 a[4:5], v123 offset:12288
  v_cvt_pk_bf16_f32 v90, v90, v91
  v_mfma_f32_16x16x32_bf16 v[28:31], a[160:163], a[12:15], v[28:31]
  v_accvgpr_write_b32 a226, v88
  v_accvgpr_write_b32 a227, v90
  v_mfma_f32_16x16x32_bf16 v[32:35], a[156:159], a[8:11], v[32:35]
  s_waitcnt lgkmcnt(3)
  ds_read_b64_tr_b16 a[6:7], v123 offset:12800
  v_mfma_f32_16x16x32_bf16 v[32:35], a[164:167], a[12:15], v[32:35]
  s_waitcnt vmcnt(16)
  ds_read_b128 v[84:87], v126 offset:0
  v_mfma_f32_16x16x32_bf16 v[36:39], v[240:243], a[16:19], v[36:39]
  s_barrier
  ds_read_b128 v[88:91], v126 offset:64
  v_mfma_f32_16x16x32_bf16 v[36:39], v[248:251], a[20:23], v[36:39]
  ds_read_b64_tr_b16 a[8:9], v118 offset:24576
  s_add_u32 m0, s64, 65536
  v_mfma_f32_16x16x32_bf16 v[40:43], v[244:247], a[16:19], v[40:43]
  buffer_load_dwordx4 v106, s[12:15], s62 offen lds
  v_mfma_f32_16x16x32_bf16 v[40:43], v[252:255], a[20:23], v[40:43]
  ds_read_b64_tr_b16 a[10:11], v118 offset:25088
  ds_read_b128 v[96:99], v126 offset:128
  v_mfma_f32_16x16x32_bf16 v[44:47], a[152:155], a[16:19], v[44:47]
  v_mfma_f32_16x16x32_bf16 v[44:47], a[160:163], a[20:23], v[44:47]
  ds_read_b64_tr_b16 a[12:13], v118 offset:36864
  v_mfma_f32_16x16x32_bf16 v[48:51], a[156:159], a[16:19], v[48:51]
  v_mfma_f32_16x16x32_bf16 v[48:51], a[164:167], a[20:23], v[48:51]
  ds_read_b64_tr_b16 a[14:15], v118 offset:37376
  s_waitcnt lgkmcnt(7)
  v_mfma_f32_16x16x32_bf16 v[52:55], v[240:243], a[0:3], v[52:55]
  ds_read_b64_tr_b16 a[16:17], v120 offset:24576
  v_mfma_f32_16x16x32_bf16 v[52:55], v[248:251], a[4:7], v[52:55]
  ds_read_b64_tr_b16 a[18:19], v120 offset:25088
  s_waitcnt lgkmcnt(8)
  v_mul_f32 v84, s88, v84
  v_mfma_f32_16x16x32_bf16 v[56:59], v[244:247], a[0:3], v[56:59]
  ds_read_b64_tr_b16 a[20:21], v120 offset:36864
  v_mul_f32 v85, s88, v85
  v_mfma_f32_16x16x32_bf16 v[56:59], v[252:255], a[4:7], v[56:59]
  ds_read_b64_tr_b16 a[22:23], v120 offset:37376
  v_mul_f32 v86, s88, v86
  v_mfma_f32_16x16x32_bf16 v[60:63], a[152:155], a[0:3], v[60:63]
  buffer_load_dwordx4 v107, s[12:15], s62 offen offset:1024 lds
  v_mfma_f32_16x16x32_bf16 v[60:63], a[160:163], a[4:7], v[60:63]
  buffer_load_dwordx4 v106, s[16:19], s62 offen offset:2048 lds
  v_mfma_f32_16x16x32_bf16 v[64:67], a[156:159], a[0:3], v[64:67]
  s_waitcnt lgkmcnt(4)
  v_mul_f32 v87, s88, v87
  v_mfma_f32_16x16x32_bf16 v[64:67], a[164:167], a[4:7], v[64:67]
  v_mul_f32 v88, s88, v88
  v_mul_f32 v89, s88, v89
  v_mfma_f32_16x16x32_bf16 v[68:71], a[24:27], a[8:11], v[68:71]
  ds_read_b64_tr_b16 a[0:1], v121 offset:24576
  v_mul_f32 v90, s88, v90
  v_mfma_f32_16x16x32_bf16 v[68:71], a[32:35], a[12:15], v[68:71]
  ds_read_b64_tr_b16 a[2:3], v121 offset:25088
  v_mul_f32 v91, s88, v91
  v_mfma_f32_16x16x32_bf16 v[72:75], a[28:31], a[8:11], v[72:75]
  s_waitcnt lgkmcnt(2)
  ds_read_b64_tr_b16 a[4:5], v121 offset:36864
  v_mfma_f32_16x16x32_bf16 v[72:75], a[36:39], a[12:15], v[72:75]
  ds_read_b64_tr_b16 a[6:7], v121 offset:37376
  v_mul_f32 v96, s88, v96
  v_mfma_f32_16x16x32_bf16 v[4:7], a[24:27], a[16:19], v[4:7]
  ds_read_b64_tr_b16 a[8:9], v122 offset:24576
  v_mul_f32 v97, s88, v97
  v_mfma_f32_16x16x32_bf16 v[4:7], a[32:35], a[20:23], v[4:7]
  buffer_load_dwordx4 v107, s[16:19], s62 offen offset:3072 lds
  v_mfma_f32_16x16x32_bf16 v[8:11], a[28:31], a[16:19], v[8:11]
  ds_read_b64_tr_b16 a[10:11], v122 offset:25088
  v_mul_f32 v98, s88, v98
  v_mfma_f32_16x16x32_bf16 v[8:11], a[36:39], a[20:23], v[8:11]
  v_mul_f32 v99, s88, v99
  v_mfma_f32_16x16x32_bf16 v[12:15], a[168:171], a[16:19], v[12:15]
  ds_read_b64_tr_b16 a[12:13], v122 offset:36864
  v_mfma_f32_16x16x32_bf16 v[12:15], a[176:179], a[20:23], v[12:15]
  s_add_u32 s62, s62, 589824
  s_add_u32 m0, s64, 81920
  v_mfma_f32_16x16x32_bf16 v[16:19], a[172:175], a[16:19], v[16:19]
  s_waitcnt lgkmcnt(3)
  ds_read_b64_tr_b16 a[14:15], v122 offset:37376
  v_mfma_f32_16x16x32_bf16 v[16:19], a[180:183], a[20:23], v[16:19]
  buffer_load_dwordx4 v106, s[12:15], s62 offen lds
  v_mfma_f32_16x16x32_bf16 v[20:23], a[24:27], a[0:3], v[20:23]
  ds_read_b64_tr_b16 a[16:17], v123 offset:24576
  v_mfma_f32_16x16x32_bf16 v[20:23], a[32:35], a[4:7], v[20:23]
  v_mfma_f32_16x16x32_bf16 v[24:27], a[28:31], a[0:3], v[24:27]
  ds_read_b64_tr_b16 a[18:19], v123 offset:25088
  v_mfma_f32_16x16x32_bf16 v[24:27], a[36:39], a[4:7], v[24:27]
  v_mfma_f32_16x16x32_bf16 v[28:31], a[168:171], a[0:3], v[28:31]
  ds_read_b64_tr_b16 a[20:21], v123 offset:36864
  v_mfma_f32_16x16x32_bf16 v[28:31], a[176:179], a[4:7], v[28:31]
  buffer_load_dwordx4 v107, s[12:15], s62 offen offset:1024 lds
  v_mfma_f32_16x16x32_bf16 v[32:35], a[172:175], a[0:3], v[32:35]
  s_waitcnt lgkmcnt(3)
  ds_read_b64_tr_b16 a[22:23], v123 offset:37376
  v_mfma_f32_16x16x32_bf16 v[32:35], a[180:183], a[4:7], v[32:35]
  v_mfma_f32_16x16x32_bf16 v[36:39], a[24:27], a[8:11], v[36:39]
  v_mfma_f32_16x16x32_bf16 v[36:39], a[32:35], a[12:15], v[36:39]
  v_mfma_f32_16x16x32_bf16 v[40:43], a[28:31], a[8:11], v[40:43]
  v_mfma_f32_16x16x32_bf16 v[40:43], a[36:39], a[12:15], v[40:43]
  buffer_load_dwordx4 v106, s[16:19], s62 offen offset:2048 lds
  v_mfma_f32_16x16x32_bf16 v[44:47], a[168:171], a[8:11], v[44:47]
  v_mfma_f32_16x16x32_bf16 v[44:47], a[176:179], a[12:15], v[44:47]
  v_mfma_f32_16x16x32_bf16 v[48:51], a[172:175], a[8:11], v[48:51]
  s_waitcnt lgkmcnt(0)
  v_mfma_f32_16x16x32_bf16 v[48:51], a[180:183], a[12:15], v[48:51]
  v_mfma_f32_16x16x32_bf16 v[52:55], a[24:27], a[16:19], v[52:55]
  v_mfma_f32_16x16x32_bf16 v[52:55], a[32:35], a[20:23], v[52:55]
  buffer_load_dwordx4 v107, s[16:19], s62 offen offset:3072 lds
  v_mfma_f32_16x16x32_bf16 v[56:59], a[28:31], a[16:19], v[56:59]
  s_add_u32 s62, s62, 589824
  v_mfma_f32_16x16x32_bf16 v[56:59], a[36:39], a[20:23], v[56:59]
  v_mfma_f32_16x16x32_bf16 v[60:63], a[168:171], a[16:19], v[60:63]
  v_mfma_f32_16x16x32_bf16 v[60:63], a[176:179], a[20:23], v[60:63]
  v_mfma_f32_16x16x32_bf16 v[64:67], a[172:175], a[16:19], v[64:67]
  v_mfma_f32_16x16x32_bf16 v[64:67], a[180:183], a[20:23], v[64:67]
  ds_read_b128 v[120:123], v126 offset:192
  s_waitcnt lgkmcnt(0)
  s_barrier
  v_accvgpr_write_b32 a0, s95
  v_accvgpr_write_b32 a1, s95
  v_accvgpr_write_b32 a2, s95
  v_accvgpr_write_b32 a3, s95
  v_pk_mul_f32 v[120:121], v[120:121], s[88:89]
  v_pk_mul_f32 v[122:123], v[122:123], s[88:89]
  v_pk_fma_f32 v[68:69], v[68:69], v[84:85], s[90:91]
  v_pk_fma_f32 v[70:71], v[70:71], v[86:87], s[90:91]
  v_exp_f32_e64 v110, v68 clamp
  v_exp_f32_e64 v112, v70 clamp
  s_add_u32 m0, s64, 98304
  v_exp_f32_e64 v111, v69 clamp
  v_exp_f32_e64 v113, v71 clamp
  buffer_load_dwordx4 v106, s[12:15], s62 offen lds
  v_max_f32 v68, s90, v68
  v_max_f32 v70, s90, v70
  buffer_load_dwordx4 v107, s[12:15], s62 offen offset:1024 lds
  v_max_f32 v69, s90, v69
  v_max_f32 v71, s90, v71
  v_pk_fma_f32 v[68:69], v[110:111], s[88:89], v[68:69]
  v_pk_fma_f32 v[70:71], v[112:113], s[88:89], v[70:71]
  v_cvt_pk_bf16_f32 v68, v68, v69
  v_cvt_pk_bf16_f32 v69, v70, v71
  v_pk_fma_f32 v[72:73], v[72:73], v[88:89], s[90:91]
  v_pk_fma_f32 v[74:75], v[74:75], v[90:91], s[90:91]
  v_exp_f32_e64 v110, v72 clamp
  v_exp_f32_e64 v112, v74 clamp
  buffer_load_dwordx4 v106, s[16:19], s62 offen offset:2048 lds
  v_exp_f32_e64 v111, v73 clamp
  v_exp_f32_e64 v113, v75 clamp
  buffer_load_dwordx4 v107, s[16:19], s62 offen offset:3072 lds
  v_max_f32 v72, s90, v72
  v_max_f32 v74, s90, v74
  s_add_u32 s62, s62, 589824
  v_max_f32 v73, s90, v73
  v_max_f32 v75, s90, v75
  v_pk_fma_f32 v[72:73], v[110:111], s[88:89], v[72:73]
  v_pk_fma_f32 v[74:75], v[112:113], s[88:89], v[74:75]
  v_cvt_pk_bf16_f32 v70, v72, v73
  v_cvt_pk_bf16_f32 v71, v74, v75
  ds_write_b128 v80, v[68:71] offset:2048
  v_pk_fma_f32 v[52:53], v[52:53], v[84:85], s[90:91]
  v_pk_fma_f32 v[54:55], v[54:55], v[86:87], s[90:91]
  v_exp_f32_e64 v110, v52 clamp
  v_exp_f32_e64 v112, v54 clamp
  v_exp_f32_e64 v111, v53 clamp
  v_exp_f32_e64 v113, v55 clamp
  v_max_f32 v52, s90, v52
  v_max_f32 v54, s90, v54
  v_max_f32 v53, s90, v53
  v_max_f32 v55, s90, v55
  v_pk_fma_f32 v[52:53], v[110:111], s[88:89], v[52:53]
  v_pk_fma_f32 v[54:55], v[112:113], s[88:89], v[54:55]
  v_cvt_pk_bf16_f32 v52, v52, v53
  v_cvt_pk_bf16_f32 v53, v54, v55
  v_pk_fma_f32 v[56:57], v[56:57], v[88:89], s[90:91]
  v_pk_fma_f32 v[58:59], v[58:59], v[90:91], s[90:91]
  v_exp_f32_e64 v110, v56 clamp
  v_exp_f32_e64 v112, v58 clamp
  v_exp_f32_e64 v111, v57 clamp
  v_exp_f32_e64 v113, v59 clamp
  v_max_f32 v56, s90, v56
  v_max_f32 v58, s90, v58
  v_max_f32 v57, s90, v57
  v_max_f32 v59, s90, v59
  v_pk_fma_f32 v[56:57], v[110:111], s[88:89], v[56:57]
  v_pk_fma_f32 v[58:59], v[112:113], s[88:89], v[58:59]
  v_cvt_pk_bf16_f32 v54, v56, v57
  v_cvt_pk_bf16_f32 v55, v58, v59
  v_pk_fma_f32 v[60:61], v[60:61], v[96:97], s[90:91]
  v_pk_fma_f32 v[62:63], v[62:63], v[98:99], s[90:91]
  v_exp_f32_e64 v110, v60 clamp
  v_exp_f32_e64 v112, v62 clamp
  v_exp_f32_e64 v111, v61 clamp
  v_exp_f32_e64 v113, v63 clamp
  v_max_f32 v60, s90, v60
  v_max_f32 v62, s90, v62
  v_max_f32 v61, s90, v61
  v_max_f32 v63, s90, v63
  v_pk_fma_f32 v[60:61], v[110:111], s[88:89], v[60:61]
  v_pk_fma_f32 v[62:63], v[112:113], s[88:89], v[62:63]
  v_cvt_pk_bf16_f32 v60, v60, v61
  v_cvt_pk_bf16_f32 v61, v62, v63
  v_pk_fma_f32 v[64:65], v[64:65], v[120:121], s[90:91]
  v_pk_fma_f32 v[66:67], v[66:67], v[122:123], s[90:91]
  v_exp_f32_e64 v110, v64 clamp
  v_exp_f32_e64 v112, v66 clamp
  v_exp_f32_e64 v111, v65 clamp
  v_exp_f32_e64 v113, v67 clamp
  v_max_f32 v64, s90, v64
  v_max_f32 v66, s90, v66
  v_max_f32 v65, s90, v65
  v_max_f32 v67, s90, v67
  v_pk_fma_f32 v[64:65], v[110:111], s[88:89], v[64:65]
  v_pk_fma_f32 v[66:67], v[112:113], s[88:89], v[66:67]
  v_cvt_pk_bf16_f32 v62, v64, v65
  v_cvt_pk_bf16_f32 v63, v66, v67
  s_waitcnt lgkmcnt(0)
  s_barrier
  ds_read_b128 v[76:79], v81 offset:2048
  v_pk_fma_f32 v[36:37], v[36:37], v[84:85], s[90:91]
  v_pk_fma_f32 v[38:39], v[38:39], v[86:87], s[90:91]
  v_exp_f32_e64 v110, v36 clamp
  v_exp_f32_e64 v112, v38 clamp
  v_mfma_f32_16x16x32_bf16 a[4:7], v[52:55], a[200:203], 0
  v_exp_f32_e64 v111, v37 clamp
  v_exp_f32_e64 v113, v39 clamp
  v_mfma_f32_16x16x32_bf16 a[4:7], v[60:63], a[208:211], a[4:7]
  v_max_f32 v36, s90, v36
  v_max_f32 v38, s90, v38
  v_mfma_f32_16x16x32_bf16 a[8:11], v[52:55], a[216:219], 0
  v_max_f32 v37, s90, v37
  v_max_f32 v39, s90, v39
  v_pk_fma_f32 v[36:37], v[110:111], s[88:89], v[36:37]
  v_pk_fma_f32 v[38:39], v[112:113], s[88:89], v[38:39]
  v_cvt_pk_bf16_f32 v36, v36, v37
  v_cvt_pk_bf16_f32 v37, v38, v39
  v_pk_fma_f32 v[40:41], v[40:41], v[88:89], s[90:91]
  v_pk_fma_f32 v[42:43], v[42:43], v[90:91], s[90:91]
  v_exp_f32_e64 v110, v40 clamp
  v_exp_f32_e64 v112, v42 clamp
  v_mfma_f32_16x16x32_bf16 a[8:11], v[60:63], a[224:227], a[8:11]
  v_exp_f32_e64 v111, v41 clamp
  v_exp_f32_e64 v113, v43 clamp
  v_mfma_f32_16x16x32_bf16 a[12:15], v[52:55], a[232:235], 0
  v_max_f32 v40, s90, v40
  v_max_f32 v42, s90, v42
  v_mfma_f32_16x16x32_bf16 a[12:15], v[60:63], a[240:243], a[12:15]
  v_max_f32 v41, s90, v41
  v_max_f32 v43, s90, v43
  v_pk_fma_f32 v[40:41], v[110:111], s[88:89], v[40:41]
  v_pk_fma_f32 v[42:43], v[112:113], s[88:89], v[42:43]
  v_cvt_pk_bf16_f32 v38, v40, v41
  v_cvt_pk_bf16_f32 v39, v42, v43
  v_pk_fma_f32 v[44:45], v[44:45], v[96:97], s[90:91]
  v_pk_fma_f32 v[46:47], v[46:47], v[98:99], s[90:91]
  v_exp_f32_e64 v110, v44 clamp
  v_exp_f32_e64 v112, v46 clamp
  v_mfma_f32_16x16x32_bf16 a[16:19], v[52:55], a[0:3], 0
  s_add_u32 s69, s68, 8192
  buffer_store_dwordx4 a[4:7], v108, s[20:23], s69 offen sc1
  v_exp_f32_e64 v111, v45 clamp
  v_exp_f32_e64 v113, v47 clamp
  v_mfma_f32_16x16x32_bf16 a[16:19], v[60:63], a[0:3], a[16:19]
  v_max_f32 v44, s90, v44
  v_max_f32 v46, s90, v46
  v_mfma_f32_16x16x32_bf16 a[20:23], v[68:71], a[216:219], 0
  s_add_u32 s69, s68, 9216
  buffer_store_dwordx4 a[8:11], v108, s[20:23], s69 offen sc1
  v_max_f32 v45, s90, v45
  v_max_f32 v47, s90, v47
  v_pk_fma_f32 v[44:45], v[110:111], s[88:89], v[44:45]
  v_pk_fma_f32 v[46:47], v[112:113], s[88:89], v[46:47]
  v_cvt_pk_bf16_f32 v44, v44, v45
  v_cvt_pk_bf16_f32 v45, v46, v47
  v_pk_fma_f32 v[48:49], v[48:49], v[120:121], s[90:91]
  v_pk_fma_f32 v[50:51], v[50:51], v[122:123], s[90:91]
  v_exp_f32_e64 v110, v48 clamp
  v_exp_f32_e64 v112, v50 clamp
  s_waitcnt lgkmcnt(0)
  v_mfma_f32_16x16x32_bf16 a[20:23], v[76:79], a[224:227], a[20:23]
  v_exp_f32_e64 v111, v49 clamp
  v_exp_f32_e64 v113, v51 clamp
  v_mfma_f32_16x16x32_bf16 a[4:7], v[68:71], a[232:235], 0
  s_add_u32 s69, s68, 10240
  buffer_store_dwordx4 a[12:15], v108, s[20:23], s69 offen sc1
  v_max_f32 v48, s90, v48
  v_max_f32 v50, s90, v50
  v_mfma_f32_16x16x32_bf16 a[4:7], v[76:79], a[240:243], a[4:7]
  v_max_f32 v49, s90, v49
  v_max_f32 v51, s90, v51
  v_pk_fma_f32 v[48:49], v[110:111], s[88:89], v[48:49]
  v_pk_fma_f32 v[50:51], v[112:113], s[88:89], v[50:51]
  v_cvt_pk_bf16_f32 v46, v48, v49
  v_cvt_pk_bf16_f32 v47, v50, v51
  v_pk_fma_f32 v[20:21], v[20:21], v[84:85], s[90:91]
  v_pk_fma_f32 v[22:23], v[22:23], v[86:87], s[90:91]
  v_exp_f32_e64 v110, v20 clamp
  v_exp_f32_e64 v112, v22 clamp
  v_mfma_f32_16x16x32_bf16 a[8:11], v[68:71], a[0:3], 0
  s_add_u32 s69, s68, 16384
  buffer_store_dwordx4 a[16:19], v108, s[20:23], s69 offen sc1
  v_exp_f32_e64 v111, v21 clamp
  v_exp_f32_e64 v113, v23 clamp
  v_mfma_f32_16x16x32_bf16 a[8:11], v[76:79], a[0:3], a[8:11]
  v_max_f32 v20, s90, v20
  v_max_f32 v22, s90, v22
  v_mfma_f32_16x16x32_bf16 a[12:15], v[36:39], a[184:187], 0
  s_add_u32 s69, s68, 11264
  buffer_store_dwordx4 a[20:23], v108, s[20:23], s69 offen sc1
  v_max_f32 v21, s90, v21
  v_max_f32 v23, s90, v23
  v_pk_fma_f32 v[20:21], v[110:111], s[88:89], v[20:21]
  v_pk_fma_f32 v[22:23], v[112:113], s[88:89], v[22:23]
  v_cvt_pk_bf16_f32 v20, v20, v21
  v_cvt_pk_bf16_f32 v21, v22, v23
  v_pk_fma_f32 v[24:25], v[24:25], v[88:89], s[90:91]
  v_pk_fma_f32 v[26:27], v[26:27], v[90:91], s[90:91]
  v_exp_f32_e64 v110, v24 clamp
  v_exp_f32_e64 v112, v26 clamp
  v_mfma_f32_16x16x32_bf16 a[12:15], v[44:47], a[192:195], a[12:15]
  v_exp_f32_e64 v111, v25 clamp
  v_exp_f32_e64 v113, v27 clamp
  v_mfma_f32_16x16x32_bf16 a[16:19], v[36:39], a[200:203], 0
  s_add_u32 s69, s68, 12288
  buffer_store_dwordx4 a[4:7], v108, s[20:23], s69 offen sc1
  v_max_f32 v24, s90, v24
  v_max_f32 v26, s90, v26
  v_mfma_f32_16x16x32_bf16 a[16:19], v[44:47], a[208:211], a[16:19]
  v_max_f32 v25, s90, v25
  v_max_f32 v27, s90, v27
  v_pk_fma_f32 v[24:25], v[110:111], s[88:89], v[24:25]
  v_pk_fma_f32 v[26:27], v[112:113], s[88:89], v[26:27]
  v_cvt_pk_bf16_f32 v22, v24, v25
  v_cvt_pk_bf16_f32 v23, v26, v27
  v_pk_fma_f32 v[28:29], v[28:29], v[96:97], s[90:91]
  v_pk_fma_f32 v[30:31], v[30:31], v[98:99], s[90:91]
  v_exp_f32_e64 v110, v28 clamp
  v_exp_f32_e64 v112, v30 clamp
  v_mfma_f32_16x16x32_bf16 a[20:23], v[36:39], a[216:219], 0
  s_add_u32 s69, s68, 17408
  buffer_store_dwordx4 a[8:11], v108, s[20:23], s69 offen sc1
  v_exp_f32_e64 v111, v29 clamp
  v_exp_f32_e64 v113, v31 clamp
  v_mfma_f32_16x16x32_bf16 a[20:23], v[44:47], a[224:227], a[20:23]
  v_max_f32 v28, s90, v28
  v_max_f32 v30, s90, v30
  v_mfma_f32_16x16x32_bf16 a[4:7], v[36:39], a[0:3], 0
  s_add_u32 s69, s68, 5120
  buffer_store_dwordx4 a[12:15], v108, s[20:23], s69 offen sc1
  v_max_f32 v29, s90, v29
  v_max_f32 v31, s90, v31
  v_pk_fma_f32 v[28:29], v[110:111], s[88:89], v[28:29]
  v_pk_fma_f32 v[30:31], v[112:113], s[88:89], v[30:31]
  v_cvt_pk_bf16_f32 v28, v28, v29
  v_cvt_pk_bf16_f32 v29, v30, v31
  v_pk_fma_f32 v[32:33], v[32:33], v[120:121], s[90:91]
  v_pk_fma_f32 v[34:35], v[34:35], v[122:123], s[90:91]
  v_exp_f32_e64 v110, v32 clamp
  v_exp_f32_e64 v112, v34 clamp
  v_mfma_f32_16x16x32_bf16 a[4:7], v[44:47], a[0:3], a[4:7]
  v_exp_f32_e64 v111, v33 clamp
  v_exp_f32_e64 v113, v35 clamp
  s_add_u32 s69, s68, 6144
  buffer_store_dwordx4 a[16:19], v108, s[20:23], s69 offen sc1
  v_max_f32 v32, s90, v32
  v_max_f32 v34, s90, v34
  v_max_f32 v33, s90, v33
  v_max_f32 v35, s90, v35
  v_pk_fma_f32 v[32:33], v[110:111], s[88:89], v[32:33]
  v_pk_fma_f32 v[34:35], v[112:113], s[88:89], v[34:35]
  v_cvt_pk_bf16_f32 v30, v32, v33
  v_cvt_pk_bf16_f32 v31, v34, v35
  v_pk_fma_f32 v[4:5], v[4:5], v[84:85], s[90:91]
  v_pk_fma_f32 v[6:7], v[6:7], v[86:87], s[90:91]
  v_exp_f32_e64 v110, v4 clamp
  v_exp_f32_e64 v112, v6 clamp
  v_mfma_f32_16x16x32_bf16 a[8:11], v[20:23], v[92:95], 0
  s_add_u32 s69, s68, 7168
  buffer_store_dwordx4 a[20:23], v108, s[20:23], s69 offen sc1
  v_exp_f32_e64 v111, v5 clamp
  v_exp_f32_e64 v113, v7 clamp
  v_mfma_f32_16x16x32_bf16 a[8:11], v[28:31], a[248:251], a[8:11]
  v_max_f32 v4, s90, v4
  v_max_f32 v6, s90, v6
  v_mfma_f32_16x16x32_bf16 a[12:15], v[20:23], a[184:187], 0
  s_add_u32 s69, s68, 15360
  buffer_store_dwordx4 a[4:7], v108, s[20:23], s69 offen sc1
  v_max_f32 v5, s90, v5
  v_max_f32 v7, s90, v7
  v_pk_fma_f32 v[4:5], v[110:111], s[88:89], v[4:5]
  v_pk_fma_f32 v[6:7], v[112:113], s[88:89], v[6:7]
  v_cvt_pk_bf16_f32 v4, v4, v5
  v_cvt_pk_bf16_f32 v5, v6, v7
  v_pk_fma_f32 v[8:9], v[8:9], v[88:89], s[90:91]
  v_pk_fma_f32 v[10:11], v[10:11], v[90:91], s[90:91]
  v_exp_f32_e64 v110, v8 clamp
  v_exp_f32_e64 v112, v10 clamp
  v_mfma_f32_16x16x32_bf16 a[12:15], v[28:31], a[192:195], a[12:15]
  v_exp_f32_e64 v111, v9 clamp
  v_exp_f32_e64 v113, v11 clamp
  v_mfma_f32_16x16x32_bf16 a[16:19], v[20:23], a[200:203], 0
  v_max_f32 v8, s90, v8
  v_max_f32 v10, s90, v10
  v_mfma_f32_16x16x32_bf16 a[16:19], v[28:31], a[208:211], a[16:19]
  v_max_f32 v9, s90, v9
  v_max_f32 v11, s90, v11
  v_pk_fma_f32 v[8:9], v[110:111], s[88:89], v[8:9]
  v_pk_fma_f32 v[10:11], v[112:113], s[88:89], v[10:11]
  v_cvt_pk_bf16_f32 v6, v8, v9
  v_cvt_pk_bf16_f32 v7, v10, v11
  v_pk_fma_f32 v[12:13], v[12:13], v[96:97], s[90:91]
  v_pk_fma_f32 v[14:15], v[14:15], v[98:99], s[90:91]
  v_exp_f32_e64 v110, v12 clamp
  v_exp_f32_e64 v112, v14 clamp
  v_mfma_f32_16x16x32_bf16 a[20:23], v[20:23], a[0:3], 0
  s_add_u32 s69, s68, 2048
  buffer_store_dwordx4 a[8:11], v108, s[20:23], s69 offen sc1
  v_exp_f32_e64 v111, v13 clamp
  v_exp_f32_e64 v113, v15 clamp
  v_mfma_f32_16x16x32_bf16 a[20:23], v[28:31], a[0:3], a[20:23]
  v_max_f32 v12, s90, v12
  v_max_f32 v14, s90, v14
  s_add_u32 s69, s68, 3072
  buffer_store_dwordx4 a[12:15], v108, s[20:23], s69 offen sc1
  v_max_f32 v13, s90, v13
  v_max_f32 v15, s90, v15
  v_pk_fma_f32 v[12:13], v[110:111], s[88:89], v[12:13]
  v_pk_fma_f32 v[14:15], v[112:113], s[88:89], v[14:15]
  v_cvt_pk_bf16_f32 v12, v12, v13
  v_cvt_pk_bf16_f32 v13, v14, v15
  v_pk_fma_f32 v[16:17], v[16:17], v[120:121], s[90:91]
  v_pk_fma_f32 v[18:19], v[18:19], v[122:123], s[90:91]
  v_exp_f32_e64 v110, v16 clamp
  v_exp_f32_e64 v112, v18 clamp
  v_exp_f32_e64 v111, v17 clamp
  v_exp_f32_e64 v113, v19 clamp
  s_add_u32 s69, s68, 4096
  buffer_store_dwordx4 a[16:19], v108, s[20:23], s69 offen sc1
  v_max_f32 v16, s90, v16
  v_max_f32 v18, s90, v18
  v_max_f32 v17, s90, v17
  v_max_f32 v19, s90, v19
  v_pk_fma_f32 v[16:17], v[110:111], s[88:89], v[16:17]
  v_pk_fma_f32 v[18:19], v[112:113], s[88:89], v[18:19]
  v_cvt_pk_bf16_f32 v14, v16, v17
  v_cvt_pk_bf16_f32 v15, v18, v19
  v_mfma_f32_16x16x32_bf16 a[4:7], v[4:7], v[92:95], 0
  s_add_u32 s69, s68, 14336
  buffer_store_dwordx4 a[20:23], v108, s[20:23], s69 offen sc1
  v_mfma_f32_16x16x32_bf16 a[4:7], v[12:15], a[248:251], a[4:7]
  v_mfma_f32_16x16x32_bf16 a[8:11], v[4:7], a[184:187], 0
  v_mfma_f32_16x16x32_bf16 a[8:11], v[12:15], a[192:195], a[8:11]
  v_mfma_f32_16x16x32_bf16 a[12:15], v[4:7], a[0:3], 0
  v_mfma_f32_16x16x32_bf16 a[12:15], v[12:15], a[0:3], a[12:15]
  s_add_u32 s69, s68, 0
  s_nop 2
  buffer_store_dwordx4 a[4:7], v108, s[20:23], s69 offen sc1
  s_add_u32 s69, s68, 1024
  buffer_store_dwordx4 a[8:11], v108, s[20:23], s69 offen sc1
  s_add_u32 s69, s68, 13312
  buffer_store_dwordx4 a[12:15], v108, s[20:23], s69 offen sc1
recurrent_scan__linear_attn_block__glu_gated_bilinear__prompt_kernel_hdr:
  v_mov_b32 v124, s48
  v_mov_b32 v125, s49
  v_min_u32 v126, 1, v0
  v_lshlrev_b32 v126, 30, v126
  s_mov_b32 s84, 6144
  s_mov_b32 s85, 10240
  s_cmp_eq_u32 s61, 0
  s_cselect_b32 s84, 2048, s84
  s_cselect_b32 s85, 8192, s85
  s_lshl_b32 s67, s59, 2
  s_add_u32 s67, s67, s60
  s_lshl_b32 s87, s67, 7
  s_add_u32 s87, s87, 41508864
  s_mul_i32 s67, s67, 3
  s_add_u32 s67, s67, s61
  s_sub_u32 s67, s67, 1
  s_lshl_b32 s68, s60, 4
  s_add_u32 s68, s68, s59
  s_add_u32 s68, s68, 192
  s_cmp_eq_u32 s61, 0
  s_cselect_b32 s67, s68, s67
  s_lshl_b32 s67, s67, 3
  s_add_u32 s86, s67, 41472000
  s_waitcnt vmcnt(20) lgkmcnt(0)
  s_barrier
  ds_read_b64_tr_b16 a[0:1], v100 offset:0
  ds_read_b64_tr_b16 a[2:3], v100 offset:512
  ds_read_b64_tr_b16 a[4:5], v100 offset:8192
  ds_read_b64_tr_b16 a[6:7], v100 offset:8704
  ds_read_b64_tr_b16 a[8:9], v100 offset:2048
  ds_read_b64_tr_b16 a[10:11], v100 offset:2560
  ds_read_b64_tr_b16 a[12:13], v100 offset:10240
  ds_read_b64_tr_b16 a[14:15], v100 offset:10752
recurrent_scan__linear_attn_block__glu_gated_bilinear__prompt_kernel_loop:
  s_waitcnt lgkmcnt(4)
  v_mfma_f32_16x16x32_bf16 v[4:7], a[0:3], v[128:131], 0
  ds_read_b64_tr_b16 a[16:17], v101 offset:0
  v_mul_f32 v84, v36, v52
  v_mfma_f32_16x16x32_bf16 v[4:7], a[4:7], v[136:139], v[4:7]
  v_mul_f32 v85, v37, v53
  v_mul_f32 v86, v38, v54
  v_mfma_f32_16x16x32_bf16 v[8:11], a[0:3], v[132:135], 0
  ds_read_b64_tr_b16 a[18:19], v101 offset:512
  v_mul_f32 v87, v39, v55
  v_mfma_f32_16x16x32_bf16 v[8:11], a[4:7], v[140:143], v[8:11]
  v_mul_f32 v88, v40, v56
  v_mul_f32 v89, v41, v57
  v_mfma_f32_16x16x32_bf16 v[12:15], a[0:3], a[40:43], 0
  ds_read_b64_tr_b16 a[20:21], v101 offset:8192
  v_mul_f32 v90, v42, v58
  v_mfma_f32_16x16x32_bf16 v[12:15], a[4:7], a[48:51], v[12:15]
  v_mul_f32 v91, v43, v59
  v_mul_f32 v92, v44, v60
  v_mfma_f32_16x16x32_bf16 v[16:19], a[0:3], a[44:47], 0
  s_waitcnt lgkmcnt(3)
  ds_read_b64_tr_b16 a[22:23], v101 offset:8704
  v_mfma_f32_16x16x32_bf16 v[16:19], a[4:7], a[52:55], v[16:19]
  v_mul_f32 v93, v45, v61
  v_mul_f32 v94, v46, v62
  v_mfma_f32_16x16x32_bf16 v[20:23], a[8:11], v[128:131], 0
  ds_read_b64_tr_b16 a[0:1], v101 offset:2048
  v_mul_f32 v95, v47, v63
  v_mfma_f32_16x16x32_bf16 v[20:23], a[12:15], v[136:139], v[20:23]
  v_mul_f32 v96, v48, v64
  v_mul_f32 v97, v49, v65
  v_mfma_f32_16x16x32_bf16 v[24:27], a[8:11], v[132:135], 0
  ds_read_b64_tr_b16 a[2:3], v101 offset:2560
  v_mul_f32 v98, v50, v66
  v_mfma_f32_16x16x32_bf16 v[24:27], a[12:15], v[140:143], v[24:27]
  v_mul_f32 v99, v51, v67
  v_mfma_f32_16x16x32_bf16 v[28:31], a[8:11], a[40:43], 0
  ds_read_b64_tr_b16 a[4:5], v101 offset:10240
  v_mfma_f32_16x16x32_bf16 v[28:31], a[12:15], a[48:51], v[28:31]
  v_mfma_f32_16x16x32_bf16 v[32:35], a[8:11], a[44:47], 0
  s_waitcnt lgkmcnt(3)
  ds_read_b64_tr_b16 a[6:7], v101 offset:10752
  v_mfma_f32_16x16x32_bf16 v[32:35], a[12:15], a[52:55], v[32:35]
  v_mfma_f32_16x16x32_bf16 v[36:39], a[16:19], v[128:131], 0
  ds_read_b64_tr_b16 a[8:9], v100 offset:16384
  v_mul_f32 v68, v68, v114
  v_mfma_f32_16x16x32_bf16 v[36:39], a[20:23], v[136:139], v[36:39]
  s_mov_b32 s66, s39
  s_mov_b32 m0, s80
  v_mfma_f32_16x16x32_bf16 v[40:43], a[16:19], v[132:135], 0
  ds_read_b64_tr_b16 a[10:11], v100 offset:16896
  v_mul_f32 v69, v69, v114
  v_mfma_f32_16x16x32_bf16 v[40:43], a[20:23], v[140:143], v[40:43]
  buffer_load_dwordx4 v1, s[28:31], s66 offen offset:0 lds
  v_mfma_f32_16x16x32_bf16 v[44:47], a[16:19], a[40:43], 0
  ds_read_b64_tr_b16 a[12:13], v100 offset:24576
  v_mul_f32 v70, v70, v114
  v_mfma_f32_16x16x32_bf16 v[44:47], a[20:23], a[48:51], v[44:47]
  v_mul_f32 v71, v71, v114
  v_mul_f32 v84, v84, v114
  v_mfma_f32_16x16x32_bf16 v[48:51], a[16:19], a[44:47], 0
  s_waitcnt lgkmcnt(3)
  ds_read_b64_tr_b16 a[14:15], v100 offset:25088
  v_mfma_f32_16x16x32_bf16 v[48:51], a[20:23], a[52:55], v[48:51]
  s_add_u32 s66, s66, 8192
  v_mul_f32 v85, v85, v114
  v_mfma_f32_16x16x32_bf16 v[52:55], a[0:3], v[128:131], 0
  ds_read_b64_tr_b16 a[16:17], v100 offset:18432
  v_mul_f32 v86, v86, v114
  v_mfma_f32_16x16x32_bf16 v[52:55], a[4:7], v[136:139], v[52:55]
  buffer_load_dwordx4 v1, s[28:31], s66 offen offset:1024 lds
  v_mfma_f32_16x16x32_bf16 v[56:59], a[0:3], v[132:135], 0
  ds_read_b64_tr_b16 a[18:19], v100 offset:18944
  v_mul_f32 v87, v87, v114
  v_mfma_f32_16x16x32_bf16 v[56:59], a[4:7], v[140:143], v[56:59]
  v_cvt_pk_bf16_f32 v68, v68, v69
  v_cvt_pk_bf16_f32 v69, v70, v71
  v_mfma_f32_16x16x32_bf16 v[60:63], a[0:3], a[40:43], 0
  ds_read_b64_tr_b16 a[20:21], v100 offset:26624
  s_add_u32 s66, s66, 8192
  v_mfma_f32_16x16x32_bf16 v[60:63], a[4:7], a[48:51], v[60:63]
  buffer_load_dwordx4 v1, s[28:31], s66 offen offset:2048 lds
  v_mfma_f32_16x16x32_bf16 v[64:67], a[0:3], a[44:47], 0
  s_waitcnt lgkmcnt(3)
  ds_read_b64_tr_b16 a[22:23], v100 offset:27136
  v_mfma_f32_16x16x32_bf16 v[64:67], a[4:7], a[52:55], v[64:67]
  v_cvt_pk_bf16_f32 v70, v84, v85
  v_cvt_pk_bf16_f32 v71, v86, v87
  v_mfma_f32_16x16x32_bf16 v[4:7], a[8:11], v[144:147], v[4:7]
  ds_read_b64_tr_b16 a[0:1], v101 offset:16384
  v_mul_f32 v72, v72, v115
  v_mfma_f32_16x16x32_bf16 v[4:7], a[12:15], v[152:155], v[4:7]
  v_mul_f32 v73, v73, v115
  v_mul_f32 v74, v74, v115
  v_mfma_f32_16x16x32_bf16 v[8:11], a[8:11], v[148:151], v[8:11]
  ds_read_b64_tr_b16 a[2:3], v101 offset:16896
  s_add_u32 s66, s66, 8192
  v_mfma_f32_16x16x32_bf16 v[8:11], a[12:15], v[156:159], v[8:11]
  buffer_load_dwordx4 v1, s[28:31], s66 offen offset:3072 lds
  v_mfma_f32_16x16x32_bf16 v[12:15], a[8:11], a[56:59], v[12:15]
  ds_read_b64_tr_b16 a[4:5], v101 offset:24576
  v_mul_f32 v75, v75, v115
  v_mfma_f32_16x16x32_bf16 v[12:15], a[12:15], a[64:67], v[12:15]
  v_mul_f32 v88, v88, v115
  v_mul_f32 v89, v89, v115
  v_mfma_f32_16x16x32_bf16 v[16:19], a[8:11], a[60:63], v[16:19]
  s_waitcnt lgkmcnt(3)
  ds_read_b64_tr_b16 a[6:7], v101 offset:25088
  v_mfma_f32_16x16x32_bf16 v[16:19], a[12:15], a[68:71], v[16:19]
  v_mul_f32 v90, v90, v115
  v_mul_f32 v91, v91, v115
  v_mfma_f32_16x16x32_bf16 v[20:23], a[16:19], v[144:147], v[20:23]
  ds_read_b64_tr_b16 a[8:9], v101 offset:18432
  s_add_u32 s66, s66, 8192
  v_mfma_f32_16x16x32_bf16 v[20:23], a[20:23], v[152:155], v[20:23]
  buffer_store_dwordx4 v[68:71], v108, s[24:27], s70 offen sc1
  v_mfma_f32_16x16x32_bf16 v[24:27], a[16:19], v[148:151], v[24:27]
  ds_read_b64_tr_b16 a[10:11], v101 offset:18944
  s_add_u32 s70, s70, s84
  v_mfma_f32_16x16x32_bf16 v[24:27], a[20:23], v[156:159], v[24:27]
  v_cvt_pk_bf16_f32 v72, v72, v73
  v_cvt_pk_bf16_f32 v73, v74, v75
  v_mfma_f32_16x16x32_bf16 v[28:31], a[16:19], a[56:59], v[28:31]
  ds_read_b64_tr_b16 a[12:13], v101 offset:26624
  v_cvt_pk_bf16_f32 v74, v88, v89
  v_mfma_f32_16x16x32_bf16 v[28:31], a[20:23], a[64:67], v[28:31]
  v_cvt_pk_bf16_f32 v75, v90, v91
  v_mul_f32 v76, v76, v116
  v_mfma_f32_16x16x32_bf16 v[32:35], a[16:19], a[60:63], v[32:35]
  s_waitcnt lgkmcnt(3)
  ds_read_b64_tr_b16 a[14:15], v101 offset:27136
  v_mfma_f32_16x16x32_bf16 v[32:35], a[20:23], a[68:71], v[32:35]
  s_waitcnt vmcnt(13)
  v_mul_f32 v77, v77, v116
  v_mfma_f32_16x16x32_bf16 v[36:39], a[0:3], v[144:147], v[36:39]
  s_barrier
  v_mul_f32 v78, v78, v116
  v_mfma_f32_16x16x32_bf16 v[36:39], a[4:7], v[152:155], v[36:39]
  ds_read_b64_tr_b16 a[16:17], v100 offset:32768
  s_add_u32 m0, s64, 114688
  v_mfma_f32_16x16x32_bf16 v[40:43], a[0:3], v[148:151], v[40:43]
  buffer_load_dwordx4 v106, s[12:15], s62 offen lds
  v_mfma_f32_16x16x32_bf16 v[40:43], a[4:7], v[156:159], v[40:43]
  ds_read_b64_tr_b16 a[18:19], v100 offset:33280
  v_mul_f32 v79, v79, v116
  v_mfma_f32_16x16x32_bf16 v[44:47], a[0:3], a[56:59], v[44:47]
  v_mul_f32 v92, v92, v116
  v_mul_f32 v93, v93, v116
  v_mfma_f32_16x16x32_bf16 v[44:47], a[4:7], a[64:67], v[44:47]
  ds_read_b64_tr_b16 a[20:21], v100 offset:40960
  v_mul_f32 v94, v94, v116
  v_mfma_f32_16x16x32_bf16 v[48:51], a[0:3], a[60:63], v[48:51]
  buffer_load_dwordx4 v107, s[12:15], s62 offen offset:1024 lds
  v_mfma_f32_16x16x32_bf16 v[48:51], a[4:7], a[68:71], v[48:51]
  ds_read_b64_tr_b16 a[22:23], v100 offset:41472
  s_waitcnt lgkmcnt(4)
  v_mfma_f32_16x16x32_bf16 v[52:55], a[8:11], v[144:147], v[52:55]
  ds_read_b64_tr_b16 a[0:1], v100 offset:34816
  v_mul_f32 v95, v95, v116
  v_mfma_f32_16x16x32_bf16 v[52:55], a[12:15], v[152:155], v[52:55]
  v_cvt_pk_bf16_f32 v76, v76, v77
  v_cvt_pk_bf16_f32 v77, v78, v79
  v_mfma_f32_16x16x32_bf16 v[56:59], a[8:11], v[148:151], v[56:59]
  ds_read_b64_tr_b16 a[2:3], v100 offset:35328
  v_cvt_pk_bf16_f32 v78, v92, v93
  v_mfma_f32_16x16x32_bf16 v[56:59], a[12:15], v[156:159], v[56:59]
  v_cvt_pk_bf16_f32 v79, v94, v95
  v_mul_f32 v80, v80, v117
  v_mfma_f32_16x16x32_bf16 v[60:63], a[8:11], a[56:59], v[60:63]
  ds_read_b64_tr_b16 a[4:5], v100 offset:43008
  v_mul_f32 v81, v81, v117
  v_mfma_f32_16x16x32_bf16 v[60:63], a[12:15], a[64:67], v[60:63]
  buffer_store_dwordx4 v[72:75], v108, s[24:27], s71 offen sc1
  v_mfma_f32_16x16x32_bf16 v[64:67], a[8:11], a[60:63], v[64:67]
  s_waitcnt lgkmcnt(3)
  ds_read_b64_tr_b16 a[6:7], v100 offset:43520
  v_mfma_f32_16x16x32_bf16 v[64:67], a[12:15], a[68:71], v[64:67]
  s_add_u32 s71, s71, s84
  v_mul_f32 v82, v82, v117
  v_mfma_f32_16x16x32_bf16 v[4:7], a[16:19], v[160:163], v[4:7]
  ds_read_b64_tr_b16 a[8:9], v101 offset:32768
  v_mul_f32 v83, v83, v117
  v_mfma_f32_16x16x32_bf16 v[4:7], a[20:23], v[168:171], v[4:7]
  v_mul_f32 v96, v96, v117
  v_mul_f32 v97, v97, v117
  v_mfma_f32_16x16x32_bf16 v[8:11], a[16:19], v[164:167], v[8:11]
  ds_read_b64_tr_b16 a[10:11], v101 offset:33280
  v_mul_f32 v98, v98, v117
  v_mfma_f32_16x16x32_bf16 v[8:11], a[20:23], v[172:175], v[8:11]
  buffer_load_dwordx4 v106, s[16:19], s62 offen offset:2048 lds
  v_mfma_f32_16x16x32_bf16 v[12:15], a[16:19], a[72:75], v[12:15]
  ds_read_b64_tr_b16 a[12:13], v101 offset:40960
  v_mul_f32 v99, v99, v117
  v_mfma_f32_16x16x32_bf16 v[12:15], a[20:23], a[80:83], v[12:15]
  v_cvt_pk_bf16_f32 v80, v80, v81
  v_cvt_pk_bf16_f32 v81, v82, v83
  v_mfma_f32_16x16x32_bf16 v[16:19], a[16:19], a[76:79], v[16:19]
  s_waitcnt lgkmcnt(3)
  ds_read_b64_tr_b16 a[14:15], v101 offset:41472
  v_mfma_f32_16x16x32_bf16 v[16:19], a[20:23], a[84:87], v[16:19]
  v_cvt_pk_bf16_f32 v82, v96, v97
  v_cvt_pk_bf16_f32 v83, v98, v99
  v_mfma_f32_16x16x32_bf16 v[20:23], a[0:3], v[160:163], v[20:23]
  ds_read_b64_tr_b16 a[16:17], v101 offset:34816
  s_mul_i32 s74, s61, 144
  v_mfma_f32_16x16x32_bf16 v[20:23], a[4:7], v[168:171], v[20:23]
  buffer_load_dwordx4 v107, s[16:19], s62 offen offset:3072 lds
  v_mfma_f32_16x16x32_bf16 v[24:27], a[0:3], v[164:167], v[24:27]
  ds_read_b64_tr_b16 a[18:19], v101 offset:35328
  s_mul_i32 s75, s60, 36
  v_mfma_f32_16x16x32_bf16 v[24:27], a[4:7], v[172:175], v[24:27]
  s_add_u32 s74, s74, s75
  s_mul_i32 s74, s74, 9216
  v_mfma_f32_16x16x32_bf16 v[28:31], a[0:3], a[72:75], v[28:31]
  ds_read_b64_tr_b16 a[20:21], v101 offset:43008
  s_add_u32 s74, s74, 25952256
  v_mfma_f32_16x16x32_bf16 v[28:31], a[4:7], a[80:83], v[28:31]
  s_add_u32 s62, s62, 589824
  s_add_u32 s76, s74, s64
  v_mfma_f32_16x16x32_bf16 v[32:35], a[0:3], a[76:79], v[32:35]
  s_waitcnt lgkmcnt(3)
  ds_read_b64_tr_b16 a[22:23], v101 offset:43520
  v_mfma_f32_16x16x32_bf16 v[32:35], a[4:7], a[84:87], v[32:35]
  buffer_store_dwordx4 v[76:79], v108, s[24:27], s72 offen sc1
  v_mfma_f32_16x16x32_bf16 v[36:39], a[8:11], v[160:163], v[36:39]
  ds_read_b64_tr_b16 a[0:1], v100 offset:49152
  s_add_u32 s72, s72, s84
  v_mfma_f32_16x16x32_bf16 v[36:39], a[12:15], v[168:171], v[36:39]
  v_writelane_b32 v110, s76, 0
  s_mul_i32 s76, s56, 9216
  v_mfma_f32_16x16x32_bf16 v[40:43], a[8:11], v[164:167], v[40:43]
  ds_read_b64_tr_b16 a[2:3], v100 offset:49664
  v_writelane_b32 v110, s76, 1
  v_mfma_f32_16x16x32_bf16 v[40:43], a[12:15], v[172:175], v[40:43]
  s_add_u32 m0, s64, 131072
  s_add_u32 s74, s74, s76
  v_mfma_f32_16x16x32_bf16 v[44:47], a[8:11], a[72:75], v[44:47]
  ds_read_b64_tr_b16 a[4:5], v100 offset:57344
  s_add_u32 s74, s74, 147456
  v_mfma_f32_16x16x32_bf16 v[44:47], a[12:15], a[80:83], v[44:47]
  buffer_load_dwordx4 v106, s[12:15], s62 offen lds
  v_mfma_f32_16x16x32_bf16 v[48:51], a[8:11], a[76:79], v[48:51]
  s_waitcnt lgkmcnt(3)
  ds_read_b64_tr_b16 a[6:7], v100 offset:57856
  v_mfma_f32_16x16x32_bf16 v[48:51], a[12:15], a[84:87], v[48:51]
  v_writelane_b32 v110, s74, 2
  s_lshl_b32 s74, s59, 3
  v_mfma_f32_16x16x32_bf16 v[52:55], a[16:19], v[160:163], v[52:55]
  ds_read_b64_tr_b16 a[8:9], v100 offset:51200
  s_lshl_b32 s76, s56, 1
  v_mfma_f32_16x16x32_bf16 v[52:55], a[20:23], v[168:171], v[52:55]
  s_add_u32 s74, s74, s76
  s_mul_i32 s74, s74, 144
  v_mfma_f32_16x16x32_bf16 v[56:59], a[16:19], v[164:167], v[56:59]
  ds_read_b64_tr_b16 a[10:11], v100 offset:51712
  s_add_u32 s74, s74, s75
  v_mfma_f32_16x16x32_bf16 v[56:59], a[20:23], v[172:175], v[56:59]
  buffer_load_dwordx4 v107, s[12:15], s62 offen offset:1024 lds
  v_mfma_f32_16x16x32_bf16 v[60:63], a[16:19], a[72:75], v[60:63]
  ds_read_b64_tr_b16 a[12:13], v100 offset:59392
  s_lshl_b32 s74, s74, 10
  v_mfma_f32_16x16x32_bf16 v[60:63], a[20:23], a[80:83], v[60:63]
  v_writelane_b32 v110, s74, 3
  s_add_u32 s74, s74, 147456
  v_mfma_f32_16x16x32_bf16 v[64:67], a[16:19], a[76:79], v[64:67]
  s_waitcnt lgkmcnt(3)
  ds_read_b64_tr_b16 a[14:15], v100 offset:59904
  v_mfma_f32_16x16x32_bf16 v[64:67], a[20:23], a[84:87], v[64:67]
  v_writelane_b32 v110, s74, 4
  s_mul_i32 s74, s2, 10923
  v_mfma_f32_16x16x32_bf16 v[4:7], a[0:3], v[176:179], v[4:7]
  ds_read_b64_tr_b16 a[16:17], v101 offset:49152
  s_lshr_b32 s74, s74, 16
  v_mfma_f32_16x16x32_bf16 v[4:7], a[4:7], v[184:187], v[4:7]
  buffer_store_dwordx4 v[80:83], v108, s[24:27], s73 offen sc1
  v_mfma_f32_16x16x32_bf16 v[8:11], a[0:3], v[180:183], v[8:11]
  ds_read_b64_tr_b16 a[18:19], v101 offset:49664
  s_add_u32 s73, s73, s84
  v_mfma_f32_16x16x32_bf16 v[8:11], a[4:7], v[188:191], v[8:11]
  s_mov_b32 s34, s43
  s_and_b32 s88, s43, 15
  v_mfma_f32_16x16x32_bf16 v[12:15], a[0:3], a[88:91], v[12:15]
  ds_read_b64_tr_b16 a[20:21], v101 offset:57344
  s_mov_b32 s66, s42
  v_mfma_f32_16x16x32_bf16 v[12:15], a[4:7], a[96:99], v[12:15]
  s_mov_b32 s36, s44
  s_mov_b32 s37, s45
  v_mfma_f32_16x16x32_bf16 v[16:19], a[0:3], a[92:95], v[16:19]
  s_waitcnt lgkmcnt(3)
  ds_read_b64_tr_b16 a[22:23], v101 offset:57856
  v_mfma_f32_16x16x32_bf16 v[16:19], a[4:7], a[100:103], v[16:19]
  buffer_load_dwordx4 v106, s[16:19], s62 offen offset:2048 lds
  v_mfma_f32_16x16x32_bf16 v[20:23], a[8:11], v[176:179], v[20:23]
  ds_read_b64_tr_b16 a[0:1], v101 offset:51200
  s_mov_b32 s38, s46
  v_mfma_f32_16x16x32_bf16 v[20:23], a[12:15], v[184:187], v[20:23]
  s_mov_b32 s39, s47
  s_mov_b32 s42, s50
  v_mfma_f32_16x16x32_bf16 v[24:27], a[8:11], v[180:183], v[24:27]
  ds_read_b64_tr_b16 a[2:3], v101 offset:51712
  s_mov_b32 s43, s51
  v_mfma_f32_16x16x32_bf16 v[24:27], a[12:15], v[188:191], v[24:27]
  s_mov_b32 s46, 0
  s_mov_b32 s51, 0
  v_mfma_f32_16x16x32_bf16 v[28:31], a[8:11], a[88:91], v[28:31]
  ds_read_b64_tr_b16 a[4:5], v101 offset:59392
  v_xor_b32 v121, 32, v2
  v_mfma_f32_16x16x32_bf16 v[28:31], a[12:15], a[96:99], v[28:31]
  buffer_load_dwordx4 v107, s[16:19], s62 offen offset:3072 lds
  v_mfma_f32_16x16x32_bf16 v[32:35], a[8:11], a[92:95], v[32:35]
  s_waitcnt lgkmcnt(3)
  ds_read_b64_tr_b16 a[6:7], v101 offset:59904
  v_mfma_f32_16x16x32_bf16 v[32:35], a[12:15], a[100:103], v[32:35]
  v_xor_b32 v122, 64, v2
  v_xor_b32 v123, 96, v2
  v_mfma_f32_16x16x32_bf16 v[36:39], a[16:19], v[176:179], v[36:39]
  ds_read_b64_tr_b16 a[8:9], v102 offset:0
  s_mov_b32 s28, s36
  v_mfma_f32_16x16x32_bf16 v[36:39], a[20:23], v[184:187], v[36:39]
  s_add_u32 s62, s62, 0xffb80080
  s_mov_b32 s29, s37
  v_mfma_f32_16x16x32_bf16 v[40:43], a[16:19], v[180:183], v[40:43]
  ds_read_b64_tr_b16 a[10:11], v102 offset:512
  s_mov_b32 s30, s38
  v_mfma_f32_16x16x32_bf16 v[40:43], a[20:23], v[188:191], v[40:43]
  buffer_load_dword v109, v3, s[4:7], s83 offen
  v_mfma_f32_16x16x32_bf16 v[44:47], a[16:19], a[88:91], v[44:47]
  ds_read_b64_tr_b16 a[12:13], v102 offset:8192
  s_mul_i32 s75, s74, 6
  v_mfma_f32_16x16x32_bf16 v[44:47], a[20:23], a[96:99], v[44:47]
  buffer_load_dword v109, v118, s[28:31], s39 offen
  v_mfma_f32_16x16x32_bf16 v[48:51], a[16:19], a[92:95], v[48:51]
  s_waitcnt lgkmcnt(3)
  ds_read_b64_tr_b16 a[14:15], v102 offset:8704
  v_mfma_f32_16x16x32_bf16 v[48:51], a[20:23], a[100:103], v[48:51]
  s_add_u32 s83, s83, 128
  s_add_u32 m0, s64, 0
  v_mfma_f32_16x16x32_bf16 v[52:55], a[0:3], v[176:179], v[52:55]
  ds_read_b64_tr_b16 a[16:17], v102 offset:2048
  s_sub_u32 s75, s2, s75
  v_mfma_f32_16x16x32_bf16 v[52:55], a[4:7], v[184:187], v[52:55]
  buffer_load_dwordx4 v106, s[12:15], s62 offen lds
  v_mfma_f32_16x16x32_bf16 v[56:59], a[0:3], v[180:183], v[56:59]
  ds_read_b64_tr_b16 a[18:19], v102 offset:2560
  s_lshr_b32 s75, s75, 1
  v_mfma_f32_16x16x32_bf16 v[56:59], a[4:7], v[188:191], v[56:59]
  s_mul_i32 s76, s74, 7282
  s_lshr_b32 s76, s76, 16
  v_mfma_f32_16x16x32_bf16 v[60:63], a[0:3], a[88:91], v[60:63]
  ds_read_b64_tr_b16 a[20:21], v102 offset:10240
  s_mul_i32 s77, s76, 9
  v_mfma_f32_16x16x32_bf16 v[60:63], a[4:7], a[96:99], v[60:63]
  s_sub_u32 s97, s74, s77
  s_add_u32 s96, s97, s75
  v_mfma_f32_16x16x32_bf16 v[64:67], a[0:3], a[92:95], v[64:67]
  s_waitcnt lgkmcnt(3)
  ds_read_b64_tr_b16 a[22:23], v102 offset:10752
  v_mfma_f32_16x16x32_bf16 v[64:67], a[4:7], a[100:103], v[64:67]
  buffer_load_dwordx4 v107, s[12:15], s62 offen offset:1024 lds
  v_mfma_f32_16x16x32_bf16 v[4:7], a[8:11], v[192:195], v[4:7]
  ds_read_b64_tr_b16 a[0:1], v103 offset:0
  s_sub_u32 s96, s96, 1
  v_mfma_f32_16x16x32_bf16 v[4:7], a[12:15], v[200:203], v[4:7]
  s_and_b32 s98, s2, 1
  s_and_b32 s77, s74, 1
  v_mfma_f32_16x16x32_bf16 v[8:11], a[8:11], v[196:199], v[8:11]
  ds_read_b64_tr_b16 a[2:3], v103 offset:512
  s_add_u32 s77, s77, s75
  v_mfma_f32_16x16x32_bf16 v[8:11], a[12:15], v[204:207], v[8:11]
  s_sub_u32 s77, s77, 1
  s_lshl_b32 s78, s98, 10
  v_mfma_f32_16x16x32_bf16 v[12:15], a[8:11], a[104:107], v[12:15]
  ds_read_b64_tr_b16 a[4:5], v103 offset:8192
  s_lshl_b32 s79, s77, 3
  v_mfma_f32_16x16x32_bf16 v[12:15], a[12:15], a[112:115], v[12:15]
  buffer_load_dwordx4 v106, s[16:19], s62 offen offset:2048 lds
  v_mfma_f32_16x16x32_bf16 v[16:19], a[8:11], a[108:111], v[16:19]
  s_waitcnt lgkmcnt(3)
  ds_read_b64_tr_b16 a[6:7], v103 offset:8704
  v_mfma_f32_16x16x32_bf16 v[16:19], a[12:15], a[116:119], v[16:19]
  s_add_u32 s78, s78, s79
  s_lshl_b32 s79, s98, 3
  v_mfma_f32_16x16x32_bf16 v[20:23], a[16:19], v[192:195], v[20:23]
  ds_read_b64_tr_b16 a[8:9], v103 offset:2048
  s_add_u32 s79, s79, 2048
  v_mfma_f32_16x16x32_bf16 v[20:23], a[20:23], v[200:203], v[20:23]
  s_cmp_lt_u32 s77, 2
  s_cselect_b32 s78, s78, s79
  s_mul_i32 s74, s74, 3072
  v_mfma_f32_16x16x32_bf16 v[24:27], a[16:19], v[196:199], v[24:27]
  ds_read_b64_tr_b16 a[10:11], v103 offset:2560
  s_add_u32 s78, s78, s74
  v_mfma_f32_16x16x32_bf16 v[24:27], a[20:23], v[204:207], v[24:27]
  buffer_load_dwordx4 v107, s[16:19], s62 offen offset:3072 lds
  v_mfma_f32_16x16x32_bf16 v[28:31], a[16:19], a[104:107], v[28:31]
  ds_read_b64_tr_b16 a[12:13], v103 offset:10240
  s_add_u32 s62, s62, 589824
  v_mfma_f32_16x16x32_bf16 v[28:31], a[20:23], a[112:115], v[28:31]
  s_lshl_b32 s79, s56, 8
  s_add_u32 s78, s78, s79
  v_mfma_f32_16x16x32_bf16 v[32:35], a[16:19], a[108:111], v[32:35]
  s_waitcnt lgkmcnt(3)
  ds_read_b64_tr_b16 a[14:15], v103 offset:10752
  v_mfma_f32_16x16x32_bf16 v[32:35], a[20:23], a[116:119], v[32:35]
  s_waitcnt vmcnt(12)
  s_add_u32 s78, s78, 31924224
  v_mfma_f32_16x16x32_bf16 v[36:39], a[0:3], v[192:195], v[36:39]
  s_barrier
  s_max_i32 s74, s96, s97
  v_mfma_f32_16x16x32_bf16 v[36:39], a[4:7], v[200:203], v[36:39]
  ds_read_b64_tr_b16 a[16:17], v102 offset:16384
  s_add_u32 m0, s64, 16384
  v_mfma_f32_16x16x32_bf16 v[40:43], a[0:3], v[196:199], v[40:43]
  buffer_load_dwordx4 v106, s[12:15], s62 offen lds
  v_mfma_f32_16x16x32_bf16 v[40:43], a[4:7], v[204:207], v[40:43]
  ds_read_b64_tr_b16 a[18:19], v102 offset:16896
  s_cmp_gt_i32 s74, 4
  s_cselect_b32 s74, 1, 0
  v_mfma_f32_16x16x32_bf16 v[44:47], a[0:3], a[104:107], v[44:47]
  s_sub_u32 s77, 8, s96
  s_sub_u32 s75, 8, s97
  v_mfma_f32_16x16x32_bf16 v[44:47], a[4:7], a[112:115], v[44:47]
  ds_read_b64_tr_b16 a[20:21], v102 offset:24576
  s_cmp_eq_u32 s74, 1
  s_cselect_b32 s77, s77, s96
  s_cselect_b32 s75, s75, s97
  v_mfma_f32_16x16x32_bf16 v[48:51], a[0:3], a[108:111], v[48:51]
  s_add_u32 s75, s75, s77
  s_cmp_eq_u32 s98, 0
  s_cselect_b32 s75, s75, 13
  v_mfma_f32_16x16x32_bf16 v[48:51], a[4:7], a[116:119], v[48:51]
  ds_read_b64_tr_b16 a[22:23], v102 offset:25088
  s_waitcnt lgkmcnt(4)
  v_mfma_f32_16x16x32_bf16 v[52:55], a[8:11], v[192:195], v[52:55]
  ds_read_b64_tr_b16 a[0:1], v102 offset:18432
  s_add_u32 s75, s75, s77
  v_mfma_f32_16x16x32_bf16 v[52:55], a[12:15], v[200:203], v[52:55]
  buffer_load_dwordx4 v107, s[12:15], s62 offen offset:1024 lds
  v_mfma_f32_16x16x32_bf16 v[56:59], a[8:11], v[196:199], v[56:59]
  ds_read_b64_tr_b16 a[2:3], v102 offset:18944
  s_lshl_b32 s76, s76, 1
  v_mfma_f32_16x16x32_bf16 v[56:59], a[12:15], v[204:207], v[56:59]
  s_add_u32 s76, s76, s74
  s_mul_i32 s76, s76, 18
  v_mfma_f32_16x16x32_bf16 v[60:63], a[8:11], a[104:107], v[60:63]
  ds_read_b64_tr_b16 a[4:5], v102 offset:26624
  s_add_u32 s75, s75, s76
  v_mfma_f32_16x16x32_bf16 v[60:63], a[12:15], a[112:115], v[60:63]
  s_lshl_b32 s75, s75, 10
  s_add_u32 s75, s75, s79
  v_mfma_f32_16x16x32_bf16 v[64:67], a[8:11], a[108:111], v[64:67]
  s_waitcnt lgkmcnt(3)
  ds_read_b64_tr_b16 a[6:7], v102 offset:27136
  v_mfma_f32_16x16x32_bf16 v[64:67], a[12:15], a[116:119], v[64:67]
  s_add_u32 s75, s75, 21233664
  v_writelane_b32 v110, s75, 5
  v_mfma_f32_16x16x32_bf16 v[4:7], a[16:19], v[208:211], v[4:7]
  ds_read_b64_tr_b16 a[8:9], v103 offset:16384
  s_mov_b32 s26, 18874368
  v_mfma_f32_16x16x32_bf16 v[4:7], a[20:23], v[216:219], v[4:7]
  buffer_load_dwordx4 v106, s[16:19], s62 offen offset:2048 lds
  v_mfma_f32_16x16x32_bf16 v[8:11], a[16:19], v[212:215], v[8:11]
  ds_read_b64_tr_b16 a[10:11], v103 offset:16896
  v_writelane_b32 v110, s78, 6
  v_mfma_f32_16x16x32_bf16 v[8:11], a[20:23], v[220:223], v[8:11]
  s_cmp_lt_u32 s96, 9
  s_cselect_b32 s74, 25952256, 0
  s_cmp_lt_u32 s2, 216
  s_cselect_b32 s74, s74, 0
  s_cselect_b32 s75, 41517056, 0
  v_mfma_f32_16x16x32_bf16 v[12:15], a[16:19], a[120:123], v[12:15]
  ds_read_b64_tr_b16 a[12:13], v103 offset:24576
  v_writelane_b32 v110, s74, 7
  v_mfma_f32_16x16x32_bf16 v[12:15], a[20:23], a[128:131], v[12:15]
  v_writelane_b32 v110, s75, 8
  s_lshl_b32 s74, s2, 3
  v_mfma_f32_16x16x32_bf16 v[16:19], a[16:19], a[124:127], v[16:19]
  s_waitcnt lgkmcnt(3)
  ds_read_b64_tr_b16 a[14:15], v103 offset:25088
  v_mfma_f32_16x16x32_bf16 v[16:19], a[20:23], a[132:135], v[16:19]
  s_add_u32 s74, s74, 41474048
  v_writelane_b32 v110, s74, 9
  v_mfma_f32_16x16x32_bf16 v[20:23], a[0:3], v[208:211], v[20:23]
  ds_read_b64_tr_b16 a[16:17], v103 offset:18432
  s_lshl_b32 s97, s97, 4
  v_mfma_f32_16x16x32_bf16 v[20:23], a[4:7], v[216:219], v[20:23]
  buffer_load_dwordx4 v107, s[16:19], s62 offen offset:3072 lds
  v_mfma_f32_16x16x32_bf16 v[24:27], a[0:3], v[212:215], v[24:27]
  ds_read_b64_tr_b16 a[18:19], v103 offset:18944
  v_writelane_b32 v110, s97, 10
  v_mfma_f32_16x16x32_bf16 v[24:27], a[4:7], v[220:223], v[24:27]
  s_lshl_b32 s74, s96, 4
  s_lshl_b32 s75, s56, 2
  v_mfma_f32_16x16x32_bf16 v[28:31], a[0:3], a[120:123], v[28:31]
  ds_read_b64_tr_b16 a[20:21], v103 offset:26624
  s_add_u32 s74, s74, s75
  v_mfma_f32_16x16x32_bf16 v[28:31], a[4:7], a[128:131], v[28:31]
  s_mul_i32 s74, s74, 3641
  s_lshr_b32 s75, s74, 16
  v_mfma_f32_16x16x32_bf16 v[32:35], a[0:3], a[124:127], v[32:35]
  s_waitcnt lgkmcnt(3)
  ds_read_b64_tr_b16 a[22:23], v103 offset:27136
  v_mfma_f32_16x16x32_bf16 v[32:35], a[4:7], a[132:135], v[32:35]
  s_add_u32 s62, s62, 589824
  s_add_u32 m0, s64, 32768
  v_mfma_f32_16x16x32_bf16 v[36:39], a[8:11], v[208:211], v[36:39]
  ds_read_b64_tr_b16 a[0:1], v102 offset:32768
  v_writelane_b32 v110, s75, 11
  v_mfma_f32_16x16x32_bf16 v[36:39], a[12:15], v[216:219], v[36:39]
  buffer_load_dwordx4 v106, s[12:15], s62 offen lds
  v_mfma_f32_16x16x32_bf16 v[40:43], a[8:11], v[212:215], v[40:43]
  ds_read_b64_tr_b16 a[2:3], v102 offset:33280
  s_add_u32 s74, s74, 3641
  v_mfma_f32_16x16x32_bf16 v[40:43], a[12:15], v[220:223], v[40:43]
  s_lshr_b32 s75, s74, 16
  v_writelane_b32 v110, s75, 12
  v_mfma_f32_16x16x32_bf16 v[44:47], a[8:11], a[120:123], v[44:47]
  ds_read_b64_tr_b16 a[4:5], v102 offset:40960
  s_add_u32 s74, s74, 3641
  v_mfma_f32_16x16x32_bf16 v[44:47], a[12:15], a[128:131], v[44:47]
  s_lshr_b32 s75, s74, 16
  v_writelane_b32 v110, s75, 13
  v_mfma_f32_16x16x32_bf16 v[48:51], a[8:11], a[124:127], v[48:51]
  s_waitcnt lgkmcnt(3)
  ds_read_b64_tr_b16 a[6:7], v102 offset:41472
  v_mfma_f32_16x16x32_bf16 v[48:51], a[12:15], a[132:135], v[48:51]
  s_add_u32 s74, s74, 3641
  s_lshr_b32 s75, s74, 16
  v_mfma_f32_16x16x32_bf16 v[52:55], a[16:19], v[208:211], v[52:55]
  ds_read_b64_tr_b16 a[8:9], v102 offset:34816
  v_writelane_b32 v110, s75, 14
  v_mfma_f32_16x16x32_bf16 v[52:55], a[20:23], v[216:219], v[52:55]
  buffer_load_dwordx4 v107, s[12:15], s62 offen offset:1024 lds
  v_mfma_f32_16x16x32_bf16 v[56:59], a[16:19], v[212:215], v[56:59]
  ds_read_b64_tr_b16 a[10:11], v102 offset:35328
  s_mul_i32 s74, s2, 1214
  v_mfma_f32_16x16x32_bf16 v[56:59], a[20:23], v[220:223], v[56:59]
  s_lshr_b32 s74, s74, 16
  s_lshl_b32 s74, s74, 4
  v_mfma_f32_16x16x32_bf16 v[60:63], a[16:19], a[120:123], v[60:63]
  ds_read_b64_tr_b16 a[12:13], v102 offset:43008
  s_add_u32 s74, s74, 144
  v_mfma_f32_16x16x32_bf16 v[60:63], a[20:23], a[128:131], v[60:63]
  s_mul_i32 s75, s56, 48
  s_cmp_lt_u32 s2, 216
  s_cselect_b32 s74, s74, 0
  s_cselect_b32 s76, 1, 3
  v_mfma_f32_16x16x32_bf16 v[64:67], a[16:19], a[124:127], v[64:67]
  s_waitcnt lgkmcnt(3)
  ds_read_b64_tr_b16 a[14:15], v102 offset:43520
  v_mfma_f32_16x16x32_bf16 v[64:67], a[20:23], a[132:135], v[64:67]
  v_and_b32 v111, 63, v0
  v_cmp_gt_u32 vcc, 48, v111
  v_mfma_f32_16x16x32_bf16 v[4:7], a[0:3], v[224:227], v[4:7]
  ds_read_b64_tr_b16 a[16:17], v103 offset:32768
  v_mfma_f32_16x16x32_bf16 v[4:7], a[4:7], v[232:235], v[4:7]
  buffer_load_dwordx4 v106, s[16:19], s62 offen offset:2048 lds
  v_mfma_f32_16x16x32_bf16 v[8:11], a[0:3], v[228:231], v[8:11]
  ds_read_b64_tr_b16 a[18:19], v103 offset:33280
  ds_read_b64_tr_b16 a[184:185], v2 offset:0
  v_mfma_f32_16x16x32_bf16 v[8:11], a[4:7], v[236:239], v[8:11]
  ds_read_b64_tr_b16 a[186:187], v2 offset:2048
  v_mov_b32 v112, s74
  v_mfma_f32_16x16x32_bf16 v[12:15], a[0:3], a[136:139], v[12:15]
  ds_read_b64_tr_b16 a[20:21], v103 offset:40960
  ds_read_b64_tr_b16 a[188:189], v121 offset:0
  v_mfma_f32_16x16x32_bf16 v[12:15], a[4:7], a[144:147], v[12:15]
  ds_read_b64_tr_b16 a[190:191], v121 offset:2048
  v_mov_b32 v113, s75
  v_mfma_f32_16x16x32_bf16 v[16:19], a[0:3], a[140:143], v[16:19]
  s_waitcnt lgkmcnt(7)
  ds_read_b64_tr_b16 a[22:23], v103 offset:41472
  v_mfma_f32_16x16x32_bf16 v[16:19], a[4:7], a[148:151], v[16:19]
  ds_read_b64_tr_b16 a[192:193], v122 offset:0
  v_mov_b32 v120, s76
  v_mfma_f32_16x16x32_bf16 v[20:23], a[8:11], v[224:227], v[20:23]
  ds_read_b64_tr_b16 a[0:1], v103 offset:34816
  ds_read_b64_tr_b16 a[194:195], v122 offset:2048
  v_mfma_f32_16x16x32_bf16 v[20:23], a[12:15], v[232:235], v[20:23]
  buffer_load_dwordx4 v107, s[16:19], s62 offen offset:3072 lds
  v_mfma_f32_16x16x32_bf16 v[24:27], a[8:11], v[228:231], v[24:27]
  ds_read_b64_tr_b16 a[2:3], v103 offset:35328
  ds_read_b64_tr_b16 a[196:197], v123 offset:0
  v_mfma_f32_16x16x32_bf16 v[24:27], a[12:15], v[236:239], v[24:27]
  ds_read_b64_tr_b16 a[198:199], v123 offset:2048
  v_cndmask_b32 v112, v112, v113, vcc
  v_mfma_f32_16x16x32_bf16 v[28:31], a[8:11], a[136:139], v[28:31]
  ds_read_b64_tr_b16 a[4:5], v103 offset:43008
  v_cndmask_b32 v120, v120, 3, vcc
  v_mfma_f32_16x16x32_bf16 v[28:31], a[12:15], a[144:147], v[28:31]
  s_waitcnt lgkmcnt(11)
  buffer_store_dwordx4 a[184:187], v108, s[32:35], s66 offen offset:0 sc1
  v_mfma_f32_16x16x32_bf16 v[32:35], a[8:11], a[140:143], v[32:35]
  s_waitcnt lgkmcnt(7)
  ds_read_b64_tr_b16 a[6:7], v103 offset:43520
  s_cmp_le_u32 s88, 1
  s_cselect_b32 s67, 1317888, 0
  s_add_u32 s67, s67, s66
  v_mfma_f32_16x16x32_bf16 v[32:35], a[12:15], a[148:151], v[32:35]
  s_add_u32 s62, s62, 589824
  s_add_u32 m0, s64, 49152
  v_mfma_f32_16x16x32_bf16 v[36:39], a[16:19], v[224:227], v[36:39]
  ds_read_b64_tr_b16 a[8:9], v102 offset:49152
  v_add_u32 v111, v111, v112
  v_mfma_f32_16x16x32_bf16 v[36:39], a[20:23], v[232:235], v[36:39]
  buffer_load_dwordx4 v106, s[12:15], s62 offen lds
  v_mfma_f32_16x16x32_bf16 v[40:43], a[16:19], v[228:231], v[40:43]
  ds_read_b64_tr_b16 a[10:11], v102 offset:49664
  v_lshlrev_b32 v111, 3, v111
  v_mfma_f32_16x16x32_bf16 v[40:43], a[20:23], v[236:239], v[40:43]
  buffer_store_dwordx4 a[188:191], v108, s[32:35], s67 offen offset:1024 sc1
  v_mfma_f32_16x16x32_bf16 v[44:47], a[16:19], a[136:139], v[44:47]
  ds_read_b64_tr_b16 a[12:13], v102 offset:57344
  s_cmp_le_u32 s88, 2
  s_cselect_b32 s67, 1317888, 0
  s_add_u32 s67, s67, s66
  v_mfma_f32_16x16x32_bf16 v[44:47], a[20:23], a[144:147], v[44:47]
  v_add_u32 v111, 41472000, v111
  v_add_u32 v120, s49, v120
  v_mfma_f32_16x16x32_bf16 v[48:51], a[16:19], a[140:143], v[48:51]
  s_waitcnt lgkmcnt(3)
  ds_read_b64_tr_b16 a[14:15], v102 offset:57856
  v_mfma_f32_16x16x32_bf16 v[48:51], a[20:23], a[148:151], v[48:51]
  buffer_store_dwordx4 a[192:195], v108, s[32:35], s67 offen offset:2048 sc1
  v_mfma_f32_16x16x32_bf16 v[52:55], a[0:3], v[224:227], v[52:55]
  ds_read_b64_tr_b16 a[16:17], v102 offset:51200
  s_cmp_le_u32 s88, 3
  s_cselect_b32 s67, 1317888, 0
  s_add_u32 s67, s67, s66
  v_mfma_f32_16x16x32_bf16 v[52:55], a[4:7], v[232:235], v[52:55]
  buffer_load_dwordx4 v107, s[12:15], s62 offen offset:1024 lds
  v_mfma_f32_16x16x32_bf16 v[56:59], a[0:3], v[228:231], v[56:59]
  ds_read_b64_tr_b16 a[18:19], v102 offset:51712
  v_mfma_f32_16x16x32_bf16 v[56:59], a[4:7], v[236:239], v[56:59]
  buffer_store_dwordx4 a[196:199], v108, s[32:35], s67 offen offset:3072 sc1
  v_mfma_f32_16x16x32_bf16 v[60:63], a[0:3], a[136:139], v[60:63]
  ds_read_b64_tr_b16 a[20:21], v102 offset:59392
  v_mfma_f32_16x16x32_bf16 v[60:63], a[4:7], a[144:147], v[60:63]
  v_mfma_f32_16x16x32_bf16 v[64:67], a[0:3], a[140:143], v[64:67]
  s_waitcnt lgkmcnt(3)
  ds_read_b64_tr_b16 a[22:23], v102 offset:59904
  v_mfma_f32_16x16x32_bf16 v[64:67], a[4:7], a[148:151], v[64:67]
  v_mfma_f32_16x16x32_bf16 v[4:7], a[8:11], v[240:243], v[4:7]
  ds_read_b64_tr_b16 a[0:1], v103 offset:49152
  v_mfma_f32_16x16x32_bf16 v[4:7], a[12:15], v[248:251], v[4:7]
  buffer_load_dwordx4 v106, s[16:19], s62 offen offset:2048 lds
  v_mfma_f32_16x16x32_bf16 v[8:11], a[8:11], v[244:247], v[8:11]
  ds_read_b64_tr_b16 a[2:3], v103 offset:49664
  v_mfma_f32_16x16x32_bf16 v[8:11], a[12:15], v[252:255], v[8:11]
  v_mfma_f32_16x16x32_bf16 v[12:15], a[8:11], a[152:155], v[12:15]
  ds_read_b64_tr_b16 a[4:5], v103 offset:57344
  v_mfma_f32_16x16x32_bf16 v[12:15], a[12:15], a[160:163], v[12:15]
  v_mfma_f32_16x16x32_bf16 v[16:19], a[8:11], a[156:159], v[16:19]
  s_waitcnt lgkmcnt(3)
  ds_read_b64_tr_b16 a[6:7], v103 offset:57856
  v_mfma_f32_16x16x32_bf16 v[16:19], a[12:15], a[164:167], v[16:19]
  v_mfma_f32_16x16x32_bf16 v[20:23], a[16:19], v[240:243], v[20:23]
  ds_read_b64_tr_b16 a[8:9], v103 offset:51200
  v_mfma_f32_16x16x32_bf16 v[20:23], a[20:23], v[248:251], v[20:23]
  buffer_load_dwordx4 v107, s[16:19], s62 offen offset:3072 lds
  v_mfma_f32_16x16x32_bf16 v[24:27], a[16:19], v[244:247], v[24:27]
  ds_read_b64_tr_b16 a[10:11], v103 offset:51712
  s_add_u32 s62, s62, 589824
  v_mfma_f32_16x16x32_bf16 v[24:27], a[20:23], v[252:255], v[24:27]
  v_mfma_f32_16x16x32_bf16 v[28:31], a[16:19], a[152:155], v[28:31]
  ds_read_b64_tr_b16 a[12:13], v103 offset:59392
  v_mfma_f32_16x16x32_bf16 v[28:31], a[20:23], a[160:163], v[28:31]
  s_waitcnt vmcnt(24)
  v_mfma_f32_16x16x32_bf16 v[32:35], a[16:19], a[156:159], v[32:35]
  s_waitcnt lgkmcnt(3)
  ds_read_b64_tr_b16 a[14:15], v103 offset:59904
  v_mfma_f32_16x16x32_bf16 v[32:35], a[20:23], a[164:167], v[32:35]
  s_waitcnt vmcnt(12)
  v_mfma_f32_16x16x32_bf16 v[36:39], a[0:3], v[240:243], v[36:39]
  s_barrier
  v_mfma_f32_16x16x32_bf16 v[36:39], a[4:7], v[248:251], v[36:39]
  ds_read_b64_tr_b16 a[16:17], v104 offset:0
  s_add_u32 m0, s64, 65536
  v_mfma_f32_16x16x32_bf16 v[40:43], a[0:3], v[244:247], v[40:43]
  buffer_load_dwordx4 v106, s[12:15], s62 offen lds
  v_mfma_f32_16x16x32_bf16 v[40:43], a[4:7], v[252:255], v[40:43]
  ds_read_b64_tr_b16 a[18:19], v104 offset:512
  v_mfma_f32_16x16x32_bf16 v[44:47], a[0:3], a[152:155], v[44:47]
  buffer_load_dwordx4 v107, s[12:15], s62 offen offset:1024 lds
  v_mfma_f32_16x16x32_bf16 v[44:47], a[4:7], a[160:163], v[44:47]
  ds_read_b64_tr_b16 a[20:21], v104 offset:8192
  v_mfma_f32_16x16x32_bf16 v[48:51], a[0:3], a[156:159], v[48:51]
  v_mfma_f32_16x16x32_bf16 v[48:51], a[4:7], a[164:167], v[48:51]
  ds_read_b64_tr_b16 a[22:23], v104 offset:8704
  s_waitcnt lgkmcnt(4)
  v_mfma_f32_16x16x32_bf16 v[52:55], a[8:11], v[240:243], v[52:55]
  ds_read_b64_tr_b16 a[0:1], v104 offset:2048
  v_mfma_f32_16x16x32_bf16 v[52:55], a[12:15], v[248:251], v[52:55]
  buffer_load_dwordx4 v106, s[16:19], s62 offen offset:2048 lds
  v_mfma_f32_16x16x32_bf16 v[56:59], a[8:11], v[244:247], v[56:59]
  ds_read_b64_tr_b16 a[2:3], v104 offset:2560
  v_mfma_f32_16x16x32_bf16 v[56:59], a[12:15], v[252:255], v[56:59]
  buffer_load_dwordx4 v107, s[16:19], s62 offen offset:3072 lds
  v_mfma_f32_16x16x32_bf16 v[60:63], a[8:11], a[152:155], v[60:63]
  ds_read_b64_tr_b16 a[4:5], v104 offset:10240
  v_mfma_f32_16x16x32_bf16 v[60:63], a[12:15], a[160:163], v[60:63]
  v_mfma_f32_16x16x32_bf16 v[64:67], a[8:11], a[156:159], v[64:67]
  s_waitcnt lgkmcnt(3)
  ds_read_b64_tr_b16 a[6:7], v104 offset:10752
  v_mfma_f32_16x16x32_bf16 v[64:67], a[12:15], a[164:167], v[64:67]
  s_add_u32 s62, s62, 589824
  s_cmp_eq_u32 s63, 2
  s_cselect_b32 s67, s86, 0x20000000
  v_mfma_f32_16x16x32_bf16 v[4:7], a[16:19], a[24:27], v[4:7]
  ds_read_b64_tr_b16 a[8:9], v105 offset:0
  v_add_u32 v125, 1, v125
  v_mfma_f32_16x16x32_bf16 v[4:7], a[20:23], a[32:35], v[4:7]
  buffer_store_dwordx2 v[124:125], v126, s[20:23], s67 offen sc1
  v_mfma_f32_16x16x32_bf16 v[8:11], a[16:19], a[28:31], v[8:11]
  ds_read_b64_tr_b16 a[10:11], v105 offset:512
  s_add_u32 m0, s64, 81920
  v_mfma_f32_16x16x32_bf16 v[8:11], a[20:23], a[36:39], v[8:11]
  buffer_load_dwordx4 v106, s[12:15], s62 offen lds
  v_mfma_f32_16x16x32_bf16 v[12:15], a[16:19], a[168:171], v[12:15]
  ds_read_b64_tr_b16 a[12:13], v105 offset:8192
  v_mfma_f32_16x16x32_bf16 v[12:15], a[20:23], a[176:179], v[12:15]
  v_mfma_f32_16x16x32_bf16 v[16:19], a[16:19], a[172:175], v[16:19]
  s_waitcnt lgkmcnt(3)
  ds_read_b64_tr_b16 a[14:15], v105 offset:8704
  v_mfma_f32_16x16x32_bf16 v[16:19], a[20:23], a[180:183], v[16:19]
  buffer_load_dwordx4 v107, s[12:15], s62 offen offset:1024 lds
  v_mfma_f32_16x16x32_bf16 v[20:23], a[0:3], a[24:27], v[20:23]
  ds_read_b64_tr_b16 a[16:17], v105 offset:2048
  v_mfma_f32_16x16x32_bf16 v[20:23], a[4:7], a[32:35], v[20:23]
  v_mfma_f32_16x16x32_bf16 v[24:27], a[0:3], a[28:31], v[24:27]
  ds_read_b64_tr_b16 a[18:19], v105 offset:2560
  v_mfma_f32_16x16x32_bf16 v[24:27], a[4:7], a[36:39], v[24:27]
  buffer_load_dwordx4 v106, s[16:19], s62 offen offset:2048 lds
  v_mfma_f32_16x16x32_bf16 v[28:31], a[0:3], a[168:171], v[28:31]
  ds_read_b64_tr_b16 a[20:21], v105 offset:10240
  v_mfma_f32_16x16x32_bf16 v[28:31], a[4:7], a[176:179], v[28:31]
  s_nop 0
  v_mul_f32 v68, v4, v20
  v_mul_f32 v69, v5, v21
  v_mul_f32 v70, v6, v22
  v_mfma_f32_16x16x32_bf16 v[32:35], a[0:3], a[172:175], v[32:35]
  s_waitcnt lgkmcnt(3)
  ds_read_b64_tr_b16 a[22:23], v105 offset:10752
  v_mul_f32 v71, v7, v23
  v_mfma_f32_16x16x32_bf16 v[32:35], a[4:7], a[180:183], v[32:35]
  buffer_load_dwordx4 v107, s[16:19], s62 offen offset:3072 lds
  v_mfma_f32_16x16x32_bf16 v[36:39], a[8:11], a[24:27], v[36:39]
  ds_read_b64_tr_b16 a[0:1], v100 offset:0
  s_add_u32 s62, s62, 589824
  v_mfma_f32_16x16x32_bf16 v[36:39], a[12:15], a[32:35], v[36:39]
  v_mul_f32 v72, v8, v24
  v_mul_f32 v73, v9, v25
  v_mfma_f32_16x16x32_bf16 v[40:43], a[8:11], a[28:31], v[40:43]
  ds_read_b64_tr_b16 a[2:3], v100 offset:512
  v_mul_f32 v74, v10, v26
  v_mfma_f32_16x16x32_bf16 v[40:43], a[12:15], a[36:39], v[40:43]
  v_mul_f32 v75, v11, v27
  v_mul_f32 v76, v12, v28
  v_mfma_f32_16x16x32_bf16 v[44:47], a[8:11], a[168:171], v[44:47]
  ds_read_b64_tr_b16 a[4:5], v100 offset:8192
  v_mul_f32 v77, v13, v29
  v_mfma_f32_16x16x32_bf16 v[44:47], a[12:15], a[176:179], v[44:47]
  v_mul_f32 v78, v14, v30
  v_mul_f32 v79, v15, v31
  v_mfma_f32_16x16x32_bf16 v[48:51], a[8:11], a[172:175], v[48:51]
  s_waitcnt lgkmcnt(3)
  ds_read_b64_tr_b16 a[6:7], v100 offset:8704
  v_mfma_f32_16x16x32_bf16 v[48:51], a[12:15], a[180:183], v[48:51]
  v_mul_f32 v80, v16, v32
  v_mul_f32 v81, v17, v33
  v_mfma_f32_16x16x32_bf16 v[52:55], a[16:19], a[24:27], v[52:55]
  ds_read_b64_tr_b16 a[8:9], v100 offset:2048
  v_mul_f32 v82, v18, v34
  v_mfma_f32_16x16x32_bf16 v[52:55], a[20:23], a[32:35], v[52:55]
  v_mul_f32 v83, v19, v35
  s_add_u32 m0, s64, 98304
  v_mfma_f32_16x16x32_bf16 v[56:59], a[16:19], a[28:31], v[56:59]
  ds_read_b64_tr_b16 a[10:11], v100 offset:2560
  v_mfma_f32_16x16x32_bf16 v[56:59], a[20:23], a[36:39], v[56:59]
  buffer_load_dwordx4 v106, s[12:15], s62 offen lds
  v_mfma_f32_16x16x32_bf16 v[60:63], a[16:19], a[168:171], v[60:63]
  ds_read_b64_tr_b16 a[12:13], v100 offset:10240
  v_mfma_f32_16x16x32_bf16 v[60:63], a[20:23], a[176:179], v[60:63]
  buffer_load_dwordx4 v107, s[12:15], s62 offen offset:1024 lds
  v_mfma_f32_16x16x32_bf16 v[64:67], a[16:19], a[172:175], v[64:67]
  ds_read_b64_tr_b16 a[14:15], v100 offset:10752
  v_mfma_f32_16x16x32_bf16 v[64:67], a[20:23], a[180:183], v[64:67]
  buffer_load_dwordx4 v106, s[16:19], s62 offen offset:2048 lds
  buffer_load_dwordx4 v107, s[16:19], s62 offen offset:3072 lds
  s_add_u32 s62, s62, 589824
  s_sub_u32 s63, s63, 1
  s_cmp_lg_u32 s63, 0
  s_cbranch_scc1 recurrent_scan__linear_attn_block__glu_gated_bilinear__prompt_kernel_loop
  s_waitcnt lgkmcnt(4)
  v_mfma_f32_16x16x32_bf16 v[4:7], a[0:3], v[128:131], 0
  ds_read_b64_tr_b16 a[16:17], v101 offset:0
  v_mul_f32 v84, v36, v52
  v_mfma_f32_16x16x32_bf16 v[4:7], a[4:7], v[136:139], v[4:7]
  v_mul_f32 v85, v37, v53
  v_mul_f32 v86, v38, v54
  v_mfma_f32_16x16x32_bf16 v[8:11], a[0:3], v[132:135], 0
  ds_read_b64_tr_b16 a[18:19], v101 offset:512
  v_mul_f32 v87, v39, v55
  v_mfma_f32_16x16x32_bf16 v[8:11], a[4:7], v[140:143], v[8:11]
  v_mul_f32 v88, v40, v56
  v_mul_f32 v89, v41, v57
  v_mfma_f32_16x16x32_bf16 v[12:15], a[0:3], a[40:43], 0
  ds_read_b64_tr_b16 a[20:21], v101 offset:8192
  v_mul_f32 v90, v42, v58
  v_mfma_f32_16x16x32_bf16 v[12:15], a[4:7], a[48:51], v[12:15]
  v_mul_f32 v91, v43, v59
  v_mul_f32 v92, v44, v60
  v_mfma_f32_16x16x32_bf16 v[16:19], a[0:3], a[44:47], 0
  s_waitcnt lgkmcnt(3)
  ds_read_b64_tr_b16 a[22:23], v101 offset:8704
  v_mfma_f32_16x16x32_bf16 v[16:19], a[4:7], a[52:55], v[16:19]
  v_mul_f32 v93, v45, v61
  v_mul_f32 v94, v46, v62
  v_mfma_f32_16x16x32_bf16 v[20:23], a[8:11], v[128:131], 0
  ds_read_b64_tr_b16 a[0:1], v101 offset:2048
  v_mul_f32 v95, v47, v63
  v_mfma_f32_16x16x32_bf16 v[20:23], a[12:15], v[136:139], v[20:23]
  v_mul_f32 v96, v48, v64
  v_mul_f32 v97, v49, v65
  v_mfma_f32_16x16x32_bf16 v[24:27], a[8:11], v[132:135], 0
  ds_read_b64_tr_b16 a[2:3], v101 offset:2560
  v_mul_f32 v98, v50, v66
  v_mfma_f32_16x16x32_bf16 v[24:27], a[12:15], v[140:143], v[24:27]
  v_mul_f32 v99, v51, v67
  v_mfma_f32_16x16x32_bf16 v[28:31], a[8:11], a[40:43], 0
  ds_read_b64_tr_b16 a[4:5], v101 offset:10240
  v_mfma_f32_16x16x32_bf16 v[28:31], a[12:15], a[48:51], v[28:31]
  v_mfma_f32_16x16x32_bf16 v[32:35], a[8:11], a[44:47], 0
  s_waitcnt lgkmcnt(3)
  ds_read_b64_tr_b16 a[6:7], v101 offset:10752
  v_mfma_f32_16x16x32_bf16 v[32:35], a[12:15], a[52:55], v[32:35]
  v_mfma_f32_16x16x32_bf16 v[36:39], a[16:19], v[128:131], 0
  s_barrier
  v_mul_f32 v68, v68, v114
  v_mfma_f32_16x16x32_bf16 v[36:39], a[20:23], v[136:139], v[36:39]
  ds_read_b64_tr_b16 a[8:9], v100 offset:16384
  v_mul_f32 v69, v69, v114
  v_mfma_f32_16x16x32_bf16 v[40:43], a[16:19], v[132:135], 0
  buffer_load_dwordx2 v[112:113], v111, s[20:23], 0 offen sc1
  v_mfma_f32_16x16x32_bf16 v[40:43], a[20:23], v[140:143], v[40:43]
  ds_read_b64_tr_b16 a[10:11], v100 offset:16896
  v_mul_f32 v70, v70, v114
  v_mfma_f32_16x16x32_bf16 v[44:47], a[16:19], a[40:43], 0
  s_add_u32 m0, s64, 114688
  v_mul_f32 v71, v71, v114
  v_mfma_f32_16x16x32_bf16 v[44:47], a[20:23], a[48:51], v[44:47]
  ds_read_b64_tr_b16 a[12:13], v100 offset:24576
  v_mul_f32 v84, v84, v114
  v_mfma_f32_16x16x32_bf16 v[48:51], a[16:19], a[44:47], 0
  buffer_load_dwordx4 v106, s[12:15], s62 offen lds
  v_mfma_f32_16x16x32_bf16 v[48:51], a[20:23], a[52:55], v[48:51]
  ds_read_b64_tr_b16 a[14:15], v100 offset:25088
  s_waitcnt lgkmcnt(4)
  v_mfma_f32_16x16x32_bf16 v[52:55], a[0:3], v[128:131], 0
  ds_read_b64_tr_b16 a[16:17], v100 offset:18432
  v_mul_f32 v85, v85, v114
  v_mfma_f32_16x16x32_bf16 v[52:55], a[4:7], v[136:139], v[52:55]
  v_mul_f32 v86, v86, v114
  v_mul_f32 v87, v87, v114
  v_mfma_f32_16x16x32_bf16 v[56:59], a[0:3], v[132:135], 0
  ds_read_b64_tr_b16 a[18:19], v100 offset:18944
  v_cvt_pk_bf16_f32 v68, v68, v69
  v_mfma_f32_16x16x32_bf16 v[56:59], a[4:7], v[140:143], v[56:59]
  buffer_load_dwordx4 v107, s[12:15], s62 offen offset:1024 lds
  v_mfma_f32_16x16x32_bf16 v[60:63], a[0:3], a[40:43], 0
  ds_read_b64_tr_b16 a[20:21], v100 offset:26624
  v_cvt_pk_bf16_f32 v69, v70, v71
  v_mfma_f32_16x16x32_bf16 v[60:63], a[4:7], a[48:51], v[60:63]
  v_cvt_pk_bf16_f32 v70, v84, v85
  v_cvt_pk_bf16_f32 v71, v86, v87
  v_mfma_f32_16x16x32_bf16 v[64:67], a[0:3], a[44:47], 0
  s_waitcnt lgkmcnt(3)
  ds_read_b64_tr_b16 a[22:23], v100 offset:27136
  v_mfma_f32_16x16x32_bf16 v[64:67], a[4:7], a[52:55], v[64:67]
  buffer_store_dwordx4 v[68:71], v108, s[24:27], s70 offen sc1
  v_mfma_f32_16x16x32_bf16 v[4:7], a[8:11], v[144:147], v[4:7]
  ds_read_b64_tr_b16 a[0:1], v101 offset:16384
  s_add_u32 s70, s70, s85
  v_mfma_f32_16x16x32_bf16 v[4:7], a[12:15], v[152:155], v[4:7]
  v_mul_f32 v72, v72, v115
  v_mul_f32 v73, v73, v115
  v_mfma_f32_16x16x32_bf16 v[8:11], a[8:11], v[148:151], v[8:11]
  ds_read_b64_tr_b16 a[2:3], v101 offset:16896
  s_lshl_b32 s86, s61, 3
  v_mfma_f32_16x16x32_bf16 v[8:11], a[12:15], v[156:159], v[8:11]
  s_add_u32 s86, s86, s87
  v_mul_f32 v74, v74, v115
  v_mfma_f32_16x16x32_bf16 v[12:15], a[8:11], a[56:59], v[12:15]
  ds_read_b64_tr_b16 a[4:5], v101 offset:24576
  v_mul_f32 v75, v75, v115
  v_mfma_f32_16x16x32_bf16 v[12:15], a[12:15], a[64:67], v[12:15]
  buffer_load_dwordx4 v106, s[16:19], s62 offen offset:2048 lds
  v_mfma_f32_16x16x32_bf16 v[16:19], a[8:11], a[60:63], v[16:19]
  s_waitcnt lgkmcnt(3)
  ds_read_b64_tr_b16 a[6:7], v101 offset:25088
  v_mfma_f32_16x16x32_bf16 v[16:19], a[12:15], a[68:71], v[16:19]
  v_mul_f32 v88, v88, v115
  v_mul_f32 v89, v89, v115
  v_mfma_f32_16x16x32_bf16 v[20:23], a[16:19], v[144:147], v[20:23]
  ds_read_b64_tr_b16 a[8:9], v101 offset:18432
  v_mul_f32 v90, v90, v115
  v_mfma_f32_16x16x32_bf16 v[20:23], a[20:23], v[152:155], v[20:23]
  buffer_load_dwordx4 v107, s[16:19], s62 offen offset:3072 lds
  v_mfma_f32_16x16x32_bf16 v[24:27], a[16:19], v[148:151], v[24:27]
  ds_read_b64_tr_b16 a[10:11], v101 offset:18944
  v_mul_f32 v91, v91, v115
  v_mfma_f32_16x16x32_bf16 v[24:27], a[20:23], v[156:159], v[24:27]
  v_cvt_pk_bf16_f32 v72, v72, v73
  v_cvt_pk_bf16_f32 v73, v74, v75
  v_mfma_f32_16x16x32_bf16 v[28:31], a[16:19], a[56:59], v[28:31]
  ds_read_b64_tr_b16 a[12:13], v101 offset:26624
  v_cvt_pk_bf16_f32 v74, v88, v89
  v_mfma_f32_16x16x32_bf16 v[28:31], a[20:23], a[64:67], v[28:31]
  s_add_u32 s62, s62, 589824
  v_cvt_pk_bf16_f32 v75, v90, v91
  v_mfma_f32_16x16x32_bf16 v[32:35], a[16:19], a[60:63], v[32:35]
  s_waitcnt lgkmcnt(3)
  ds_read_b64_tr_b16 a[14:15], v101 offset:27136
  v_mfma_f32_16x16x32_bf16 v[32:35], a[20:23], a[68:71], v[32:35]
  s_waitcnt vmcnt(27)
  v_mul_f32 v76, v76, v116
  v_mfma_f32_16x16x32_bf16 v[36:39], a[0:3], v[144:147], v[36:39]
  s_barrier
  v_mul_f32 v77, v77, v116
  v_mfma_f32_16x16x32_bf16 v[36:39], a[4:7], v[152:155], v[36:39]
  ds_read_b64_tr_b16 a[16:17], v100 offset:32768
  v_mul_f32 v78, v78, v116
  v_mfma_f32_16x16x32_bf16 v[40:43], a[0:3], v[148:151], v[40:43]
  buffer_store_dwordx4 v[72:75], v108, s[24:27], s71 offen sc1
  v_mfma_f32_16x16x32_bf16 v[40:43], a[4:7], v[156:159], v[40:43]
  ds_read_b64_tr_b16 a[18:19], v100 offset:33280
  s_add_u32 m0, s64, 131072
  v_mfma_f32_16x16x32_bf16 v[44:47], a[0:3], a[56:59], v[44:47]
  buffer_load_dwordx4 v106, s[12:15], s62 offen lds
  v_mfma_f32_16x16x32_bf16 v[44:47], a[4:7], a[64:67], v[44:47]
  ds_read_b64_tr_b16 a[20:21], v100 offset:40960
  s_add_u32 s71, s71, s85
  v_mfma_f32_16x16x32_bf16 v[48:51], a[0:3], a[60:63], v[48:51]
  v_mul_f32 v79, v79, v116
  v_mul_f32 v92, v92, v116
  v_mfma_f32_16x16x32_bf16 v[48:51], a[4:7], a[68:71], v[48:51]
  ds_read_b64_tr_b16 a[22:23], v100 offset:41472
  s_waitcnt lgkmcnt(4)
  v_mfma_f32_16x16x32_bf16 v[52:55], a[8:11], v[144:147], v[52:55]
  ds_read_b64_tr_b16 a[0:1], v100 offset:34816
  v_mul_f32 v93, v93, v116
  v_mfma_f32_16x16x32_bf16 v[52:55], a[12:15], v[152:155], v[52:55]
  buffer_load_dwordx4 v107, s[12:15], s62 offen offset:1024 lds
  v_mfma_f32_16x16x32_bf16 v[56:59], a[8:11], v[148:151], v[56:59]
  ds_read_b64_tr_b16 a[2:3], v100 offset:35328
  v_mul_f32 v94, v94, v116
  v_mfma_f32_16x16x32_bf16 v[56:59], a[12:15], v[156:159], v[56:59]
  v_mul_f32 v95, v95, v116
  v_cvt_pk_bf16_f32 v76, v76, v77
  v_mfma_f32_16x16x32_bf16 v[60:63], a[8:11], a[56:59], v[60:63]
  ds_read_b64_tr_b16 a[4:5], v100 offset:43008
  v_cvt_pk_bf16_f32 v77, v78, v79
  v_cvt_pk_bf16_f32 v78, v92, v93
  v_cvt_pk_bf16_f32 v79, v94, v95
  v_mfma_f32_16x16x32_bf16 v[60:63], a[12:15], a[64:67], v[60:63]
  buffer_store_dwordx4 v[76:79], v108, s[24:27], s72 offen sc1
  v_mfma_f32_16x16x32_bf16 v[64:67], a[8:11], a[60:63], v[64:67]
  s_waitcnt lgkmcnt(3)
  ds_read_b64_tr_b16 a[6:7], v100 offset:43520
  v_mfma_f32_16x16x32_bf16 v[64:67], a[12:15], a[68:71], v[64:67]
  s_add_u32 s72, s72, s85
  v_mul_f32 v80, v80, v117
  v_mfma_f32_16x16x32_bf16 v[4:7], a[16:19], v[160:163], v[4:7]
  ds_read_b64_tr_b16 a[8:9], v101 offset:32768
  v_mul_f32 v81, v81, v117
  v_mfma_f32_16x16x32_bf16 v[4:7], a[20:23], v[168:171], v[4:7]
  buffer_load_dwordx4 v106, s[16:19], s62 offen offset:2048 lds
  v_mfma_f32_16x16x32_bf16 v[8:11], a[16:19], v[164:167], v[8:11]
  ds_read_b64_tr_b16 a[10:11], v101 offset:33280
  v_mul_f32 v82, v82, v117
  v_mfma_f32_16x16x32_bf16 v[8:11], a[20:23], v[172:175], v[8:11]
  v_mul_f32 v83, v83, v117
  v_mul_f32 v96, v96, v117
  v_mfma_f32_16x16x32_bf16 v[12:15], a[16:19], a[72:75], v[12:15]
  ds_read_b64_tr_b16 a[12:13], v101 offset:40960
  v_mul_f32 v97, v97, v117
  v_mfma_f32_16x16x32_bf16 v[12:15], a[20:23], a[80:83], v[12:15]
  v_mul_f32 v98, v98, v117
  v_mul_f32 v99, v99, v117
  v_mfma_f32_16x16x32_bf16 v[16:19], a[16:19], a[76:79], v[16:19]
  s_waitcnt lgkmcnt(3)
  ds_read_b64_tr_b16 a[14:15], v101 offset:41472
  v_mfma_f32_16x16x32_bf16 v[16:19], a[20:23], a[84:87], v[16:19]
  buffer_load_dwordx4 v107, s[16:19], s62 offen offset:3072 lds
  v_mfma_f32_16x16x32_bf16 v[20:23], a[0:3], v[160:163], v[20:23]
  ds_read_b64_tr_b16 a[16:17], v101 offset:34816
  v_cvt_pk_bf16_f32 v80, v80, v81
  v_mfma_f32_16x16x32_bf16 v[20:23], a[4:7], v[168:171], v[20:23]
  v_cvt_pk_bf16_f32 v81, v82, v83
  v_cvt_pk_bf16_f32 v82, v96, v97
  v_mfma_f32_16x16x32_bf16 v[24:27], a[0:3], v[164:167], v[24:27]
  ds_read_b64_tr_b16 a[18:19], v101 offset:35328
  v_cvt_pk_bf16_f32 v83, v98, v99
  v_mfma_f32_16x16x32_bf16 v[24:27], a[4:7], v[172:175], v[24:27]
  buffer_store_dwordx4 v[80:83], v108, s[24:27], s73 offen sc1
  v_readlane_b32 s37, v110, 0
  v_readlane_b32 s96, v110, 1
  v_readlane_b32 s36, v110, 2
  v_readlane_b32 s38, v110, 3
  v_readlane_b32 s39, v110, 4
  v_readlane_b32 s42, v110, 5
  v_readlane_b32 s43, v110, 6
  v_readlane_b32 s30, v110, 7
  s_mov_b32 s28, s20
  s_mov_b32 s29, s21
  v_readlane_b32 s45, v110, 10
  v_mfma_f32_16x16x32_bf16 v[28:31], a[0:3], a[72:75], v[28:31]
  ds_read_b64_tr_b16 a[20:21], v101 offset:43008
  s_add_u32 s73, s73, s85
  s_waitcnt vmcnt(12)
  v_xor_b32 v112, s48, v112
  v_sub_u32 v113, v113, v120
  v_lshrrev_b32 v113, 4, v113
  v_or_b32 v112, v112, v113
  v_cmp_ne_u32 vcc, 0, v112
  s_nop 0
  s_cmp_eq_u64 vcc, 0
  s_cbranch_scc0 recurrent_scan__linear_attn_block__glu_gated_bilinear__prompt_kernel_ca_w
recurrent_scan__linear_attn_block__glu_gated_bilinear__prompt_kernel_ca_d:
  v_mfma_f32_16x16x32_bf16 v[28:31], a[4:7], a[80:83], v[28:31]
  v_mfma_f32_16x16x32_bf16 v[32:35], a[0:3], a[76:79], v[32:35]
  s_waitcnt lgkmcnt(3)
  ds_read_b64_tr_b16 a[22:23], v101 offset:43520
  v_mfma_f32_16x16x32_bf16 v[32:35], a[4:7], a[84:87], v[32:35]
  v_mfma_f32_16x16x32_bf16 v[36:39], a[8:11], v[160:163], v[36:39]
  s_barrier
  v_mfma_f32_16x16x32_bf16 v[36:39], a[12:15], v[168:171], v[36:39]
  ds_read_b64_tr_b16 a[0:1], v100 offset:49152
  s_add_u32 m0, s64, 0
  v_mfma_f32_16x16x32_bf16 v[40:43], a[8:11], v[164:167], v[40:43]
  buffer_load_dwordx4 v108, s[20:23], s37 offen offset:0 sc1 lds
  v_mfma_f32_16x16x32_bf16 v[40:43], a[12:15], v[172:175], v[40:43]
  ds_read_b64_tr_b16 a[2:3], v100 offset:49664
  v_mfma_f32_16x16x32_bf16 v[44:47], a[8:11], a[72:75], v[44:47]
  v_mfma_f32_16x16x32_bf16 v[44:47], a[12:15], a[80:83], v[44:47]
  ds_read_b64_tr_b16 a[4:5], v100 offset:57344
  v_mfma_f32_16x16x32_bf16 v[48:51], a[8:11], a[76:79], v[48:51]
  buffer_load_dwordx4 v108, s[20:23], s37 offen offset:1024 sc1 lds
  v_mfma_f32_16x16x32_bf16 v[48:51], a[12:15], a[84:87], v[48:51]
  ds_read_b64_tr_b16 a[6:7], v100 offset:57856
  s_waitcnt lgkmcnt(4)
  v_mfma_f32_16x16x32_bf16 v[52:55], a[16:19], v[160:163], v[52:55]
  ds_read_b64_tr_b16 a[8:9], v100 offset:51200
  v_mfma_f32_16x16x32_bf16 v[52:55], a[20:23], v[168:171], v[52:55]
  buffer_load_dwordx4 v108, s[20:23], s37 offen offset:2048 sc1 lds
  v_mfma_f32_16x16x32_bf16 v[56:59], a[16:19], v[164:167], v[56:59]
  ds_read_b64_tr_b16 a[10:11], v100 offset:51712
  v_mfma_f32_16x16x32_bf16 v[56:59], a[20:23], v[172:175], v[56:59]
  v_mfma_f32_16x16x32_bf16 v[60:63], a[16:19], a[72:75], v[60:63]
  ds_read_b64_tr_b16 a[12:13], v100 offset:59392
  v_mfma_f32_16x16x32_bf16 v[60:63], a[20:23], a[80:83], v[60:63]
  buffer_load_dwordx4 v108, s[20:23], s37 offen offset:3072 sc1 lds
  v_mfma_f32_16x16x32_bf16 v[64:67], a[16:19], a[76:79], v[64:67]
  s_waitcnt lgkmcnt(3)
  ds_read_b64_tr_b16 a[14:15], v100 offset:59904
  v_mfma_f32_16x16x32_bf16 v[64:67], a[20:23], a[84:87], v[64:67]
  v_mfma_f32_16x16x32_bf16 v[4:7], a[0:3], v[176:179], v[4:7]
  ds_read_b64_tr_b16 a[16:17], v101 offset:49152
  s_add_u32 s37, s37, 16384
  v_mfma_f32_16x16x32_bf16 v[4:7], a[4:7], v[184:187], v[4:7]
  s_add_u32 m0, s64, 16384
  v_and_b32 v113, 15, v0
  v_mfma_f32_16x16x32_bf16 v[8:11], a[0:3], v[180:183], v[8:11]
  ds_read_b64_tr_b16 a[18:19], v101 offset:49664
  v_bfe_u32 v112, v0, 4, 2
  v_mfma_f32_16x16x32_bf16 v[8:11], a[4:7], v[188:191], v[8:11]
  buffer_load_dwordx4 v108, s[20:23], s37 offen offset:0 sc1 lds
  v_mfma_f32_16x16x32_bf16 v[12:15], a[0:3], a[88:91], v[12:15]
  ds_read_b64_tr_b16 a[20:21], v101 offset:57344
  v_mul_u32_u24 v160, 147456, v112
  v_mfma_f32_16x16x32_bf16 v[12:15], a[4:7], a[96:99], v[12:15]
  buffer_load_dwordx4 v108, s[20:23], s37 offen offset:1024 sc1 lds
  v_mfma_f32_16x16x32_bf16 v[16:19], a[0:3], a[92:95], v[16:19]
  s_waitcnt lgkmcnt(3)
  ds_read_b64_tr_b16 a[22:23], v101 offset:57856
  v_mfma_f32_16x16x32_bf16 v[16:19], a[4:7], a[100:103], v[16:19]
  v_lshl_add_u32 v160, v113, 4, v160
  v_lshlrev_b32 v112, 28, v112
  v_mfma_f32_16x16x32_bf16 v[20:23], a[8:11], v[176:179], v[20:23]
  ds_read_b64_tr_b16 a[0:1], v101 offset:51200
  v_lshl_add_u32 v112, v113, 4, v112
  v_mfma_f32_16x16x32_bf16 v[20:23], a[12:15], v[184:187], v[20:23]
  buffer_load_dwordx4 v108, s[20:23], s37 offen offset:2048 sc1 lds
  v_mfma_f32_16x16x32_bf16 v[24:27], a[8:11], v[180:183], v[24:27]
  ds_read_b64_tr_b16 a[2:3], v101 offset:51712
  v_add_u32 v113, s45, v113
  v_mfma_f32_16x16x32_bf16 v[24:27], a[12:15], v[188:191], v[24:27]
  v_mul_u32_u24 v113, 3641, v113
  v_lshrrev_b32 v113, 16, v113
  v_mfma_f32_16x16x32_bf16 v[28:31], a[8:11], a[88:91], v[28:31]
  ds_read_b64_tr_b16 a[4:5], v101 offset:59392
  v_mfma_f32_16x16x32_bf16 v[28:31], a[12:15], a[96:99], v[28:31]
  buffer_load_dwordx4 v108, s[20:23], s37 offen offset:3072 sc1 lds
  v_mfma_f32_16x16x32_bf16 v[32:35], a[8:11], a[92:95], v[32:35]
  s_waitcnt lgkmcnt(3)
  ds_read_b64_tr_b16 a[6:7], v101 offset:59904
  v_mfma_f32_16x16x32_bf16 v[32:35], a[12:15], a[100:103], v[32:35]
  s_add_u32 s37, s37, 16384
  v_mfma_f32_16x16x32_bf16 v[36:39], a[16:19], v[176:179], v[36:39]
  s_barrier
  v_mfma_f32_16x16x32_bf16 v[36:39], a[20:23], v[184:187], v[36:39]
  ds_read_b64_tr_b16 a[8:9], v102 offset:0
  s_add_u32 m0, s64, 32768
  v_mfma_f32_16x16x32_bf16 v[40:43], a[16:19], v[180:183], v[40:43]
  buffer_load_dwordx4 v108, s[20:23], s37 offen offset:0 sc1 lds
  v_mfma_f32_16x16x32_bf16 v[40:43], a[20:23], v[188:191], v[40:43]
  ds_read_b64_tr_b16 a[10:11], v102 offset:512
  v_readlane_b32 s34, v110, 8
  v_mfma_f32_16x16x32_bf16 v[44:47], a[16:19], a[88:91], v[44:47]
  v_readlane_b32 s97, v110, 9
  v_readlane_b32 s98, v110, 11
  v_mfma_f32_16x16x32_bf16 v[44:47], a[20:23], a[96:99], v[44:47]
  ds_read_b64_tr_b16 a[12:13], v102 offset:8192
  v_readlane_b32 s99, v110, 12
  v_mfma_f32_16x16x32_bf16 v[48:51], a[16:19], a[92:95], v[48:51]
  buffer_load_dwordx4 v108, s[20:23], s37 offen offset:1024 sc1 lds
  v_mfma_f32_16x16x32_bf16 v[48:51], a[20:23], a[100:103], v[48:51]
  ds_read_b64_tr_b16 a[14:15], v102 offset:8704
  s_waitcnt lgkmcnt(4)
  v_mfma_f32_16x16x32_bf16 v[52:55], a[0:3], v[176:179], v[52:55]
  ds_read_b64_tr_b16 a[16:17], v102 offset:2048
  v_readlane_b32 s65, v110, 13
  v_mfma_f32_16x16x32_bf16 v[52:55], a[4:7], v[184:187], v[52:55]
  buffer_load_dwordx4 v108, s[20:23], s37 offen offset:2048 sc1 lds
  v_mfma_f32_16x16x32_bf16 v[56:59], a[0:3], v[180:183], v[56:59]
  ds_read_b64_tr_b16 a[18:19], v102 offset:2560
  v_readlane_b32 s66, v110, 14
  v_mfma_f32_16x16x32_bf16 v[56:59], a[4:7], v[188:191], v[56:59]
  v_add_u32 v120, 0, v108
  v_add_u32 v121, 36864, v108
  v_mfma_f32_16x16x32_bf16 v[60:63], a[0:3], a[88:91], v[60:63]
  ds_read_b64_tr_b16 a[20:21], v102 offset:10240
  v_add_u32 v122, 73728, v108
  v_mfma_f32_16x16x32_bf16 v[60:63], a[4:7], a[96:99], v[60:63]
  buffer_load_dwordx4 v108, s[20:23], s37 offen offset:3072 sc1 lds
  v_mfma_f32_16x16x32_bf16 v[64:67], a[0:3], a[92:95], v[64:67]
  s_waitcnt lgkmcnt(3)
  ds_read_b64_tr_b16 a[22:23], v102 offset:10752
  v_mfma_f32_16x16x32_bf16 v[64:67], a[4:7], a[100:103], v[64:67]
  v_add_u32 v123, 110592, v108
  v_add_u32 v3, 4096, v108
  v_mfma_f32_16x16x32_bf16 v[4:7], a[8:11], v[192:195], v[4:7]
  ds_read_b64_tr_b16 a[0:1], v103 offset:0
  s_add_u32 s37, s37, 16384
  v_mfma_f32_16x16x32_bf16 v[4:7], a[12:15], v[200:203], v[4:7]
  buffer_load_dwordx4 v[128:131], v160, s[28:31], s42 offen sc1
  v_mfma_f32_16x16x32_bf16 v[8:11], a[8:11], v[196:199], v[8:11]
  ds_read_b64_tr_b16 a[2:3], v103 offset:512
  v_add_u32 v111, 8192, v108
  v_mfma_f32_16x16x32_bf16 v[8:11], a[12:15], v[204:207], v[8:11]
  s_mov_b32 s4, s100
  s_mov_b32 s5, s101
  v_mfma_f32_16x16x32_bf16 v[12:15], a[8:11], a[104:107], v[12:15]
  ds_read_b64_tr_b16 a[4:5], v103 offset:8192
  s_add_u32 s42, s42, 589824
  v_mfma_f32_16x16x32_bf16 v[12:15], a[12:15], a[112:115], v[12:15]
  buffer_load_dwordx4 v[132:135], v160, s[28:31], s42 offen sc1
  v_mfma_f32_16x16x32_bf16 v[16:19], a[8:11], a[108:111], v[16:19]
  s_waitcnt lgkmcnt(3)
  ds_read_b64_tr_b16 a[6:7], v103 offset:8704
  v_mfma_f32_16x16x32_bf16 v[16:19], a[12:15], a[116:119], v[16:19]
  s_mov_b32 s6, 2359296
  s_mov_b32 s8, s54
  v_mfma_f32_16x16x32_bf16 v[20:23], a[16:19], v[192:195], v[20:23]
  ds_read_b64_tr_b16 a[8:9], v103 offset:2048
  s_add_u32 s42, s42, 589824
  v_mfma_f32_16x16x32_bf16 v[20:23], a[20:23], v[200:203], v[20:23]
  buffer_load_dwordx4 v[136:139], v160, s[28:31], s42 offen sc1
  v_mfma_f32_16x16x32_bf16 v[24:27], a[16:19], v[196:199], v[24:27]
  ds_read_b64_tr_b16 a[10:11], v103 offset:2560
  s_mov_b32 s9, s55
  v_mfma_f32_16x16x32_bf16 v[24:27], a[20:23], v[204:207], v[24:27]
  s_mov_b32 s10, 2359296
  s_mov_b32 s12, s20
  v_mfma_f32_16x16x32_bf16 v[28:31], a[16:19], a[104:107], v[28:31]
  ds_read_b64_tr_b16 a[12:13], v103 offset:10240
  s_add_u32 s42, s42, 589824
  v_mfma_f32_16x16x32_bf16 v[28:31], a[20:23], a[112:115], v[28:31]
  buffer_load_dwordx4 v[140:143], v160, s[28:31], s42 offen sc1
  v_mfma_f32_16x16x32_bf16 v[32:35], a[16:19], a[108:111], v[32:35]
  s_waitcnt lgkmcnt(3)
  ds_read_b64_tr_b16 a[14:15], v103 offset:10752
  v_mfma_f32_16x16x32_bf16 v[32:35], a[20:23], a[116:119], v[32:35]
  s_add_u32 s42, s42, 589824
  v_mfma_f32_16x16x32_bf16 v[36:39], a[0:3], v[192:195], v[36:39]
  s_barrier
  s_mov_b32 s13, s21
  v_mfma_f32_16x16x32_bf16 v[36:39], a[4:7], v[200:203], v[36:39]
  ds_read_b64_tr_b16 a[16:17], v102 offset:16384
  s_add_u32 m0, s64, 49152
  v_mfma_f32_16x16x32_bf16 v[40:43], a[0:3], v[196:199], v[40:43]
  buffer_load_dwordx4 v108, s[20:23], s37 offen offset:0 sc1 lds
  v_mfma_f32_16x16x32_bf16 v[40:43], a[4:7], v[204:207], v[40:43]
  ds_read_b64_tr_b16 a[18:19], v102 offset:16896
  s_lshl_b32 s68, s59, 2
  v_mfma_f32_16x16x32_bf16 v[44:47], a[0:3], a[104:107], v[44:47]
  s_add_u32 s68, s68, s60
  s_mul_i32 s44, s68, 36864
  v_mfma_f32_16x16x32_bf16 v[44:47], a[4:7], a[112:115], v[44:47]
  ds_read_b64_tr_b16 a[20:21], v102 offset:24576
  s_mul_i32 s69, s61, 288
  v_mfma_f32_16x16x32_bf16 v[48:51], a[0:3], a[108:111], v[48:51]
  buffer_load_dwordx4 v108, s[20:23], s37 offen offset:1024 sc1 lds
  v_mfma_f32_16x16x32_bf16 v[48:51], a[4:7], a[116:119], v[48:51]
  ds_read_b64_tr_b16 a[22:23], v102 offset:25088
  s_waitcnt lgkmcnt(4)
  v_mfma_f32_16x16x32_bf16 v[52:55], a[8:11], v[192:195], v[52:55]
  ds_read_b64_tr_b16 a[0:1], v102 offset:18432
  s_add_u32 s44, s44, s69
  v_mfma_f32_16x16x32_bf16 v[52:55], a[12:15], v[200:203], v[52:55]
  buffer_load_dwordx4 v108, s[20:23], s37 offen offset:2048 sc1 lds
  v_mfma_f32_16x16x32_bf16 v[56:59], a[8:11], v[196:199], v[56:59]
  ds_read_b64_tr_b16 a[2:3], v102 offset:18944
  s_mul_i32 s68, s68, 36
  v_mfma_f32_16x16x32_bf16 v[56:59], a[12:15], v[204:207], v[56:59]
  s_mul_i32 s69, s56, 9
  s_lshr_b32 s69, s69, 1
  v_mfma_f32_16x16x32_bf16 v[60:63], a[8:11], a[104:107], v[60:63]
  ds_read_b64_tr_b16 a[4:5], v102 offset:26624
  s_add_u32 s68, s68, s69
  v_mfma_f32_16x16x32_bf16 v[60:63], a[12:15], a[112:115], v[60:63]
  buffer_load_dwordx4 v108, s[20:23], s37 offen offset:3072 sc1 lds
  v_mfma_f32_16x16x32_bf16 v[64:67], a[8:11], a[108:111], v[64:67]
  s_waitcnt lgkmcnt(3)
  ds_read_b64_tr_b16 a[6:7], v102 offset:27136
  v_mfma_f32_16x16x32_bf16 v[64:67], a[12:15], a[116:119], v[64:67]
  s_lshl_b32 s68, s68, 10
  s_add_u32 s74, s68, 18874368
  v_mfma_f32_16x16x32_bf16 v[4:7], a[16:19], v[208:211], v[4:7]
  ds_read_b64_tr_b16 a[8:9], v103 offset:16384
  s_add_u32 s37, s37, 16384
  v_mfma_f32_16x16x32_bf16 v[4:7], a[20:23], v[216:219], v[4:7]
  buffer_load_dwordx4 v[144:147], v160, s[28:31], s42 offen sc1
  v_mfma_f32_16x16x32_bf16 v[8:11], a[16:19], v[212:215], v[8:11]
  ds_read_b64_tr_b16 a[10:11], v103 offset:16896
  s_add_u32 s75, s74, 18432
  v_mfma_f32_16x16x32_bf16 v[8:11], a[20:23], v[220:223], v[8:11]
  s_mul_i32 s47, s56, 27648
  s_add_u32 s47, s47, 31924224
  v_mfma_f32_16x16x32_bf16 v[12:15], a[16:19], a[120:123], v[12:15]
  ds_read_b64_tr_b16 a[12:13], v103 offset:24576
  s_add_u32 s42, s42, 589824
  v_mfma_f32_16x16x32_bf16 v[12:15], a[20:23], a[128:131], v[12:15]
  buffer_load_dwordx4 v[148:151], v160, s[28:31], s42 offen sc1
  v_mfma_f32_16x16x32_bf16 v[16:19], a[16:19], a[124:127], v[16:19]
  s_waitcnt lgkmcnt(3)
  ds_read_b64_tr_b16 a[14:15], v103 offset:25088
  v_mfma_f32_16x16x32_bf16 v[16:19], a[20:23], a[132:135], v[16:19]
  v_mfma_f32_16x16x32_bf16 v[20:23], a[0:3], v[208:211], v[20:23]
  ds_read_b64_tr_b16 a[16:17], v103 offset:18432
  s_add_u32 s42, s42, 589824
  v_mfma_f32_16x16x32_bf16 v[20:23], a[4:7], v[216:219], v[20:23]
  buffer_load_dwordx4 v[152:155], v160, s[28:31], s42 offen sc1
  v_mfma_f32_16x16x32_bf16 v[24:27], a[0:3], v[212:215], v[24:27]
  ds_read_b64_tr_b16 a[18:19], v103 offset:18944
  v_mfma_f32_16x16x32_bf16 v[24:27], a[4:7], v[220:223], v[24:27]
  v_mfma_f32_16x16x32_bf16 v[28:31], a[0:3], a[120:123], v[28:31]
  ds_read_b64_tr_b16 a[20:21], v103 offset:26624
  s_add_u32 s42, s42, 589824
  v_mfma_f32_16x16x32_bf16 v[28:31], a[4:7], a[128:131], v[28:31]
  buffer_load_dwordx4 v[156:159], v160, s[28:31], s42 offen sc1
  v_mfma_f32_16x16x32_bf16 v[32:35], a[0:3], a[124:127], v[32:35]
  s_waitcnt lgkmcnt(3)
  ds_read_b64_tr_b16 a[22:23], v103 offset:27136
  v_mfma_f32_16x16x32_bf16 v[32:35], a[4:7], a[132:135], v[32:35]
  s_add_u32 s42, s42, 589824
  v_mfma_f32_16x16x32_bf16 v[36:39], a[8:11], v[208:211], v[36:39]
  s_barrier
  v_mfma_f32_16x16x32_bf16 v[36:39], a[12:15], v[216:219], v[36:39]
  ds_read_b64_tr_b16 a[0:1], v102 offset:32768
  s_add_u32 m0, s64, 65536
  v_mfma_f32_16x16x32_bf16 v[40:43], a[8:11], v[212:215], v[40:43]
  buffer_load_dwordx4 v108, s[20:23], s37 offen offset:0 sc1 lds
  v_mfma_f32_16x16x32_bf16 v[40:43], a[12:15], v[220:223], v[40:43]
  ds_read_b64_tr_b16 a[2:3], v102 offset:33280
  v_mfma_f32_16x16x32_bf16 v[44:47], a[8:11], a[120:123], v[44:47]
  v_mfma_f32_16x16x32_bf16 v[44:47], a[12:15], a[128:131], v[44:47]
  ds_read_b64_tr_b16 a[4:5], v102 offset:40960
  v_mfma_f32_16x16x32_bf16 v[48:51], a[8:11], a[124:127], v[48:51]
  buffer_load_dwordx4 v108, s[20:23], s37 offen offset:1024 sc1 lds
  v_mfma_f32_16x16x32_bf16 v[48:51], a[12:15], a[132:135], v[48:51]
  ds_read_b64_tr_b16 a[6:7], v102 offset:41472
  s_waitcnt lgkmcnt(4)
  v_mfma_f32_16x16x32_bf16 v[52:55], a[16:19], v[208:211], v[52:55]
  ds_read_b64_tr_b16 a[8:9], v102 offset:34816
  v_mfma_f32_16x16x32_bf16 v[52:55], a[20:23], v[216:219], v[52:55]
  buffer_load_dwordx4 v108, s[20:23], s37 offen offset:2048 sc1 lds
  v_mfma_f32_16x16x32_bf16 v[56:59], a[16:19], v[212:215], v[56:59]
  ds_read_b64_tr_b16 a[10:11], v102 offset:35328
  v_mfma_f32_16x16x32_bf16 v[56:59], a[20:23], v[220:223], v[56:59]
  v_mfma_f32_16x16x32_bf16 v[60:63], a[16:19], a[120:123], v[60:63]
  ds_read_b64_tr_b16 a[12:13], v102 offset:43008
  v_mfma_f32_16x16x32_bf16 v[60:63], a[20:23], a[128:131], v[60:63]
  buffer_load_dwordx4 v108, s[20:23], s37 offen offset:3072 sc1 lds
  v_mfma_f32_16x16x32_bf16 v[64:67], a[16:19], a[124:127], v[64:67]
  s_waitcnt lgkmcnt(3)
  ds_read_b64_tr_b16 a[14:15], v102 offset:43520
  v_mfma_f32_16x16x32_bf16 v[64:67], a[20:23], a[132:135], v[64:67]
  v_mfma_f32_16x16x32_bf16 v[4:7], a[0:3], v[224:227], v[4:7]
  ds_read_b64_tr_b16 a[16:17], v103 offset:32768
  s_add_u32 s37, s37, 16384
  v_mfma_f32_16x16x32_bf16 v[4:7], a[4:7], v[232:235], v[4:7]
  buffer_load_dwordx4 a[184:187], v108, s[20:23], s38 offen offset:0 sc1
  v_mfma_f32_16x16x32_bf16 v[8:11], a[0:3], v[228:231], v[8:11]
  ds_read_b64_tr_b16 a[18:19], v103 offset:33280
  v_mfma_f32_16x16x32_bf16 v[8:11], a[4:7], v[236:239], v[8:11]
  v_mfma_f32_16x16x32_bf16 v[12:15], a[0:3], a[136:139], v[12:15]
  ds_read_b64_tr_b16 a[20:21], v103 offset:40960
  v_mfma_f32_16x16x32_bf16 v[12:15], a[4:7], a[144:147], v[12:15]
  buffer_load_dwordx4 a[188:191], v108, s[20:23], s38 offen offset:1024 sc1
  v_mfma_f32_16x16x32_bf16 v[16:19], a[0:3], a[140:143], v[16:19]
  s_waitcnt lgkmcnt(3)
  ds_read_b64_tr_b16 a[22:23], v103 offset:41472
  v_mfma_f32_16x16x32_bf16 v[16:19], a[4:7], a[148:151], v[16:19]
  v_mfma_f32_16x16x32_bf16 v[20:23], a[8:11], v[224:227], v[20:23]
  ds_read_b64_tr_b16 a[0:1], v103 offset:34816
  v_mfma_f32_16x16x32_bf16 v[20:23], a[12:15], v[232:235], v[20:23]
  buffer_load_dwordx4 a[192:195], v108, s[20:23], s38 offen offset:2048 sc1
  v_mfma_f32_16x16x32_bf16 v[24:27], a[8:11], v[228:231], v[24:27]
  ds_read_b64_tr_b16 a[2:3], v103 offset:35328
  v_mfma_f32_16x16x32_bf16 v[24:27], a[12:15], v[236:239], v[24:27]
  v_mfma_f32_16x16x32_bf16 v[28:31], a[8:11], a[136:139], v[28:31]
  ds_read_b64_tr_b16 a[4:5], v103 offset:43008
  v_mfma_f32_16x16x32_bf16 v[28:31], a[12:15], a[144:147], v[28:31]
  buffer_load_dwordx4 a[196:199], v108, s[20:23], s38 offen offset:3072 sc1
  v_mfma_f32_16x16x32_bf16 v[32:35], a[8:11], a[140:143], v[32:35]
  s_waitcnt lgkmcnt(3)
  ds_read_b64_tr_b16 a[6:7], v103 offset:43520
  v_mfma_f32_16x16x32_bf16 v[32:35], a[12:15], a[148:151], v[32:35]
  s_waitcnt vmcnt(39)
  s_add_u32 s38, s38, 4096
  v_mfma_f32_16x16x32_bf16 v[36:39], a[16:19], v[224:227], v[36:39]
  s_barrier
  v_mfma_f32_16x16x32_bf16 v[36:39], a[20:23], v[232:235], v[36:39]
  ds_read_b64_tr_b16 a[8:9], v102 offset:49152
  s_add_u32 m0, s64, 81920
  v_mfma_f32_16x16x32_bf16 v[40:43], a[16:19], v[228:231], v[40:43]
  buffer_load_dwordx4 v108, s[20:23], s37 offen offset:0 sc1 lds
  v_mfma_f32_16x16x32_bf16 v[40:43], a[20:23], v[236:239], v[40:43]
  ds_read_b64_tr_b16 a[10:11], v102 offset:49664
  v_mfma_f32_16x16x32_bf16 v[44:47], a[16:19], a[136:139], v[44:47]
  v_mfma_f32_16x16x32_bf16 v[44:47], a[20:23], a[144:147], v[44:47]
  ds_read_b64_tr_b16 a[12:13], v102 offset:57344
  v_mfma_f32_16x16x32_bf16 v[48:51], a[16:19], a[140:143], v[48:51]
  buffer_load_dwordx4 v108, s[20:23], s37 offen offset:1024 sc1 lds
  v_mfma_f32_16x16x32_bf16 v[48:51], a[20:23], a[148:151], v[48:51]
  ds_read_b64_tr_b16 a[14:15], v102 offset:57856
  s_waitcnt lgkmcnt(4)
  v_mfma_f32_16x16x32_bf16 v[52:55], a[0:3], v[224:227], v[52:55]
  ds_read_b64_tr_b16 a[16:17], v102 offset:51200
  v_mfma_f32_16x16x32_bf16 v[52:55], a[4:7], v[232:235], v[52:55]
  buffer_load_dwordx4 v108, s[20:23], s37 offen offset:2048 sc1 lds
  v_mfma_f32_16x16x32_bf16 v[56:59], a[0:3], v[228:231], v[56:59]
  ds_read_b64_tr_b16 a[18:19], v102 offset:51712
  v_mfma_f32_16x16x32_bf16 v[56:59], a[4:7], v[236:239], v[56:59]
  v_mfma_f32_16x16x32_bf16 v[60:63], a[0:3], a[136:139], v[60:63]
  ds_read_b64_tr_b16 a[20:21], v102 offset:59392
  v_mfma_f32_16x16x32_bf16 v[60:63], a[4:7], a[144:147], v[60:63]
  buffer_load_dwordx4 v108, s[20:23], s37 offen offset:3072 sc1 lds
  v_mfma_f32_16x16x32_bf16 v[64:67], a[0:3], a[140:143], v[64:67]
  s_waitcnt lgkmcnt(3)
  ds_read_b64_tr_b16 a[22:23], v102 offset:59904
  v_mfma_f32_16x16x32_bf16 v[64:67], a[4:7], a[148:151], v[64:67]
  s_waitcnt vmcnt(22)
  v_add_f32 v200, v128, v132
  v_add_f32 v201, v129, v133
  v_mfma_f32_16x16x32_bf16 v[4:7], a[8:11], v[240:243], v[4:7]
  ds_read_b64_tr_b16 a[0:1], v103 offset:49152
  s_add_u32 s37, s37, 16384
  v_mfma_f32_16x16x32_bf16 v[4:7], a[12:15], v[248:251], v[4:7]
  buffer_load_dwordx4 a[200:203], v108, s[20:23], s39 offen offset:0 sc1
  v_mfma_f32_16x16x32_bf16 v[8:11], a[8:11], v[244:247], v[8:11]
  ds_read_b64_tr_b16 a[2:3], v103 offset:49664
  v_add_f32 v202, v130, v134
  v_mfma_f32_16x16x32_bf16 v[8:11], a[12:15], v[252:255], v[8:11]
  v_add_f32 v203, v131, v135
  s_waitcnt vmcnt(22)
  v_add_f32 v200, v200, v136
  v_mfma_f32_16x16x32_bf16 v[12:15], a[8:11], a[152:155], v[12:15]
  ds_read_b64_tr_b16 a[4:5], v103 offset:57344
  v_add_f32 v201, v201, v137
  v_mfma_f32_16x16x32_bf16 v[12:15], a[12:15], a[160:163], v[12:15]
  buffer_load_dwordx4 a[204:207], v108, s[20:23], s39 offen offset:1024 sc1
  v_mfma_f32_16x16x32_bf16 v[16:19], a[8:11], a[156:159], v[16:19]
  s_waitcnt lgkmcnt(3)
  ds_read_b64_tr_b16 a[6:7], v103 offset:57856
  v_mfma_f32_16x16x32_bf16 v[16:19], a[12:15], a[164:167], v[16:19]
  v_add_f32 v202, v202, v138
  v_add_f32 v203, v203, v139
  v_mfma_f32_16x16x32_bf16 v[20:23], a[16:19], v[240:243], v[20:23]
  ds_read_b64_tr_b16 a[8:9], v103 offset:51200
  s_waitcnt vmcnt(22)
  v_add_f32 v200, v200, v140
  v_mfma_f32_16x16x32_bf16 v[20:23], a[20:23], v[248:251], v[20:23]
  buffer_load_dwordx4 a[208:211], v108, s[20:23], s39 offen offset:2048 sc1
  v_mfma_f32_16x16x32_bf16 v[24:27], a[16:19], v[244:247], v[24:27]
  ds_read_b64_tr_b16 a[10:11], v103 offset:51712
  v_add_f32 v201, v201, v141
  v_mfma_f32_16x16x32_bf16 v[24:27], a[20:23], v[252:255], v[24:27]
  v_add_f32 v202, v202, v142
  v_add_f32 v203, v203, v143
  v_mfma_f32_16x16x32_bf16 v[28:31], a[16:19], a[152:155], v[28:31]
  ds_read_b64_tr_b16 a[12:13], v103 offset:59392
  s_waitcnt vmcnt(18)
  v_add_f32 v200, v200, v144
  v_mfma_f32_16x16x32_bf16 v[28:31], a[20:23], a[160:163], v[28:31]
  v_add_f32 v201, v201, v145
  v_mfma_f32_16x16x32_bf16 v[32:35], a[16:19], a[156:159], v[32:35]
  s_waitcnt lgkmcnt(3)
  ds_read_b64_tr_b16 a[14:15], v103 offset:59904
  v_mfma_f32_16x16x32_bf16 v[32:35], a[20:23], a[164:167], v[32:35]
  v_add_f32 v202, v202, v146
  v_mfma_f32_16x16x32_bf16 v[36:39], a[0:3], v[240:243], v[36:39]
  s_barrier
  buffer_load_dwordx4 a[212:215], v108, s[20:23], s39 offen offset:3072 sc1
  s_add_u32 s39, s39, 4096
  v_mfma_f32_16x16x32_bf16 v[36:39], a[4:7], v[248:251], v[36:39]
  ds_read_b64_tr_b16 a[16:17], v104 offset:0
  s_add_u32 m0, s64, 98304
  v_mfma_f32_16x16x32_bf16 v[40:43], a[0:3], v[244:247], v[40:43]
  buffer_load_dwordx4 v108, s[20:23], s37 offen offset:0 sc1 lds
  v_mfma_f32_16x16x32_bf16 v[40:43], a[4:7], v[252:255], v[40:43]
  ds_read_b64_tr_b16 a[18:19], v104 offset:512
  v_add_f32 v203, v203, v147
  v_mfma_f32_16x16x32_bf16 v[44:47], a[0:3], a[152:155], v[44:47]
  buffer_load_dwordx4 v108, s[20:23], s37 offen offset:1024 sc1 lds
  v_mfma_f32_16x16x32_bf16 v[44:47], a[4:7], a[160:163], v[44:47]
  ds_read_b64_tr_b16 a[20:21], v104 offset:8192
  s_waitcnt vmcnt(20)
  v_add_f32 v200, v200, v148
  v_mfma_f32_16x16x32_bf16 v[48:51], a[0:3], a[156:159], v[48:51]
  v_add_f32 v201, v201, v149
  v_add_f32 v202, v202, v150
  v_mfma_f32_16x16x32_bf16 v[48:51], a[4:7], a[164:167], v[48:51]
  ds_read_b64_tr_b16 a[22:23], v104 offset:8704
  s_waitcnt lgkmcnt(4)
  v_mfma_f32_16x16x32_bf16 v[52:55], a[8:11], v[240:243], v[52:55]
  ds_read_b64_tr_b16 a[0:1], v104 offset:2048
  v_add_f32 v203, v203, v151
  v_mfma_f32_16x16x32_bf16 v[52:55], a[12:15], v[248:251], v[52:55]
  buffer_load_dwordx4 v108, s[20:23], s37 offen offset:2048 sc1 lds
  v_mfma_f32_16x16x32_bf16 v[56:59], a[8:11], v[244:247], v[56:59]
  ds_read_b64_tr_b16 a[2:3], v104 offset:2560
  s_waitcnt vmcnt(20)
  v_add_f32 v200, v200, v152
  v_mfma_f32_16x16x32_bf16 v[56:59], a[12:15], v[252:255], v[56:59]
  buffer_load_dwordx4 v108, s[20:23], s37 offen offset:3072 sc1 lds
  v_mfma_f32_16x16x32_bf16 v[60:63], a[8:11], a[152:155], v[60:63]
  ds_read_b64_tr_b16 a[4:5], v104 offset:10240
  v_add_f32 v201, v201, v153
  v_mfma_f32_16x16x32_bf16 v[60:63], a[12:15], a[160:163], v[60:63]
  s_add_u32 s37, s37, 16384
  v_add_u32 v125, 1, v125
  v_mfma_f32_16x16x32_bf16 v[64:67], a[8:11], a[156:159], v[64:67]
  s_waitcnt lgkmcnt(3)
  ds_read_b64_tr_b16 a[6:7], v104 offset:10752
  v_mfma_f32_16x16x32_bf16 v[64:67], a[12:15], a[164:167], v[64:67]
  buffer_store_dwordx2 v[124:125], v126, s[20:23], s86 offen sc1
  v_mfma_f32_16x16x32_bf16 v[4:7], a[16:19], a[24:27], v[4:7]
  ds_read_b64_tr_b16 a[8:9], v105 offset:0
  v_add_f32 v202, v202, v154
  v_mfma_f32_16x16x32_bf16 v[4:7], a[20:23], a[32:35], v[4:7]
  v_add_f32 v203, v203, v155
  s_waitcnt vmcnt(21)
  v_add_f32 v200, v200, v156
  v_mfma_f32_16x16x32_bf16 v[8:11], a[16:19], a[28:31], v[8:11]
  ds_read_b64_tr_b16 a[10:11], v105 offset:512
  v_add_f32 v201, v201, v157
  v_mfma_f32_16x16x32_bf16 v[8:11], a[20:23], a[36:39], v[8:11]
  buffer_load_dwordx4 a[216:219], v108, s[20:23], s38 offen offset:0 sc1
  v_mfma_f32_16x16x32_bf16 v[12:15], a[16:19], a[168:171], v[12:15]
  ds_read_b64_tr_b16 a[12:13], v105 offset:8192
  v_add_f32 v202, v202, v158
  v_mfma_f32_16x16x32_bf16 v[12:15], a[20:23], a[176:179], v[12:15]
  buffer_load_dwordx4 a[220:223], v108, s[20:23], s38 offen offset:1024 sc1
  v_mfma_f32_16x16x32_bf16 v[16:19], a[16:19], a[172:175], v[16:19]
  s_waitcnt lgkmcnt(3)
  ds_read_b64_tr_b16 a[14:15], v105 offset:8704
  v_mfma_f32_16x16x32_bf16 v[16:19], a[20:23], a[180:183], v[16:19]
  v_add_f32 v203, v203, v159
  v_and_b32 v255, 3, v0
  v_mfma_f32_16x16x32_bf16 v[20:23], a[0:3], a[24:27], v[20:23]
  ds_read_b64_tr_b16 a[16:17], v105 offset:2048
  v_max_u32 v254, 1, v255
  v_mfma_f32_16x16x32_bf16 v[20:23], a[4:7], a[32:35], v[20:23]
  buffer_load_dwordx4 a[224:227], v108, s[20:23], s38 offen offset:2048 sc1
  v_mfma_f32_16x16x32_bf16 v[24:27], a[0:3], a[28:31], v[24:27]
  ds_read_b64_tr_b16 a[18:19], v105 offset:2560
  v_lshlrev_b32 v254, 3, v254
  v_mfma_f32_16x16x32_bf16 v[24:27], a[4:7], a[36:39], v[24:27]
  v_mfma_f32_16x16x32_bf16 v[28:31], a[0:3], a[168:171], v[28:31]
  ds_read_b64_tr_b16 a[20:21], v105 offset:10240
  v_mfma_f32_16x16x32_bf16 v[28:31], a[4:7], a[176:179], v[28:31]
  v_mul_f32 v68, v4, v20
  v_mul_f32 v69, v5, v21
  v_mul_f32 v70, v6, v22
  v_mfma_f32_16x16x32_bf16 v[32:35], a[0:3], a[172:175], v[32:35]
  s_waitcnt lgkmcnt(3)
  ds_read_b64_tr_b16 a[22:23], v105 offset:10752
  v_mul_f32 v71, v7, v23
  v_mfma_f32_16x16x32_bf16 v[32:35], a[4:7], a[180:183], v[32:35]
  buffer_load_dwordx4 a[228:231], v108, s[20:23], s38 offen offset:3072 sc1
  s_add_u32 s38, s38, 4096
  v_mfma_f32_16x16x32_bf16 v[36:39], a[8:11], a[24:27], v[36:39]
  s_barrier
  v_mfma_f32_16x16x32_bf16 v[36:39], a[12:15], a[32:35], v[36:39]
  ds_read_b128 a[104:107], v120 offset:0
  v_mul_f32 v72, v8, v24
  v_mfma_f32_16x16x32_bf16 v[40:43], a[8:11], a[28:31], v[40:43]
  v_mul_f32 v73, v9, v25
  v_mul_f32 v74, v10, v26
  v_mfma_f32_16x16x32_bf16 v[40:43], a[12:15], a[36:39], v[40:43]
  ds_read_b128 a[108:111], v120 offset:9216
  v_mul_f32 v75, v11, v27
  v_mfma_f32_16x16x32_bf16 v[44:47], a[8:11], a[168:171], v[44:47]
  v_mul_f32 v76, v12, v28
  v_mul_f32 v77, v13, v29
  v_mfma_f32_16x16x32_bf16 v[44:47], a[12:15], a[176:179], v[44:47]
  ds_read_b128 a[112:115], v120 offset:18432
  v_mul_f32 v78, v14, v30
  v_mfma_f32_16x16x32_bf16 v[48:51], a[8:11], a[172:175], v[48:51]
  v_mul_f32 v79, v15, v31
  v_mul_f32 v80, v16, v32
  v_mfma_f32_16x16x32_bf16 v[48:51], a[12:15], a[180:183], v[48:51]
  s_waitcnt lgkmcnt(3)
  ds_read_b128 a[116:119], v120 offset:27648
  v_mfma_f32_16x16x32_bf16 v[52:55], a[16:19], a[24:27], v[52:55]
  ds_read_b128 a[120:123], v120 offset:1024
  v_mul_f32 v81, v17, v33
  v_mfma_f32_16x16x32_bf16 v[52:55], a[20:23], a[32:35], v[52:55]
  v_mul_f32 v82, v18, v34
  v_mul_f32 v83, v19, v35
  v_mfma_f32_16x16x32_bf16 v[56:59], a[16:19], a[28:31], v[56:59]
  ds_read_b128 a[124:127], v120 offset:10240
  s_add_u32 m0, s64, 114688
  v_mfma_f32_16x16x32_bf16 v[56:59], a[20:23], a[36:39], v[56:59]
  buffer_load_dwordx4 v108, s[20:23], s37 offen offset:0 sc1 lds
  v_mfma_f32_16x16x32_bf16 v[60:63], a[16:19], a[168:171], v[60:63]
  ds_read_b128 a[128:131], v120 offset:19456
  v_mfma_f32_16x16x32_bf16 v[60:63], a[20:23], a[176:179], v[60:63]
  buffer_load_dwordx4 v108, s[20:23], s37 offen offset:1024 sc1 lds
  v_mfma_f32_16x16x32_bf16 v[64:67], a[16:19], a[172:175], v[64:67]
  ds_read_b128 a[132:135], v120 offset:28672
  v_mfma_f32_16x16x32_bf16 v[64:67], a[20:23], a[180:183], v[64:67]
  s_waitcnt vmcnt(11) lgkmcnt(4)
  buffer_load_dwordx4 v108, s[20:23], s37 offen offset:2048 sc1 lds
  buffer_load_dwordx4 v108, s[20:23], s37 offen offset:3072 sc1 lds
  s_add_u32 s37, s37, 16384
  v_mfma_f32_16x16x32_bf16 v[128:131], a[104:107], a[184:187], 0
  ds_read_b128 a[136:139], v120 offset:2048
  v_mul_f32 v84, v36, v52
  v_mfma_f32_16x16x32_bf16 v[128:131], a[108:111], a[188:191], v[128:131]
  v_mul_f32 v85, v37, v53
  v_mul_f32 v86, v38, v54
  v_mfma_f32_16x16x32_bf16 v[128:131], a[112:115], a[192:195], v[128:131]
  ds_read_b128 a[140:143], v120 offset:11264
  v_mul_f32 v87, v39, v55
  v_mfma_f32_16x16x32_bf16 v[128:131], a[116:119], a[196:199], v[128:131]
  v_mul_f32 v88, v40, v56
  v_mul_f32 v89, v41, v57
  v_mfma_f32_16x16x32_bf16 v[132:135], a[104:107], a[200:203], 0
  ds_read_b128 a[144:147], v120 offset:20480
  s_barrier
  v_mfma_f32_16x16x32_bf16 v[132:135], a[108:111], a[204:207], v[132:135]
  v_mul_f32 v90, v42, v58
  v_mul_f32 v91, v43, v59
  v_mfma_f32_16x16x32_bf16 v[132:135], a[112:115], a[208:211], v[132:135]
  s_waitcnt lgkmcnt(3)
  ds_read_b128 a[148:151], v120 offset:29696
  v_mfma_f32_16x16x32_bf16 v[132:135], a[116:119], a[212:215], v[132:135]
  v_mul_f32 v92, v44, v60
  v_mul_f32 v93, v45, v61
  v_mfma_f32_16x16x32_bf16 v[136:139], a[120:123], a[184:187], 0
  ds_read_b128 a[104:107], v120 offset:3072
  v_mul_f32 v94, v46, v62
  v_mfma_f32_16x16x32_bf16 v[136:139], a[124:127], a[188:191], v[136:139]
  v_mul_f32 v95, v47, v63
  v_mul_f32 v96, v48, v64
  v_mfma_f32_16x16x32_bf16 v[136:139], a[128:131], a[192:195], v[136:139]
  ds_read_b128 a[108:111], v120 offset:12288
  v_mul_f32 v97, v49, v65
  v_mfma_f32_16x16x32_bf16 v[136:139], a[132:135], a[196:199], v[136:139]
  v_mul_f32 v98, v50, v66
  v_mul_f32 v99, v51, v67
  v_mfma_f32_16x16x32_bf16 v[140:143], a[120:123], a[200:203], 0
  ds_read_b128 a[112:115], v120 offset:21504
  v_mul_f32 v68, v68, v114
  v_mfma_f32_16x16x32_bf16 v[140:143], a[124:127], a[204:207], v[140:143]
  buffer_load_dwordx4 a[232:235], v108, s[20:23], s39 offen offset:0 sc1
  v_mfma_f32_16x16x32_bf16 v[140:143], a[128:131], a[208:211], v[140:143]
  s_waitcnt lgkmcnt(3)
  ds_read_b128 a[116:119], v120 offset:30720
  v_mfma_f32_16x16x32_bf16 v[140:143], a[132:135], a[212:215], v[140:143]
  buffer_load_dwordx4 a[236:239], v108, s[20:23], s39 offen offset:1024 sc1
  v_mfma_f32_16x16x32_bf16 v[144:147], a[136:139], a[184:187], 0
  ds_read_b128 a[120:123], v120 offset:4096
  v_mul_f32 v69, v69, v114
  v_mfma_f32_16x16x32_bf16 v[144:147], a[140:143], a[188:191], v[144:147]
  buffer_load_dwordx4 a[240:243], v108, s[20:23], s39 offen offset:2048 sc1
  v_mfma_f32_16x16x32_bf16 v[144:147], a[144:147], a[192:195], v[144:147]
  ds_read_b128 a[124:127], v120 offset:13312
  v_mul_f32 v70, v70, v114
  v_mfma_f32_16x16x32_bf16 v[144:147], a[148:151], a[196:199], v[144:147]
  buffer_load_dwordx4 a[244:247], v108, s[20:23], s39 offen offset:3072 sc1
  v_mfma_f32_16x16x32_bf16 v[148:151], a[136:139], a[200:203], 0
  ds_read_b128 a[128:131], v120 offset:22528
  s_add_u32 s39, s39, 4096
  v_mfma_f32_16x16x32_bf16 v[148:151], a[140:143], a[204:207], v[148:151]
  s_add_u32 m0, s64, 131072
  v_mul_f32 v71, v71, v114
  v_mfma_f32_16x16x32_bf16 v[148:151], a[144:147], a[208:211], v[148:151]
  s_waitcnt lgkmcnt(3)
  ds_read_b128 a[132:135], v120 offset:31744
  v_mfma_f32_16x16x32_bf16 v[148:151], a[148:151], a[212:215], v[148:151]
  buffer_load_dwordx4 v108, s[20:23], s37 offen offset:0 sc1 lds
  v_mfma_f32_16x16x32_bf16 v[152:155], a[104:107], a[184:187], 0
  ds_read_b128 a[136:139], v120 offset:5120
  v_mul_f32 v84, v84, v114
  v_mfma_f32_16x16x32_bf16 v[152:155], a[108:111], a[188:191], v[152:155]
  buffer_load_dwordx4 v108, s[20:23], s37 offen offset:1024 sc1 lds
  v_mfma_f32_16x16x32_bf16 v[152:155], a[112:115], a[192:195], v[152:155]
  ds_read_b128 a[140:143], v120 offset:14336
  v_mul_f32 v85, v85, v114
  v_mfma_f32_16x16x32_bf16 v[152:155], a[116:119], a[196:199], v[152:155]
  buffer_load_dwordx2 v[252:253], v254, s[20:23], s87 offen sc1
  v_mfma_f32_16x16x32_bf16 v[156:159], a[104:107], a[200:203], 0
  ds_read_b128 a[144:147], v120 offset:23552
  v_mul_f32 v86, v86, v114
  v_mfma_f32_16x16x32_bf16 v[156:159], a[108:111], a[204:207], v[156:159]
  buffer_load_dwordx4 v108, s[20:23], s37 offen offset:2048 sc1 lds
  v_mfma_f32_16x16x32_bf16 v[156:159], a[112:115], a[208:211], v[156:159]
  s_waitcnt lgkmcnt(3)
  ds_read_b128 a[148:151], v120 offset:32768
  v_mfma_f32_16x16x32_bf16 v[156:159], a[116:119], a[212:215], v[156:159]
  buffer_load_dwordx4 v108, s[20:23], s37 offen offset:3072 sc1 lds
  v_mfma_f32_16x16x32_bf16 v[160:163], a[120:123], a[184:187], 0
  ds_read_b128 a[104:107], v120 offset:6144
  v_mul_f32 v87, v87, v114
  v_cvt_pk_bf16_f32 v68, v68, v69
  v_cvt_pk_bf16_f32 v69, v70, v71
  v_cvt_pk_bf16_f32 v70, v84, v85
  v_cvt_pk_bf16_f32 v71, v86, v87
  v_mfma_f32_16x16x32_bf16 v[160:163], a[124:127], a[188:191], v[160:163]
  buffer_store_dwordx4 v[68:71], v108, s[24:27], s70 offen sc1
  v_mfma_f32_16x16x32_bf16 v[160:163], a[128:131], a[192:195], v[160:163]
  ds_read_b128 a[108:111], v120 offset:15360
  v_mul_f32 v72, v72, v115
  v_mfma_f32_16x16x32_bf16 v[160:163], a[132:135], a[196:199], v[160:163]
  buffer_load_dwordx4 a[40:43], v108, s[20:23], s38 offen offset:0 sc1
  v_mfma_f32_16x16x32_bf16 v[164:167], a[120:123], a[200:203], 0
  ds_read_b128 a[112:115], v120 offset:24576
  v_mul_f32 v73, v73, v115
  v_mfma_f32_16x16x32_bf16 v[164:167], a[124:127], a[204:207], v[164:167]
  v_mul_f32 v74, v74, v115
  v_mul_f32 v75, v75, v115
  v_mfma_f32_16x16x32_bf16 v[164:167], a[128:131], a[208:211], v[164:167]
  s_waitcnt lgkmcnt(3)
  ds_read_b128 a[116:119], v120 offset:33792
  v_mfma_f32_16x16x32_bf16 v[164:167], a[132:135], a[212:215], v[164:167]
  buffer_load_dwordx4 a[44:47], v108, s[20:23], s38 offen offset:1024 sc1
  v_mfma_f32_16x16x32_bf16 v[168:171], a[136:139], a[184:187], 0
  ds_read_b128 a[120:123], v120 offset:7168
  v_mul_f32 v88, v88, v115
  v_mfma_f32_16x16x32_bf16 v[168:171], a[140:143], a[188:191], v[168:171]
  buffer_load_dwordx4 a[48:51], v108, s[20:23], s38 offen offset:2048 sc1
  v_mfma_f32_16x16x32_bf16 v[168:171], a[144:147], a[192:195], v[168:171]
  ds_read_b128 a[124:127], v120 offset:16384
  v_mul_f32 v89, v89, v115
  v_mfma_f32_16x16x32_bf16 v[168:171], a[148:151], a[196:199], v[168:171]
  v_mul_f32 v90, v90, v115
  v_mul_f32 v91, v91, v115
  v_mfma_f32_16x16x32_bf16 v[172:175], a[136:139], a[200:203], 0
  ds_read_b128 a[128:131], v120 offset:25600
  v_cvt_pk_bf16_f32 v72, v72, v73
  v_cvt_pk_bf16_f32 v73, v74, v75
  v_cvt_pk_bf16_f32 v74, v88, v89
  v_cvt_pk_bf16_f32 v75, v90, v91
  v_mfma_f32_16x16x32_bf16 v[172:175], a[140:143], a[204:207], v[172:175]
  buffer_store_dwordx4 v[72:75], v108, s[24:27], s71 offen sc1
  v_mfma_f32_16x16x32_bf16 v[172:175], a[144:147], a[208:211], v[172:175]
  s_waitcnt lgkmcnt(3)
  ds_read_b128 a[132:135], v120 offset:34816
  v_mfma_f32_16x16x32_bf16 v[172:175], a[148:151], a[212:215], v[172:175]
  v_mul_f32 v76, v76, v116
  v_mul_f32 v77, v77, v116
  v_mfma_f32_16x16x32_bf16 v[176:179], a[104:107], a[184:187], 0
  ds_read_b128 a[136:139], v120 offset:8192
  v_mul_f32 v78, v78, v116
  v_mfma_f32_16x16x32_bf16 v[176:179], a[108:111], a[188:191], v[176:179]
  buffer_load_dwordx4 a[52:55], v108, s[20:23], s38 offen offset:3072 sc1
  v_mfma_f32_16x16x32_bf16 v[176:179], a[112:115], a[192:195], v[176:179]
  ds_read_b128 a[140:143], v120 offset:17408
  s_add_u32 s38, s38, 4096
  v_mfma_f32_16x16x32_bf16 v[176:179], a[116:119], a[196:199], v[176:179]
  buffer_load_dwordx4 a[56:59], v108, s[20:23], s39 offen offset:0 sc1
  v_mfma_f32_16x16x32_bf16 v[180:183], a[104:107], a[200:203], 0
  ds_read_b128 a[144:147], v120 offset:26624
  v_mul_f32 v79, v79, v116
  v_mfma_f32_16x16x32_bf16 v[180:183], a[108:111], a[204:207], v[180:183]
  v_mul_f32 v92, v92, v116
  v_mul_f32 v93, v93, v116
  v_mfma_f32_16x16x32_bf16 v[180:183], a[112:115], a[208:211], v[180:183]
  s_waitcnt lgkmcnt(3)
  ds_read_b128 a[148:151], v120 offset:35840
  v_mfma_f32_16x16x32_bf16 v[180:183], a[116:119], a[212:215], v[180:183]
  v_mul_f32 v94, v94, v116
  v_mfma_f32_16x16x32_bf16 v[184:187], a[120:123], a[184:187], 0
  s_barrier
  v_mul_f32 v95, v95, v116
  v_mfma_f32_16x16x32_bf16 v[184:187], a[124:127], a[188:191], v[184:187]
  ds_read_b128 a[104:107], v121 offset:0
  v_cvt_pk_bf16_f32 v76, v76, v77
  v_mfma_f32_16x16x32_bf16 v[184:187], a[128:131], a[192:195], v[184:187]
  buffer_load_dwordx4 a[60:63], v108, s[20:23], s39 offen offset:1024 sc1
  v_mfma_f32_16x16x32_bf16 v[184:187], a[132:135], a[196:199], v[184:187]
  ds_read_b128 a[108:111], v121 offset:9216
  v_cvt_pk_bf16_f32 v77, v78, v79
  v_cvt_pk_bf16_f32 v78, v92, v93
  v_cvt_pk_bf16_f32 v79, v94, v95
  v_mfma_f32_16x16x32_bf16 v[188:191], a[120:123], a[200:203], 0
  buffer_store_dwordx4 v[76:79], v108, s[24:27], s72 offen sc1
  v_mfma_f32_16x16x32_bf16 v[188:191], a[124:127], a[204:207], v[188:191]
  ds_read_b128 a[112:115], v121 offset:18432
  v_mul_f32 v80, v80, v117
  v_mfma_f32_16x16x32_bf16 v[188:191], a[128:131], a[208:211], v[188:191]
  buffer_load_dwordx4 a[64:67], v108, s[20:23], s39 offen offset:2048 sc1
  v_mfma_f32_16x16x32_bf16 v[188:191], a[132:135], a[212:215], v[188:191]
  ds_read_b128 a[116:119], v121 offset:27648
  s_waitcnt lgkmcnt(4)
  v_mfma_f32_16x16x32_bf16 v[192:195], a[136:139], a[184:187], 0
  ds_read_b128 a[120:123], v121 offset:1024
  v_mul_f32 v81, v81, v117
  v_mfma_f32_16x16x32_bf16 v[192:195], a[140:143], a[188:191], v[192:195]
  buffer_load_dwordx4 a[68:71], v108, s[20:23], s39 offen offset:3072 sc1
  v_mfma_f32_16x16x32_bf16 v[192:195], a[144:147], a[192:195], v[192:195]
  ds_read_b128 a[124:127], v121 offset:10240
  v_mul_f32 v82, v82, v117
  v_mfma_f32_16x16x32_bf16 v[192:195], a[148:151], a[196:199], v[192:195]
  s_add_u32 s39, s39, 4096
  v_mul_f32 v83, v83, v117
  v_mfma_f32_16x16x32_bf16 v[196:199], a[136:139], a[200:203], 0
  ds_read_b128 a[128:131], v121 offset:19456
  v_mul_f32 v96, v96, v117
  v_mul_f32 v97, v97, v117
  v_mul_f32 v98, v98, v117
  v_mul_f32 v99, v99, v117
  v_cvt_pk_bf16_f32 v80, v80, v81
  v_cvt_pk_bf16_f32 v81, v82, v83
  v_cvt_pk_bf16_f32 v82, v96, v97
  v_cvt_pk_bf16_f32 v83, v98, v99
  v_mfma_f32_16x16x32_bf16 v[196:199], a[140:143], a[204:207], v[196:199]
  buffer_store_dwordx4 v[80:83], v108, s[24:27], s73 offen sc1
  v_mfma_f32_16x16x32_bf16 v[196:199], a[144:147], a[208:211], v[196:199]
  s_waitcnt vmcnt(17) lgkmcnt(3)
  ds_read_b128 a[132:135], v121 offset:28672
  v_mfma_f32_16x16x32_bf16 v[196:199], a[148:151], a[212:215], v[196:199]
  v_mov_b32 v204, v200
  v_mov_b32 v205, v201
  v_mfma_f32_16x16x32_bf16 v[128:131], a[104:107], a[216:219], v[128:131]
  ds_read_b128 a[136:139], v121 offset:2048
  v_mov_b32 v206, v202
  v_mfma_f32_16x16x32_bf16 v[128:131], a[108:111], a[220:223], v[128:131]
  v_mov_b32 v207, v203
  v_permlane32_swap_b32 v204, v200
  v_mfma_f32_16x16x32_bf16 v[128:131], a[112:115], a[224:227], v[128:131]
  ds_read_b128 a[140:143], v121 offset:11264
  v_permlane32_swap_b32 v205, v201
  v_mfma_f32_16x16x32_bf16 v[128:131], a[116:119], a[228:231], v[128:131]
  v_permlane32_swap_b32 v206, v202
  v_permlane32_swap_b32 v207, v203
  v_mfma_f32_16x16x32_bf16 v[132:135], a[104:107], a[232:235], v[132:135]
  ds_read_b128 a[144:147], v121 offset:20480
  s_barrier
  v_mfma_f32_16x16x32_bf16 v[132:135], a[108:111], a[236:239], v[132:135]
  s_add_u32 m0, s96, 0
  v_add_f32 v200, v200, v204
  v_mfma_f32_16x16x32_bf16 v[132:135], a[112:115], a[240:243], v[132:135]
  s_waitcnt lgkmcnt(3)
  ds_read_b128 a[148:151], v121 offset:29696
  v_mfma_f32_16x16x32_bf16 v[132:135], a[116:119], a[244:247], v[132:135]
  buffer_load_dwordx4 v108, s[20:23], s36 offen offset:0 sc1 lds
  v_mfma_f32_16x16x32_bf16 v[136:139], a[120:123], a[216:219], v[136:139]
  ds_read_b128 a[104:107], v121 offset:3072
  v_add_f32 v201, v201, v205
  v_mfma_f32_16x16x32_bf16 v[136:139], a[124:127], a[220:223], v[136:139]
  buffer_load_dwordx4 v108, s[20:23], s36 offen offset:1024 sc1 lds
  v_mfma_f32_16x16x32_bf16 v[136:139], a[128:131], a[224:227], v[136:139]
  ds_read_b128 a[108:111], v121 offset:12288
  v_add_f32 v202, v202, v206
  v_mfma_f32_16x16x32_bf16 v[136:139], a[132:135], a[228:231], v[136:139]
  v_add_f32 v203, v203, v207
  v_mov_b32 v204, v200
  v_mfma_f32_16x16x32_bf16 v[140:143], a[120:123], a[232:235], v[140:143]
  ds_read_b128 a[112:115], v121 offset:21504
  v_mov_b32 v205, v201
  v_mfma_f32_16x16x32_bf16 v[140:143], a[124:127], a[236:239], v[140:143]
  buffer_load_dwordx4 v108, s[20:23], s36 offen offset:2048 sc1 lds
  v_mfma_f32_16x16x32_bf16 v[140:143], a[128:131], a[240:243], v[140:143]
  s_waitcnt lgkmcnt(3)
  ds_read_b128 a[116:119], v121 offset:30720
  v_mfma_f32_16x16x32_bf16 v[140:143], a[132:135], a[244:247], v[140:143]
  v_mov_b32 v206, v202
  v_mov_b32 v207, v203
  v_mfma_f32_16x16x32_bf16 v[144:147], a[136:139], a[216:219], v[144:147]
  ds_read_b128 a[120:123], v121 offset:4096
  v_permlane16_swap_b32 v204, v200
  v_mfma_f32_16x16x32_bf16 v[144:147], a[140:143], a[220:223], v[144:147]
  buffer_load_dwordx4 v108, s[20:23], s36 offen offset:3072 sc1 lds
  v_mfma_f32_16x16x32_bf16 v[144:147], a[144:147], a[224:227], v[144:147]
  ds_read_b128 a[124:127], v121 offset:13312
  s_add_u32 m0, s96, 4096
  v_mfma_f32_16x16x32_bf16 v[144:147], a[148:151], a[228:231], v[144:147]
  buffer_load_dwordx4 v3, s[20:23], s36 offen offset:0 sc1 lds
  v_mfma_f32_16x16x32_bf16 v[148:151], a[136:139], a[232:235], v[148:151]
  ds_read_b128 a[128:131], v121 offset:22528
  v_permlane16_swap_b32 v205, v201
  v_mfma_f32_16x16x32_bf16 v[148:151], a[140:143], a[236:239], v[148:151]
  v_permlane16_swap_b32 v206, v202
  v_permlane16_swap_b32 v207, v203
  v_mfma_f32_16x16x32_bf16 v[148:151], a[144:147], a[240:243], v[148:151]
  s_waitcnt lgkmcnt(3)
  ds_read_b128 a[132:135], v121 offset:31744
  v_mfma_f32_16x16x32_bf16 v[148:151], a[148:151], a[244:247], v[148:151]
  buffer_load_dwordx4 v3, s[20:23], s36 offen offset:1024 sc1 lds
  v_mfma_f32_16x16x32_bf16 v[152:155], a[104:107], a[216:219], v[152:155]
  ds_read_b128 a[136:139], v121 offset:5120
  v_add_f32 v200, v200, v204
  v_mfma_f32_16x16x32_bf16 v[152:155], a[108:111], a[220:223], v[152:155]
  v_add_f32 v201, v201, v205
  v_add_f32 v202, v202, v206
  v_mfma_f32_16x16x32_bf16 v[152:155], a[112:115], a[224:227], v[152:155]
  ds_read_b128 a[140:143], v121 offset:14336
  v_add_f32 v203, v203, v207
  v_mfma_f32_16x16x32_bf16 v[152:155], a[116:119], a[228:231], v[152:155]
  buffer_load_dwordx4 v3, s[20:23], s36 offen offset:2048 sc1 lds
  v_mfma_f32_16x16x32_bf16 v[156:159], a[104:107], a[232:235], v[156:159]
  ds_read_b128 a[144:147], v121 offset:23552
  v_mfma_f32_16x16x32_bf16 v[156:159], a[108:111], a[236:239], v[156:159]
  v_mfma_f32_16x16x32_bf16 v[156:159], a[112:115], a[240:243], v[156:159]
  s_waitcnt lgkmcnt(3)
  ds_read_b128 a[148:151], v121 offset:32768
  v_mfma_f32_16x16x32_bf16 v[156:159], a[116:119], a[244:247], v[156:159]
  buffer_load_dwordx4 v3, s[20:23], s36 offen offset:3072 sc1 lds
  v_mfma_f32_16x16x32_bf16 v[160:163], a[120:123], a[216:219], v[160:163]
  ds_read_b128 a[104:107], v121 offset:6144
  v_mfma_f32_16x16x32_bf16 v[160:163], a[124:127], a[220:223], v[160:163]
  s_add_u32 m0, s96, 8192
  v_mfma_f32_16x16x32_bf16 v[160:163], a[128:131], a[224:227], v[160:163]
  ds_read_b128 a[108:111], v121 offset:15360
  v_mfma_f32_16x16x32_bf16 v[160:163], a[132:135], a[228:231], v[160:163]
  buffer_load_dwordx4 v111, s[20:23], s36 offen offset:0 sc1 lds
  v_mfma_f32_16x16x32_bf16 v[164:167], a[120:123], a[232:235], v[164:167]
  ds_read_b128 a[112:115], v121 offset:24576
  v_mfma_f32_16x16x32_bf16 v[164:167], a[124:127], a[236:239], v[164:167]
  s_add_u32 s36, s36, 36864
  s_add_u32 s67, s49, 5
  s_waitcnt vmcnt(23)
  v_xor_b32 v252, s48, v252
  v_sub_u32 v253, v253, s67
  v_lshrrev_b32 v253, 4, v253
  v_or_b32 v252, v252, v253
  v_cmp_ne_u32 vcc, 0, v252
  s_nop 0
  s_cmp_eq_u64 vcc, 0
  s_cbranch_scc0 recurrent_scan__linear_attn_block__glu_gated_bilinear__prompt_kernel_cb_w
recurrent_scan__linear_attn_block__glu_gated_bilinear__prompt_kernel_cb_d:
  v_mfma_f32_16x16x32_bf16 v[164:167], a[128:131], a[240:243], v[164:167]
  s_waitcnt lgkmcnt(3)
  ds_read_b128 a[116:119], v121 offset:33792
  v_mfma_f32_16x16x32_bf16 v[164:167], a[132:135], a[244:247], v[164:167]
  buffer_load_dwordx4 a[72:75], v108, s[20:23], s38 offen offset:0 sc1
  v_mfma_f32_16x16x32_bf16 v[168:171], a[136:139], a[216:219], v[168:171]
  ds_read_b128 a[120:123], v121 offset:7168
  v_cmp_eq_u32 vcc, s98, v113
  v_mfma_f32_16x16x32_bf16 v[168:171], a[140:143], a[220:223], v[168:171]
  s_nop 0
  v_cndmask_b32 v200, 0, v200, vcc
  v_cmp_eq_u32 vcc, s99, v113
  v_mfma_f32_16x16x32_bf16 v[168:171], a[144:147], a[224:227], v[168:171]
  ds_read_b128 a[124:127], v121 offset:16384
  v_cndmask_b32 v201, 0, v201, vcc
  v_mfma_f32_16x16x32_bf16 v[168:171], a[148:151], a[228:231], v[168:171]
  buffer_load_dwordx4 a[76:79], v108, s[20:23], s38 offen offset:1024 sc1
  v_mfma_f32_16x16x32_bf16 v[172:175], a[136:139], a[232:235], v[172:175]
  ds_read_b128 a[128:131], v121 offset:25600
  v_cmp_eq_u32 vcc, s65, v113
  v_mfma_f32_16x16x32_bf16 v[172:175], a[140:143], a[236:239], v[172:175]
  buffer_load_dwordx4 a[80:83], v108, s[20:23], s38 offen offset:2048 sc1
  v_mfma_f32_16x16x32_bf16 v[172:175], a[144:147], a[240:243], v[172:175]
  s_waitcnt lgkmcnt(3)
  ds_read_b128 a[132:135], v121 offset:34816
  v_mfma_f32_16x16x32_bf16 v[172:175], a[148:151], a[244:247], v[172:175]
  v_cndmask_b32 v202, 0, v202, vcc
  v_cmp_eq_u32 vcc, s66, v113
  v_mfma_f32_16x16x32_bf16 v[176:179], a[104:107], a[216:219], v[176:179]
  ds_read_b128 a[136:139], v121 offset:8192
  v_cndmask_b32 v203, 0, v203, vcc
  v_mfma_f32_16x16x32_bf16 v[176:179], a[108:111], a[220:223], v[176:179]
  buffer_load_dwordx4 a[84:87], v108, s[20:23], s38 offen offset:3072 sc1
  v_mfma_f32_16x16x32_bf16 v[176:179], a[112:115], a[224:227], v[176:179]
  ds_read_b128 a[140:143], v121 offset:17408
  v_cvt_pk_bf16_f32 v200, v200, v201
  v_mfma_f32_16x16x32_bf16 v[176:179], a[116:119], a[228:231], v[176:179]
  v_cvt_pk_bf16_f32 v201, v202, v203
  v_mfma_f32_16x16x32_bf16 v[180:183], a[104:107], a[232:235], v[180:183]
  ds_read_b128 a[144:147], v121 offset:26624
  s_add_u32 s38, s38, 4096
  v_mfma_f32_16x16x32_bf16 v[180:183], a[108:111], a[236:239], v[180:183]
  buffer_load_dwordx4 a[88:91], v108, s[20:23], s39 offen offset:0 sc1
  v_mfma_f32_16x16x32_bf16 v[180:183], a[112:115], a[240:243], v[180:183]
  s_waitcnt lgkmcnt(3)
  ds_read_b128 a[148:151], v121 offset:35840
  v_mfma_f32_16x16x32_bf16 v[180:183], a[116:119], a[244:247], v[180:183]
  v_mfma_f32_16x16x32_bf16 v[184:187], a[120:123], a[216:219], v[184:187]
  s_barrier
  v_mfma_f32_16x16x32_bf16 v[184:187], a[124:127], a[220:223], v[184:187]
  ds_read_b128 a[104:107], v122 offset:0
  v_mfma_f32_16x16x32_bf16 v[184:187], a[128:131], a[224:227], v[184:187]
  buffer_load_dwordx4 a[92:95], v108, s[20:23], s39 offen offset:1024 sc1
  v_mfma_f32_16x16x32_bf16 v[184:187], a[132:135], a[228:231], v[184:187]
  ds_read_b128 a[108:111], v122 offset:9216
  v_mfma_f32_16x16x32_bf16 v[188:191], a[120:123], a[232:235], v[188:191]
  buffer_load_dwordx4 a[96:99], v108, s[20:23], s39 offen offset:2048 sc1
  v_mfma_f32_16x16x32_bf16 v[188:191], a[124:127], a[236:239], v[188:191]
  ds_read_b128 a[112:115], v122 offset:18432
  v_mfma_f32_16x16x32_bf16 v[188:191], a[128:131], a[240:243], v[188:191]
  v_mfma_f32_16x16x32_bf16 v[188:191], a[132:135], a[244:247], v[188:191]
  ds_read_b128 a[116:119], v122 offset:27648
  s_waitcnt lgkmcnt(4)
  v_mfma_f32_16x16x32_bf16 v[192:195], a[136:139], a[216:219], v[192:195]
  ds_read_b128 a[120:123], v122 offset:1024
  v_mfma_f32_16x16x32_bf16 v[192:195], a[140:143], a[220:223], v[192:195]
  buffer_load_dwordx4 a[100:103], v108, s[20:23], s39 offen offset:3072 sc1
  v_mfma_f32_16x16x32_bf16 v[192:195], a[144:147], a[224:227], v[192:195]
  ds_read_b128 a[124:127], v122 offset:10240
  v_mfma_f32_16x16x32_bf16 v[192:195], a[148:151], a[228:231], v[192:195]
  s_add_u32 s39, s39, 4096
  v_mfma_f32_16x16x32_bf16 v[196:199], a[136:139], a[232:235], v[196:199]
  ds_read_b128 a[128:131], v122 offset:19456
  v_mfma_f32_16x16x32_bf16 v[196:199], a[140:143], a[236:239], v[196:199]
  buffer_store_dwordx2 v[200:201], v112, s[32:35], s43 offen sc1
  v_mfma_f32_16x16x32_bf16 v[196:199], a[144:147], a[240:243], v[196:199]
  s_waitcnt vmcnt(19) lgkmcnt(3)
  ds_read_b128 a[132:135], v122 offset:28672
  v_mfma_f32_16x16x32_bf16 v[196:199], a[148:151], a[244:247], v[196:199]
  v_mfma_f32_16x16x32_bf16 v[128:131], a[104:107], a[40:43], v[128:131]
  ds_read_b128 a[136:139], v122 offset:2048
  v_mov_b32 v208, s48
  v_mfma_f32_16x16x32_bf16 v[128:131], a[108:111], a[44:47], v[128:131]
  v_mov_b32 v209, s49
  v_lshlrev_b32 v254, 3, v255
  v_mfma_f32_16x16x32_bf16 v[128:131], a[112:115], a[48:51], v[128:131]
  ds_read_b128 a[140:143], v122 offset:11264
  v_min_u32 v255, 1, v255
  v_mfma_f32_16x16x32_bf16 v[128:131], a[116:119], a[52:55], v[128:131]
  v_lshl_add_u32 v255, v255, 1, 4
  v_add_u32 v255, s49, v255
  v_mfma_f32_16x16x32_bf16 v[132:135], a[104:107], a[56:59], v[132:135]
  ds_read_b128 a[144:147], v122 offset:20480
  s_barrier
  v_mfma_f32_16x16x32_bf16 v[132:135], a[108:111], a[60:63], v[132:135]
  s_add_u32 m0, s96, 36864
  v_and_b32 v1, 31, v0
  v_mfma_f32_16x16x32_bf16 v[132:135], a[112:115], a[64:67], v[132:135]
  s_waitcnt lgkmcnt(3)
  ds_read_b128 a[148:151], v122 offset:29696
  v_mfma_f32_16x16x32_bf16 v[132:135], a[116:119], a[68:71], v[132:135]
  buffer_load_dwordx4 v108, s[20:23], s36 offen offset:0 sc1 lds
  v_mfma_f32_16x16x32_bf16 v[136:139], a[120:123], a[40:43], v[136:139]
  ds_read_b128 a[104:107], v122 offset:3072
  v_mul_u32_u24 v1, 1152, v1
  v_mfma_f32_16x16x32_bf16 v[136:139], a[124:127], a[44:47], v[136:139]
  buffer_load_dwordx4 v108, s[20:23], s36 offen offset:1024 sc1 lds
  v_mfma_f32_16x16x32_bf16 v[136:139], a[128:131], a[48:51], v[136:139]
  ds_read_b128 a[108:111], v122 offset:12288
  v_bfe_u32 v2, v0, 5, 1
  v_mfma_f32_16x16x32_bf16 v[136:139], a[132:135], a[52:55], v[136:139]
  v_lshl_add_u32 v1, v2, 4, v1
  v_add_u32 v2, s44, v1
  v_mfma_f32_16x16x32_bf16 v[140:143], a[120:123], a[56:59], v[140:143]
  ds_read_b128 a[112:115], v122 offset:21504
  s_lshl_b32 s68, s56, 5
  v_mfma_f32_16x16x32_bf16 v[140:143], a[124:127], a[60:63], v[140:143]
  buffer_load_dwordx4 v108, s[20:23], s36 offen offset:2048 sc1 lds
  v_mfma_f32_16x16x32_bf16 v[140:143], a[128:131], a[64:67], v[140:143]
  s_waitcnt lgkmcnt(3)
  ds_read_b128 a[116:119], v122 offset:30720
  v_mfma_f32_16x16x32_bf16 v[140:143], a[132:135], a[68:71], v[140:143]
  v_add_u32 v1, s68, v2
  s_mul_i32 s69, s61, 9216
  v_mfma_f32_16x16x32_bf16 v[144:147], a[136:139], a[40:43], v[144:147]
  ds_read_b128 a[120:123], v122 offset:4096
  s_add_u32 s51, s69, 31268864
  v_mfma_f32_16x16x32_bf16 v[144:147], a[140:143], a[44:47], v[144:147]
  buffer_load_dwordx4 v108, s[20:23], s36 offen offset:3072 sc1 lds
  v_mfma_f32_16x16x32_bf16 v[144:147], a[144:147], a[48:51], v[144:147]
  ds_read_b128 a[124:127], v122 offset:13312
  s_lshl_b32 s68, s56, 10
  v_mfma_f32_16x16x32_bf16 v[144:147], a[148:151], a[52:55], v[144:147]
  s_add_u32 m0, s96, 40960
  s_add_u32 s69, s69, s68
  v_mfma_f32_16x16x32_bf16 v[148:151], a[136:139], a[56:59], v[148:151]
  ds_read_b128 a[128:131], v122 offset:22528
  s_add_u32 s50, s69, 31260672
  v_mfma_f32_16x16x32_bf16 v[148:151], a[140:143], a[60:63], v[148:151]
  buffer_load_dwordx4 v3, s[20:23], s36 offen offset:0 sc1 lds
  v_mfma_f32_16x16x32_bf16 v[148:151], a[144:147], a[64:67], v[148:151]
  s_waitcnt lgkmcnt(3)
  ds_read_b128 a[132:135], v122 offset:31744
  v_mfma_f32_16x16x32_bf16 v[148:151], a[148:151], a[68:71], v[148:151]
  s_and_b32 s68, s2, 0xfc
  s_add_u32 s68, s68, s56
  v_mfma_f32_16x16x32_bf16 v[152:155], a[104:107], a[40:43], v[152:155]
  ds_read_b128 a[136:139], v122 offset:5120
  s_lshl_b32 s69, s68, 4
  v_mfma_f32_16x16x32_bf16 v[152:155], a[108:111], a[44:47], v[152:155]
  buffer_load_dwordx4 v3, s[20:23], s36 offen offset:1024 sc1 lds
  v_mfma_f32_16x16x32_bf16 v[152:155], a[112:115], a[48:51], v[152:155]
  ds_read_b128 a[140:143], v122 offset:14336
  s_add_u32 s69, s69, s60
  v_mfma_f32_16x16x32_bf16 v[152:155], a[116:119], a[52:55], v[152:155]
  s_lshl_b32 s69, s69, 3
  s_add_u32 s77, s69, 41476096
  v_mfma_f32_16x16x32_bf16 v[156:159], a[104:107], a[56:59], v[156:159]
  ds_read_b128 a[144:147], v122 offset:23552
  s_lshl_b32 s68, s68, 2
  v_mfma_f32_16x16x32_bf16 v[156:159], a[108:111], a[60:63], v[156:159]
  buffer_load_dwordx4 v3, s[20:23], s36 offen offset:2048 sc1 lds
  v_mfma_f32_16x16x32_bf16 v[156:159], a[112:115], a[64:67], v[156:159]
  s_waitcnt lgkmcnt(3)
  ds_read_b128 a[148:151], v122 offset:32768
  v_mfma_f32_16x16x32_bf16 v[156:159], a[116:119], a[68:71], v[156:159]
  s_add_u32 s68, s68, s60
  s_mul_i32 s68, s68, 9216
  v_mfma_f32_16x16x32_bf16 v[160:163], a[120:123], a[40:43], v[160:163]
  ds_read_b128 a[104:107], v122 offset:6144
  s_add_u32 s76, s68, 32034816
  v_mfma_f32_16x16x32_bf16 v[160:163], a[124:127], a[44:47], v[160:163]
  buffer_load_dwordx4 v3, s[20:23], s36 offen offset:3072 sc1 lds
  v_mfma_f32_16x16x32_bf16 v[160:163], a[128:131], a[48:51], v[160:163]
  ds_read_b128 a[108:111], v122 offset:15360
  s_cmp_eq_u32 s56, s60
  s_cselect_b32 s14, 0, 41517056
  v_mfma_f32_16x16x32_bf16 v[160:163], a[132:135], a[52:55], v[160:163]
  s_add_u32 m0, s96, 45056
  s_add_u32 s78, s60, 1
  v_mfma_f32_16x16x32_bf16 v[164:167], a[120:123], a[56:59], v[164:167]
  ds_read_b128 a[112:115], v122 offset:24576
  s_and_b32 s78, s78, 3
  v_mfma_f32_16x16x32_bf16 v[164:167], a[124:127], a[60:63], v[164:167]
  buffer_load_dwordx4 v111, s[20:23], s36 offen offset:0 sc1 lds
  v_mfma_f32_16x16x32_bf16 v[164:167], a[128:131], a[64:67], v[164:167]
  s_waitcnt lgkmcnt(3)
  ds_read_b128 a[116:119], v122 offset:33792
  v_mfma_f32_16x16x32_bf16 v[164:167], a[132:135], a[68:71], v[164:167]
  s_add_u32 s36, s36, 36864
  v_mfma_f32_16x16x32_bf16 v[168:171], a[136:139], a[40:43], v[168:171]
  ds_read_b128 a[120:123], v122 offset:7168
  v_mfma_f32_16x16x32_bf16 v[168:171], a[140:143], a[44:47], v[168:171]
  buffer_load_dwordx4 a[184:187], v108, s[20:23], s38 offen offset:0 sc1
  v_mfma_f32_16x16x32_bf16 v[168:171], a[144:147], a[48:51], v[168:171]
  ds_read_b128 a[124:127], v122 offset:16384
  v_mfma_f32_16x16x32_bf16 v[168:171], a[148:151], a[52:55], v[168:171]
  v_mfma_f32_16x16x32_bf16 v[172:175], a[136:139], a[56:59], v[172:175]
  ds_read_b128 a[128:131], v122 offset:25600
  v_mfma_f32_16x16x32_bf16 v[172:175], a[140:143], a[60:63], v[172:175]
  buffer_load_dwordx4 a[188:191], v108, s[20:23], s38 offen offset:1024 sc1
  v_mfma_f32_16x16x32_bf16 v[172:175], a[144:147], a[64:67], v[172:175]
  s_waitcnt lgkmcnt(3)
  ds_read_b128 a[132:135], v122 offset:34816
  v_mfma_f32_16x16x32_bf16 v[172:175], a[148:151], a[68:71], v[172:175]
  v_mfma_f32_16x16x32_bf16 v[176:179], a[104:107], a[40:43], v[176:179]
  ds_read_b128 a[136:139], v122 offset:8192
  v_mfma_f32_16x16x32_bf16 v[176:179], a[108:111], a[44:47], v[176:179]
  buffer_load_dwordx4 a[192:195], v108, s[20:23], s38 offen offset:2048 sc1
  v_mfma_f32_16x16x32_bf16 v[176:179], a[112:115], a[48:51], v[176:179]
  ds_read_b128 a[140:143], v122 offset:17408
  v_mfma_f32_16x16x32_bf16 v[176:179], a[116:119], a[52:55], v[176:179]
  v_mfma_f32_16x16x32_bf16 v[180:183], a[104:107], a[56:59], v[180:183]
  ds_read_b128 a[144:147], v122 offset:26624
  v_mfma_f32_16x16x32_bf16 v[180:183], a[108:111], a[60:63], v[180:183]
  buffer_load_dwordx4 a[196:199], v108, s[20:23], s38 offen offset:3072 sc1
  s_waitcnt vmcnt(31)
  v_mfma_f32_16x16x32_bf16 v[180:183], a[112:115], a[64:67], v[180:183]
  s_waitcnt lgkmcnt(3)
  ds_read_b128 a[148:151], v122 offset:35840
  v_mfma_f32_16x16x32_bf16 v[180:183], a[116:119], a[68:71], v[180:183]
  s_add_u32 s38, s38, 4096
  v_mfma_f32_16x16x32_bf16 v[184:187], a[120:123], a[40:43], v[184:187]
  s_barrier
  v_mfma_f32_16x16x32_bf16 v[184:187], a[124:127], a[44:47], v[184:187]
  ds_read_b128 a[104:107], v123 offset:0
  v_mfma_f32_16x16x32_bf16 v[184:187], a[128:131], a[48:51], v[184:187]
  buffer_load_dwordx4 a[200:203], v108, s[20:23], s39 offen offset:0 sc1
  v_add_u32 v125, 1, v125
  v_mfma_f32_16x16x32_bf16 v[184:187], a[132:135], a[52:55], v[184:187]
  ds_read_b128 a[108:111], v123 offset:9216
  buffer_store_dwordx2 v[124:125], v126, s[20:23], s86 offen sc1
  v_mfma_f32_16x16x32_bf16 v[188:191], a[120:123], a[56:59], v[188:191]
  buffer_load_dwordx4 a[204:207], v108, s[20:23], s39 offen offset:1024 sc1
  v_mfma_f32_16x16x32_bf16 v[188:191], a[124:127], a[60:63], v[188:191]
  ds_read_b128 a[112:115], v123 offset:18432
  v_mfma_f32_16x16x32_bf16 v[188:191], a[128:131], a[64:67], v[188:191]
  v_mfma_f32_16x16x32_bf16 v[188:191], a[132:135], a[68:71], v[188:191]
  ds_read_b128 a[116:119], v123 offset:27648
  s_waitcnt lgkmcnt(4)
  v_mfma_f32_16x16x32_bf16 v[192:195], a[136:139], a[40:43], v[192:195]
  ds_read_b128 a[120:123], v123 offset:1024
  v_mfma_f32_16x16x32_bf16 v[192:195], a[140:143], a[44:47], v[192:195]
  buffer_load_dwordx4 a[208:211], v108, s[20:23], s39 offen offset:2048 sc1
  v_mfma_f32_16x16x32_bf16 v[192:195], a[144:147], a[48:51], v[192:195]
  ds_read_b128 a[124:127], v123 offset:10240
  v_mfma_f32_16x16x32_bf16 v[192:195], a[148:151], a[52:55], v[192:195]
  v_mfma_f32_16x16x32_bf16 v[196:199], a[136:139], a[56:59], v[196:199]
  ds_read_b128 a[128:131], v123 offset:19456
  v_mfma_f32_16x16x32_bf16 v[196:199], a[140:143], a[60:63], v[196:199]
  buffer_load_dwordx4 a[212:215], v108, s[20:23], s39 offen offset:3072 sc1
  v_mfma_f32_16x16x32_bf16 v[196:199], a[144:147], a[64:67], v[196:199]
  s_waitcnt vmcnt(19) lgkmcnt(3)
  ds_read_b128 a[132:135], v123 offset:28672
  v_mfma_f32_16x16x32_bf16 v[196:199], a[148:151], a[68:71], v[196:199]
  s_add_u32 s39, s39, 4096
  v_mfma_f32_16x16x32_bf16 v[128:131], a[104:107], a[72:75], v[128:131]
  ds_read_b128 a[136:139], v123 offset:2048
  v_mfma_f32_16x16x32_bf16 v[128:131], a[108:111], a[76:79], v[128:131]
  v_mfma_f32_16x16x32_bf16 v[128:131], a[112:115], a[80:83], v[128:131]
  ds_read_b128 a[140:143], v123 offset:11264
  v_mfma_f32_16x16x32_bf16 v[128:131], a[116:119], a[84:87], v[128:131]
  s_waitcnt vmcnt(18)
  v_mfma_f32_16x16x32_bf16 v[132:135], a[104:107], a[88:91], v[132:135]
  ds_read_b128 a[144:147], v123 offset:20480
  s_barrier
  v_mfma_f32_16x16x32_bf16 v[132:135], a[108:111], a[92:95], v[132:135]
  s_add_u32 m0, s96, 73728
  buffer_store_dwordx2 v[208:209], v126, s[32:35], s97 offen sc1
  v_mfma_f32_16x16x32_bf16 v[132:135], a[112:115], a[96:99], v[132:135]
  s_waitcnt lgkmcnt(3)
  ds_read_b128 a[148:151], v123 offset:29696
  v_mfma_f32_16x16x32_bf16 v[132:135], a[116:119], a[100:103], v[132:135]
  buffer_load_dwordx4 v108, s[20:23], s36 offen offset:0 sc1 lds
  v_mfma_f32_16x16x32_bf16 v[136:139], a[120:123], a[72:75], v[136:139]
  ds_read_b128 a[104:107], v123 offset:3072
  v_mfma_f32_16x16x32_bf16 v[136:139], a[124:127], a[76:79], v[136:139]
  buffer_load_dwordx4 v108, s[20:23], s36 offen offset:1024 sc1 lds
  v_mfma_f32_16x16x32_bf16 v[136:139], a[128:131], a[80:83], v[136:139]
  ds_read_b128 a[108:111], v123 offset:12288
  v_mfma_f32_16x16x32_bf16 v[136:139], a[132:135], a[84:87], v[136:139]
  v_mfma_f32_16x16x32_bf16 v[140:143], a[120:123], a[88:91], v[140:143]
  ds_read_b128 a[112:115], v123 offset:21504
  v_mfma_f32_16x16x32_bf16 v[140:143], a[124:127], a[92:95], v[140:143]
  buffer_load_dwordx4 v108, s[20:23], s36 offen offset:2048 sc1 lds
  v_mfma_f32_16x16x32_bf16 v[140:143], a[128:131], a[96:99], v[140:143]
  s_waitcnt lgkmcnt(3)
  ds_read_b128 a[116:119], v123 offset:30720
  v_mfma_f32_16x16x32_bf16 v[140:143], a[132:135], a[100:103], v[140:143]
  v_mfma_f32_16x16x32_bf16 v[144:147], a[136:139], a[72:75], v[144:147]
  ds_read_b128 a[120:123], v123 offset:4096
  v_mfma_f32_16x16x32_bf16 v[144:147], a[140:143], a[76:79], v[144:147]
  buffer_load_dwordx4 v108, s[20:23], s36 offen offset:3072 sc1 lds
  v_mfma_f32_16x16x32_bf16 v[144:147], a[144:147], a[80:83], v[144:147]
  ds_read_b128 a[124:127], v123 offset:13312
  s_add_u32 m0, s96, 77824
  v_mfma_f32_16x16x32_bf16 v[144:147], a[148:151], a[84:87], v[144:147]
  buffer_load_dwordx4 v3, s[20:23], s36 offen offset:0 sc1 lds
  v_mfma_f32_16x16x32_bf16 v[148:151], a[136:139], a[88:91], v[148:151]
  ds_read_b128 a[128:131], v123 offset:22528
  v_mfma_f32_16x16x32_bf16 v[148:151], a[140:143], a[92:95], v[148:151]
  v_mfma_f32_16x16x32_bf16 v[148:151], a[144:147], a[96:99], v[148:151]
  s_waitcnt lgkmcnt(3)
  ds_read_b128 a[132:135], v123 offset:31744
  v_mfma_f32_16x16x32_bf16 v[148:151], a[148:151], a[100:103], v[148:151]
  buffer_load_dwordx4 v3, s[20:23], s36 offen offset:1024 sc1 lds
  v_mfma_f32_16x16x32_bf16 v[152:155], a[104:107], a[72:75], v[152:155]
  ds_read_b128 a[136:139], v123 offset:5120
  v_mfma_f32_16x16x32_bf16 v[152:155], a[108:111], a[76:79], v[152:155]
  v_mfma_f32_16x16x32_bf16 v[152:155], a[112:115], a[80:83], v[152:155]
  ds_read_b128 a[140:143], v123 offset:14336
  v_mfma_f32_16x16x32_bf16 v[152:155], a[116:119], a[84:87], v[152:155]
  buffer_load_dwordx4 v3, s[20:23], s36 offen offset:2048 sc1 lds
  v_mfma_f32_16x16x32_bf16 v[156:159], a[104:107], a[88:91], v[156:159]
  ds_read_b128 a[144:147], v123 offset:23552
  v_mfma_f32_16x16x32_bf16 v[156:159], a[108:111], a[92:95], v[156:159]
  v_mfma_f32_16x16x32_bf16 v[156:159], a[112:115], a[96:99], v[156:159]
  s_waitcnt lgkmcnt(3)
  ds_read_b128 a[148:151], v123 offset:32768
  v_mfma_f32_16x16x32_bf16 v[156:159], a[116:119], a[100:103], v[156:159]
  buffer_load_dwordx4 v3, s[20:23], s36 offen offset:3072 sc1 lds
  v_mfma_f32_16x16x32_bf16 v[160:163], a[120:123], a[72:75], v[160:163]
  ds_read_b128 a[104:107], v123 offset:6144
  v_mfma_f32_16x16x32_bf16 v[160:163], a[124:127], a[76:79], v[160:163]
  s_add_u32 m0, s96, 81920
  v_mfma_f32_16x16x32_bf16 v[160:163], a[128:131], a[80:83], v[160:163]
  ds_read_b128 a[108:111], v123 offset:15360
  v_mfma_f32_16x16x32_bf16 v[160:163], a[132:135], a[84:87], v[160:163]
  buffer_load_dwordx4 v111, s[20:23], s36 offen offset:0 sc1 lds
  v_mfma_f32_16x16x32_bf16 v[164:167], a[120:123], a[88:91], v[164:167]
  ds_read_b128 a[112:115], v123 offset:24576
  v_mfma_f32_16x16x32_bf16 v[164:167], a[124:127], a[92:95], v[164:167]
  s_add_u32 s36, s36, 36864
  v_mfma_f32_16x16x32_bf16 v[164:167], a[128:131], a[96:99], v[164:167]
  s_waitcnt lgkmcnt(3)
  ds_read_b128 a[116:119], v123 offset:33792
  v_mfma_f32_16x16x32_bf16 v[164:167], a[132:135], a[100:103], v[164:167]
  buffer_load_dwordx4 a[216:219], v108, s[20:23], s38 offen offset:0 sc1
  v_mfma_f32_16x16x32_bf16 v[168:171], a[136:139], a[72:75], v[168:171]
  ds_read_b128 a[120:123], v123 offset:7168
  v_mfma_f32_16x16x32_bf16 v[168:171], a[140:143], a[76:79], v[168:171]
  v_mfma_f32_16x16x32_bf16 v[168:171], a[144:147], a[80:83], v[168:171]
  ds_read_b128 a[124:127], v123 offset:16384
  v_mfma_f32_16x16x32_bf16 v[168:171], a[148:151], a[84:87], v[168:171]
  buffer_load_dwordx4 a[220:223], v108, s[20:23], s38 offen offset:1024 sc1
  v_mfma_f32_16x16x32_bf16 v[172:175], a[136:139], a[88:91], v[172:175]
  ds_read_b128 a[128:131], v123 offset:25600
  v_mfma_f32_16x16x32_bf16 v[172:175], a[140:143], a[92:95], v[172:175]
  buffer_load_dwordx4 a[224:227], v108, s[20:23], s38 offen offset:2048 sc1
  v_mfma_f32_16x16x32_bf16 v[172:175], a[144:147], a[96:99], v[172:175]
  s_waitcnt lgkmcnt(3)
  ds_read_b128 a[132:135], v123 offset:34816
  v_mfma_f32_16x16x32_bf16 v[172:175], a[148:151], a[100:103], v[172:175]
  v_mfma_f32_16x16x32_bf16 v[176:179], a[104:107], a[72:75], v[176:179]
  ds_read_b128 a[136:139], v123 offset:8192
  v_mfma_f32_16x16x32_bf16 v[176:179], a[108:111], a[76:79], v[176:179]
  buffer_load_dwordx4 a[228:231], v108, s[20:23], s38 offen offset:3072 sc1
  v_mfma_f32_16x16x32_bf16 v[176:179], a[112:115], a[80:83], v[176:179]
  ds_read_b128 a[140:143], v123 offset:17408
  v_mfma_f32_16x16x32_bf16 v[176:179], a[116:119], a[84:87], v[176:179]
  v_mfma_f32_16x16x32_bf16 v[180:183], a[104:107], a[88:91], v[180:183]
  ds_read_b128 a[144:147], v123 offset:26624
  s_add_u32 s38, s38, 4096
  v_mfma_f32_16x16x32_bf16 v[180:183], a[108:111], a[92:95], v[180:183]
  buffer_load_dwordx4 a[232:235], v108, s[20:23], s39 offen offset:0 sc1
  v_mfma_f32_16x16x32_bf16 v[180:183], a[112:115], a[96:99], v[180:183]
  s_waitcnt lgkmcnt(3)
  ds_read_b128 a[148:151], v123 offset:35840
  v_mfma_f32_16x16x32_bf16 v[180:183], a[116:119], a[100:103], v[180:183]
  v_mfma_f32_16x16x32_bf16 v[184:187], a[120:123], a[72:75], v[184:187]
  s_barrier
  v_mfma_f32_16x16x32_bf16 v[184:187], a[124:127], a[76:79], v[184:187]
  ds_read_b128 a[104:107], v120 offset:0
  v_mfma_f32_16x16x32_bf16 v[184:187], a[128:131], a[80:83], v[184:187]
  buffer_load_dwordx4 a[236:239], v108, s[20:23], s39 offen offset:1024 sc1
  v_mfma_f32_16x16x32_bf16 v[184:187], a[132:135], a[84:87], v[184:187]
  ds_read_b128 a[108:111], v120 offset:9216
  v_mfma_f32_16x16x32_bf16 v[188:191], a[120:123], a[88:91], v[188:191]
  buffer_load_dwordx4 a[240:243], v108, s[20:23], s39 offen offset:2048 sc1
  v_mfma_f32_16x16x32_bf16 v[188:191], a[124:127], a[92:95], v[188:191]
  ds_read_b128 a[112:115], v120 offset:18432
  v_mfma_f32_16x16x32_bf16 v[188:191], a[128:131], a[96:99], v[188:191]
  v_mfma_f32_16x16x32_bf16 v[188:191], a[132:135], a[100:103], v[188:191]
  ds_read_b128 a[116:119], v120 offset:27648
  s_waitcnt lgkmcnt(4)
  v_mfma_f32_16x16x32_bf16 v[192:195], a[136:139], a[72:75], v[192:195]
  ds_read_b128 a[120:123], v120 offset:1024
  v_mfma_f32_16x16x32_bf16 v[192:195], a[140:143], a[76:79], v[192:195]
  buffer_load_dwordx4 a[244:247], v108, s[20:23], s39 offen offset:3072 sc1
  v_mfma_f32_16x16x32_bf16 v[192:195], a[144:147], a[80:83], v[192:195]
  ds_read_b128 a[124:127], v120 offset:10240
  v_mfma_f32_16x16x32_bf16 v[192:195], a[148:151], a[84:87], v[192:195]
  s_add_u32 s39, s39, 4096
  v_mfma_f32_16x16x32_bf16 v[196:199], a[136:139], a[88:91], v[196:199]
  ds_read_b128 a[128:131], v120 offset:19456
  v_mfma_f32_16x16x32_bf16 v[196:199], a[140:143], a[92:95], v[196:199]
  buffer_load_dwordx2 v[252:253], v254, s[20:23], s87 offen sc1
  v_mfma_f32_16x16x32_bf16 v[196:199], a[144:147], a[96:99], v[196:199]
  s_waitcnt vmcnt(19) lgkmcnt(3)
  ds_read_b128 a[132:135], v120 offset:28672
  v_mfma_f32_16x16x32_bf16 v[196:199], a[148:151], a[100:103], v[196:199]
  v_mfma_f32_16x16x32_bf16 v[128:131], a[104:107], a[184:187], v[128:131]
  ds_read_b128 a[136:139], v120 offset:2048
  v_mfma_f32_16x16x32_bf16 v[128:131], a[108:111], a[188:191], v[128:131]
  v_mfma_f32_16x16x32_bf16 v[128:131], a[112:115], a[192:195], v[128:131]
  ds_read_b128 a[140:143], v120 offset:11264
  v_mfma_f32_16x16x32_bf16 v[128:131], a[116:119], a[196:199], v[128:131]
  v_mfma_f32_16x16x32_bf16 v[132:135], a[104:107], a[200:203], v[132:135]
  ds_read_b128 a[144:147], v120 offset:20480
  s_barrier
  v_mfma_f32_16x16x32_bf16 v[132:135], a[108:111], a[204:207], v[132:135]
  s_add_u32 m0, s96, 110592
  v_mfma_f32_16x16x32_bf16 v[132:135], a[112:115], a[208:211], v[132:135]
  s_waitcnt lgkmcnt(3)
  ds_read_b128 a[148:151], v120 offset:29696
  v_mfma_f32_16x16x32_bf16 v[132:135], a[116:119], a[212:215], v[132:135]
  buffer_load_dwordx4 v108, s[20:23], s36 offen offset:0 sc1 lds
  v_mfma_f32_16x16x32_bf16 v[136:139], a[120:123], a[184:187], v[136:139]
  ds_read_b128 a[104:107], v120 offset:3072
  v_mfma_f32_16x16x32_bf16 v[136:139], a[124:127], a[188:191], v[136:139]
  buffer_load_dwordx4 v108, s[20:23], s36 offen offset:1024 sc1 lds
  v_mfma_f32_16x16x32_bf16 v[136:139], a[128:131], a[192:195], v[136:139]
  ds_read_b128 a[108:111], v120 offset:12288
  v_mfma_f32_16x16x32_bf16 v[136:139], a[132:135], a[196:199], v[136:139]
  v_mfma_f32_16x16x32_bf16 v[140:143], a[120:123], a[200:203], v[140:143]
  ds_read_b128 a[112:115], v120 offset:21504
  v_mfma_f32_16x16x32_bf16 v[140:143], a[124:127], a[204:207], v[140:143]
  buffer_load_dwordx4 v108, s[20:23], s36 offen offset:2048 sc1 lds
  v_mfma_f32_16x16x32_bf16 v[140:143], a[128:131], a[208:211], v[140:143]
  s_waitcnt lgkmcnt(3)
  ds_read_b128 a[116:119], v120 offset:30720
  v_mfma_f32_16x16x32_bf16 v[140:143], a[132:135], a[212:215], v[140:143]
  v_mfma_f32_16x16x32_bf16 v[144:147], a[136:139], a[184:187], v[144:147]
  ds_read_b128 a[120:123], v120 offset:4096
  v_mfma_f32_16x16x32_bf16 v[144:147], a[140:143], a[188:191], v[144:147]
  buffer_load_dwordx4 v108, s[20:23], s36 offen offset:3072 sc1 lds
  v_mfma_f32_16x16x32_bf16 v[144:147], a[144:147], a[192:195], v[144:147]
  ds_read_b128 a[124:127], v120 offset:13312
  v_mfma_f32_16x16x32_bf16 v[144:147], a[148:151], a[196:199], v[144:147]
  s_add_u32 m0, s96, 114688
  v_mfma_f32_16x16x32_bf16 v[148:151], a[136:139], a[200:203], v[148:151]
  ds_read_b128 a[128:131], v120 offset:22528
  v_mfma_f32_16x16x32_bf16 v[148:151], a[140:143], a[204:207], v[148:151]
  buffer_load_dwordx4 v3, s[20:23], s36 offen offset:0 sc1 lds
  v_mfma_f32_16x16x32_bf16 v[148:151], a[144:147], a[208:211], v[148:151]
  s_waitcnt lgkmcnt(3)
  ds_read_b128 a[132:135], v120 offset:31744
  v_mfma_f32_16x16x32_bf16 v[148:151], a[148:151], a[212:215], v[148:151]
  v_mfma_f32_16x16x32_bf16 v[152:155], a[104:107], a[184:187], v[152:155]
  ds_read_b128 a[136:139], v120 offset:5120
  v_mfma_f32_16x16x32_bf16 v[152:155], a[108:111], a[188:191], v[152:155]
  buffer_load_dwordx4 v3, s[20:23], s36 offen offset:1024 sc1 lds
  v_mfma_f32_16x16x32_bf16 v[152:155], a[112:115], a[192:195], v[152:155]
  ds_read_b128 a[140:143], v120 offset:14336
  v_mfma_f32_16x16x32_bf16 v[152:155], a[116:119], a[196:199], v[152:155]
  v_mfma_f32_16x16x32_bf16 v[156:159], a[104:107], a[200:203], v[156:159]
  ds_read_b128 a[144:147], v120 offset:23552
  v_mfma_f32_16x16x32_bf16 v[156:159], a[108:111], a[204:207], v[156:159]
  buffer_load_dwordx4 v3, s[20:23], s36 offen offset:2048 sc1 lds
  v_mfma_f32_16x16x32_bf16 v[156:159], a[112:115], a[208:211], v[156:159]
  s_waitcnt lgkmcnt(3)
  ds_read_b128 a[148:151], v120 offset:32768
  v_mfma_f32_16x16x32_bf16 v[156:159], a[116:119], a[212:215], v[156:159]
  v_mfma_f32_16x16x32_bf16 v[160:163], a[120:123], a[184:187], v[160:163]
  ds_read_b128 a[104:107], v120 offset:6144
  v_mfma_f32_16x16x32_bf16 v[160:163], a[124:127], a[188:191], v[160:163]
  buffer_load_dwordx4 v3, s[20:23], s36 offen offset:3072 sc1 lds
  v_mfma_f32_16x16x32_bf16 v[160:163], a[128:131], a[192:195], v[160:163]
  ds_read_b128 a[108:111], v120 offset:15360
  v_mfma_f32_16x16x32_bf16 v[160:163], a[132:135], a[196:199], v[160:163]
  s_add_u32 m0, s96, 118784
  v_mfma_f32_16x16x32_bf16 v[164:167], a[120:123], a[200:203], v[164:167]
  ds_read_b128 a[112:115], v120 offset:24576
  v_mfma_f32_16x16x32_bf16 v[164:167], a[124:127], a[204:207], v[164:167]
  buffer_load_dwordx4 v111, s[20:23], s36 offen offset:0 sc1 lds
  v_mfma_f32_16x16x32_bf16 v[164:167], a[128:131], a[208:211], v[164:167]
  s_waitcnt lgkmcnt(3)
  ds_read_b128 a[116:119], v120 offset:33792
  v_mfma_f32_16x16x32_bf16 v[164:167], a[132:135], a[212:215], v[164:167]
  s_add_u32 s36, s36, 36864
  s_waitcnt vmcnt(9)
  v_xor_b32 v252, s48, v252
  v_sub_u32 v253, v253, v255
  v_lshrrev_b32 v253, 4, v253
  v_or_b32 v252, v252, v253
  v_cmp_ne_u32 vcc, 0, v252
  s_nop 0
  s_cmp_eq_u64 vcc, 0
  s_cbranch_scc0 recurrent_scan__linear_attn_block__glu_gated_bilinear__prompt_kernel_cc_w
recurrent_scan__linear_attn_block__glu_gated_bilinear__prompt_kernel_cc_d:
  v_mfma_f32_16x16x32_bf16 v[168:171], a[136:139], a[184:187], v[168:171]
  ds_read_b128 a[120:123], v120 offset:7168
  v_mfma_f32_16x16x32_bf16 v[168:171], a[140:143], a[188:191], v[168:171]
  buffer_load_dwordx4 a[40:43], v108, s[20:23], s38 offen offset:0 sc1
  v_mfma_f32_16x16x32_bf16 v[168:171], a[144:147], a[192:195], v[168:171]
  ds_read_b128 a[124:127], v120 offset:16384
  v_mfma_f32_16x16x32_bf16 v[168:171], a[148:151], a[196:199], v[168:171]
  v_mfma_f32_16x16x32_bf16 v[172:175], a[136:139], a[200:203], v[172:175]
  ds_read_b128 a[128:131], v120 offset:25600
  v_mfma_f32_16x16x32_bf16 v[172:175], a[140:143], a[204:207], v[172:175]
  buffer_load_dwordx4 a[44:47], v108, s[20:23], s38 offen offset:1024 sc1
  v_mfma_f32_16x16x32_bf16 v[172:175], a[144:147], a[208:211], v[172:175]
  s_waitcnt lgkmcnt(3)
  ds_read_b128 a[132:135], v120 offset:34816
  v_mfma_f32_16x16x32_bf16 v[172:175], a[148:151], a[212:215], v[172:175]
  v_mfma_f32_16x16x32_bf16 v[176:179], a[104:107], a[184:187], v[176:179]
  ds_read_b128 a[136:139], v120 offset:8192
  v_mfma_f32_16x16x32_bf16 v[176:179], a[108:111], a[188:191], v[176:179]
  buffer_load_dwordx4 a[48:51], v108, s[20:23], s38 offen offset:2048 sc1
  v_mfma_f32_16x16x32_bf16 v[176:179], a[112:115], a[192:195], v[176:179]
  ds_read_b128 a[140:143], v120 offset:17408
  v_mfma_f32_16x16x32_bf16 v[176:179], a[116:119], a[196:199], v[176:179]
  v_mfma_f32_16x16x32_bf16 v[180:183], a[104:107], a[200:203], v[180:183]
  ds_read_b128 a[144:147], v120 offset:26624
  v_mfma_f32_16x16x32_bf16 v[180:183], a[108:111], a[204:207], v[180:183]
  buffer_load_dwordx4 a[52:55], v108, s[20:23], s38 offen offset:3072 sc1
  v_mfma_f32_16x16x32_bf16 v[180:183], a[112:115], a[208:211], v[180:183]
  s_waitcnt lgkmcnt(3)
  ds_read_b128 a[148:151], v120 offset:35840
  v_mfma_f32_16x16x32_bf16 v[180:183], a[116:119], a[212:215], v[180:183]
  s_add_u32 s38, s38, 4096
  v_mfma_f32_16x16x32_bf16 v[184:187], a[120:123], a[184:187], v[184:187]
  s_barrier
  v_mfma_f32_16x16x32_bf16 v[184:187], a[124:127], a[188:191], v[184:187]
  ds_read_b128 a[104:107], v121 offset:0
  v_mfma_f32_16x16x32_bf16 v[184:187], a[128:131], a[192:195], v[184:187]
  buffer_load_dwordx4 a[56:59], v108, s[20:23], s39 offen offset:0 sc1
  v_mfma_f32_16x16x32_bf16 v[184:187], a[132:135], a[196:199], v[184:187]
  ds_read_b128 a[108:111], v121 offset:9216
  v_mfma_f32_16x16x32_bf16 v[188:191], a[120:123], a[200:203], v[188:191]
  buffer_load_dwordx4 a[60:63], v108, s[20:23], s39 offen offset:1024 sc1
  v_mfma_f32_16x16x32_bf16 v[188:191], a[124:127], a[204:207], v[188:191]
  ds_read_b128 a[112:115], v121 offset:18432
  v_mfma_f32_16x16x32_bf16 v[188:191], a[128:131], a[208:211], v[188:191]
  v_mfma_f32_16x16x32_bf16 v[188:191], a[132:135], a[212:215], v[188:191]
  ds_read_b128 a[116:119], v121 offset:27648
  s_waitcnt lgkmcnt(4)
  v_mfma_f32_16x16x32_bf16 v[192:195], a[136:139], a[184:187], v[192:195]
  ds_read_b128 a[120:123], v121 offset:1024
  v_mfma_f32_16x16x32_bf16 v[192:195], a[140:143], a[188:191], v[192:195]
  buffer_load_dwordx4 a[64:67], v108, s[20:23], s39 offen offset:2048 sc1
  v_mfma_f32_16x16x32_bf16 v[192:195], a[144:147], a[192:195], v[192:195]
  ds_read_b128 a[124:127], v121 offset:10240
  v_mfma_f32_16x16x32_bf16 v[192:195], a[148:151], a[196:199], v[192:195]
  v_mfma_f32_16x16x32_bf16 v[196:199], a[136:139], a[200:203], v[196:199]
  ds_read_b128 a[128:131], v121 offset:19456
  v_mfma_f32_16x16x32_bf16 v[196:199], a[140:143], a[204:207], v[196:199]
  buffer_load_dwordx4 a[68:71], v108, s[20:23], s39 offen offset:3072 sc1
  v_mfma_f32_16x16x32_bf16 v[196:199], a[144:147], a[208:211], v[196:199]
  s_waitcnt lgkmcnt(3)
  ds_read_b128 a[132:135], v121 offset:28672
  v_mfma_f32_16x16x32_bf16 v[196:199], a[148:151], a[212:215], v[196:199]
  s_add_u32 s39, s39, 4096
  v_mfma_f32_16x16x32_bf16 v[128:131], a[104:107], a[216:219], v[128:131]
  ds_read_b128 a[136:139], v121 offset:2048
  v_mfma_f32_16x16x32_bf16 v[128:131], a[108:111], a[220:223], v[128:131]
  v_mfma_f32_16x16x32_bf16 v[128:131], a[112:115], a[224:227], v[128:131]
  ds_read_b128 a[140:143], v121 offset:11264
  v_mfma_f32_16x16x32_bf16 v[128:131], a[116:119], a[228:231], v[128:131]
  v_mfma_f32_16x16x32_bf16 v[132:135], a[104:107], a[232:235], v[132:135]
  ds_read_b128 a[144:147], v121 offset:20480
  s_barrier
  v_mfma_f32_16x16x32_bf16 v[132:135], a[108:111], a[236:239], v[132:135]
  s_add_u32 m0, s96, 0
  v_mfma_f32_16x16x32_bf16 v[132:135], a[112:115], a[240:243], v[132:135]
  s_waitcnt lgkmcnt(3)
  ds_read_b128 a[148:151], v121 offset:29696
  v_mfma_f32_16x16x32_bf16 v[132:135], a[116:119], a[244:247], v[132:135]
  buffer_load_dwordx4 v108, s[20:23], s36 offen offset:0 sc1 lds
  v_mfma_f32_16x16x32_bf16 v[136:139], a[120:123], a[216:219], v[136:139]
  ds_read_b128 a[104:107], v121 offset:3072
  v_mfma_f32_16x16x32_bf16 v[136:139], a[124:127], a[220:223], v[136:139]
  buffer_load_dwordx4 v108, s[20:23], s36 offen offset:1024 sc1 lds
  v_mfma_f32_16x16x32_bf16 v[136:139], a[128:131], a[224:227], v[136:139]
  ds_read_b128 a[108:111], v121 offset:12288
  v_mfma_f32_16x16x32_bf16 v[136:139], a[132:135], a[228:231], v[136:139]
  v_mfma_f32_16x16x32_bf16 v[140:143], a[120:123], a[232:235], v[140:143]
  ds_read_b128 a[112:115], v121 offset:21504
  v_mfma_f32_16x16x32_bf16 v[140:143], a[124:127], a[236:239], v[140:143]
  buffer_load_dwordx4 v108, s[20:23], s36 offen offset:2048 sc1 lds
  v_mfma_f32_16x16x32_bf16 v[140:143], a[128:131], a[240:243], v[140:143]
  s_waitcnt lgkmcnt(3)
  ds_read_b128 a[116:119], v121 offset:30720
  v_mfma_f32_16x16x32_bf16 v[140:143], a[132:135], a[244:247], v[140:143]
  v_mfma_f32_16x16x32_bf16 v[144:147], a[136:139], a[216:219], v[144:147]
  ds_read_b128 a[120:123], v121 offset:4096
  v_mfma_f32_16x16x32_bf16 v[144:147], a[140:143], a[220:223], v[144:147]
  buffer_load_dwordx4 v108, s[20:23], s36 offen offset:3072 sc1 lds
  v_mfma_f32_16x16x32_bf16 v[144:147], a[144:147], a[224:227], v[144:147]
  ds_read_b128 a[124:127], v121 offset:13312
  v_mfma_f32_16x16x32_bf16 v[144:147], a[148:151], a[228:231], v[144:147]
  s_add_u32 m0, s96, 4096
  v_mfma_f32_16x16x32_bf16 v[148:151], a[136:139], a[232:235], v[148:151]
  ds_read_b128 a[128:131], v121 offset:22528
  v_mfma_f32_16x16x32_bf16 v[148:151], a[140:143], a[236:239], v[148:151]
  buffer_load_dwordx4 v3, s[20:23], s36 offen offset:0 sc1 lds
  v_mfma_f32_16x16x32_bf16 v[148:151], a[144:147], a[240:243], v[148:151]
  s_waitcnt lgkmcnt(3)
  ds_read_b128 a[132:135], v121 offset:31744
  v_mfma_f32_16x16x32_bf16 v[148:151], a[148:151], a[244:247], v[148:151]
  v_mfma_f32_16x16x32_bf16 v[152:155], a[104:107], a[216:219], v[152:155]
  ds_read_b128 a[136:139], v121 offset:5120
  v_mfma_f32_16x16x32_bf16 v[152:155], a[108:111], a[220:223], v[152:155]
  buffer_load_dwordx4 v3, s[20:23], s36 offen offset:1024 sc1 lds
  v_mfma_f32_16x16x32_bf16 v[152:155], a[112:115], a[224:227], v[152:155]
  ds_read_b128 a[140:143], v121 offset:14336
  v_mfma_f32_16x16x32_bf16 v[152:155], a[116:119], a[228:231], v[152:155]
  v_mfma_f32_16x16x32_bf16 v[156:159], a[104:107], a[232:235], v[156:159]
  ds_read_b128 a[144:147], v121 offset:23552
  v_mfma_f32_16x16x32_bf16 v[156:159], a[108:111], a[236:239], v[156:159]
  buffer_load_dwordx4 v3, s[20:23], s36 offen offset:2048 sc1 lds
  v_mfma_f32_16x16x32_bf16 v[156:159], a[112:115], a[240:243], v[156:159]
  s_waitcnt lgkmcnt(3)
  ds_read_b128 a[148:151], v121 offset:32768
  v_mfma_f32_16x16x32_bf16 v[156:159], a[116:119], a[244:247], v[156:159]
  v_mfma_f32_16x16x32_bf16 v[160:163], a[120:123], a[216:219], v[160:163]
  ds_read_b128 a[104:107], v121 offset:6144
  v_mfma_f32_16x16x32_bf16 v[160:163], a[124:127], a[220:223], v[160:163]
  buffer_load_dwordx4 v3, s[20:23], s36 offen offset:3072 sc1 lds
  v_mfma_f32_16x16x32_bf16 v[160:163], a[128:131], a[224:227], v[160:163]
  ds_read_b128 a[108:111], v121 offset:15360
  v_mfma_f32_16x16x32_bf16 v[160:163], a[132:135], a[228:231], v[160:163]
  s_add_u32 m0, s96, 8192
  v_mfma_f32_16x16x32_bf16 v[164:167], a[120:123], a[232:235], v[164:167]
  ds_read_b128 a[112:115], v121 offset:24576
  v_mfma_f32_16x16x32_bf16 v[164:167], a[124:127], a[236:239], v[164:167]
  buffer_load_dwordx4 v111, s[20:23], s36 offen offset:0 sc1 lds
  v_mfma_f32_16x16x32_bf16 v[164:167], a[128:131], a[240:243], v[164:167]
  s_waitcnt lgkmcnt(3)
  ds_read_b128 a[116:119], v121 offset:33792
  v_mfma_f32_16x16x32_bf16 v[164:167], a[132:135], a[244:247], v[164:167]
  s_add_u32 s36, s36, 36864
  v_mfma_f32_16x16x32_bf16 v[168:171], a[136:139], a[216:219], v[168:171]
  ds_read_b128 a[120:123], v121 offset:7168
  v_mfma_f32_16x16x32_bf16 v[168:171], a[140:143], a[220:223], v[168:171]
  buffer_load_dwordx4 a[72:75], v108, s[20:23], s38 offen offset:0 sc1
  v_mfma_f32_16x16x32_bf16 v[168:171], a[144:147], a[224:227], v[168:171]
  ds_read_b128 a[124:127], v121 offset:16384
  v_and_b32 v254, 63, v0
  v_mfma_f32_16x16x32_bf16 v[168:171], a[148:151], a[228:231], v[168:171]
  v_min_u32 v254, 53, v254
  v_lshlrev_b32 v254, 3, v254
  v_mfma_f32_16x16x32_bf16 v[172:175], a[136:139], a[232:235], v[172:175]
  ds_read_b128 a[128:131], v121 offset:25600
  s_mul_i32 s79, s56, 432
  v_mfma_f32_16x16x32_bf16 v[172:175], a[140:143], a[236:239], v[172:175]
  buffer_load_dwordx4 a[76:79], v108, s[20:23], s38 offen offset:1024 sc1
  v_mfma_f32_16x16x32_bf16 v[172:175], a[144:147], a[240:243], v[172:175]
  s_waitcnt lgkmcnt(3)
  ds_read_b128 a[132:135], v121 offset:34816
  v_mfma_f32_16x16x32_bf16 v[172:175], a[148:151], a[244:247], v[172:175]
  s_add_u32 s79, s79, 41474048
  v_mfma_f32_16x16x32_bf16 v[176:179], a[104:107], a[216:219], v[176:179]
  ds_read_b128 a[136:139], v121 offset:8192
  v_mfma_f32_16x16x32_bf16 v[176:179], a[108:111], a[220:223], v[176:179]
  buffer_load_dwordx4 a[80:83], v108, s[20:23], s38 offen offset:2048 sc1
  v_mfma_f32_16x16x32_bf16 v[176:179], a[112:115], a[224:227], v[176:179]
  ds_read_b128 a[140:143], v121 offset:17408
  v_mfma_f32_16x16x32_bf16 v[176:179], a[116:119], a[228:231], v[176:179]
  v_mfma_f32_16x16x32_bf16 v[180:183], a[104:107], a[232:235], v[180:183]
  ds_read_b128 a[144:147], v121 offset:26624
  v_mfma_f32_16x16x32_bf16 v[180:183], a[108:111], a[236:239], v[180:183]
  buffer_load_dwordx4 a[84:87], v108, s[20:23], s38 offen offset:3072 sc1
  v_mfma_f32_16x16x32_bf16 v[180:183], a[112:115], a[240:243], v[180:183]
  s_waitcnt lgkmcnt(3)
  ds_read_b128 a[148:151], v121 offset:35840
  v_mfma_f32_16x16x32_bf16 v[180:183], a[116:119], a[244:247], v[180:183]
  s_add_u32 s38, s38, 4096
  v_mfma_f32_16x16x32_bf16 v[184:187], a[120:123], a[216:219], v[184:187]
  s_barrier
  v_mfma_f32_16x16x32_bf16 v[184:187], a[124:127], a[220:223], v[184:187]
  ds_read_b128 a[104:107], v122 offset:0
  v_mfma_f32_16x16x32_bf16 v[184:187], a[128:131], a[224:227], v[184:187]
  buffer_load_dwordx4 a[88:91], v108, s[20:23], s39 offen offset:0 sc1
  v_mfma_f32_16x16x32_bf16 v[184:187], a[132:135], a[228:231], v[184:187]
  ds_read_b128 a[108:111], v122 offset:9216
  v_mfma_f32_16x16x32_bf16 v[188:191], a[120:123], a[232:235], v[188:191]
  buffer_load_dwordx4 a[92:95], v108, s[20:23], s39 offen offset:1024 sc1
  v_mfma_f32_16x16x32_bf16 v[188:191], a[124:127], a[236:239], v[188:191]
  ds_read_b128 a[112:115], v122 offset:18432
  v_mfma_f32_16x16x32_bf16 v[188:191], a[128:131], a[240:243], v[188:191]
  v_mfma_f32_16x16x32_bf16 v[188:191], a[132:135], a[244:247], v[188:191]
  ds_read_b128 a[116:119], v122 offset:27648
  s_waitcnt lgkmcnt(4)
  v_mfma_f32_16x16x32_bf16 v[192:195], a[136:139], a[216:219], v[192:195]
  ds_read_b128 a[120:123], v122 offset:1024
  v_mfma_f32_16x16x32_bf16 v[192:195], a[140:143], a[220:223], v[192:195]
  buffer_load_dwordx4 a[96:99], v108, s[20:23], s39 offen offset:2048 sc1
  v_mfma_f32_16x16x32_bf16 v[192:195], a[144:147], a[224:227], v[192:195]
  ds_read_b128 a[124:127], v122 offset:10240
  v_mfma_f32_16x16x32_bf16 v[192:195], a[148:151], a[228:231], v[192:195]
  v_mfma_f32_16x16x32_bf16 v[196:199], a[136:139], a[232:235], v[196:199]
  ds_read_b128 a[128:131], v122 offset:19456
  v_mfma_f32_16x16x32_bf16 v[196:199], a[140:143], a[236:239], v[196:199]
  buffer_load_dwordx4 a[100:103], v108, s[20:23], s39 offen offset:3072 sc1
  v_mfma_f32_16x16x32_bf16 v[196:199], a[144:147], a[240:243], v[196:199]
  s_waitcnt vmcnt(17) lgkmcnt(3)
  ds_read_b128 a[132:135], v122 offset:28672
  v_mfma_f32_16x16x32_bf16 v[196:199], a[148:151], a[244:247], v[196:199]
  s_add_u32 s39, s39, 4096
  v_mfma_f32_16x16x32_bf16 v[128:131], a[104:107], a[40:43], v[128:131]
  ds_read_b128 a[136:139], v122 offset:2048
  v_mfma_f32_16x16x32_bf16 v[128:131], a[108:111], a[44:47], v[128:131]
  buffer_load_dwordx2 v[252:253], v254, s[20:23], s79 offen sc1
  v_mfma_f32_16x16x32_bf16 v[128:131], a[112:115], a[48:51], v[128:131]
  ds_read_b128 a[140:143], v122 offset:11264
  v_mfma_f32_16x16x32_bf16 v[128:131], a[116:119], a[52:55], v[128:131]
  buffer_load_dwordx4 a[184:187], v108, s[20:23], s38 offen offset:0 sc1
  v_mfma_f32_16x16x32_bf16 v[132:135], a[104:107], a[56:59], v[132:135]
  ds_read_b128 a[144:147], v122 offset:20480
  v_mfma_f32_16x16x32_bf16 v[132:135], a[108:111], a[60:63], v[132:135]
  v_mfma_f32_16x16x32_bf16 v[132:135], a[112:115], a[64:67], v[132:135]
  s_waitcnt lgkmcnt(3)
  ds_read_b128 a[148:151], v122 offset:29696
  v_mfma_f32_16x16x32_bf16 v[132:135], a[116:119], a[68:71], v[132:135]
  buffer_load_dwordx4 a[188:191], v108, s[20:23], s38 offen offset:1024 sc1
  v_mfma_f32_16x16x32_bf16 v[136:139], a[120:123], a[40:43], v[136:139]
  ds_read_b128 a[104:107], v122 offset:3072
  v_mfma_f32_16x16x32_bf16 v[136:139], a[124:127], a[44:47], v[136:139]
  v_mfma_f32_16x16x32_bf16 v[136:139], a[128:131], a[48:51], v[136:139]
  ds_read_b128 a[108:111], v122 offset:12288
  v_mfma_f32_16x16x32_bf16 v[136:139], a[132:135], a[52:55], v[136:139]
  buffer_load_dwordx4 a[192:195], v108, s[20:23], s38 offen offset:2048 sc1
  v_mfma_f32_16x16x32_bf16 v[140:143], a[120:123], a[56:59], v[140:143]
  ds_read_b128 a[112:115], v122 offset:21504
  v_mfma_f32_16x16x32_bf16 v[140:143], a[124:127], a[60:63], v[140:143]
  v_mfma_f32_16x16x32_bf16 v[140:143], a[128:131], a[64:67], v[140:143]
  s_waitcnt lgkmcnt(3)
  ds_read_b128 a[116:119], v122 offset:30720
  v_mfma_f32_16x16x32_bf16 v[140:143], a[132:135], a[68:71], v[140:143]
  buffer_load_dwordx4 a[196:199], v108, s[20:23], s38 offen offset:3072 sc1
  v_mfma_f32_16x16x32_bf16 v[144:147], a[136:139], a[40:43], v[144:147]
  ds_read_b128 a[120:123], v122 offset:4096
  v_mfma_f32_16x16x32_bf16 v[144:147], a[140:143], a[44:47], v[144:147]
  s_add_u32 s38, s38, 4096
  v_mfma_f32_16x16x32_bf16 v[144:147], a[144:147], a[48:51], v[144:147]
  ds_read_b128 a[124:127], v122 offset:13312
  v_mfma_f32_16x16x32_bf16 v[144:147], a[148:151], a[52:55], v[144:147]
  buffer_load_dwordx4 a[200:203], v108, s[20:23], s39 offen offset:0 sc1
  v_mfma_f32_16x16x32_bf16 v[148:151], a[136:139], a[56:59], v[148:151]
  ds_read_b128 a[128:131], v122 offset:22528
  v_mfma_f32_16x16x32_bf16 v[148:151], a[140:143], a[60:63], v[148:151]
  v_mfma_f32_16x16x32_bf16 v[148:151], a[144:147], a[64:67], v[148:151]
  s_waitcnt lgkmcnt(3)
  ds_read_b128 a[132:135], v122 offset:31744
  v_mfma_f32_16x16x32_bf16 v[148:151], a[148:151], a[68:71], v[148:151]
  buffer_load_dwordx4 a[204:207], v108, s[20:23], s39 offen offset:1024 sc1
  v_mfma_f32_16x16x32_bf16 v[152:155], a[104:107], a[40:43], v[152:155]
  ds_read_b128 a[136:139], v122 offset:5120
  v_mfma_f32_16x16x32_bf16 v[152:155], a[108:111], a[44:47], v[152:155]
  v_mfma_f32_16x16x32_bf16 v[152:155], a[112:115], a[48:51], v[152:155]
  ds_read_b128 a[140:143], v122 offset:14336
  v_mfma_f32_16x16x32_bf16 v[152:155], a[116:119], a[52:55], v[152:155]
  buffer_load_dwordx4 a[208:211], v108, s[20:23], s39 offen offset:2048 sc1
  v_mfma_f32_16x16x32_bf16 v[156:159], a[104:107], a[56:59], v[156:159]
  ds_read_b128 a[144:147], v122 offset:23552
  v_mfma_f32_16x16x32_bf16 v[156:159], a[108:111], a[60:63], v[156:159]
  v_mfma_f32_16x16x32_bf16 v[156:159], a[112:115], a[64:67], v[156:159]
  s_waitcnt lgkmcnt(3)
  ds_read_b128 a[148:151], v122 offset:32768
  v_mfma_f32_16x16x32_bf16 v[156:159], a[116:119], a[68:71], v[156:159]
  buffer_load_dwordx4 a[212:215], v108, s[20:23], s39 offen offset:3072 sc1
  v_mfma_f32_16x16x32_bf16 v[160:163], a[120:123], a[40:43], v[160:163]
  ds_read_b128 a[104:107], v122 offset:6144
  v_mfma_f32_16x16x32_bf16 v[160:163], a[124:127], a[44:47], v[160:163]
  s_add_u32 s39, s39, 4096
  v_mfma_f32_16x16x32_bf16 v[160:163], a[128:131], a[48:51], v[160:163]
  ds_read_b128 a[108:111], v122 offset:15360
  v_mfma_f32_16x16x32_bf16 v[160:163], a[132:135], a[52:55], v[160:163]
  buffer_load_dwordx4 v[212:215], v108, s[20:23], s74 offen offset:0 sc1
  v_mfma_f32_16x16x32_bf16 v[164:167], a[120:123], a[56:59], v[164:167]
  ds_read_b128 a[112:115], v122 offset:24576
  v_mfma_f32_16x16x32_bf16 v[164:167], a[124:127], a[60:63], v[164:167]
  buffer_load_dwordx4 v[216:219], v108, s[20:23], s74 offen offset:1024 sc1
  v_mfma_f32_16x16x32_bf16 v[164:167], a[128:131], a[64:67], v[164:167]
  s_waitcnt lgkmcnt(3)
  ds_read_b128 a[116:119], v122 offset:33792
  v_mfma_f32_16x16x32_bf16 v[164:167], a[132:135], a[68:71], v[164:167]
  v_mfma_f32_16x16x32_bf16 v[168:171], a[136:139], a[40:43], v[168:171]
  ds_read_b128 a[120:123], v122 offset:7168
  v_mfma_f32_16x16x32_bf16 v[168:171], a[140:143], a[44:47], v[168:171]
  buffer_load_dwordx4 v[220:223], v108, s[20:23], s74 offen offset:2048 sc1
  v_mfma_f32_16x16x32_bf16 v[168:171], a[144:147], a[48:51], v[168:171]
  ds_read_b128 a[124:127], v122 offset:16384
  v_mfma_f32_16x16x32_bf16 v[168:171], a[148:151], a[52:55], v[168:171]
  v_mfma_f32_16x16x32_bf16 v[172:175], a[136:139], a[56:59], v[172:175]
  ds_read_b128 a[128:131], v122 offset:25600
  v_mfma_f32_16x16x32_bf16 v[172:175], a[140:143], a[60:63], v[172:175]
  buffer_load_dwordx4 v[224:227], v108, s[20:23], s74 offen offset:3072 sc1
  v_mfma_f32_16x16x32_bf16 v[172:175], a[144:147], a[64:67], v[172:175]
  s_waitcnt lgkmcnt(3)
  ds_read_b128 a[132:135], v122 offset:34816
  v_mfma_f32_16x16x32_bf16 v[172:175], a[148:151], a[68:71], v[172:175]
  v_mfma_f32_16x16x32_bf16 v[176:179], a[104:107], a[40:43], v[176:179]
  ds_read_b128 a[136:139], v122 offset:8192
  v_mfma_f32_16x16x32_bf16 v[176:179], a[108:111], a[44:47], v[176:179]
  buffer_load_dwordx4 v[228:231], v3, s[20:23], s74 offen offset:0 sc1
  v_mfma_f32_16x16x32_bf16 v[176:179], a[112:115], a[48:51], v[176:179]
  ds_read_b128 a[140:143], v122 offset:17408
  v_mfma_f32_16x16x32_bf16 v[176:179], a[116:119], a[52:55], v[176:179]
  v_mfma_f32_16x16x32_bf16 v[180:183], a[104:107], a[56:59], v[180:183]
  ds_read_b128 a[144:147], v122 offset:26624
  v_mfma_f32_16x16x32_bf16 v[180:183], a[108:111], a[60:63], v[180:183]
  buffer_load_dwordx4 v[232:235], v108, s[20:23], s75 offen offset:0 sc1
  v_mfma_f32_16x16x32_bf16 v[180:183], a[112:115], a[64:67], v[180:183]
  s_waitcnt lgkmcnt(3)
  ds_read_b128 a[148:151], v122 offset:35840
  v_mfma_f32_16x16x32_bf16 v[180:183], a[116:119], a[68:71], v[180:183]
  v_mfma_f32_16x16x32_bf16 v[184:187], a[120:123], a[40:43], v[184:187]
  s_barrier
  v_mfma_f32_16x16x32_bf16 v[184:187], a[124:127], a[44:47], v[184:187]
  ds_read_b128 a[104:107], v123 offset:0
  v_mfma_f32_16x16x32_bf16 v[184:187], a[128:131], a[48:51], v[184:187]
  buffer_load_dwordx4 v[236:239], v108, s[20:23], s75 offen offset:1024 sc1
  v_mfma_f32_16x16x32_bf16 v[184:187], a[132:135], a[52:55], v[184:187]
  ds_read_b128 a[108:111], v123 offset:9216
  v_mfma_f32_16x16x32_bf16 v[188:191], a[120:123], a[56:59], v[188:191]
  buffer_load_dwordx4 v[240:243], v108, s[20:23], s75 offen offset:2048 sc1
  v_mfma_f32_16x16x32_bf16 v[188:191], a[124:127], a[60:63], v[188:191]
  ds_read_b128 a[112:115], v123 offset:18432
  v_mfma_f32_16x16x32_bf16 v[188:191], a[128:131], a[64:67], v[188:191]
  v_mfma_f32_16x16x32_bf16 v[188:191], a[132:135], a[68:71], v[188:191]
  ds_read_b128 a[116:119], v123 offset:27648
  s_waitcnt lgkmcnt(4)
  v_mfma_f32_16x16x32_bf16 v[192:195], a[136:139], a[40:43], v[192:195]
  ds_read_b128 a[120:123], v123 offset:1024
  s_waitcnt vmcnt(16)
  v_xor_b32 v252, s48, v252
  v_sub_u32 v253, v253, s49
  v_lshrrev_b32 v253, 4, v253
  v_or_b32 v252, v252, v253
  v_cmp_ne_u32 vcc, 0, v252
  s_nop 0
  s_cmp_eq_u64 vcc, 0
  s_cbranch_scc0 recurrent_scan__linear_attn_block__glu_gated_bilinear__prompt_kernel_cr_w
recurrent_scan__linear_attn_block__glu_gated_bilinear__prompt_kernel_cr_d:
  v_mfma_f32_16x16x32_bf16 v[192:195], a[140:143], a[44:47], v[192:195]
  buffer_load_dwordx4 v[244:247], v108, s[20:23], s75 offen offset:3072 sc1
  v_mfma_f32_16x16x32_bf16 v[192:195], a[144:147], a[48:51], v[192:195]
  ds_read_b128 a[124:127], v123 offset:10240
  v_mfma_f32_16x16x32_bf16 v[192:195], a[148:151], a[52:55], v[192:195]
  v_mfma_f32_16x16x32_bf16 v[196:199], a[136:139], a[56:59], v[196:199]
  ds_read_b128 a[128:131], v123 offset:19456
  v_mfma_f32_16x16x32_bf16 v[196:199], a[140:143], a[60:63], v[196:199]
  buffer_load_dwordx4 v[248:251], v3, s[20:23], s75 offen offset:0 sc1
  v_mfma_f32_16x16x32_bf16 v[196:199], a[144:147], a[64:67], v[196:199]
  s_waitcnt lgkmcnt(3)
  ds_read_b128 a[132:135], v123 offset:28672
  v_mfma_f32_16x16x32_bf16 v[196:199], a[148:151], a[68:71], v[196:199]
  v_mfma_f32_16x16x32_bf16 v[128:131], a[104:107], a[72:75], v[128:131]
  ds_read_b128 a[136:139], v123 offset:2048
  v_mfma_f32_16x16x32_bf16 v[128:131], a[108:111], a[76:79], v[128:131]
  buffer_load_dwordx4 v[4:7], v108, s[20:23], s47 offen offset:0 sc1
  v_mfma_f32_16x16x32_bf16 v[128:131], a[112:115], a[80:83], v[128:131]
  ds_read_b128 a[140:143], v123 offset:11264
  v_and_b32 v254, 3, v0
  v_mfma_f32_16x16x32_bf16 v[128:131], a[116:119], a[84:87], v[128:131]
  v_cmp_eq_u32 vcc, s60, v254
  v_mov_b32 v255, s78
  v_mfma_f32_16x16x32_bf16 v[132:135], a[104:107], a[88:91], v[132:135]
  ds_read_b128 a[144:147], v123 offset:20480
  s_lshl_b32 s42, s2, 7
  v_mfma_f32_16x16x32_bf16 v[132:135], a[108:111], a[92:95], v[132:135]
  v_cndmask_b32 v254, v254, v255, vcc
  v_lshlrev_b32 v254, 3, v254
  v_mfma_f32_16x16x32_bf16 v[132:135], a[112:115], a[96:99], v[132:135]
  s_waitcnt lgkmcnt(3)
  ds_read_b128 a[148:151], v123 offset:29696
  v_mfma_f32_16x16x32_bf16 v[132:135], a[116:119], a[100:103], v[132:135]
  s_add_u32 s42, s42, 41476096
  s_mul_i32 s43, s56, 9
  v_mfma_f32_16x16x32_bf16 v[136:139], a[120:123], a[72:75], v[136:139]
  ds_read_b128 a[104:107], v123 offset:3072
  s_lshr_b32 s43, s43, 1
  v_mfma_f32_16x16x32_bf16 v[136:139], a[124:127], a[76:79], v[136:139]
  s_lshl_b32 s43, s43, 10
  s_lshl_b32 s97, s56, 10
  v_mfma_f32_16x16x32_bf16 v[136:139], a[128:131], a[80:83], v[136:139]
  ds_read_b128 a[108:111], v123 offset:12288
  s_mul_i32 s39, s2, 36864
  v_mfma_f32_16x16x32_bf16 v[136:139], a[132:135], a[84:87], v[136:139]
  s_add_u32 s39, s39, 32034816
  s_add_u32 s68, s60, 1
  v_mfma_f32_16x16x32_bf16 v[140:143], a[120:123], a[88:91], v[140:143]
  ds_read_b128 a[112:115], v123 offset:21504
  s_and_b32 s68, s68, 3
  v_mfma_f32_16x16x32_bf16 v[140:143], a[124:127], a[92:95], v[140:143]
  s_mul_i32 s68, s68, 9216
  s_add_u32 s37, s68, s39
  v_mfma_f32_16x16x32_bf16 v[140:143], a[128:131], a[96:99], v[140:143]
  s_waitcnt lgkmcnt(3)
  ds_read_b128 a[116:119], v123 offset:30720
  v_mfma_f32_16x16x32_bf16 v[140:143], a[132:135], a[100:103], v[140:143]
  s_add_u32 s68, s60, 2
  s_and_b32 s68, s68, 3
  v_mfma_f32_16x16x32_bf16 v[144:147], a[136:139], a[72:75], v[144:147]
  ds_read_b128 a[120:123], v123 offset:4096
  s_mul_i32 s68, s68, 9216
  v_mfma_f32_16x16x32_bf16 v[144:147], a[140:143], a[76:79], v[144:147]
  s_add_u32 s36, s68, s39
  s_add_u32 s68, s60, 3
  v_mfma_f32_16x16x32_bf16 v[144:147], a[144:147], a[80:83], v[144:147]
  ds_read_b128 a[124:127], v123 offset:13312
  s_and_b32 s68, s68, 3
  v_mfma_f32_16x16x32_bf16 v[144:147], a[148:151], a[84:87], v[144:147]
  s_mul_i32 s68, s68, 9216
  s_add_u32 s38, s68, s39
  v_mfma_f32_16x16x32_bf16 v[148:151], a[136:139], a[88:91], v[148:151]
  ds_read_b128 a[128:131], v123 offset:22528
  s_cmp_eq_u32 s56, s78
  s_cselect_b32 s34, 41517056, 0
  v_mfma_f32_16x16x32_bf16 v[148:151], a[140:143], a[92:95], v[148:151]
  s_mov_b32 s46, 0xffff0000
  s_mov_b32 s98, 0x3f80
  v_mfma_f32_16x16x32_bf16 v[148:151], a[144:147], a[96:99], v[148:151]
  s_waitcnt lgkmcnt(3)
  ds_read_b128 a[132:135], v123 offset:31744
  v_mfma_f32_16x16x32_bf16 v[148:151], a[148:151], a[100:103], v[148:151]
  s_mov_b32 s99, 0x3f800000
  s_mov_b32 s90, 0xbfb8aa3b
  v_mfma_f32_16x16x32_bf16 v[152:155], a[104:107], a[72:75], v[152:155]
  ds_read_b128 a[136:139], v123 offset:5120
  s_mov_b32 s91, 0xbfb8aa3b
  v_mfma_f32_16x16x32_bf16 v[152:155], a[108:111], a[76:79], v[152:155]
  buffer_load_dwordx4 v[8:11], v108, s[20:23], s47 offen offset:1024 sc1
  v_mfma_f32_16x16x32_bf16 v[152:155], a[112:115], a[80:83], v[152:155]
  ds_read_b128 a[140:143], v123 offset:14336
  v_mfma_f32_16x16x32_bf16 v[152:155], a[116:119], a[84:87], v[152:155]
  buffer_load_dwordx4 v[12:15], v108, s[20:23], s47 offen offset:2048 sc1
  v_mfma_f32_16x16x32_bf16 v[156:159], a[104:107], a[88:91], v[156:159]
  ds_read_b128 a[144:147], v123 offset:23552
  v_mfma_f32_16x16x32_bf16 v[156:159], a[108:111], a[92:95], v[156:159]
  buffer_load_dwordx4 v[16:19], v108, s[20:23], s47 offen offset:3072 sc1
  v_mfma_f32_16x16x32_bf16 v[156:159], a[112:115], a[96:99], v[156:159]
  s_waitcnt lgkmcnt(3)
  ds_read_b128 a[148:151], v123 offset:32768
  v_mfma_f32_16x16x32_bf16 v[156:159], a[116:119], a[100:103], v[156:159]
  buffer_load_dwordx4 v[20:23], v3, s[20:23], s47 offen offset:0 sc1
  v_mfma_f32_16x16x32_bf16 v[160:163], a[120:123], a[72:75], v[160:163]
  ds_read_b128 a[104:107], v123 offset:6144
  v_mfma_f32_16x16x32_bf16 v[160:163], a[124:127], a[76:79], v[160:163]
  buffer_load_dwordx4 v[24:27], v3, s[20:23], s47 offen offset:1024 sc1
  v_mfma_f32_16x16x32_bf16 v[160:163], a[128:131], a[80:83], v[160:163]
  ds_read_b128 a[108:111], v123 offset:15360
  v_mfma_f32_16x16x32_bf16 v[160:163], a[132:135], a[84:87], v[160:163]
  buffer_load_dwordx4 v[28:31], v3, s[20:23], s47 offen offset:2048 sc1
  v_mfma_f32_16x16x32_bf16 v[164:167], a[120:123], a[88:91], v[164:167]
  ds_read_b128 a[112:115], v123 offset:24576
  v_mfma_f32_16x16x32_bf16 v[164:167], a[124:127], a[92:95], v[164:167]
  buffer_load_dwordx4 v[32:35], v3, s[20:23], s47 offen offset:3072 sc1
  v_mfma_f32_16x16x32_bf16 v[164:167], a[128:131], a[96:99], v[164:167]
  s_waitcnt lgkmcnt(3)
  ds_read_b128 a[116:119], v123 offset:33792
  v_mfma_f32_16x16x32_bf16 v[164:167], a[132:135], a[100:103], v[164:167]
  buffer_load_dwordx4 v[36:39], v111, s[20:23], s47 offen offset:0 sc1
  v_mfma_f32_16x16x32_bf16 v[168:171], a[136:139], a[72:75], v[168:171]
  ds_read_b128 a[120:123], v123 offset:7168
  v_mfma_f32_16x16x32_bf16 v[168:171], a[140:143], a[76:79], v[168:171]
  buffer_load_dwordx4 v[40:43], v111, s[20:23], s47 offen offset:1024 sc1
  v_mfma_f32_16x16x32_bf16 v[168:171], a[144:147], a[80:83], v[168:171]
  ds_read_b128 a[124:127], v123 offset:16384
  v_mfma_f32_16x16x32_bf16 v[168:171], a[148:151], a[84:87], v[168:171]
  buffer_load_dwordx4 v[44:47], v111, s[20:23], s47 offen offset:2048 sc1
  v_mfma_f32_16x16x32_bf16 v[172:175], a[136:139], a[88:91], v[172:175]
  ds_read_b128 a[128:131], v123 offset:25600
  v_mfma_f32_16x16x32_bf16 v[172:175], a[140:143], a[92:95], v[172:175]
  buffer_load_dwordx4 v[48:51], v111, s[20:23], s47 offen offset:3072 sc1
  v_mfma_f32_16x16x32_bf16 v[172:175], a[144:147], a[96:99], v[172:175]
  s_waitcnt lgkmcnt(3)
  ds_read_b128 a[132:135], v123 offset:34816
  v_mfma_f32_16x16x32_bf16 v[172:175], a[148:151], a[100:103], v[172:175]
  s_add_u32 s47, s47, 12288
  v_mfma_f32_16x16x32_bf16 v[176:179], a[104:107], a[72:75], v[176:179]
  ds_read_b128 a[136:139], v123 offset:8192
  v_mfma_f32_16x16x32_bf16 v[176:179], a[108:111], a[76:79], v[176:179]
  buffer_load_dwordx4 v[52:55], v108, s[20:23], s47 offen offset:0 sc1
  v_mfma_f32_16x16x32_bf16 v[176:179], a[112:115], a[80:83], v[176:179]
  ds_read_b128 a[140:143], v123 offset:17408
  v_mfma_f32_16x16x32_bf16 v[176:179], a[116:119], a[84:87], v[176:179]
  v_mfma_f32_16x16x32_bf16 v[180:183], a[104:107], a[88:91], v[180:183]
  ds_read_b128 a[144:147], v123 offset:26624
  v_mfma_f32_16x16x32_bf16 v[180:183], a[108:111], a[92:95], v[180:183]
  buffer_load_dwordx4 v[56:59], v108, s[20:23], s47 offen offset:1024 sc1
  v_mfma_f32_16x16x32_bf16 v[180:183], a[112:115], a[96:99], v[180:183]
  s_waitcnt lgkmcnt(3)
  ds_read_b128 a[148:151], v123 offset:35840
  v_mfma_f32_16x16x32_bf16 v[180:183], a[116:119], a[100:103], v[180:183]
  v_mfma_f32_16x16x32_bf16 v[184:187], a[120:123], a[72:75], v[184:187]
  s_barrier
  v_mfma_f32_16x16x32_bf16 v[184:187], a[124:127], a[76:79], v[184:187]
  ds_read_b128 a[104:107], v120 offset:0
  v_mfma_f32_16x16x32_bf16 v[184:187], a[128:131], a[80:83], v[184:187]
  buffer_load_dwordx4 v[60:63], v108, s[20:23], s47 offen offset:2048 sc1
  v_mfma_f32_16x16x32_bf16 v[184:187], a[132:135], a[84:87], v[184:187]
  ds_read_b128 a[108:111], v120 offset:9216
  v_mfma_f32_16x16x32_bf16 v[188:191], a[120:123], a[88:91], v[188:191]
  buffer_load_dwordx4 v[64:67], v108, s[20:23], s47 offen offset:3072 sc1
  v_mfma_f32_16x16x32_bf16 v[188:191], a[124:127], a[92:95], v[188:191]
  ds_read_b128 a[112:115], v120 offset:18432
  v_mfma_f32_16x16x32_bf16 v[188:191], a[128:131], a[96:99], v[188:191]
  v_mfma_f32_16x16x32_bf16 v[188:191], a[132:135], a[100:103], v[188:191]
  ds_read_b128 a[116:119], v120 offset:27648
  s_waitcnt lgkmcnt(4)
  v_mfma_f32_16x16x32_bf16 v[192:195], a[136:139], a[72:75], v[192:195]
  ds_read_b128 a[120:123], v120 offset:1024
  v_mfma_f32_16x16x32_bf16 v[192:195], a[140:143], a[76:79], v[192:195]
  buffer_load_dwordx4 v[68:71], v3, s[20:23], s47 offen offset:0 sc1
  v_mfma_f32_16x16x32_bf16 v[192:195], a[144:147], a[80:83], v[192:195]
  ds_read_b128 a[124:127], v120 offset:10240
  v_mfma_f32_16x16x32_bf16 v[192:195], a[148:151], a[84:87], v[192:195]
  v_mfma_f32_16x16x32_bf16 v[196:199], a[136:139], a[88:91], v[196:199]
  ds_read_b128 a[128:131], v120 offset:19456
  v_mfma_f32_16x16x32_bf16 v[196:199], a[140:143], a[92:95], v[196:199]
  buffer_load_dwordx4 v[72:75], v3, s[20:23], s47 offen offset:1024 sc1
  v_mfma_f32_16x16x32_bf16 v[196:199], a[144:147], a[96:99], v[196:199]
  s_waitcnt vmcnt(28) lgkmcnt(3)
  ds_read_b128 a[132:135], v120 offset:28672
  v_mfma_f32_16x16x32_bf16 v[196:199], a[148:151], a[100:103], v[196:199]
  v_mfma_f32_16x16x32_bf16 v[128:131], a[104:107], a[184:187], v[128:131]
  ds_read_b128 a[136:139], v120 offset:2048
  v_mfma_f32_16x16x32_bf16 v[128:131], a[108:111], a[188:191], v[128:131]
  buffer_load_dwordx4 v[76:79], v3, s[20:23], s47 offen offset:2048 sc1
  v_mfma_f32_16x16x32_bf16 v[128:131], a[112:115], a[192:195], v[128:131]
  ds_read_b128 a[140:143], v120 offset:11264
  v_mfma_f32_16x16x32_bf16 v[128:131], a[116:119], a[196:199], v[128:131]
  v_mfma_f32_16x16x32_bf16 v[132:135], a[104:107], a[200:203], v[132:135]
  ds_read_b128 a[144:147], v120 offset:20480
  v_mfma_f32_16x16x32_bf16 v[132:135], a[108:111], a[204:207], v[132:135]
  v_mfma_f32_16x16x32_bf16 v[132:135], a[112:115], a[208:211], v[132:135]
  s_waitcnt lgkmcnt(3)
  ds_read_b128 a[148:151], v120 offset:29696
  v_mfma_f32_16x16x32_bf16 v[132:135], a[116:119], a[212:215], v[132:135]
  buffer_load_dwordx4 v[80:83], v3, s[20:23], s47 offen offset:3072 sc1
  v_mfma_f32_16x16x32_bf16 v[136:139], a[120:123], a[184:187], v[136:139]
  ds_read_b128 a[104:107], v120 offset:3072
  v_mfma_f32_16x16x32_bf16 v[136:139], a[124:127], a[188:191], v[136:139]
  v_mfma_f32_16x16x32_bf16 v[136:139], a[128:131], a[192:195], v[136:139]
  ds_read_b128 a[108:111], v120 offset:12288
  v_mfma_f32_16x16x32_bf16 v[136:139], a[132:135], a[196:199], v[136:139]
  v_cvt_pk_bf16_f32 v124, v128, v129
  v_cvt_pk_bf16_f32 v125, v130, v131
  v_mfma_f32_16x16x32_bf16 v[140:143], a[120:123], a[200:203], v[140:143]
  ds_read_b128 a[112:115], v120 offset:21504
  v_cvt_pk_bf16_f32 v126, v132, v133
  v_mfma_f32_16x16x32_bf16 v[140:143], a[124:127], a[204:207], v[140:143]
  v_cvt_pk_bf16_f32 v127, v134, v135
  v_mfma_f32_16x16x32_bf16 v[140:143], a[128:131], a[208:211], v[140:143]
  s_waitcnt lgkmcnt(3)
  ds_read_b128 a[116:119], v120 offset:30720
  v_mfma_f32_16x16x32_bf16 v[140:143], a[132:135], a[212:215], v[140:143]
  buffer_store_dwordx4 v[124:127], v108, s[12:15], s76 offen offset:0 sc1
  v_mfma_f32_16x16x32_bf16 v[144:147], a[136:139], a[184:187], v[144:147]
  ds_read_b128 a[120:123], v120 offset:4096
  v_mfma_f32_16x16x32_bf16 v[144:147], a[140:143], a[188:191], v[144:147]
  buffer_load_dwordx4 v[84:87], v111, s[20:23], s47 offen offset:0 sc1
  v_mfma_f32_16x16x32_bf16 v[144:147], a[144:147], a[192:195], v[144:147]
  ds_read_b128 a[124:127], v120 offset:13312
  v_mfma_f32_16x16x32_bf16 v[144:147], a[148:151], a[196:199], v[144:147]
  v_cvt_pk_bf16_f32 v116, v136, v137
  v_cvt_pk_bf16_f32 v117, v138, v139
  v_mfma_f32_16x16x32_bf16 v[148:151], a[136:139], a[200:203], v[148:151]
  ds_read_b128 a[128:131], v120 offset:22528
  v_cvt_pk_bf16_f32 v118, v140, v141
  v_mfma_f32_16x16x32_bf16 v[148:151], a[140:143], a[204:207], v[148:151]
  v_cvt_pk_bf16_f32 v119, v142, v143
  v_mfma_f32_16x16x32_bf16 v[148:151], a[144:147], a[208:211], v[148:151]
  s_waitcnt lgkmcnt(3)
  ds_read_b128 a[132:135], v120 offset:31744
  v_mfma_f32_16x16x32_bf16 v[148:151], a[148:151], a[212:215], v[148:151]
  buffer_store_dwordx4 v[116:119], v108, s[12:15], s76 offen offset:1024 sc1
  v_mfma_f32_16x16x32_bf16 v[152:155], a[104:107], a[184:187], v[152:155]
  ds_read_b128 a[136:139], v120 offset:5120
  v_mfma_f32_16x16x32_bf16 v[152:155], a[108:111], a[188:191], v[152:155]
  buffer_load_dwordx4 v[88:91], v111, s[20:23], s47 offen offset:1024 sc1
  v_mfma_f32_16x16x32_bf16 v[152:155], a[112:115], a[192:195], v[152:155]
  ds_read_b128 a[140:143], v120 offset:14336
  v_mfma_f32_16x16x32_bf16 v[152:155], a[116:119], a[196:199], v[152:155]
  v_cvt_pk_bf16_f32 v124, v144, v145
  v_cvt_pk_bf16_f32 v125, v146, v147
  v_mfma_f32_16x16x32_bf16 v[156:159], a[104:107], a[200:203], v[156:159]
  ds_read_b128 a[144:147], v120 offset:23552
  v_cvt_pk_bf16_f32 v126, v148, v149
  v_mfma_f32_16x16x32_bf16 v[156:159], a[108:111], a[204:207], v[156:159]
  v_cvt_pk_bf16_f32 v127, v150, v151
  v_mfma_f32_16x16x32_bf16 v[156:159], a[112:115], a[208:211], v[156:159]
  s_waitcnt lgkmcnt(3)
  ds_read_b128 a[148:151], v120 offset:32768
  v_mfma_f32_16x16x32_bf16 v[156:159], a[116:119], a[212:215], v[156:159]
  buffer_store_dwordx4 v[124:127], v108, s[12:15], s76 offen offset:2048 sc1
  v_mfma_f32_16x16x32_bf16 v[160:163], a[120:123], a[184:187], v[160:163]
  ds_read_b128 a[104:107], v120 offset:6144
  v_mfma_f32_16x16x32_bf16 v[160:163], a[124:127], a[188:191], v[160:163]
  buffer_load_dwordx4 v[92:95], v111, s[20:23], s47 offen offset:2048 sc1
  v_mfma_f32_16x16x32_bf16 v[160:163], a[128:131], a[192:195], v[160:163]
  ds_read_b128 a[108:111], v120 offset:15360
  v_mfma_f32_16x16x32_bf16 v[160:163], a[132:135], a[196:199], v[160:163]
  v_cvt_pk_bf16_f32 v116, v152, v153
  v_cvt_pk_bf16_f32 v117, v154, v155
  v_mfma_f32_16x16x32_bf16 v[164:167], a[120:123], a[200:203], v[164:167]
  ds_read_b128 a[112:115], v120 offset:24576
  v_cvt_pk_bf16_f32 v118, v156, v157
  v_mfma_f32_16x16x32_bf16 v[164:167], a[124:127], a[204:207], v[164:167]
  v_cvt_pk_bf16_f32 v119, v158, v159
  v_mfma_f32_16x16x32_bf16 v[164:167], a[128:131], a[208:211], v[164:167]
  s_waitcnt lgkmcnt(3)
  ds_read_b128 a[116:119], v120 offset:33792
  v_mfma_f32_16x16x32_bf16 v[164:167], a[132:135], a[212:215], v[164:167]
  buffer_store_dwordx4 v[116:119], v108, s[12:15], s76 offen offset:3072 sc1
  v_mfma_f32_16x16x32_bf16 v[168:171], a[136:139], a[184:187], v[168:171]
  ds_read_b128 a[120:123], v120 offset:7168
  v_mfma_f32_16x16x32_bf16 v[168:171], a[140:143], a[188:191], v[168:171]
  buffer_load_dwordx4 v[96:99], v111, s[20:23], s47 offen offset:3072 sc1
  v_mfma_f32_16x16x32_bf16 v[168:171], a[144:147], a[192:195], v[168:171]
  ds_read_b128 a[124:127], v120 offset:16384
  s_add_u32 s47, s47, 12288
  v_mfma_f32_16x16x32_bf16 v[168:171], a[148:151], a[196:199], v[168:171]
  v_cvt_pk_bf16_f32 v124, v160, v161
  v_cvt_pk_bf16_f32 v125, v162, v163
  v_mfma_f32_16x16x32_bf16 v[172:175], a[136:139], a[200:203], v[172:175]
  ds_read_b128 a[128:131], v120 offset:25600
  v_cvt_pk_bf16_f32 v126, v164, v165
  v_mfma_f32_16x16x32_bf16 v[172:175], a[140:143], a[204:207], v[172:175]
  v_cvt_pk_bf16_f32 v127, v166, v167
  v_mfma_f32_16x16x32_bf16 v[172:175], a[144:147], a[208:211], v[172:175]
  s_waitcnt lgkmcnt(3)
  ds_read_b128 a[132:135], v120 offset:34816
  v_mfma_f32_16x16x32_bf16 v[172:175], a[148:151], a[212:215], v[172:175]
  buffer_store_dwordx4 v[124:127], v3, s[12:15], s76 offen offset:0 sc1
  v_mfma_f32_16x16x32_bf16 v[176:179], a[104:107], a[184:187], v[176:179]
  ds_read_b128 a[136:139], v120 offset:8192
  v_mfma_f32_16x16x32_bf16 v[176:179], a[108:111], a[188:191], v[176:179]
  buffer_load_dwordx4 v[200:203], v108, s[20:23], s47 offen offset:0 sc1
  v_mfma_f32_16x16x32_bf16 v[176:179], a[112:115], a[192:195], v[176:179]
  ds_read_b128 a[140:143], v120 offset:17408
  v_mfma_f32_16x16x32_bf16 v[176:179], a[116:119], a[196:199], v[176:179]
  v_cvt_pk_bf16_f32 v116, v168, v169
  v_cvt_pk_bf16_f32 v117, v170, v171
  v_mfma_f32_16x16x32_bf16 v[180:183], a[104:107], a[200:203], v[180:183]
  ds_read_b128 a[144:147], v120 offset:26624
  v_cvt_pk_bf16_f32 v118, v172, v173
  v_mfma_f32_16x16x32_bf16 v[180:183], a[108:111], a[204:207], v[180:183]
  v_cvt_pk_bf16_f32 v119, v174, v175
  v_mfma_f32_16x16x32_bf16 v[180:183], a[112:115], a[208:211], v[180:183]
  s_waitcnt lgkmcnt(3)
  ds_read_b128 a[148:151], v120 offset:35840
  v_mfma_f32_16x16x32_bf16 v[180:183], a[116:119], a[212:215], v[180:183]
  buffer_store_dwordx4 v[116:119], v3, s[12:15], s76 offen offset:1024 sc1
  v_mfma_f32_16x16x32_bf16 v[184:187], a[120:123], a[184:187], v[184:187]
  buffer_load_dwordx4 v[204:207], v108, s[20:23], s47 offen offset:1024 sc1
  v_mfma_f32_16x16x32_bf16 v[184:187], a[124:127], a[188:191], v[184:187]
  buffer_load_dwordx4 v[208:211], v108, s[20:23], s47 offen offset:2048 sc1
  v_mfma_f32_16x16x32_bf16 v[184:187], a[128:131], a[192:195], v[184:187]
  buffer_load_dwordx4 v[100:103], v1, s[4:7], 0 offen
  v_mfma_f32_16x16x32_bf16 v[184:187], a[132:135], a[196:199], v[184:187]
  v_cvt_pk_bf16_f32 v124, v176, v177
  v_cvt_pk_bf16_f32 v125, v178, v179
  v_mfma_f32_16x16x32_bf16 v[188:191], a[120:123], a[200:203], v[188:191]
  v_cvt_pk_bf16_f32 v126, v180, v181
  v_cvt_pk_bf16_f32 v127, v182, v183
  v_mfma_f32_16x16x32_bf16 v[188:191], a[124:127], a[204:207], v[188:191]
  buffer_load_dwordx4 v[104:107], v1, s[4:7], 0 offen offset:128
  v_mfma_f32_16x16x32_bf16 v[188:191], a[128:131], a[208:211], v[188:191]
  s_waitcnt lgkmcnt(0)
  v_mfma_f32_16x16x32_bf16 v[188:191], a[132:135], a[212:215], v[188:191]
  buffer_store_dwordx4 v[124:127], v3, s[12:15], s76 offen offset:2048 sc1
  v_mfma_f32_16x16x32_bf16 v[192:195], a[136:139], a[184:187], v[192:195]
  v_mfma_f32_16x16x32_bf16 v[192:195], a[140:143], a[188:191], v[192:195]
  v_mfma_f32_16x16x32_bf16 v[192:195], a[144:147], a[192:195], v[192:195]
  buffer_load_dwordx4 v[112:115], v2, s[4:7], 0 offen offset:256
  v_mfma_f32_16x16x32_bf16 v[192:195], a[148:151], a[196:199], v[192:195]
  v_cvt_pk_bf16_f32 v116, v184, v185
  v_cvt_pk_bf16_f32 v117, v186, v187
  v_mfma_f32_16x16x32_bf16 v[196:199], a[136:139], a[200:203], v[196:199]
  v_cvt_pk_bf16_f32 v118, v188, v189
  v_cvt_pk_bf16_f32 v119, v190, v191
  v_mfma_f32_16x16x32_bf16 v[196:199], a[140:143], a[204:207], v[196:199]
  v_mfma_f32_16x16x32_bf16 v[196:199], a[144:147], a[208:211], v[196:199]
  v_mfma_f32_16x16x32_bf16 v[196:199], a[148:151], a[212:215], v[196:199]
  buffer_store_dwordx4 v[116:119], v3, s[12:15], s76 offen offset:3072 sc1
  v_cvt_pk_bf16_f32 v124, v192, v193
  v_cvt_pk_bf16_f32 v125, v194, v195
  s_nop 4
  v_cvt_pk_bf16_f32 v126, v196, v197
  v_cvt_pk_bf16_f32 v127, v198, v199
  buffer_store_dwordx4 v[124:127], v111, s[12:15], s76 offen offset:0 sc1
  s_cmp_lg_u32 s56, s60
  s_cbranch_scc1 recurrent_scan__linear_attn_block__glu_gated_bilinear__prompt_kernel_att
  ds_write_b128 v122, v[128:131] offset:0
  ds_write_b128 v122, v[132:135] offset:1024
  ds_write_b128 v122, v[136:139] offset:2048
  ds_write_b128 v122, v[140:143] offset:3072
  ds_write_b128 v122, v[144:147] offset:4096
  ds_write_b128 v122, v[148:151] offset:5120
  ds_write_b128 v122, v[152:155] offset:6144
  ds_write_b128 v122, v[156:159] offset:7168
  ds_write_b128 v122, v[160:163] offset:8192
  ds_write_b128 v122, v[164:167] offset:9216
  ds_write_b128 v122, v[168:171] offset:10240
  ds_write_b128 v122, v[172:175] offset:11264
  ds_write_b128 v122, v[176:179] offset:12288
  ds_write_b128 v122, v[180:183] offset:13312
  ds_write_b128 v122, v[184:187] offset:14336
  ds_write_b128 v122, v[188:191] offset:15360
  ds_write_b128 v122, v[192:195] offset:16384
  ds_write_b128 v122, v[196:199] offset:17408
  s_waitcnt lgkmcnt(0)
recurrent_scan__linear_attn_block__glu_gated_bilinear__prompt_kernel_att:
  v_mov_b32 v116, 0x360bada6
  v_mov_b32 v117, 0x360bada6
  v_mov_b32 v118, 0x360bada6
  v_mov_b32 v119, 0x360bada6
  v_add_u32 v184, s43, v121
  s_and_b32 s67, s56, 1
  s_cmp_eq_u32 s67, 1
  s_cbranch_scc1 recurrent_scan__linear_attn_block__glu_gated_bilinear__prompt_kernel_oodd
  s_waitcnt vmcnt(38)
  v_mfma_f32_16x16x32_bf16 v[128:131], v[4:7], v[212:215], 0
  s_add_u32 s69, s50, 0
  buffer_load_dwordx4 a[152:155], v108, s[20:23], s69 offen sc1
  v_and_b32 v126, 63, v0
  v_min_u32 v126, 1, v126
  v_lshlrev_b32 v126, 30, v126
  s_waitcnt vmcnt(38)
  v_mfma_f32_16x16x32_bf16 v[132:135], v[8:11], v[212:215], v[116:119]
  v_mov_b32 v124, s48
  v_mov_b32 v125, s49
  v_add_u32 v185, s97, v108
  v_mfma_f32_16x16x32_bf16 v[136:139], v[4:7], v[232:235], 0
  s_add_u32 s69, s50, 36864
  buffer_load_dwordx4 a[156:159], v108, s[20:23], s69 offen sc1
  v_add_u32 v186, s97, v3
  v_add_u32 v187, s97, v122
  v_add_u32 v187, s97, v187
  v_mfma_f32_16x16x32_bf16 v[140:143], v[8:11], v[232:235], v[116:119]
  s_waitcnt vmcnt(37)
  v_mfma_f32_16x16x32_bf16 v[144:147], v[16:19], v[212:215], 0
  s_add_u32 s69, s50, 73728
  buffer_load_dwordx4 a[160:163], v108, s[20:23], s69 offen sc1
  s_waitcnt vmcnt(37)
  v_mfma_f32_16x16x32_bf16 v[148:151], v[20:23], v[212:215], v[116:119]
  v_mfma_f32_16x16x32_bf16 v[152:155], v[16:19], v[232:235], 0
  s_add_u32 s69, s50, 110592
  buffer_load_dwordx4 a[164:167], v108, s[20:23], s69 offen sc1
  v_mfma_f32_16x16x32_bf16 v[156:159], v[20:23], v[232:235], v[116:119]
  v_mfma_f32_16x16x16_bf16 v[128:131], v[12:13], v[214:215], v[128:131]
  s_add_u32 s69, s50, 147456
  buffer_load_dwordx4 a[168:171], v108, s[20:23], s69 offen sc1
  v_mfma_f32_16x16x16_bf16 v[132:135], v[14:15], v[214:215], v[132:135]
  v_mfma_f32_16x16x16_bf16 v[136:139], v[12:13], v[234:235], v[136:139]
  s_add_u32 s69, s50, 184320
  buffer_load_dwordx4 a[172:175], v108, s[20:23], s69 offen sc1
  v_mfma_f32_16x16x16_bf16 v[140:143], v[14:15], v[234:235], v[140:143]
  s_waitcnt vmcnt(38)
  v_mfma_f32_16x16x32_bf16 v[160:163], v[28:31], v[216:219], 0
  s_add_u32 s69, s50, 221184
  buffer_load_dwordx4 a[176:179], v108, s[20:23], s69 offen sc1
  s_waitcnt vmcnt(38)
  v_mfma_f32_16x16x32_bf16 v[164:167], v[32:35], v[216:219], v[116:119]
  v_rcp_f32 v132, v132
  v_rcp_f32 v134, v134
  v_rcp_f32 v140, v140
  v_mfma_f32_16x16x32_bf16 v[168:171], v[28:31], v[236:239], 0
  s_add_u32 s69, s50, 258048
  buffer_load_dwordx4 a[180:183], v108, s[20:23], s69 offen sc1
  v_rcp_f32 v142, v142
  v_mul_f32 v128, v128, v132
  v_mul_f32 v129, v129, v132
  v_mfma_f32_16x16x32_bf16 v[172:175], v[32:35], v[236:239], v[116:119]
  v_mul_f32 v130, v130, v134
  v_mul_f32 v131, v131, v134
  v_cvt_pk_bf16_f32 v176, v128, v129
  v_mfma_f32_16x16x16_bf16 v[144:147], v[24:25], v[216:217], v[144:147]
  s_add_u32 s69, s50, 294912
  buffer_load_dwordx4 a[24:27], v108, s[20:23], s69 offen sc1
  v_cvt_pk_bf16_f32 v177, v130, v131
  ds_write_b64 v184, v[176:177] offset:0
  v_mul_f32 v136, v136, v140
  v_mfma_f32_16x16x16_bf16 v[148:151], v[26:27], v[216:217], v[148:151]
  v_mul_f32 v137, v137, v140
  v_mul_f32 v138, v138, v142
  v_mul_f32 v139, v139, v142
  v_mfma_f32_16x16x16_bf16 v[152:155], v[24:25], v[236:237], v[152:155]
  s_add_u32 s69, s50, 331776
  buffer_load_dwordx4 a[28:31], v108, s[20:23], s69 offen sc1
  v_cvt_pk_bf16_f32 v178, v136, v137
  v_cvt_pk_bf16_f32 v179, v138, v139
  ds_write_b64 v184, v[178:179] offset:18432
  v_mfma_f32_16x16x16_bf16 v[156:159], v[26:27], v[236:237], v[156:159]
  s_waitcnt vmcnt(39)
  v_mfma_f32_16x16x32_bf16 v[128:131], v[40:43], v[216:219], 0
  s_add_u32 s69, s50, 368640
  buffer_load_dwordx4 a[32:35], v108, s[20:23], s69 offen sc1
  s_waitcnt vmcnt(39)
  v_mfma_f32_16x16x32_bf16 v[132:135], v[44:47], v[216:219], v[116:119]
  v_rcp_f32 v148, v148
  v_rcp_f32 v150, v150
  v_rcp_f32 v156, v156
  v_mfma_f32_16x16x32_bf16 v[136:139], v[40:43], v[236:239], 0
  s_add_u32 s69, s50, 405504
  buffer_load_dwordx4 a[36:39], v108, s[20:23], s69 offen sc1
  v_rcp_f32 v158, v158
  v_mul_f32 v144, v144, v148
  v_mul_f32 v145, v145, v148
  v_mfma_f32_16x16x32_bf16 v[140:143], v[44:47], v[236:239], v[116:119]
  v_mul_f32 v146, v146, v150
  v_mul_f32 v147, v147, v150
  v_cvt_pk_bf16_f32 v180, v144, v145
  v_mfma_f32_16x16x16_bf16 v[160:163], v[36:37], v[214:215], v[160:163]
  s_add_u32 s69, s50, 442368
  buffer_load_dwordx4 a[0:3], v108, s[20:23], s69 offen sc1
  v_cvt_pk_bf16_f32 v181, v146, v147
  ds_write_b64 v184, v[180:181] offset:8
  v_mul_f32 v152, v152, v156
  v_mfma_f32_16x16x16_bf16 v[164:167], v[38:39], v[214:215], v[164:167]
  v_mul_f32 v153, v153, v156
  v_mul_f32 v154, v154, v158
  v_mul_f32 v155, v155, v158
  v_mfma_f32_16x16x16_bf16 v[168:171], v[36:37], v[234:235], v[168:171]
  s_add_u32 s69, s50, 479232
  buffer_load_dwordx4 a[4:7], v108, s[20:23], s69 offen sc1
  v_cvt_pk_bf16_f32 v182, v152, v153
  v_cvt_pk_bf16_f32 v183, v154, v155
  ds_write_b64 v184, v[182:183] offset:18440
  v_mfma_f32_16x16x16_bf16 v[172:175], v[38:39], v[234:235], v[172:175]
  s_waitcnt vmcnt(40)
  v_mfma_f32_16x16x32_bf16 v[144:147], v[52:55], v[220:223], 0
  s_add_u32 s69, s50, 516096
  buffer_load_dwordx4 a[8:11], v108, s[20:23], s69 offen sc1
  s_waitcnt vmcnt(40)
  v_mfma_f32_16x16x32_bf16 v[148:151], v[56:59], v[220:223], v[116:119]
  v_rcp_f32 v164, v164
  v_rcp_f32 v166, v166
  v_rcp_f32 v172, v172
  v_mfma_f32_16x16x32_bf16 v[152:155], v[52:55], v[240:243], 0
  s_add_u32 s69, s50, 552960
  buffer_load_dwordx4 a[12:15], v108, s[20:23], s69 offen sc1
  v_rcp_f32 v174, v174
  v_mul_f32 v160, v160, v164
  v_mul_f32 v161, v161, v164
  v_mfma_f32_16x16x32_bf16 v[156:159], v[56:59], v[240:243], v[116:119]
  v_mul_f32 v162, v162, v166
  v_mul_f32 v163, v163, v166
  v_cvt_pk_bf16_f32 v176, v160, v161
  v_mfma_f32_16x16x16_bf16 v[128:131], v[48:49], v[220:221], v[128:131]
  s_add_u32 s69, s50, 589824
  buffer_load_dwordx4 a[16:19], v108, s[20:23], s69 offen sc1
  v_cvt_pk_bf16_f32 v177, v162, v163
  ds_write_b64 v184, v[176:177] offset:1024
  v_mul_f32 v168, v168, v172
  v_mfma_f32_16x16x16_bf16 v[132:135], v[50:51], v[220:221], v[132:135]
  v_mul_f32 v169, v169, v172
  v_mul_f32 v170, v170, v174
  v_mul_f32 v171, v171, v174
  v_mfma_f32_16x16x16_bf16 v[136:139], v[48:49], v[240:241], v[136:139]
  s_add_u32 s69, s50, 626688
  buffer_load_dwordx4 a[20:23], v108, s[20:23], s69 offen sc1
  v_cvt_pk_bf16_f32 v178, v168, v169
  v_cvt_pk_bf16_f32 v179, v170, v171
  ds_write_b64 v184, v[178:179] offset:19456
  v_mfma_f32_16x16x16_bf16 v[140:143], v[50:51], v[240:241], v[140:143]
  s_waitcnt vmcnt(41)
  v_mfma_f32_16x16x32_bf16 v[160:163], v[64:67], v[220:223], 0
  s_add_u32 s69, s50, 4096
  buffer_load_dwordx4 a[252:255], v108, s[20:23], s69 offen sc1
  s_waitcnt vmcnt(41)
  v_mfma_f32_16x16x32_bf16 v[164:167], v[68:71], v[220:223], v[116:119]
  v_rcp_f32 v132, v132
  v_rcp_f32 v134, v134
  v_rcp_f32 v140, v140
  v_mfma_f32_16x16x32_bf16 v[168:171], v[64:67], v[240:243], 0
  s_add_u32 s69, s50, 40960
  buffer_load_dwordx4 a[148:151], v108, s[20:23], s69 offen sc1
  v_rcp_f32 v142, v142
  v_mul_f32 v128, v128, v132
  v_mul_f32 v129, v129, v132
  v_mfma_f32_16x16x32_bf16 v[172:175], v[68:71], v[240:243], v[116:119]
  v_mul_f32 v130, v130, v134
  v_mul_f32 v131, v131, v134
  v_cvt_pk_bf16_f32 v180, v128, v129
  v_mfma_f32_16x16x16_bf16 v[144:147], v[60:61], v[218:219], v[144:147]
  s_add_u32 s69, s50, 77824
  buffer_load_dwordx4 a[216:219], v108, s[20:23], s69 offen sc1
  v_cvt_pk_bf16_f32 v181, v130, v131
  ds_write_b64 v184, v[180:181] offset:1032
  v_mul_f32 v136, v136, v140
  v_mfma_f32_16x16x16_bf16 v[148:151], v[62:63], v[218:219], v[148:151]
  v_mul_f32 v137, v137, v140
  v_mul_f32 v138, v138, v142
  v_mul_f32 v139, v139, v142
  v_mfma_f32_16x16x16_bf16 v[152:155], v[60:61], v[238:239], v[152:155]
  s_add_u32 s69, s50, 114688
  buffer_load_dwordx4 a[220:223], v108, s[20:23], s69 offen sc1
  v_cvt_pk_bf16_f32 v182, v136, v137
  v_cvt_pk_bf16_f32 v183, v138, v139
  ds_write_b64 v184, v[182:183] offset:19464
  v_mfma_f32_16x16x16_bf16 v[156:159], v[62:63], v[238:239], v[156:159]
  s_waitcnt vmcnt(22)
  buffer_store_dwordx2 v[124:125], v126, s[12:15], s77 offen sc1
  v_mfma_f32_16x16x32_bf16 v[128:131], v[76:79], v[224:227], 0
  s_add_u32 s69, s50, 151552
  buffer_load_dwordx4 a[224:227], v108, s[20:23], s69 offen sc1
  v_mfma_f32_16x16x32_bf16 v[132:135], v[80:83], v[224:227], v[116:119]
  v_rcp_f32 v148, v148
  v_rcp_f32 v150, v150
  v_rcp_f32 v156, v156
  v_mfma_f32_16x16x32_bf16 v[136:139], v[76:79], v[244:247], 0
  s_add_u32 s69, s50, 188416
  buffer_load_dwordx4 a[228:231], v108, s[20:23], s69 offen sc1
  v_rcp_f32 v158, v158
  v_mul_f32 v144, v144, v148
  v_mul_f32 v145, v145, v148
  v_mfma_f32_16x16x32_bf16 v[140:143], v[80:83], v[244:247], v[116:119]
  v_mul_f32 v146, v146, v150
  v_mul_f32 v147, v147, v150
  v_cvt_pk_bf16_f32 v176, v144, v145
  v_mfma_f32_16x16x16_bf16 v[160:163], v[72:73], v[224:225], v[160:163]
  s_add_u32 s69, s50, 225280
  buffer_load_dwordx4 a[232:235], v108, s[20:23], s69 offen sc1
  v_cvt_pk_bf16_f32 v177, v146, v147
  ds_write_b64 v184, v[176:177] offset:2048
  v_mul_f32 v152, v152, v156
  v_mfma_f32_16x16x16_bf16 v[164:167], v[74:75], v[224:225], v[164:167]
  v_mul_f32 v153, v153, v156
  v_mul_f32 v154, v154, v158
  v_mul_f32 v155, v155, v158
  v_mfma_f32_16x16x16_bf16 v[168:171], v[72:73], v[244:245], v[168:171]
  s_add_u32 s69, s50, 262144
  buffer_load_dwordx4 a[236:239], v108, s[20:23], s69 offen sc1
  v_cvt_pk_bf16_f32 v178, v152, v153
  v_cvt_pk_bf16_f32 v179, v154, v155
  ds_write_b64 v184, v[178:179] offset:20480
  v_mfma_f32_16x16x16_bf16 v[172:175], v[74:75], v[244:245], v[172:175]
  v_mfma_f32_16x16x32_bf16 v[144:147], v[88:91], v[224:227], 0
  s_add_u32 s69, s50, 299008
  buffer_load_dwordx4 a[240:243], v108, s[20:23], s69 offen sc1
  v_mfma_f32_16x16x32_bf16 v[148:151], v[92:95], v[224:227], v[116:119]
  v_rcp_f32 v164, v164
  v_rcp_f32 v166, v166
  s_nop 1
  v_rcp_f32 v172, v172
  v_mfma_f32_16x16x32_bf16 v[152:155], v[88:91], v[244:247], 0
  s_add_u32 s69, s50, 335872
  buffer_load_dwordx4 a[244:247], v108, s[20:23], s69 offen sc1
  v_rcp_f32 v174, v174
  v_mul_f32 v160, v160, v164
  v_mul_f32 v161, v161, v164
  v_mfma_f32_16x16x32_bf16 v[156:159], v[92:95], v[244:247], v[116:119]
  v_mul_f32 v162, v162, v166
  v_mul_f32 v163, v163, v166
  v_cvt_pk_bf16_f32 v180, v160, v161
  v_mfma_f32_16x16x16_bf16 v[128:131], v[84:85], v[222:223], v[128:131]
  s_add_u32 s69, s50, 372736
  buffer_load_dwordx4 a[40:43], v108, s[20:23], s69 offen sc1
  v_cvt_pk_bf16_f32 v181, v162, v163
  ds_write_b64 v184, v[180:181] offset:2056
  v_mul_f32 v168, v168, v172
  v_mfma_f32_16x16x16_bf16 v[132:135], v[86:87], v[222:223], v[132:135]
  v_mul_f32 v169, v169, v172
  v_mul_f32 v170, v170, v174
  v_mul_f32 v171, v171, v174
  v_mfma_f32_16x16x16_bf16 v[136:139], v[84:85], v[242:243], v[136:139]
  s_add_u32 s69, s50, 409600
  buffer_load_dwordx4 a[44:47], v108, s[20:23], s69 offen sc1
  v_cvt_pk_bf16_f32 v182, v168, v169
  v_cvt_pk_bf16_f32 v183, v170, v171
  ds_write_b64 v184, v[182:183] offset:20488
  v_mfma_f32_16x16x16_bf16 v[140:143], v[86:87], v[242:243], v[140:143]
  v_mfma_f32_16x16x32_bf16 v[160:163], v[200:203], v[228:231], 0
  s_add_u32 s69, s50, 446464
  buffer_load_dwordx4 a[48:51], v108, s[20:23], s69 offen sc1
  v_mfma_f32_16x16x32_bf16 v[164:167], v[204:207], v[228:231], v[116:119]
  v_rcp_f32 v132, v132
  v_rcp_f32 v134, v134
  s_nop 1
  v_rcp_f32 v140, v140
  v_mfma_f32_16x16x32_bf16 v[168:171], v[200:203], v[248:251], 0
  s_add_u32 s69, s50, 483328
  buffer_load_dwordx4 a[52:55], v108, s[20:23], s69 offen sc1
  v_rcp_f32 v142, v142
  v_mul_f32 v128, v128, v132
  v_mul_f32 v129, v129, v132
  v_mfma_f32_16x16x32_bf16 v[172:175], v[204:207], v[248:251], v[116:119]
  v_mul_f32 v130, v130, v134
  v_mul_f32 v131, v131, v134
  v_cvt_pk_bf16_f32 v176, v128, v129
  v_mfma_f32_16x16x16_bf16 v[144:147], v[96:97], v[228:229], v[144:147]
  s_add_u32 s69, s50, 520192
  buffer_load_dwordx4 a[56:59], v108, s[20:23], s69 offen sc1
  v_cvt_pk_bf16_f32 v177, v130, v131
  ds_write_b64 v184, v[176:177] offset:3072
  v_mul_f32 v136, v136, v140
  v_mfma_f32_16x16x16_bf16 v[148:151], v[98:99], v[228:229], v[148:151]
  v_mul_f32 v137, v137, v140
  v_mul_f32 v138, v138, v142
  v_mul_f32 v139, v139, v142
  v_mfma_f32_16x16x16_bf16 v[152:155], v[96:97], v[248:249], v[152:155]
  s_add_u32 s69, s50, 557056
  buffer_load_dwordx4 a[60:63], v108, s[20:23], s69 offen sc1
  v_cvt_pk_bf16_f32 v178, v136, v137
  v_cvt_pk_bf16_f32 v179, v138, v139
  ds_write_b64 v184, v[178:179] offset:21504
  v_mfma_f32_16x16x16_bf16 v[156:159], v[98:99], v[248:249], v[156:159]
  v_mfma_f32_16x16x16_bf16 v[160:163], v[208:209], v[226:227], v[160:163]
  s_add_u32 s69, s50, 593920
  buffer_load_dwordx4 a[64:67], v108, s[20:23], s69 offen sc1
  v_rcp_f32 v148, v148
  v_rcp_f32 v150, v150
  s_nop 2
  v_rcp_f32 v156, v156
  v_rcp_f32 v158, v158
  v_mul_f32 v144, v144, v148
  v_mul_f32 v145, v145, v148
  v_mfma_f32_16x16x16_bf16 v[164:167], v[210:211], v[226:227], v[164:167]
  v_mul_f32 v146, v146, v150
  v_mul_f32 v147, v147, v150
  v_cvt_pk_bf16_f32 v180, v144, v145
  v_cvt_pk_bf16_f32 v181, v146, v147
  ds_write_b64 v184, v[180:181] offset:3080
  v_mul_f32 v152, v152, v156
  v_mfma_f32_16x16x16_bf16 v[168:171], v[208:209], v[246:247], v[168:171]
  s_add_u32 s69, s50, 630784
  buffer_load_dwordx4 a[68:71], v108, s[20:23], s69 offen sc1
  v_mul_f32 v153, v153, v156
  v_mul_f32 v154, v154, v158
  v_mul_f32 v155, v155, v158
  v_cvt_pk_bf16_f32 v182, v152, v153
  v_cvt_pk_bf16_f32 v183, v154, v155
  ds_write_b64 v184, v[182:183] offset:21512
  v_mfma_f32_16x16x16_bf16 v[172:175], v[210:211], v[246:247], v[172:175]
  buffer_load_dwordx2 v[252:253], v254, s[20:23], s42 offen sc1
  v_rcp_f32 v164, v164
  v_rcp_f32 v166, v166
  s_nop 4
  v_rcp_f32 v172, v172
  v_rcp_f32 v174, v174
  v_mul_f32 v160, v160, v164
  v_mul_f32 v161, v161, v164
  v_mul_f32 v162, v162, v166
  v_mul_f32 v163, v163, v166
  v_cvt_pk_bf16_f32 v176, v160, v161
  v_cvt_pk_bf16_f32 v177, v162, v163
  ds_write_b64 v184, v[176:177] offset:4096
  v_mul_f32 v168, v168, v172
  v_mul_f32 v169, v169, v172
  v_mul_f32 v170, v170, v174
  v_mul_f32 v171, v171, v174
  v_cvt_pk_bf16_f32 v178, v168, v169
  v_cvt_pk_bf16_f32 v179, v170, v171
  ds_write_b64 v184, v[178:179] offset:22528
  s_branch recurrent_scan__linear_attn_block__glu_gated_bilinear__prompt_kernel_odone
recurrent_scan__linear_attn_block__glu_gated_bilinear__prompt_kernel_oodd:
  s_waitcnt vmcnt(38)
  v_mfma_f32_16x16x32_bf16 v[128:131], v[4:7], v[212:215], 0
  s_add_u32 s69, s50, 0
  buffer_load_dwordx4 a[152:155], v108, s[20:23], s69 offen sc1
  v_and_b32 v126, 63, v0
  v_min_u32 v126, 1, v126
  v_lshlrev_b32 v126, 30, v126
  s_waitcnt vmcnt(38)
  v_mfma_f32_16x16x32_bf16 v[132:135], v[8:11], v[212:215], v[116:119]
  v_mov_b32 v124, s48
  v_mov_b32 v125, s49
  v_add_u32 v185, s97, v108
  v_mfma_f32_16x16x32_bf16 v[136:139], v[4:7], v[232:235], 0
  s_add_u32 s69, s50, 36864
  buffer_load_dwordx4 a[156:159], v108, s[20:23], s69 offen sc1
  v_add_u32 v186, s97, v3
  v_add_u32 v187, s97, v122
  v_add_u32 v187, s97, v187
  v_mfma_f32_16x16x32_bf16 v[140:143], v[8:11], v[232:235], v[116:119]
  s_waitcnt vmcnt(37)
  v_mfma_f32_16x16x32_bf16 v[144:147], v[16:19], v[216:219], 0
  s_add_u32 s69, s50, 73728
  buffer_load_dwordx4 a[160:163], v108, s[20:23], s69 offen sc1
  s_waitcnt vmcnt(37)
  v_mfma_f32_16x16x32_bf16 v[148:151], v[20:23], v[216:219], v[116:119]
  v_mfma_f32_16x16x32_bf16 v[152:155], v[16:19], v[236:239], 0
  s_add_u32 s69, s50, 110592
  buffer_load_dwordx4 a[164:167], v108, s[20:23], s69 offen sc1
  v_mfma_f32_16x16x32_bf16 v[156:159], v[20:23], v[236:239], v[116:119]
  v_mfma_f32_16x16x16_bf16 v[128:131], v[12:13], v[216:217], v[128:131]
  s_add_u32 s69, s50, 147456
  buffer_load_dwordx4 a[168:171], v108, s[20:23], s69 offen sc1
  v_mfma_f32_16x16x16_bf16 v[132:135], v[14:15], v[216:217], v[132:135]
  v_mfma_f32_16x16x16_bf16 v[136:139], v[12:13], v[236:237], v[136:139]
  s_add_u32 s69, s50, 184320
  buffer_load_dwordx4 a[172:175], v108, s[20:23], s69 offen sc1
  v_mfma_f32_16x16x16_bf16 v[140:143], v[14:15], v[236:237], v[140:143]
  s_waitcnt vmcnt(38)
  v_mfma_f32_16x16x32_bf16 v[160:163], v[28:31], v[216:219], 0
  s_add_u32 s69, s50, 221184
  buffer_load_dwordx4 a[176:179], v108, s[20:23], s69 offen sc1
  s_waitcnt vmcnt(38)
  v_mfma_f32_16x16x32_bf16 v[164:167], v[32:35], v[216:219], v[116:119]
  v_rcp_f32 v132, v132
  v_rcp_f32 v134, v134
  v_rcp_f32 v140, v140
  v_mfma_f32_16x16x32_bf16 v[168:171], v[28:31], v[236:239], 0
  s_add_u32 s69, s50, 258048
  buffer_load_dwordx4 a[180:183], v108, s[20:23], s69 offen sc1
  v_rcp_f32 v142, v142
  v_mul_f32 v128, v128, v132
  v_mul_f32 v129, v129, v132
  v_mfma_f32_16x16x32_bf16 v[172:175], v[32:35], v[236:239], v[116:119]
  v_mul_f32 v130, v130, v134
  v_mul_f32 v131, v131, v134
  v_cvt_pk_bf16_f32 v176, v128, v129
  v_mfma_f32_16x16x16_bf16 v[144:147], v[24:25], v[214:215], v[144:147]
  s_add_u32 s69, s50, 294912
  buffer_load_dwordx4 a[24:27], v108, s[20:23], s69 offen sc1
  v_cvt_pk_bf16_f32 v177, v130, v131
  ds_write_b64 v184, v[176:177] offset:8
  v_mul_f32 v136, v136, v140
  v_mfma_f32_16x16x16_bf16 v[148:151], v[26:27], v[214:215], v[148:151]
  v_mul_f32 v137, v137, v140
  v_mul_f32 v138, v138, v142
  v_mul_f32 v139, v139, v142
  v_mfma_f32_16x16x16_bf16 v[152:155], v[24:25], v[234:235], v[152:155]
  s_add_u32 s69, s50, 331776
  buffer_load_dwordx4 a[28:31], v108, s[20:23], s69 offen sc1
  v_cvt_pk_bf16_f32 v178, v136, v137
  v_cvt_pk_bf16_f32 v179, v138, v139
  ds_write_b64 v184, v[178:179] offset:18440
  v_mfma_f32_16x16x16_bf16 v[156:159], v[26:27], v[234:235], v[156:159]
  s_waitcnt vmcnt(39)
  v_mfma_f32_16x16x32_bf16 v[128:131], v[40:43], v[220:223], 0
  s_add_u32 s69, s50, 368640
  buffer_load_dwordx4 a[32:35], v108, s[20:23], s69 offen sc1
  s_waitcnt vmcnt(39)
  v_mfma_f32_16x16x32_bf16 v[132:135], v[44:47], v[220:223], v[116:119]
  v_rcp_f32 v148, v148
  v_rcp_f32 v150, v150
  v_rcp_f32 v156, v156
  v_mfma_f32_16x16x32_bf16 v[136:139], v[40:43], v[240:243], 0
  s_add_u32 s69, s50, 405504
  buffer_load_dwordx4 a[36:39], v108, s[20:23], s69 offen sc1
  v_rcp_f32 v158, v158
  v_mul_f32 v144, v144, v148
  v_mul_f32 v145, v145, v148
  v_mfma_f32_16x16x32_bf16 v[140:143], v[44:47], v[240:243], v[116:119]
  v_mul_f32 v146, v146, v150
  v_mul_f32 v147, v147, v150
  v_cvt_pk_bf16_f32 v180, v144, v145
  v_mfma_f32_16x16x16_bf16 v[160:163], v[36:37], v[220:221], v[160:163]
  s_add_u32 s69, s50, 442368
  buffer_load_dwordx4 a[0:3], v108, s[20:23], s69 offen sc1
  v_cvt_pk_bf16_f32 v181, v146, v147
  ds_write_b64 v184, v[180:181] offset:1024
  v_mul_f32 v152, v152, v156
  v_mfma_f32_16x16x16_bf16 v[164:167], v[38:39], v[220:221], v[164:167]
  v_mul_f32 v153, v153, v156
  v_mul_f32 v154, v154, v158
  v_mul_f32 v155, v155, v158
  v_mfma_f32_16x16x16_bf16 v[168:171], v[36:37], v[240:241], v[168:171]
  s_add_u32 s69, s50, 479232
  buffer_load_dwordx4 a[4:7], v108, s[20:23], s69 offen sc1
  v_cvt_pk_bf16_f32 v182, v152, v153
  v_cvt_pk_bf16_f32 v183, v154, v155
  ds_write_b64 v184, v[182:183] offset:19456
  v_mfma_f32_16x16x16_bf16 v[172:175], v[38:39], v[240:241], v[172:175]
  s_waitcnt vmcnt(40)
  v_mfma_f32_16x16x32_bf16 v[144:147], v[52:55], v[220:223], 0
  s_add_u32 s69, s50, 516096
  buffer_load_dwordx4 a[8:11], v108, s[20:23], s69 offen sc1
  s_waitcnt vmcnt(40)
  v_mfma_f32_16x16x32_bf16 v[148:151], v[56:59], v[220:223], v[116:119]
  v_rcp_f32 v164, v164
  v_rcp_f32 v166, v166
  v_rcp_f32 v172, v172
  v_mfma_f32_16x16x32_bf16 v[152:155], v[52:55], v[240:243], 0
  s_add_u32 s69, s50, 552960
  buffer_load_dwordx4 a[12:15], v108, s[20:23], s69 offen sc1
  v_rcp_f32 v174, v174
  v_mul_f32 v160, v160, v164
  v_mul_f32 v161, v161, v164
  v_mfma_f32_16x16x32_bf16 v[156:159], v[56:59], v[240:243], v[116:119]
  v_mul_f32 v162, v162, v166
  v_mul_f32 v163, v163, v166
  v_cvt_pk_bf16_f32 v176, v160, v161
  v_mfma_f32_16x16x16_bf16 v[128:131], v[48:49], v[218:219], v[128:131]
  s_add_u32 s69, s50, 589824
  buffer_load_dwordx4 a[16:19], v108, s[20:23], s69 offen sc1
  v_cvt_pk_bf16_f32 v177, v162, v163
  ds_write_b64 v184, v[176:177] offset:1032
  v_mul_f32 v168, v168, v172
  v_mfma_f32_16x16x16_bf16 v[132:135], v[50:51], v[218:219], v[132:135]
  v_mul_f32 v169, v169, v172
  v_mul_f32 v170, v170, v174
  v_mul_f32 v171, v171, v174
  v_mfma_f32_16x16x16_bf16 v[136:139], v[48:49], v[238:239], v[136:139]
  s_add_u32 s69, s50, 626688
  buffer_load_dwordx4 a[20:23], v108, s[20:23], s69 offen sc1
  v_cvt_pk_bf16_f32 v178, v168, v169
  v_cvt_pk_bf16_f32 v179, v170, v171
  ds_write_b64 v184, v[178:179] offset:19464
  v_mfma_f32_16x16x16_bf16 v[140:143], v[50:51], v[238:239], v[140:143]
  s_waitcnt vmcnt(41)
  v_mfma_f32_16x16x32_bf16 v[160:163], v[64:67], v[224:227], 0
  s_add_u32 s69, s50, 4096
  buffer_load_dwordx4 a[252:255], v108, s[20:23], s69 offen sc1
  s_waitcnt vmcnt(41)
  v_mfma_f32_16x16x32_bf16 v[164:167], v[68:71], v[224:227], v[116:119]
  v_rcp_f32 v132, v132
  v_rcp_f32 v134, v134
  v_rcp_f32 v140, v140
  v_mfma_f32_16x16x32_bf16 v[168:171], v[64:67], v[244:247], 0
  s_add_u32 s69, s50, 40960
  buffer_load_dwordx4 a[148:151], v108, s[20:23], s69 offen sc1
  v_rcp_f32 v142, v142
  v_mul_f32 v128, v128, v132
  v_mul_f32 v129, v129, v132
  v_mfma_f32_16x16x32_bf16 v[172:175], v[68:71], v[244:247], v[116:119]
  v_mul_f32 v130, v130, v134
  v_mul_f32 v131, v131, v134
  v_cvt_pk_bf16_f32 v180, v128, v129
  v_mfma_f32_16x16x16_bf16 v[144:147], v[60:61], v[224:225], v[144:147]
  s_add_u32 s69, s50, 77824
  buffer_load_dwordx4 a[216:219], v108, s[20:23], s69 offen sc1
  v_cvt_pk_bf16_f32 v181, v130, v131
  ds_write_b64 v184, v[180:181] offset:2048
  v_mul_f32 v136, v136, v140
  v_mfma_f32_16x16x16_bf16 v[148:151], v[62:63], v[224:225], v[148:151]
  v_mul_f32 v137, v137, v140
  v_mul_f32 v138, v138, v142
  v_mul_f32 v139, v139, v142
  v_mfma_f32_16x16x16_bf16 v[152:155], v[60:61], v[244:245], v[152:155]
  s_add_u32 s69, s50, 114688
  buffer_load_dwordx4 a[220:223], v108, s[20:23], s69 offen sc1
  v_cvt_pk_bf16_f32 v182, v136, v137
  v_cvt_pk_bf16_f32 v183, v138, v139
  ds_write_b64 v184, v[182:183] offset:20480
  v_mfma_f32_16x16x16_bf16 v[156:159], v[62:63], v[244:245], v[156:159]
  s_waitcnt vmcnt(22)
  buffer_store_dwordx2 v[124:125], v126, s[12:15], s77 offen sc1
  v_mfma_f32_16x16x32_bf16 v[128:131], v[76:79], v[224:227], 0
  s_add_u32 s69, s50, 151552
  buffer_load_dwordx4 a[224:227], v108, s[20:23], s69 offen sc1
  v_mfma_f32_16x16x32_bf16 v[132:135], v[80:83], v[224:227], v[116:119]
  v_rcp_f32 v148, v148
  v_rcp_f32 v150, v150
  v_rcp_f32 v156, v156
  v_mfma_f32_16x16x32_bf16 v[136:139], v[76:79], v[244:247], 0
  s_add_u32 s69, s50, 188416
  buffer_load_dwordx4 a[228:231], v108, s[20:23], s69 offen sc1
  v_rcp_f32 v158, v158
  v_mul_f32 v144, v144, v148
  v_mul_f32 v145, v145, v148
  v_mfma_f32_16x16x32_bf16 v[140:143], v[80:83], v[244:247], v[116:119]
  v_mul_f32 v146, v146, v150
  v_mul_f32 v147, v147, v150
  v_cvt_pk_bf16_f32 v176, v144, v145
  v_mfma_f32_16x16x16_bf16 v[160:163], v[72:73], v[222:223], v[160:163]
  s_add_u32 s69, s50, 225280
  buffer_load_dwordx4 a[232:235], v108, s[20:23], s69 offen sc1
  v_cvt_pk_bf16_f32 v177, v146, v147
  ds_write_b64 v184, v[176:177] offset:2056
  v_mul_f32 v152, v152, v156
  v_mfma_f32_16x16x16_bf16 v[164:167], v[74:75], v[222:223], v[164:167]
  v_mul_f32 v153, v153, v156
  v_mul_f32 v154, v154, v158
  v_mul_f32 v155, v155, v158
  v_mfma_f32_16x16x16_bf16 v[168:171], v[72:73], v[242:243], v[168:171]
  s_add_u32 s69, s50, 262144
  buffer_load_dwordx4 a[236:239], v108, s[20:23], s69 offen sc1
  v_cvt_pk_bf16_f32 v178, v152, v153
  v_cvt_pk_bf16_f32 v179, v154, v155
  ds_write_b64 v184, v[178:179] offset:20488
  v_mfma_f32_16x16x16_bf16 v[172:175], v[74:75], v[242:243], v[172:175]
  v_mfma_f32_16x16x32_bf16 v[144:147], v[88:91], v[228:231], 0
  s_add_u32 s69, s50, 299008
  buffer_load_dwordx4 a[240:243], v108, s[20:23], s69 offen sc1
  v_mfma_f32_16x16x32_bf16 v[148:151], v[92:95], v[228:231], v[116:119]
  v_rcp_f32 v164, v164
  v_rcp_f32 v166, v166
  s_nop 1
  v_rcp_f32 v172, v172
  v_mfma_f32_16x16x32_bf16 v[152:155], v[88:91], v[248:251], 0
  s_add_u32 s69, s50, 335872
  buffer_load_dwordx4 a[244:247], v108, s[20:23], s69 offen sc1
  v_rcp_f32 v174, v174
  v_mul_f32 v160, v160, v164
  v_mul_f32 v161, v161, v164
  v_mfma_f32_16x16x32_bf16 v[156:159], v[92:95], v[248:251], v[116:119]
  v_mul_f32 v162, v162, v166
  v_mul_f32 v163, v163, v166
  v_cvt_pk_bf16_f32 v180, v160, v161
  v_mfma_f32_16x16x16_bf16 v[128:131], v[84:85], v[228:229], v[128:131]
  s_add_u32 s69, s50, 372736
  buffer_load_dwordx4 a[40:43], v108, s[20:23], s69 offen sc1
  v_cvt_pk_bf16_f32 v181, v162, v163
  ds_write_b64 v184, v[180:181] offset:3072
  v_mul_f32 v168, v168, v172
  v_mfma_f32_16x16x16_bf16 v[132:135], v[86:87], v[228:229], v[132:135]
  v_mul_f32 v169, v169, v172
  v_mul_f32 v170, v170, v174
  v_mul_f32 v171, v171, v174
  v_mfma_f32_16x16x16_bf16 v[136:139], v[84:85], v[248:249], v[136:139]
  s_add_u32 s69, s50, 409600
  buffer_load_dwordx4 a[44:47], v108, s[20:23], s69 offen sc1
  v_cvt_pk_bf16_f32 v182, v168, v169
  v_cvt_pk_bf16_f32 v183, v170, v171
  ds_write_b64 v184, v[182:183] offset:21504
  v_mfma_f32_16x16x16_bf16 v[140:143], v[86:87], v[248:249], v[140:143]
  v_mfma_f32_16x16x32_bf16 v[160:163], v[200:203], v[228:231], 0
  s_add_u32 s69, s50, 446464
  buffer_load_dwordx4 a[48:51], v108, s[20:23], s69 offen sc1
  v_mfma_f32_16x16x32_bf16 v[164:167], v[204:207], v[228:231], v[116:119]
  v_rcp_f32 v132, v132
  v_rcp_f32 v134, v134
  s_nop 1
  v_rcp_f32 v140, v140
  v_mfma_f32_16x16x32_bf16 v[168:171], v[200:203], v[248:251], 0
  s_add_u32 s69, s50, 483328
  buffer_load_dwordx4 a[52:55], v108, s[20:23], s69 offen sc1
  v_rcp_f32 v142, v142
  v_mul_f32 v128, v128, v132
  v_mul_f32 v129, v129, v132
  v_mfma_f32_16x16x32_bf16 v[172:175], v[204:207], v[248:251], v[116:119]
  v_mul_f32 v130, v130, v134
  v_mul_f32 v131, v131, v134
  v_cvt_pk_bf16_f32 v176, v128, v129
  v_mfma_f32_16x16x16_bf16 v[144:147], v[96:97], v[226:227], v[144:147]
  s_add_u32 s69, s50, 520192
  buffer_load_dwordx4 a[56:59], v108, s[20:23], s69 offen sc1
  v_cvt_pk_bf16_f32 v177, v130, v131
  ds_write_b64 v184, v[176:177] offset:3080
  v_mul_f32 v136, v136, v140
  v_mfma_f32_16x16x16_bf16 v[148:151], v[98:99], v[226:227], v[148:151]
  v_mul_f32 v137, v137, v140
  v_mul_f32 v138, v138, v142
  v_mul_f32 v139, v139, v142
  v_mfma_f32_16x16x16_bf16 v[152:155], v[96:97], v[246:247], v[152:155]
  s_add_u32 s69, s50, 557056
  buffer_load_dwordx4 a[60:63], v108, s[20:23], s69 offen sc1
  v_cvt_pk_bf16_f32 v178, v136, v137
  v_cvt_pk_bf16_f32 v179, v138, v139
  ds_write_b64 v184, v[178:179] offset:21512
  v_mfma_f32_16x16x16_bf16 v[156:159], v[98:99], v[246:247], v[156:159]
  v_mfma_f32_16x16x16_bf16 v[160:163], v[208:209], v[228:229], v[160:163]
  s_add_u32 s69, s50, 593920
  buffer_load_dwordx4 a[64:67], v108, s[20:23], s69 offen sc1
  v_rcp_f32 v148, v148
  v_rcp_f32 v150, v150
  s_nop 2
  v_rcp_f32 v156, v156
  v_rcp_f32 v158, v158
  v_mul_f32 v144, v144, v148
  v_mul_f32 v145, v145, v148
  v_mfma_f32_16x16x16_bf16 v[164:167], v[210:211], v[228:229], v[164:167]
  v_mul_f32 v146, v146, v150
  v_mul_f32 v147, v147, v150
  v_cvt_pk_bf16_f32 v180, v144, v145
  v_cvt_pk_bf16_f32 v181, v146, v147
  ds_write_b64 v184, v[180:181] offset:4096
  v_mul_f32 v152, v152, v156
  v_mfma_f32_16x16x16_bf16 v[168:171], v[208:209], v[248:249], v[168:171]
  s_add_u32 s69, s50, 630784
  buffer_load_dwordx4 a[68:71], v108, s[20:23], s69 offen sc1
  v_mul_f32 v153, v153, v156
  v_mul_f32 v154, v154, v158
  v_mul_f32 v155, v155, v158
  v_cvt_pk_bf16_f32 v182, v152, v153
  v_cvt_pk_bf16_f32 v183, v154, v155
  ds_write_b64 v184, v[182:183] offset:22528
  v_mfma_f32_16x16x16_bf16 v[172:175], v[210:211], v[248:249], v[172:175]
  buffer_load_dwordx2 v[252:253], v254, s[20:23], s42 offen sc1
  v_rcp_f32 v164, v164
  v_rcp_f32 v166, v166
  s_nop 4
  v_rcp_f32 v172, v172
  v_rcp_f32 v174, v174
  v_mul_f32 v160, v160, v164
  v_mul_f32 v161, v161, v164
  v_mul_f32 v162, v162, v166
  v_mul_f32 v163, v163, v166
  v_cvt_pk_bf16_f32 v176, v160, v161
  v_cvt_pk_bf16_f32 v177, v162, v163
  ds_write_b64 v184, v[176:177] offset:4104
  v_mul_f32 v168, v168, v172
  v_mul_f32 v169, v169, v172
  v_mul_f32 v170, v170, v174
  v_mul_f32 v171, v171, v174
  v_cvt_pk_bf16_f32 v178, v168, v169
  v_cvt_pk_bf16_f32 v179, v170, v171
  ds_write_b64 v184, v[178:179] offset:22536
recurrent_scan__linear_attn_block__glu_gated_bilinear__prompt_kernel_odone:
  s_waitcnt lgkmcnt(0)
  s_barrier
  ds_read_b128 v[4:7], v121 offset:0
  ds_read_b128 v[76:79], v121 offset:18432
  ds_read_b128 v[8:11], v121 offset:1024
  ds_read_b128 v[80:83], v121 offset:19456
  ds_read_b128 v[12:15], v121 offset:2048
  ds_read_b128 v[84:87], v121 offset:20480
  ds_read_b128 v[16:19], v121 offset:3072
  ds_read_b128 v[88:91], v121 offset:21504
  ds_read_b128 v[20:23], v121 offset:4096
  ds_read_b128 v[92:95], v121 offset:22528
  ds_read_b128 v[24:27], v121 offset:5120
  ds_read_b128 v[96:99], v121 offset:23552
  ds_read_b128 v[28:31], v121 offset:6144
  ds_read_b128 v[200:203], v121 offset:24576
  ds_read_b128 v[32:35], v121 offset:7168
  ds_read_b128 v[204:207], v121 offset:25600
  ds_read_b128 v[36:39], v121 offset:8192
  ds_read_b128 v[208:211], v121 offset:26624
  s_waitcnt vmcnt(0)
  v_xor_b32 v252, s48, v252
  v_sub_u32 v253, v253, s49
  v_lshrrev_b32 v253, 4, v253
  v_or_b32 v252, v252, v253
  v_cmp_ne_u32 vcc, 0, v252
  s_nop 0
  s_cmp_eq_u64 vcc, 0
  s_cbranch_scc0 recurrent_scan__linear_attn_block__glu_gated_bilinear__prompt_kernel_cf_w
recurrent_scan__linear_attn_block__glu_gated_bilinear__prompt_kernel_cf_d:
  buffer_load_dwordx4 v[188:191], v185, s[20:23], s37 offen sc1
  buffer_load_dwordx4 v[192:195], v185, s[20:23], s36 offen sc1
  buffer_load_dwordx4 v[196:199], v185, s[20:23], s38 offen sc1
  buffer_load_dwordx4 v[176:179], v186, s[20:23], s37 offen sc1
  buffer_load_dwordx4 v[180:183], v186, s[20:23], s36 offen sc1
  buffer_load_dwordx4 v[248:251], v186, s[20:23], s38 offen sc1
  ds_read_b128 v[40:43], v121 offset:9216
  ds_read_b128 v[212:215], v121 offset:27648
  ds_read_b128 v[44:47], v121 offset:10240
  ds_read_b128 v[216:219], v121 offset:28672
  ds_read_b128 v[48:51], v121 offset:11264
  ds_read_b128 v[220:223], v121 offset:29696
  ds_read_b128 v[52:55], v121 offset:12288
  ds_read_b128 v[224:227], v121 offset:30720
  ds_read_b128 v[56:59], v121 offset:13312
  ds_read_b128 v[228:231], v121 offset:31744
  ds_read_b128 v[60:63], v121 offset:14336
  ds_read_b128 v[232:235], v121 offset:32768
  ds_read_b128 v[64:67], v121 offset:15360
  ds_read_b128 v[236:239], v121 offset:33792
  ds_read_b128 v[68:71], v121 offset:16384
  ds_read_b128 v[240:243], v121 offset:34816
  ds_read_b128 v[72:75], v121 offset:17408
  ds_read_b128 v[244:247], v121 offset:35840
  s_cmp_eq_u32 s56, s78
  s_cbranch_scc1 recurrent_scan__linear_attn_block__glu_gated_bilinear__prompt_kernel_three
  s_waitcnt lgkmcnt(15)
  v_mfma_f32_16x16x32_bf16 v[128:131], a[152:155], v[4:7], 0
  v_mfma_f32_16x16x32_bf16 v[128:131], a[156:159], v[8:11], v[128:131]
  v_mfma_f32_16x16x32_bf16 v[128:131], a[160:163], v[12:15], v[128:131]
  v_mfma_f32_16x16x32_bf16 v[128:131], a[164:167], v[16:19], v[128:131]
  v_mfma_f32_16x16x32_bf16 v[128:131], a[168:171], v[20:23], v[128:131]
  v_mfma_f32_16x16x32_bf16 v[128:131], a[172:175], v[24:27], v[128:131]
  v_mfma_f32_16x16x32_bf16 v[128:131], a[176:179], v[28:31], v[128:131]
  v_mfma_f32_16x16x32_bf16 v[128:131], a[180:183], v[32:35], v[128:131]
  v_mfma_f32_16x16x32_bf16 v[128:131], a[24:27], v[36:39], v[128:131]
  v_mfma_f32_16x16x32_bf16 v[128:131], a[28:31], v[40:43], v[128:131]
  v_mfma_f32_16x16x32_bf16 v[128:131], a[32:35], v[44:47], v[128:131]
  s_waitcnt lgkmcnt(13)
  v_mfma_f32_16x16x32_bf16 v[128:131], a[36:39], v[48:51], v[128:131]
  s_waitcnt lgkmcnt(11)
  v_mfma_f32_16x16x32_bf16 v[128:131], a[0:3], v[52:55], v[128:131]
  s_waitcnt lgkmcnt(9)
  v_mfma_f32_16x16x32_bf16 v[128:131], a[4:7], v[56:59], v[128:131]
  s_waitcnt lgkmcnt(7)
  v_mfma_f32_16x16x32_bf16 v[128:131], a[8:11], v[60:63], v[128:131]
  s_waitcnt lgkmcnt(5)
  v_mfma_f32_16x16x32_bf16 v[128:131], a[12:15], v[64:67], v[128:131]
  s_waitcnt lgkmcnt(3)
  v_mfma_f32_16x16x32_bf16 v[128:131], a[16:19], v[68:71], v[128:131]
  s_waitcnt lgkmcnt(1)
  v_mfma_f32_16x16x32_bf16 v[128:131], a[20:23], v[72:75], v[128:131]
  v_mfma_f32_16x16x32_bf16 v[132:135], a[152:155], v[76:79], 0
  ds_read_b128 v[152:155], v187 offset:0
  v_mfma_f32_16x16x32_bf16 v[132:135], a[156:159], v[80:83], v[132:135]
  ds_read_b128 v[156:159], v187 offset:1024
  v_mfma_f32_16x16x32_bf16 v[132:135], a[160:163], v[84:87], v[132:135]
  ds_read_b128 v[160:163], v187 offset:8192
  v_mfma_f32_16x16x32_bf16 v[132:135], a[164:167], v[88:91], v[132:135]
  ds_read_b128 v[164:167], v187 offset:9216
  v_mfma_f32_16x16x32_bf16 v[132:135], a[168:171], v[92:95], v[132:135]
  v_mfma_f32_16x16x32_bf16 v[132:135], a[172:175], v[96:99], v[132:135]
  v_mfma_f32_16x16x32_bf16 v[132:135], a[176:179], v[200:203], v[132:135]
  v_mfma_f32_16x16x32_bf16 v[132:135], a[180:183], v[204:207], v[132:135]
  v_mfma_f32_16x16x32_bf16 v[132:135], a[24:27], v[208:211], v[132:135]
  v_mfma_f32_16x16x32_bf16 v[132:135], a[28:31], v[212:215], v[132:135]
  v_mfma_f32_16x16x32_bf16 v[132:135], a[32:35], v[216:219], v[132:135]
  v_mfma_f32_16x16x32_bf16 v[132:135], a[36:39], v[220:223], v[132:135]
  v_mfma_f32_16x16x32_bf16 v[132:135], a[0:3], v[224:227], v[132:135]
  v_mfma_f32_16x16x32_bf16 v[132:135], a[4:7], v[228:231], v[132:135]
  v_mfma_f32_16x16x32_bf16 v[132:135], a[8:11], v[232:235], v[132:135]
  v_mfma_f32_16x16x32_bf16 v[132:135], a[12:15], v[236:239], v[132:135]
  v_mfma_f32_16x16x32_bf16 v[132:135], a[16:19], v[240:243], v[132:135]
  s_waitcnt lgkmcnt(4)
  v_mfma_f32_16x16x32_bf16 v[132:135], a[20:23], v[244:247], v[132:135]
  v_mfma_f32_16x16x32_bf16 v[136:139], a[252:255], v[4:7], 0
  v_mfma_f32_16x16x32_bf16 v[136:139], a[148:151], v[8:11], v[136:139]
  v_mfma_f32_16x16x32_bf16 v[136:139], a[216:219], v[12:15], v[136:139]
  v_mfma_f32_16x16x32_bf16 v[136:139], a[220:223], v[16:19], v[136:139]
  v_mfma_f32_16x16x32_bf16 v[136:139], a[224:227], v[20:23], v[136:139]
  v_mfma_f32_16x16x32_bf16 v[136:139], a[228:231], v[24:27], v[136:139]
  v_mfma_f32_16x16x32_bf16 v[136:139], a[232:235], v[28:31], v[136:139]
  v_mfma_f32_16x16x32_bf16 v[136:139], a[236:239], v[32:35], v[136:139]
  v_mfma_f32_16x16x32_bf16 v[136:139], a[240:243], v[36:39], v[136:139]
  v_mfma_f32_16x16x32_bf16 v[136:139], a[244:247], v[40:43], v[136:139]
  v_mfma_f32_16x16x32_bf16 v[136:139], a[40:43], v[44:47], v[136:139]
  v_mfma_f32_16x16x32_bf16 v[136:139], a[44:47], v[48:51], v[136:139]
  v_mfma_f32_16x16x32_bf16 v[136:139], a[48:51], v[52:55], v[136:139]
  v_mfma_f32_16x16x32_bf16 v[136:139], a[52:55], v[56:59], v[136:139]
  v_mfma_f32_16x16x32_bf16 v[136:139], a[56:59], v[60:63], v[136:139]
  v_mfma_f32_16x16x32_bf16 v[136:139], a[60:63], v[64:67], v[136:139]
  v_mfma_f32_16x16x32_bf16 v[136:139], a[64:67], v[68:71], v[136:139]
  v_mfma_f32_16x16x32_bf16 v[136:139], a[68:71], v[72:75], v[136:139]
  v_mfma_f32_16x16x32_bf16 v[140:143], a[252:255], v[76:79], 0
  v_mfma_f32_16x16x32_bf16 v[140:143], a[148:151], v[80:83], v[140:143]
  v_mfma_f32_16x16x32_bf16 v[140:143], a[216:219], v[84:87], v[140:143]
  v_mfma_f32_16x16x32_bf16 v[140:143], a[220:223], v[88:91], v[140:143]
  v_mfma_f32_16x16x32_bf16 v[140:143], a[224:227], v[92:95], v[140:143]
  v_mfma_f32_16x16x32_bf16 v[140:143], a[228:231], v[96:99], v[140:143]
  v_mfma_f32_16x16x32_bf16 v[140:143], a[232:235], v[200:203], v[140:143]
  v_mfma_f32_16x16x32_bf16 v[140:143], a[236:239], v[204:207], v[140:143]
  v_mfma_f32_16x16x32_bf16 v[140:143], a[240:243], v[208:211], v[140:143]
  v_mfma_f32_16x16x32_bf16 v[140:143], a[244:247], v[212:215], v[140:143]
  v_mfma_f32_16x16x32_bf16 v[140:143], a[40:43], v[216:219], v[140:143]
  v_mfma_f32_16x16x32_bf16 v[140:143], a[44:47], v[220:223], v[140:143]
  v_mfma_f32_16x16x32_bf16 v[140:143], a[48:51], v[224:227], v[140:143]
  v_mfma_f32_16x16x32_bf16 v[140:143], a[52:55], v[228:231], v[140:143]
  v_mfma_f32_16x16x32_bf16 v[140:143], a[56:59], v[232:235], v[140:143]
  v_mfma_f32_16x16x32_bf16 v[140:143], a[60:63], v[236:239], v[140:143]
  v_mfma_f32_16x16x32_bf16 v[140:143], a[64:67], v[240:243], v[140:143]
  v_mfma_f32_16x16x32_bf16 v[140:143], a[68:71], v[244:247], v[140:143]
  v_lshlrev_b32 v4, 16, v100
  v_and_b32 v5, s46, v100
  v_lshlrev_b32 v6, 16, v101
  v_and_b32 v7, s46, v101
  v_lshlrev_b32 v8, 16, v102
  v_and_b32 v9, s46, v102
  v_lshlrev_b32 v10, 16, v103
  v_and_b32 v11, s46, v103
  v_lshlrev_b32 v12, 16, v104
  v_and_b32 v13, s46, v104
  v_lshlrev_b32 v14, 16, v105
  v_and_b32 v15, s46, v105
  v_lshlrev_b32 v16, 16, v106
  v_and_b32 v17, s46, v106
  v_lshlrev_b32 v18, 16, v107
  v_and_b32 v19, s46, v107
  s_waitcnt vmcnt(5) lgkmcnt(3)
  v_dot2_f32_bf16 v152, v188, s98, v152
  v_dot2_f32_bf16 v153, v188, s99, v153
  v_dot2_f32_bf16 v154, v189, s98, v154
  v_dot2_f32_bf16 v155, v189, s99, v155
  s_waitcnt lgkmcnt(2)
  v_dot2_f32_bf16 v156, v190, s98, v156
  v_dot2_f32_bf16 v157, v190, s99, v157
  v_dot2_f32_bf16 v158, v191, s98, v158
  v_dot2_f32_bf16 v159, v191, s99, v159
  s_waitcnt vmcnt(4)
  v_dot2_f32_bf16 v152, v192, s98, v152
  v_dot2_f32_bf16 v153, v192, s99, v153
  v_dot2_f32_bf16 v154, v193, s98, v154
  v_dot2_f32_bf16 v155, v193, s99, v155
  v_dot2_f32_bf16 v156, v194, s98, v156
  v_dot2_f32_bf16 v157, v194, s99, v157
  v_dot2_f32_bf16 v158, v195, s98, v158
  v_dot2_f32_bf16 v159, v195, s99, v159
  s_waitcnt vmcnt(3)
  v_dot2_f32_bf16 v152, v196, s98, v152
  v_dot2_f32_bf16 v153, v196, s99, v153
  v_dot2_f32_bf16 v154, v197, s98, v154
  v_dot2_f32_bf16 v155, v197, s99, v155
  v_dot2_f32_bf16 v156, v198, s98, v156
  v_dot2_f32_bf16 v157, v198, s99, v157
  v_dot2_f32_bf16 v158, v199, s98, v158
  v_dot2_f32_bf16 v159, v199, s99, v159
  v_pk_mul_f32 v[28:29], v[152:153], s[90:91]
  v_pk_mul_f32 v[30:31], v[154:155], s[90:91]
  v_pk_mul_f32 v[32:33], v[156:157], s[90:91]
  v_pk_mul_f32 v[34:35], v[158:159], s[90:91]
  v_exp_f32 v28, v28
  v_exp_f32 v29, v29
  v_exp_f32 v30, v30
  v_exp_f32 v31, v31
  v_exp_f32 v32, v32
  v_exp_f32 v33, v33
  v_exp_f32 v34, v34
  v_exp_f32 v35, v35
  v_pk_mul_f32 v[152:153], v[152:153], v[128:129]
  v_pk_mul_f32 v[154:155], v[154:155], v[130:131]
  v_pk_mul_f32 v[156:157], v[156:157], v[132:133]
  v_pk_mul_f32 v[158:159], v[158:159], v[134:135]
  v_pk_add_f32 v[28:29], v[28:29], 1.0 op_sel_hi:[1,0]
  v_pk_add_f32 v[30:31], v[30:31], 1.0 op_sel_hi:[1,0]
  v_pk_add_f32 v[32:33], v[32:33], 1.0 op_sel_hi:[1,0]
  v_pk_add_f32 v[34:35], v[34:35], 1.0 op_sel_hi:[1,0]
  v_rcp_f32 v28, v28
  v_rcp_f32 v29, v29
  v_rcp_f32 v30, v30
  v_rcp_f32 v31, v31
  v_rcp_f32 v32, v32
  v_rcp_f32 v33, v33
  v_rcp_f32 v34, v34
  v_rcp_f32 v35, v35
  v_pk_mul_f32 v[28:29], v[28:29], v[152:153]
  v_pk_mul_f32 v[30:31], v[30:31], v[154:155]
  v_pk_mul_f32 v[32:33], v[32:33], v[156:157]
  v_pk_mul_f32 v[34:35], v[34:35], v[158:159]
  s_nop 0
  v_permlane16_swap_b32 v28, v32
  v_permlane16_swap_b32 v29, v33
  v_permlane16_swap_b32 v30, v34
  v_permlane16_swap_b32 v31, v35
  v_pk_add_f32 v[28:29], v[28:29], v[4:5]
  v_pk_add_f32 v[30:31], v[30:31], v[6:7]
  v_pk_add_f32 v[32:33], v[32:33], v[8:9]
  v_pk_add_f32 v[34:35], v[34:35], v[10:11]
  v_cvt_pk_bf16_f32 v44, v28, v29
  v_cvt_pk_bf16_f32 v45, v30, v31
  v_cvt_pk_bf16_f32 v46, v32, v33
  v_cvt_pk_bf16_f32 v47, v34, v35
  buffer_store_dwordx4 v[44:47], v1, s[8:11], 0 offen offset:0
  s_waitcnt vmcnt(3) lgkmcnt(1)
  v_dot2_f32_bf16 v160, v176, s98, v160
  v_dot2_f32_bf16 v161, v176, s99, v161
  v_dot2_f32_bf16 v162, v177, s98, v162
  v_dot2_f32_bf16 v163, v177, s99, v163
  s_waitcnt lgkmcnt(0)
  v_dot2_f32_bf16 v164, v178, s98, v164
  v_dot2_f32_bf16 v165, v178, s99, v165
  v_dot2_f32_bf16 v166, v179, s98, v166
  v_dot2_f32_bf16 v167, v179, s99, v167
  s_waitcnt vmcnt(2)
  v_dot2_f32_bf16 v160, v180, s98, v160
  v_dot2_f32_bf16 v161, v180, s99, v161
  v_dot2_f32_bf16 v162, v181, s98, v162
  v_dot2_f32_bf16 v163, v181, s99, v163
  v_dot2_f32_bf16 v164, v182, s98, v164
  v_dot2_f32_bf16 v165, v182, s99, v165
  v_dot2_f32_bf16 v166, v183, s98, v166
  v_dot2_f32_bf16 v167, v183, s99, v167
  s_waitcnt vmcnt(1)
  v_dot2_f32_bf16 v160, v248, s98, v160
  v_dot2_f32_bf16 v161, v248, s99, v161
  v_dot2_f32_bf16 v162, v249, s98, v162
  v_dot2_f32_bf16 v163, v249, s99, v163
  v_dot2_f32_bf16 v164, v250, s98, v164
  v_dot2_f32_bf16 v165, v250, s99, v165
  v_dot2_f32_bf16 v166, v251, s98, v166
  v_dot2_f32_bf16 v167, v251, s99, v167
  v_pk_mul_f32 v[28:29], v[160:161], s[90:91]
  v_pk_mul_f32 v[30:31], v[162:163], s[90:91]
  v_pk_mul_f32 v[32:33], v[164:165], s[90:91]
  v_pk_mul_f32 v[34:35], v[166:167], s[90:91]
  v_exp_f32 v28, v28
  v_exp_f32 v29, v29
  v_exp_f32 v30, v30
  v_exp_f32 v31, v31
  v_exp_f32 v32, v32
  v_exp_f32 v33, v33
  v_exp_f32 v34, v34
  v_exp_f32 v35, v35
  v_pk_mul_f32 v[160:161], v[160:161], v[136:137]
  v_pk_mul_f32 v[162:163], v[162:163], v[138:139]
  v_pk_mul_f32 v[164:165], v[164:165], v[140:141]
  v_pk_mul_f32 v[166:167], v[166:167], v[142:143]
  v_pk_add_f32 v[28:29], v[28:29], 1.0 op_sel_hi:[1,0]
  v_pk_add_f32 v[30:31], v[30:31], 1.0 op_sel_hi:[1,0]
  v_pk_add_f32 v[32:33], v[32:33], 1.0 op_sel_hi:[1,0]
  v_pk_add_f32 v[34:35], v[34:35], 1.0 op_sel_hi:[1,0]
  v_rcp_f32 v28, v28
  v_rcp_f32 v29, v29
  v_rcp_f32 v30, v30
  v_rcp_f32 v31, v31
  v_rcp_f32 v32, v32
  v_rcp_f32 v33, v33
  v_rcp_f32 v34, v34
  v_rcp_f32 v35, v35
  v_pk_mul_f32 v[28:29], v[28:29], v[160:161]
  v_pk_mul_f32 v[30:31], v[30:31], v[162:163]
  v_pk_mul_f32 v[32:33], v[32:33], v[164:165]
  v_pk_mul_f32 v[34:35], v[34:35], v[166:167]
  s_nop 0
  v_permlane16_swap_b32 v28, v32
  v_permlane16_swap_b32 v29, v33
  v_permlane16_swap_b32 v30, v34
  v_permlane16_swap_b32 v31, v35
  v_pk_add_f32 v[28:29], v[28:29], v[12:13]
  v_pk_add_f32 v[30:31], v[30:31], v[14:15]
  v_pk_add_f32 v[32:33], v[32:33], v[16:17]
  v_pk_add_f32 v[34:35], v[34:35], v[18:19]
  v_cvt_pk_bf16_f32 v48, v28, v29
  v_cvt_pk_bf16_f32 v49, v30, v31
  v_cvt_pk_bf16_f32 v50, v32, v33
  v_cvt_pk_bf16_f32 v51, v34, v35
  buffer_store_dwordx4 v[48:51], v1, s[8:11], 0 offen offset:128
  s_branch recurrent_scan__linear_attn_block__glu_gated_bilinear__prompt_kernel_end
recurrent_scan__linear_attn_block__glu_gated_bilinear__prompt_kernel_three:
  s_waitcnt lgkmcnt(15)
  v_mfma_f32_16x16x32_bf16 v[128:131], a[152:155], v[4:7], 0
  s_add_u32 s69, s51, 0
  buffer_load_dwordx4 a[72:75], v108, s[20:23], s69 offen sc1
  v_mfma_f32_16x16x32_bf16 v[128:131], a[156:159], v[8:11], v[128:131]
  s_add_u32 s69, s51, 36864
  buffer_load_dwordx4 a[76:79], v108, s[20:23], s69 offen sc1
  v_mfma_f32_16x16x32_bf16 v[128:131], a[160:163], v[12:15], v[128:131]
  s_add_u32 s69, s51, 73728
  buffer_load_dwordx4 a[80:83], v108, s[20:23], s69 offen sc1
  v_mfma_f32_16x16x32_bf16 v[128:131], a[164:167], v[16:19], v[128:131]
  v_mfma_f32_16x16x32_bf16 v[128:131], a[168:171], v[20:23], v[128:131]
  s_add_u32 s69, s51, 110592
  buffer_load_dwordx4 a[84:87], v108, s[20:23], s69 offen sc1
  v_mfma_f32_16x16x32_bf16 v[128:131], a[172:175], v[24:27], v[128:131]
  v_mfma_f32_16x16x32_bf16 v[128:131], a[176:179], v[28:31], v[128:131]
  s_add_u32 s69, s51, 147456
  buffer_load_dwordx4 a[88:91], v108, s[20:23], s69 offen sc1
  v_mfma_f32_16x16x32_bf16 v[128:131], a[180:183], v[32:35], v[128:131]
  v_mfma_f32_16x16x32_bf16 v[128:131], a[24:27], v[36:39], v[128:131]
  s_add_u32 s69, s51, 184320
  buffer_load_dwordx4 a[92:95], v108, s[20:23], s69 offen sc1
  v_mfma_f32_16x16x32_bf16 v[128:131], a[28:31], v[40:43], v[128:131]
  v_mfma_f32_16x16x32_bf16 v[128:131], a[32:35], v[44:47], v[128:131]
  s_add_u32 s69, s51, 221184
  buffer_load_dwordx4 a[96:99], v108, s[20:23], s69 offen sc1
  s_waitcnt lgkmcnt(13)
  v_mfma_f32_16x16x32_bf16 v[128:131], a[36:39], v[48:51], v[128:131]
  s_waitcnt lgkmcnt(11)
  v_mfma_f32_16x16x32_bf16 v[128:131], a[0:3], v[52:55], v[128:131]
  s_add_u32 s69, s51, 258048
  buffer_load_dwordx4 a[100:103], v108, s[20:23], s69 offen sc1
  s_waitcnt lgkmcnt(9)
  v_mfma_f32_16x16x32_bf16 v[128:131], a[4:7], v[56:59], v[128:131]
  s_waitcnt lgkmcnt(7)
  v_mfma_f32_16x16x32_bf16 v[128:131], a[8:11], v[60:63], v[128:131]
  s_add_u32 s69, s51, 294912
  buffer_load_dwordx4 a[184:187], v108, s[20:23], s69 offen sc1
  s_waitcnt lgkmcnt(5)
  v_mfma_f32_16x16x32_bf16 v[128:131], a[12:15], v[64:67], v[128:131]
  s_waitcnt lgkmcnt(3)
  v_mfma_f32_16x16x32_bf16 v[128:131], a[16:19], v[68:71], v[128:131]
  s_add_u32 s69, s51, 331776
  buffer_load_dwordx4 a[188:191], v108, s[20:23], s69 offen sc1
  s_waitcnt lgkmcnt(1)
  v_mfma_f32_16x16x32_bf16 v[128:131], a[20:23], v[72:75], v[128:131]
  v_mfma_f32_16x16x32_bf16 v[132:135], a[152:155], v[76:79], 0
  s_add_u32 s69, s51, 368640
  buffer_load_dwordx4 a[192:195], v108, s[20:23], s69 offen sc1
  v_mfma_f32_16x16x32_bf16 v[132:135], a[156:159], v[80:83], v[132:135]
  ds_read_b128 v[152:155], v187 offset:0
  v_mfma_f32_16x16x32_bf16 v[132:135], a[160:163], v[84:87], v[132:135]
  s_add_u32 s69, s51, 405504
  buffer_load_dwordx4 a[196:199], v108, s[20:23], s69 offen sc1
  v_mfma_f32_16x16x32_bf16 v[132:135], a[164:167], v[88:91], v[132:135]
  ds_read_b128 v[156:159], v187 offset:1024
  v_mfma_f32_16x16x32_bf16 v[132:135], a[168:171], v[92:95], v[132:135]
  s_add_u32 s69, s51, 442368
  buffer_load_dwordx4 a[200:203], v108, s[20:23], s69 offen sc1
  v_mfma_f32_16x16x32_bf16 v[132:135], a[172:175], v[96:99], v[132:135]
  ds_read_b128 v[160:163], v187 offset:8192
  v_mfma_f32_16x16x32_bf16 v[132:135], a[176:179], v[200:203], v[132:135]
  s_add_u32 s69, s51, 479232
  buffer_load_dwordx4 a[204:207], v108, s[20:23], s69 offen sc1
  v_mfma_f32_16x16x32_bf16 v[132:135], a[180:183], v[204:207], v[132:135]
  ds_read_b128 v[164:167], v187 offset:9216
  v_mfma_f32_16x16x32_bf16 v[132:135], a[24:27], v[208:211], v[132:135]
  s_add_u32 s69, s51, 516096
  buffer_load_dwordx4 a[208:211], v108, s[20:23], s69 offen sc1
  v_mfma_f32_16x16x32_bf16 v[132:135], a[28:31], v[212:215], v[132:135]
  ds_read_b128 v[168:171], v122 offset:16384
  v_mfma_f32_16x16x32_bf16 v[132:135], a[32:35], v[216:219], v[132:135]
  s_add_u32 s69, s51, 552960
  buffer_load_dwordx4 a[212:215], v108, s[20:23], s69 offen sc1
  v_mfma_f32_16x16x32_bf16 v[132:135], a[36:39], v[220:223], v[132:135]
  ds_read_b128 v[172:175], v122 offset:17408
  v_mfma_f32_16x16x32_bf16 v[132:135], a[0:3], v[224:227], v[132:135]
  s_add_u32 s69, s51, 589824
  buffer_load_dwordx4 a[104:107], v108, s[20:23], s69 offen sc1
  v_mfma_f32_16x16x32_bf16 v[132:135], a[4:7], v[228:231], v[132:135]
  v_mfma_f32_16x16x32_bf16 v[132:135], a[8:11], v[232:235], v[132:135]
  s_add_u32 s69, s51, 626688
  buffer_load_dwordx4 a[108:111], v108, s[20:23], s69 offen sc1
  v_mfma_f32_16x16x32_bf16 v[132:135], a[12:15], v[236:239], v[132:135]
  v_mfma_f32_16x16x32_bf16 v[132:135], a[16:19], v[240:243], v[132:135]
  buffer_load_dwordx4 a[112:115], v111, s[20:23], s37 offen sc1
  s_waitcnt lgkmcnt(6)
  v_mfma_f32_16x16x32_bf16 v[132:135], a[20:23], v[244:247], v[132:135]
  v_mfma_f32_16x16x32_bf16 v[136:139], a[252:255], v[4:7], 0
  buffer_load_dwordx4 a[116:119], v111, s[20:23], s36 offen sc1
  v_mfma_f32_16x16x32_bf16 v[136:139], a[148:151], v[8:11], v[136:139]
  v_mfma_f32_16x16x32_bf16 v[136:139], a[216:219], v[12:15], v[136:139]
  buffer_load_dwordx4 a[120:123], v111, s[20:23], s38 offen sc1
  v_mfma_f32_16x16x32_bf16 v[136:139], a[220:223], v[16:19], v[136:139]
  v_mfma_f32_16x16x32_bf16 v[136:139], a[224:227], v[20:23], v[136:139]
  v_mfma_f32_16x16x32_bf16 v[136:139], a[228:231], v[24:27], v[136:139]
  v_mfma_f32_16x16x32_bf16 v[136:139], a[232:235], v[28:31], v[136:139]
  v_mfma_f32_16x16x32_bf16 v[136:139], a[236:239], v[32:35], v[136:139]
  v_mfma_f32_16x16x32_bf16 v[136:139], a[240:243], v[36:39], v[136:139]
  v_mfma_f32_16x16x32_bf16 v[136:139], a[244:247], v[40:43], v[136:139]
  v_mfma_f32_16x16x32_bf16 v[136:139], a[40:43], v[44:47], v[136:139]
  v_mfma_f32_16x16x32_bf16 v[136:139], a[44:47], v[48:51], v[136:139]
  v_mfma_f32_16x16x32_bf16 v[136:139], a[48:51], v[52:55], v[136:139]
  v_mfma_f32_16x16x32_bf16 v[136:139], a[52:55], v[56:59], v[136:139]
  v_mfma_f32_16x16x32_bf16 v[136:139], a[56:59], v[60:63], v[136:139]
  v_mfma_f32_16x16x32_bf16 v[136:139], a[60:63], v[64:67], v[136:139]
  v_mfma_f32_16x16x32_bf16 v[136:139], a[64:67], v[68:71], v[136:139]
  v_mfma_f32_16x16x32_bf16 v[136:139], a[68:71], v[72:75], v[136:139]
  v_mfma_f32_16x16x32_bf16 v[140:143], a[252:255], v[76:79], 0
  v_mfma_f32_16x16x32_bf16 v[140:143], a[148:151], v[80:83], v[140:143]
  v_mfma_f32_16x16x32_bf16 v[140:143], a[216:219], v[84:87], v[140:143]
  v_mfma_f32_16x16x32_bf16 v[140:143], a[220:223], v[88:91], v[140:143]
  v_mfma_f32_16x16x32_bf16 v[140:143], a[224:227], v[92:95], v[140:143]
  v_mfma_f32_16x16x32_bf16 v[140:143], a[228:231], v[96:99], v[140:143]
  v_mfma_f32_16x16x32_bf16 v[140:143], a[232:235], v[200:203], v[140:143]
  v_mfma_f32_16x16x32_bf16 v[140:143], a[236:239], v[204:207], v[140:143]
  v_mfma_f32_16x16x32_bf16 v[140:143], a[240:243], v[208:211], v[140:143]
  v_mfma_f32_16x16x32_bf16 v[140:143], a[244:247], v[212:215], v[140:143]
  v_mfma_f32_16x16x32_bf16 v[140:143], a[40:43], v[216:219], v[140:143]
  v_mfma_f32_16x16x32_bf16 v[140:143], a[44:47], v[220:223], v[140:143]
  v_mfma_f32_16x16x32_bf16 v[140:143], a[48:51], v[224:227], v[140:143]
  v_mfma_f32_16x16x32_bf16 v[140:143], a[52:55], v[228:231], v[140:143]
  v_mfma_f32_16x16x32_bf16 v[140:143], a[56:59], v[232:235], v[140:143]
  v_mfma_f32_16x16x32_bf16 v[140:143], a[60:63], v[236:239], v[140:143]
  v_mfma_f32_16x16x32_bf16 v[140:143], a[64:67], v[240:243], v[140:143]
  v_mfma_f32_16x16x32_bf16 v[140:143], a[68:71], v[244:247], v[140:143]
  s_waitcnt vmcnt(20)
  v_mfma_f32_16x16x32_bf16 v[144:147], a[72:75], v[4:7], 0
  s_waitcnt vmcnt(19)
  v_mfma_f32_16x16x32_bf16 v[144:147], a[76:79], v[8:11], v[144:147]
  s_waitcnt vmcnt(18)
  v_mfma_f32_16x16x32_bf16 v[144:147], a[80:83], v[12:15], v[144:147]
  s_waitcnt vmcnt(17)
  v_mfma_f32_16x16x32_bf16 v[144:147], a[84:87], v[16:19], v[144:147]
  s_waitcnt vmcnt(16)
  v_mfma_f32_16x16x32_bf16 v[144:147], a[88:91], v[20:23], v[144:147]
  s_waitcnt vmcnt(15)
  v_mfma_f32_16x16x32_bf16 v[144:147], a[92:95], v[24:27], v[144:147]
  s_waitcnt vmcnt(14)
  v_mfma_f32_16x16x32_bf16 v[144:147], a[96:99], v[28:31], v[144:147]
  s_waitcnt vmcnt(13)
  v_mfma_f32_16x16x32_bf16 v[144:147], a[100:103], v[32:35], v[144:147]
  s_waitcnt vmcnt(12)
  v_mfma_f32_16x16x32_bf16 v[144:147], a[184:187], v[36:39], v[144:147]
  s_waitcnt vmcnt(11)
  v_mfma_f32_16x16x32_bf16 v[144:147], a[188:191], v[40:43], v[144:147]
  s_waitcnt vmcnt(10)
  v_mfma_f32_16x16x32_bf16 v[144:147], a[192:195], v[44:47], v[144:147]
  s_waitcnt vmcnt(9)
  v_mfma_f32_16x16x32_bf16 v[144:147], a[196:199], v[48:51], v[144:147]
  s_waitcnt vmcnt(8)
  v_mfma_f32_16x16x32_bf16 v[144:147], a[200:203], v[52:55], v[144:147]
  s_waitcnt vmcnt(7)
  v_mfma_f32_16x16x32_bf16 v[144:147], a[204:207], v[56:59], v[144:147]
  s_waitcnt vmcnt(6)
  v_mfma_f32_16x16x32_bf16 v[144:147], a[208:211], v[60:63], v[144:147]
  s_waitcnt vmcnt(5)
  v_mfma_f32_16x16x32_bf16 v[144:147], a[212:215], v[64:67], v[144:147]
  s_waitcnt vmcnt(4)
  v_mfma_f32_16x16x32_bf16 v[144:147], a[104:107], v[68:71], v[144:147]
  s_waitcnt vmcnt(3)
  v_mfma_f32_16x16x32_bf16 v[144:147], a[108:111], v[72:75], v[144:147]
  v_mfma_f32_16x16x32_bf16 v[148:151], a[72:75], v[76:79], 0
  v_mfma_f32_16x16x32_bf16 v[148:151], a[76:79], v[80:83], v[148:151]
  v_mfma_f32_16x16x32_bf16 v[148:151], a[80:83], v[84:87], v[148:151]
  v_mfma_f32_16x16x32_bf16 v[148:151], a[84:87], v[88:91], v[148:151]
  v_mfma_f32_16x16x32_bf16 v[148:151], a[88:91], v[92:95], v[148:151]
  v_mfma_f32_16x16x32_bf16 v[148:151], a[92:95], v[96:99], v[148:151]
  v_mfma_f32_16x16x32_bf16 v[148:151], a[96:99], v[200:203], v[148:151]
  v_mfma_f32_16x16x32_bf16 v[148:151], a[100:103], v[204:207], v[148:151]
  v_mfma_f32_16x16x32_bf16 v[148:151], a[184:187], v[208:211], v[148:151]
  v_mfma_f32_16x16x32_bf16 v[148:151], a[188:191], v[212:215], v[148:151]
  v_mfma_f32_16x16x32_bf16 v[148:151], a[192:195], v[216:219], v[148:151]
  v_mfma_f32_16x16x32_bf16 v[148:151], a[196:199], v[220:223], v[148:151]
  v_mfma_f32_16x16x32_bf16 v[148:151], a[200:203], v[224:227], v[148:151]
  v_mfma_f32_16x16x32_bf16 v[148:151], a[204:207], v[228:231], v[148:151]
  v_mfma_f32_16x16x32_bf16 v[148:151], a[208:211], v[232:235], v[148:151]
  v_mfma_f32_16x16x32_bf16 v[148:151], a[212:215], v[236:239], v[148:151]
  v_mfma_f32_16x16x32_bf16 v[148:151], a[104:107], v[240:243], v[148:151]
  v_mfma_f32_16x16x32_bf16 v[148:151], a[108:111], v[244:247], v[148:151]
  v_lshlrev_b32 v4, 16, v100
  v_and_b32 v5, s46, v100
  v_lshlrev_b32 v6, 16, v101
  v_and_b32 v7, s46, v101
  v_lshlrev_b32 v8, 16, v102
  v_and_b32 v9, s46, v102
  v_lshlrev_b32 v10, 16, v103
  v_and_b32 v11, s46, v103
  v_lshlrev_b32 v12, 16, v104
  v_and_b32 v13, s46, v104
  v_lshlrev_b32 v14, 16, v105
  v_and_b32 v15, s46, v105
  v_lshlrev_b32 v16, 16, v106
  v_and_b32 v17, s46, v106
  v_lshlrev_b32 v18, 16, v107
  v_and_b32 v19, s46, v107
  v_lshlrev_b32 v20, 16, v112
  v_and_b32 v21, s46, v112
  v_lshlrev_b32 v22, 16, v113
  v_and_b32 v23, s46, v113
  v_lshlrev_b32 v24, 16, v114
  v_and_b32 v25, s46, v114
  v_lshlrev_b32 v26, 16, v115
  v_and_b32 v27, s46, v115
  s_waitcnt lgkmcnt(5)
  v_dot2_f32_bf16 v152, v188, s98, v152
  v_dot2_f32_bf16 v153, v188, s99, v153
  v_dot2_f32_bf16 v154, v189, s98, v154
  v_dot2_f32_bf16 v155, v189, s99, v155
  s_waitcnt lgkmcnt(4)
  v_dot2_f32_bf16 v156, v190, s98, v156
  v_dot2_f32_bf16 v157, v190, s99, v157
  v_dot2_f32_bf16 v158, v191, s98, v158
  v_dot2_f32_bf16 v159, v191, s99, v159
  v_dot2_f32_bf16 v152, v192, s98, v152
  v_dot2_f32_bf16 v153, v192, s99, v153
  v_dot2_f32_bf16 v154, v193, s98, v154
  v_dot2_f32_bf16 v155, v193, s99, v155
  v_dot2_f32_bf16 v156, v194, s98, v156
  v_dot2_f32_bf16 v157, v194, s99, v157
  v_dot2_f32_bf16 v158, v195, s98, v158
  v_dot2_f32_bf16 v159, v195, s99, v159
  v_dot2_f32_bf16 v152, v196, s98, v152
  v_dot2_f32_bf16 v153, v196, s99, v153
  v_dot2_f32_bf16 v154, v197, s98, v154
  v_dot2_f32_bf16 v155, v197, s99, v155
  v_dot2_f32_bf16 v156, v198, s98, v156
  v_dot2_f32_bf16 v157, v198, s99, v157
  v_dot2_f32_bf16 v158, v199, s98, v158
  v_dot2_f32_bf16 v159, v199, s99, v159
  v_pk_mul_f32 v[28:29], v[152:153], s[90:91]
  v_pk_mul_f32 v[30:31], v[154:155], s[90:91]
  v_pk_mul_f32 v[32:33], v[156:157], s[90:91]
  v_pk_mul_f32 v[34:35], v[158:159], s[90:91]
  v_exp_f32 v28, v28
  v_exp_f32 v29, v29
  v_exp_f32 v30, v30
  v_exp_f32 v31, v31
  v_exp_f32 v32, v32
  v_exp_f32 v33, v33
  v_exp_f32 v34, v34
  v_exp_f32 v35, v35
  v_pk_mul_f32 v[152:153], v[152:153], v[128:129]
  v_pk_mul_f32 v[154:155], v[154:155], v[130:131]
  v_pk_mul_f32 v[156:157], v[156:157], v[132:133]
  v_pk_mul_f32 v[158:159], v[158:159], v[134:135]
  v_pk_add_f32 v[28:29], v[28:29], 1.0 op_sel_hi:[1,0]
  v_pk_add_f32 v[30:31], v[30:31], 1.0 op_sel_hi:[1,0]
  v_pk_add_f32 v[32:33], v[32:33], 1.0 op_sel_hi:[1,0]
  v_pk_add_f32 v[34:35], v[34:35], 1.0 op_sel_hi:[1,0]
  v_rcp_f32 v28, v28
  v_rcp_f32 v29, v29
  v_rcp_f32 v30, v30
  v_rcp_f32 v31, v31
  v_rcp_f32 v32, v32
  v_rcp_f32 v33, v33
  v_rcp_f32 v34, v34
  v_rcp_f32 v35, v35
  v_pk_mul_f32 v[28:29], v[28:29], v[152:153]
  v_pk_mul_f32 v[30:31], v[30:31], v[154:155]
  v_pk_mul_f32 v[32:33], v[32:33], v[156:157]
  v_pk_mul_f32 v[34:35], v[34:35], v[158:159]
  s_nop 0
  v_permlane16_swap_b32 v28, v32
  v_permlane16_swap_b32 v29, v33
  v_permlane16_swap_b32 v30, v34
  v_permlane16_swap_b32 v31, v35
  v_pk_add_f32 v[28:29], v[28:29], v[4:5]
  v_pk_add_f32 v[30:31], v[30:31], v[6:7]
  v_pk_add_f32 v[32:33], v[32:33], v[8:9]
  v_pk_add_f32 v[34:35], v[34:35], v[10:11]
  v_cvt_pk_bf16_f32 v44, v28, v29
  v_cvt_pk_bf16_f32 v45, v30, v31
  v_cvt_pk_bf16_f32 v46, v32, v33
  v_cvt_pk_bf16_f32 v47, v34, v35
  buffer_store_dwordx4 v[44:47], v1, s[8:11], 0 offen offset:0
  s_waitcnt lgkmcnt(3)
  v_dot2_f32_bf16 v160, v176, s98, v160
  v_dot2_f32_bf16 v161, v176, s99, v161
  v_dot2_f32_bf16 v162, v177, s98, v162
  v_dot2_f32_bf16 v163, v177, s99, v163
  s_waitcnt lgkmcnt(2)
  v_dot2_f32_bf16 v164, v178, s98, v164
  v_dot2_f32_bf16 v165, v178, s99, v165
  v_dot2_f32_bf16 v166, v179, s98, v166
  v_dot2_f32_bf16 v167, v179, s99, v167
  v_dot2_f32_bf16 v160, v180, s98, v160
  v_dot2_f32_bf16 v161, v180, s99, v161
  v_dot2_f32_bf16 v162, v181, s98, v162
  v_dot2_f32_bf16 v163, v181, s99, v163
  v_dot2_f32_bf16 v164, v182, s98, v164
  v_dot2_f32_bf16 v165, v182, s99, v165
  v_dot2_f32_bf16 v166, v183, s98, v166
  v_dot2_f32_bf16 v167, v183, s99, v167
  v_dot2_f32_bf16 v160, v248, s98, v160
  v_dot2_f32_bf16 v161, v248, s99, v161
  v_dot2_f32_bf16 v162, v249, s98, v162
  v_dot2_f32_bf16 v163, v249, s99, v163
  v_dot2_f32_bf16 v164, v250, s98, v164
  v_dot2_f32_bf16 v165, v250, s99, v165
  v_dot2_f32_bf16 v166, v251, s98, v166
  v_dot2_f32_bf16 v167, v251, s99, v167
  v_pk_mul_f32 v[28:29], v[160:161], s[90:91]
  v_pk_mul_f32 v[30:31], v[162:163], s[90:91]
  v_pk_mul_f32 v[32:33], v[164:165], s[90:91]
  v_pk_mul_f32 v[34:35], v[166:167], s[90:91]
  v_exp_f32 v28, v28
  v_exp_f32 v29, v29
  v_exp_f32 v30, v30
  v_exp_f32 v31, v31
  v_exp_f32 v32, v32
  v_exp_f32 v33, v33
  v_exp_f32 v34, v34
  v_exp_f32 v35, v35
  v_pk_mul_f32 v[160:161], v[160:161], v[136:137]
  v_pk_mul_f32 v[162:163], v[162:163], v[138:139]
  v_pk_mul_f32 v[164:165], v[164:165], v[140:141]
  v_pk_mul_f32 v[166:167], v[166:167], v[142:143]
  v_pk_add_f32 v[28:29], v[28:29], 1.0 op_sel_hi:[1,0]
  v_pk_add_f32 v[30:31], v[30:31], 1.0 op_sel_hi:[1,0]
  v_pk_add_f32 v[32:33], v[32:33], 1.0 op_sel_hi:[1,0]
  v_pk_add_f32 v[34:35], v[34:35], 1.0 op_sel_hi:[1,0]
  v_rcp_f32 v28, v28
  v_rcp_f32 v29, v29
  v_rcp_f32 v30, v30
  v_rcp_f32 v31, v31
  v_rcp_f32 v32, v32
  v_rcp_f32 v33, v33
  v_rcp_f32 v34, v34
  v_rcp_f32 v35, v35
  v_pk_mul_f32 v[28:29], v[28:29], v[160:161]
  v_pk_mul_f32 v[30:31], v[30:31], v[162:163]
  v_pk_mul_f32 v[32:33], v[32:33], v[164:165]
  v_pk_mul_f32 v[34:35], v[34:35], v[166:167]
  s_nop 0
  v_permlane16_swap_b32 v28, v32
  v_permlane16_swap_b32 v29, v33
  v_permlane16_swap_b32 v30, v34
  v_permlane16_swap_b32 v31, v35
  v_pk_add_f32 v[28:29], v[28:29], v[12:13]
  v_pk_add_f32 v[30:31], v[30:31], v[14:15]
  v_pk_add_f32 v[32:33], v[32:33], v[16:17]
  v_pk_add_f32 v[34:35], v[34:35], v[18:19]
  v_cvt_pk_bf16_f32 v48, v28, v29
  v_cvt_pk_bf16_f32 v49, v30, v31
  v_cvt_pk_bf16_f32 v50, v32, v33
  v_cvt_pk_bf16_f32 v51, v34, v35
  buffer_store_dwordx4 v[48:51], v1, s[8:11], 0 offen offset:128
  s_waitcnt vmcnt(4)
  v_accvgpr_read_b32 v60, a112
  v_accvgpr_read_b32 v61, a113
  v_accvgpr_read_b32 v62, a114
  v_accvgpr_read_b32 v63, a115
  s_waitcnt lgkmcnt(1)
  v_dot2_f32_bf16 v168, v60, s98, v168
  v_dot2_f32_bf16 v169, v60, s99, v169
  v_dot2_f32_bf16 v170, v61, s98, v170
  v_dot2_f32_bf16 v171, v61, s99, v171
  s_waitcnt lgkmcnt(0)
  v_dot2_f32_bf16 v172, v62, s98, v172
  v_dot2_f32_bf16 v173, v62, s99, v173
  v_dot2_f32_bf16 v174, v63, s98, v174
  v_dot2_f32_bf16 v175, v63, s99, v175
  s_waitcnt vmcnt(3)
  v_accvgpr_read_b32 v64, a116
  v_accvgpr_read_b32 v65, a117
  v_accvgpr_read_b32 v66, a118
  v_accvgpr_read_b32 v67, a119
  v_dot2_f32_bf16 v168, v64, s98, v168
  v_dot2_f32_bf16 v169, v64, s99, v169
  v_dot2_f32_bf16 v170, v65, s98, v170
  v_dot2_f32_bf16 v171, v65, s99, v171
  v_dot2_f32_bf16 v172, v66, s98, v172
  v_dot2_f32_bf16 v173, v66, s99, v173
  v_dot2_f32_bf16 v174, v67, s98, v174
  v_dot2_f32_bf16 v175, v67, s99, v175
  s_waitcnt vmcnt(2)
  v_accvgpr_read_b32 v68, a120
  v_accvgpr_read_b32 v69, a121
  v_accvgpr_read_b32 v70, a122
  v_accvgpr_read_b32 v71, a123
  v_dot2_f32_bf16 v168, v68, s98, v168
  v_dot2_f32_bf16 v169, v68, s99, v169
  v_dot2_f32_bf16 v170, v69, s98, v170
  v_dot2_f32_bf16 v171, v69, s99, v171
  v_dot2_f32_bf16 v172, v70, s98, v172
  v_dot2_f32_bf16 v173, v70, s99, v173
  v_dot2_f32_bf16 v174, v71, s98, v174
  v_dot2_f32_bf16 v175, v71, s99, v175
  v_pk_mul_f32 v[28:29], v[168:169], s[90:91]
  v_pk_mul_f32 v[30:31], v[170:171], s[90:91]
  v_pk_mul_f32 v[32:33], v[172:173], s[90:91]
  v_pk_mul_f32 v[34:35], v[174:175], s[90:91]
  v_exp_f32 v28, v28
  v_exp_f32 v29, v29
  v_exp_f32 v30, v30
  v_exp_f32 v31, v31
  v_exp_f32 v32, v32
  v_exp_f32 v33, v33
  v_exp_f32 v34, v34
  v_exp_f32 v35, v35
  v_pk_mul_f32 v[168:169], v[168:169], v[144:145]
  v_pk_mul_f32 v[170:171], v[170:171], v[146:147]
  v_pk_mul_f32 v[172:173], v[172:173], v[148:149]
  v_pk_mul_f32 v[174:175], v[174:175], v[150:151]
  v_pk_add_f32 v[28:29], v[28:29], 1.0 op_sel_hi:[1,0]
  v_pk_add_f32 v[30:31], v[30:31], 1.0 op_sel_hi:[1,0]
  v_pk_add_f32 v[32:33], v[32:33], 1.0 op_sel_hi:[1,0]
  v_pk_add_f32 v[34:35], v[34:35], 1.0 op_sel_hi:[1,0]
  v_rcp_f32 v28, v28
  v_rcp_f32 v29, v29
  v_rcp_f32 v30, v30
  v_rcp_f32 v31, v31
  v_rcp_f32 v32, v32
  v_rcp_f32 v33, v33
  v_rcp_f32 v34, v34
  v_rcp_f32 v35, v35
  v_pk_mul_f32 v[28:29], v[28:29], v[168:169]
  v_pk_mul_f32 v[30:31], v[30:31], v[170:171]
  v_pk_mul_f32 v[32:33], v[32:33], v[172:173]
  v_pk_mul_f32 v[34:35], v[34:35], v[174:175]
  s_nop 0
  v_permlane16_swap_b32 v28, v32
  v_permlane16_swap_b32 v29, v33
  v_permlane16_swap_b32 v30, v34
  v_permlane16_swap_b32 v31, v35
  v_pk_add_f32 v[28:29], v[28:29], v[20:21]
  v_pk_add_f32 v[30:31], v[30:31], v[22:23]
  v_pk_add_f32 v[32:33], v[32:33], v[24:25]
  v_pk_add_f32 v[34:35], v[34:35], v[26:27]
  v_cvt_pk_bf16_f32 v52, v28, v29
  v_cvt_pk_bf16_f32 v53, v30, v31
  v_cvt_pk_bf16_f32 v54, v32, v33
  v_cvt_pk_bf16_f32 v55, v34, v35
  buffer_store_dwordx4 v[52:55], v2, s[8:11], 0 offen offset:256
  s_branch recurrent_scan__linear_attn_block__glu_gated_bilinear__prompt_kernel_end
recurrent_scan__linear_attn_block__glu_gated_bilinear__prompt_kernel_nw:
  s_memrealtime s[92:93]
  s_waitcnt lgkmcnt(0)
  s_lshl_b32 s68, s93, 4
  s_xor_b32 s68, s68, 1540483472
  s_or_b32 s69, s92, 1
  v_mov_b32 v120, s69
  v_mov_b32 v121, s68
  v_mov_b32 v122, 0
  s_cmp_lg_u32 s56, 0
  s_cbranch_scc1 recurrent_scan__linear_attn_block__glu_gated_bilinear__prompt_kernel_nn
  global_store_dwordx2 v122, v[120:121], s[52:53] sc1
  s_branch recurrent_scan__linear_attn_block__glu_gated_bilinear__prompt_kernel_nn
recurrent_scan__linear_attn_block__glu_gated_bilinear__prompt_kernel_f_nw:
  s_mov_b32 s89, 20000
recurrent_scan__linear_attn_block__glu_gated_bilinear__prompt_kernel_f_nw2:
  global_load_dwordx2 v[58:59], v74, s[52:53] sc1
  s_waitcnt vmcnt(0)
  v_readfirstlane_b32 s48, v58
  v_readfirstlane_b32 s49, v59
  s_sub_u32 s89, s89, 1
  s_cmp_lg_u32 s48, 0
  s_cbranch_scc1 recurrent_scan__linear_attn_block__glu_gated_bilinear__prompt_kernel_f_nd
  s_cmp_lg_u32 s89, 0
  s_cbranch_scc1 recurrent_scan__linear_attn_block__glu_gated_bilinear__prompt_kernel_f_nw2
  s_branch recurrent_scan__linear_attn_block__glu_gated_bilinear__prompt_kernel_f_nd
recurrent_scan__linear_attn_block__glu_gated_bilinear__prompt_kernel_qq_nw:
  s_mov_b32 s89, 20000
recurrent_scan__linear_attn_block__glu_gated_bilinear__prompt_kernel_qq_nw2:
  global_load_dwordx2 v[58:59], v74, s[52:53] sc1
  s_waitcnt vmcnt(0)
  v_readfirstlane_b32 s48, v58
  v_readfirstlane_b32 s49, v59
  s_sub_u32 s89, s89, 1
  s_cmp_lg_u32 s48, 0
  s_cbranch_scc1 recurrent_scan__linear_attn_block__glu_gated_bilinear__prompt_kernel_qq_nd
  s_cmp_lg_u32 s89, 0
  s_cbranch_scc1 recurrent_scan__linear_attn_block__glu_gated_bilinear__prompt_kernel_qq_nw2
  s_branch recurrent_scan__linear_attn_block__glu_gated_bilinear__prompt_kernel_qq_nd
recurrent_scan__linear_attn_block__glu_gated_bilinear__prompt_kernel_kk_nw:
  s_mov_b32 s89, 20000
recurrent_scan__linear_attn_block__glu_gated_bilinear__prompt_kernel_kk_nw2:
  global_load_dwordx2 v[58:59], v74, s[52:53] sc1
  s_waitcnt vmcnt(0)
  v_readfirstlane_b32 s48, v58
  v_readfirstlane_b32 s49, v59
  s_sub_u32 s89, s89, 1
  s_cmp_lg_u32 s48, 0
  s_cbranch_scc1 recurrent_scan__linear_attn_block__glu_gated_bilinear__prompt_kernel_kk_nd
  s_cmp_lg_u32 s89, 0
  s_cbranch_scc1 recurrent_scan__linear_attn_block__glu_gated_bilinear__prompt_kernel_kk_nw2
  s_branch recurrent_scan__linear_attn_block__glu_gated_bilinear__prompt_kernel_kk_nd
recurrent_scan__linear_attn_block__glu_gated_bilinear__prompt_kernel_ca_w:
  s_mov_b32 s89, 20000
recurrent_scan__linear_attn_block__glu_gated_bilinear__prompt_kernel_ca_w2:
  s_sleep 4
  buffer_load_dwordx2 v[112:113], v111, s[20:23], 0 offen sc1
  s_waitcnt vmcnt(0)
  v_xor_b32 v112, s48, v112
  v_sub_u32 v113, v113, v120
  v_lshrrev_b32 v113, 4, v113
  v_or_b32 v112, v112, v113
  v_cmp_ne_u32 vcc, 0, v112
  s_sub_u32 s89, s89, 1
  s_cmp_eq_u64 vcc, 0
  s_cbranch_scc1 recurrent_scan__linear_attn_block__glu_gated_bilinear__prompt_kernel_ca_d
  s_cmp_lg_u32 s89, 0
  s_cbranch_scc1 recurrent_scan__linear_attn_block__glu_gated_bilinear__prompt_kernel_ca_w2
  s_branch recurrent_scan__linear_attn_block__glu_gated_bilinear__prompt_kernel_ca_d
recurrent_scan__linear_attn_block__glu_gated_bilinear__prompt_kernel_cb_w:
  s_mov_b32 s89, 20000
recurrent_scan__linear_attn_block__glu_gated_bilinear__prompt_kernel_cb_w2:
  s_sleep 4
  buffer_load_dwordx2 v[252:253], v254, s[20:23], s87 offen sc1
  s_waitcnt vmcnt(0)
  v_xor_b32 v252, s48, v252
  v_sub_u32 v253, v253, s67
  v_lshrrev_b32 v253, 4, v253
  v_or_b32 v252, v252, v253
  v_cmp_ne_u32 vcc, 0, v252
  s_sub_u32 s89, s89, 1
  s_cmp_eq_u64 vcc, 0
  s_cbranch_scc1 recurrent_scan__linear_attn_block__glu_gated_bilinear__prompt_kernel_cb_d
  s_cmp_lg_u32 s89, 0
  s_cbranch_scc1 recurrent_scan__linear_attn_block__glu_gated_bilinear__prompt_kernel_cb_w2
  s_branch recurrent_scan__linear_attn_block__glu_gated_bilinear__prompt_kernel_cb_d
recurrent_scan__linear_attn_block__glu_gated_bilinear__prompt_kernel_cc_w:
  s_mov_b32 s89, 20000
recurrent_scan__linear_attn_block__glu_gated_bilinear__prompt_kernel_cc_w2:
  s_sleep 4
  buffer_load_dwordx2 v[252:253], v254, s[20:23], s87 offen sc1
  s_waitcnt vmcnt(0)
  v_xor_b32 v252, s48, v252
  v_sub_u32 v253, v253, v255
  v_lshrrev_b32 v253, 4, v253
  v_or_b32 v252, v252, v253
  v_cmp_ne_u32 vcc, 0, v252
  s_sub_u32 s89, s89, 1
  s_cmp_eq_u64 vcc, 0
  s_cbranch_scc1 recurrent_scan__linear_attn_block__glu_gated_bilinear__prompt_kernel_cc_d
  s_cmp_lg_u32 s89, 0
  s_cbranch_scc1 recurrent_scan__linear_attn_block__glu_gated_bilinear__prompt_kernel_cc_w2
  s_branch recurrent_scan__linear_attn_block__glu_gated_bilinear__prompt_kernel_cc_d
recurrent_scan__linear_attn_block__glu_gated_bilinear__prompt_kernel_cr_w:
  s_mov_b32 s89, 20000
recurrent_scan__linear_attn_block__glu_gated_bilinear__prompt_kernel_cr_w2:
  s_sleep 4
  buffer_load_dwordx2 v[252:253], v254, s[20:23], s79 offen sc1
  s_waitcnt vmcnt(0)
  v_xor_b32 v252, s48, v252
  v_sub_u32 v253, v253, s49
  v_lshrrev_b32 v253, 4, v253
  v_or_b32 v252, v252, v253
  v_cmp_ne_u32 vcc, 0, v252
  s_sub_u32 s89, s89, 1
  s_cmp_eq_u64 vcc, 0
  s_cbranch_scc1 recurrent_scan__linear_attn_block__glu_gated_bilinear__prompt_kernel_cr_d
  s_cmp_lg_u32 s89, 0
  s_cbranch_scc1 recurrent_scan__linear_attn_block__glu_gated_bilinear__prompt_kernel_cr_w2
  s_branch recurrent_scan__linear_attn_block__glu_gated_bilinear__prompt_kernel_cr_d
recurrent_scan__linear_attn_block__glu_gated_bilinear__prompt_kernel_cf_w:
  s_mov_b32 s89, 20000
recurrent_scan__linear_attn_block__glu_gated_bilinear__prompt_kernel_cf_w2:
  buffer_load_dwordx2 v[252:253], v254, s[20:23], s42 offen sc1
  s_waitcnt vmcnt(0)
  v_xor_b32 v252, s48, v252
  v_sub_u32 v253, v253, s49
  v_lshrrev_b32 v253, 4, v253
  v_or_b32 v252, v252, v253
  v_cmp_ne_u32 vcc, 0, v252
  s_sub_u32 s89, s89, 1
  s_cmp_eq_u64 vcc, 0
  s_cbranch_scc1 recurrent_scan__linear_attn_block__glu_gated_bilinear__prompt_kernel_cf_d
  s_cmp_lg_u32 s89, 0
  s_cbranch_scc1 recurrent_scan__linear_attn_block__glu_gated_bilinear__prompt_kernel_cf_w2
  s_branch recurrent_scan__linear_attn_block__glu_gated_bilinear__prompt_kernel_cf_d
recurrent_scan__linear_attn_block__glu_gated_bilinear__prompt_kernel_end:
  s_endpgm
.section .rodata,"a"
.p2align 6
.amdhsa_kernel recurrent_scan__linear_attn_block__glu_gated_bilinear__prompt_kernel
  .amdhsa_next_free_vgpr 512
  .amdhsa_next_free_sgpr 102
  .amdhsa_accum_offset 256
  .amdhsa_group_segment_fixed_size 0
  .amdhsa_kernarg_size 80
  .amdhsa_user_sgpr_count 2
  .amdhsa_user_sgpr_kernarg_segment_ptr 1
  .amdhsa_system_sgpr_workgroup_id_x 1
.end_amdhsa_kernel
.text
code_end:
```
